```python
import torch

def _softmax(x, axis=-1):
    return torch.softmax(x, dim=axis)
def _gelu(x):
    return torch.nn.functional.gelu(x, approximate="tanh")
def _silu(x):
    return torch.nn.functional.silu(x)
def _sigmoid(x):
    return torch.sigmoid(x)
def _layernorm(x, axis=-1, eps=1e-5):
    m = x.mean(dim=axis, keepdim=True)
    v = x.var(dim=axis, keepdim=True, unbiased=False)
    return (x - m) / torch.sqrt(v + eps)
def _scatter_add(tgt, idx, src, axis=0):
    return tgt.clone().index_add_(axis, idx, src)
def _segment_sum(src, seg, n):
    out = torch.zeros((n,) + src.shape[1:], dtype=src.dtype)
    return out.index_add_(0, seg, src)
def _pad(x, pw):
    flat = tuple(v for pair in reversed(pw) for v in pair)
    return torch.nn.functional.pad(x, flat)

kernel_name = 'standalone__mha_block_cached__near_ridge'

def setup_inputs():

    _w = (lambda a: (lambda t: t.to(torch.bfloat16) if t.is_floating_point() else t)(torch.as_tensor(a)))
    B, Sq, D = 16, 192, 448
    H, Sk, Dh = 16, 512, 256
    return {
        "x": _w((lambda *s: torch.randn(*s, dtype=torch.bfloat16) * 0.8)(B, Sq, D)),
        "k_cache": _w((lambda *s: torch.randn(*s, dtype=torch.bfloat16) * 0.8)(B, H, Sk, Dh)),
        "v_cache": _w((lambda *s: torch.randn(*s, dtype=torch.bfloat16) * 0.05)(B, H, Sk, Dh)),
        "wq": _w((lambda *s: torch.randn(*s, dtype=torch.bfloat16) * 0.8)(D, H * Dh) * (D ** -0.5)),
        "wo": _w((lambda *s: torch.randn(*s, dtype=torch.bfloat16) * 0.05)(H * Dh, D) * ((H * Dh) ** -0.5)),
    }

def reference(x, k_cache, v_cache, wq, wo):
    B, Sq, D = x.shape
    H, Dh = 16, 256
    q = (lambda x, *d: x.permute(*d))((x @ wq).reshape(B, Sq, H, Dh), 0, 2, 1, 3)
    scores = torch.einsum("bhqd,bhkd->bhqk", q, k_cache) * (Dh ** -0.5)
    p = _softmax(scores, axis=-1)
    o = torch.einsum("bhqk,bhkd->bhqd", p, v_cache)
    return (lambda x, *d: x.permute(*d))(o, 0, 2, 1, 3).reshape(B, Sq, H * Dh) @ wo
```

```asm
; @launch grid=(256,1,1) block=(256,1,1) lds=163840
.amdgcn_target "amdgcn-amd-amdhsa--gfx950"
.text
.globl standalone__mha_block_cached__near_ridge_kernel
.p2align 8
.type standalone__mha_block_cached__near_ridge_kernel,@function
standalone__mha_block_cached__near_ridge_kernel:
s_load_dwordx16 s[4:19], s[0:1], 0
s_cmp_ge_u32 s2, 256
s_cbranch_scc1 L_end
s_getpc_b64 s[62:63]
L_pc:
v_lshrrev_b32 v1, 6, v0
v_and_b32 v40, 63, v0
v_readfirstlane_b32 s55, v1
v_and_b32 v41, 15, v40
v_lshrrev_b32 v42, 4, v40
v_lshrrev_b32 v46, 5, v40
v_and_b32 v47, 31, v40
s_and_b32 s60, s2, 1
s_lshl_b32 s60, s60, 3
s_lshr_b32 s57, s2, 3
s_and_b32 s57, s57, 7
s_add_u32 s53, s60, s57
s_and_b32 s60, s2, 6
s_lshl_b32 s60, s60, 1
s_lshr_b32 s61, s2, 6
s_add_u32 s54, s60, s61
s_add_u32 s60, s61, s57
s_and_b32 s60, s60, 1
s_mul_i32 s56, s60, 3
s_mov_b32 s57, s57
s_cmp_ge_u32 s57, 7
s_cselect_b32 s61, 7, 0
s_sub_u32 s57, s57, s61
s_lshl_b32 s48, s55, 12
s_lshl_b32 s64, s56, 7
s_add_u32 s65, s64, 128
s_cmp_ge_u32 s65, 896
s_cselect_b32 s65, 0, s65
s_add_u32 s66, s65, 128
s_cmp_ge_u32 s66, 896
s_cselect_b32 s66, 0, s66
s_add_u32 s67, s66, 128
s_cmp_ge_u32 s67, 896
s_cselect_b32 s67, 0, s67
s_add_u32 s68, s67, 128
s_cmp_ge_u32 s68, 896
s_cselect_b32 s68, 0, s68
s_add_u32 s69, s68, 128
s_cmp_ge_u32 s69, 896
s_cselect_b32 s69, 0, s69
s_add_u32 s70, s69, 128
s_cmp_ge_u32 s70, 896
s_cselect_b32 s70, 0, s70
s_and_b32 s60, s55, 1
s_lshl_b32 s60, s60, 3
s_lshl_b32 s61, s55, 16
v_lshlrev_b32 v3, 1, v46
v_xor_b32 v3, v3, v47
v_xor_b32 v1, s60, v3
v_lshlrev_b32 v1, 4, v1
v_lshlrev_b32 v2, 13, v46
v_add3_u32 v20, v1, v2, s61
v_xor_b32 v1, 64, v20
v_add_u32 v21, 15360, v1
v_add_u32 v22, 30720, v20
v_add_u32 v23, 46080, v1
s_mul_i32 s60, s55, 43008
s_mul_i32 s3, s55, 6144
v_lshrrev_b32 v48, 3, v40
v_mul_u32_u24 v48, 896, v48
v_add_u32 v1, s60, v48
v_and_b32 v49, 7, v40
v_xor_b32 v2, v49, v42
v_lshlrev_b32 v2, 4, v2
v_add_u32 v234, v1, v2
v_xor_b32 v2, 64, v2
v_add_u32 v235, v1, v2
v_add_u32 v239, 34816, v235
v_add_u32 v238, 28672, v234
v_add_u32 v237, 18432, v235
v_add_u32 v236, 12288, v234
v_add_u32 v235, 6144, v235
s_waitcnt lgkmcnt(0)
s_lshl_b32 s60, s54, 9
s_add_u32 s32, s10, s60
s_addc_u32 s33, s11, 0
s_and_b32 s33, s33, 0xffff
s_mov_b32 s34, 3670016
s_mov_b32 s35, 0x20000
s_sub_u32 s34, s34, s60
s_mul_i32 s60, s53, 172032
s_add_u32 s20, s4, s60
s_addc_u32 s21, s5, 0
s_and_b32 s21, s21, 0xffff
s_mov_b32 s22, 172032
s_mov_b32 s23, 0x20000
s_add_u32 m0, s48, 0
s_lshl_b32 s49, s64, 12
buffer_load_dwordx4 v20, s[32:35], s49 offen lds
buffer_load_dwordx4 v21, s[32:35], s49 offen offset:1024 lds
buffer_load_dwordx4 v22, s[32:35], s49 offen offset:2048 lds
buffer_load_dwordx4 v23, s[32:35], s49 offen offset:3072 lds
s_add_u32 m0, s3, 65536
s_nop 0
buffer_load_dwordx4 v234, s[20:23], s64 offen lds
buffer_load_dwordx4 v235, s[20:23], s64 offen offset:1024 lds
buffer_load_dwordx4 v236, s[20:23], s64 offen offset:2048 lds
buffer_load_dwordx4 v237, s[20:23], s64 offen offset:3072 lds
s_add_u32 m0, s3, 69632
s_nop 0
buffer_load_dwordx4 v238, s[20:23], s64 offen lds
buffer_load_dwordx4 v239, s[20:23], s64 offen offset:1024 lds
s_add_u32 m0, s48, 16384
s_lshl_b32 s49, s64, 12
s_add_u32 s49, s49, 262144
buffer_load_dwordx4 v20, s[32:35], s49 offen lds
buffer_load_dwordx4 v21, s[32:35], s49 offen offset:1024 lds
buffer_load_dwordx4 v22, s[32:35], s49 offen offset:2048 lds
buffer_load_dwordx4 v23, s[32:35], s49 offen offset:3072 lds
s_lshl_b32 s60, s53, 14
s_add_u32 s60, s60, 50331648
s_add_u32 s44, s18, s60
s_addc_u32 s45, s19, 0
s_and_b32 s45, s45, 0xffff
s_mov_b32 s46, 16384
s_mov_b32 s47, 0x20000
v_lshrrev_b32 v1, 3, v40
v_lshlrev_b32 v1, 9, v1
v_lshl_add_u32 v1, v49, 2, v1
v_lshlrev_b32 v2, 6, v40
v_add_u32 v2, 8192, v2
v_mov_b32 v252, 0
s_or_b32 s71, s54, s55
s_cmp_lg_u32 s71, 0
s_cbranch_scc1 L_nl0
buffer_store_dword v252, v1, s[44:47], 0 offen sc1
buffer_store_dword v252, v2, s[44:47], 0 offen sc1
L_nl0:
s_lshr_b32 s60, s2, 3
s_and_b32 s60, s60, 3
s_lshl_b32 s60, s60, 2
s_add_u32 s60, s60, s55
s_lshl_b32 s60, s60, 13
v_lshlrev_b32 v1, 7, v40
v_add_u32 v1, s60, v1
v_min_u32 v255, L_textend-L_pc-4, v1
global_load_dword v254, v255, s[62:63]
s_lshl_b32 s60, s53, 4
s_add_u32 s60, s60, s54
s_lshl_b32 s60, s60, 18
s_add_u32 s24, s6, s60
s_addc_u32 s25, s7, 0
s_and_b32 s25, s25, 0xffff
s_mov_b32 s26, 262144
s_mov_b32 s27, 0x20000
s_add_u32 s28, s8, s60
s_addc_u32 s29, s9, 0
s_and_b32 s29, s29, 0xffff
s_mov_b32 s30, 262144
s_mov_b32 s31, 0x20000
v_lshlrev_b32 v1, 4, v3
v_lshlrev_b32 v2, 9, v46
v_add3_u32 v16, v1, v2, s48
v_xor_b32 v17, 64, v16
v_xor_b32 v18, 128, v16
v_xor_b32 v19, 192, v16
v_bfe_u32 v43, v40, 2, 2
v_and_b32 v44, 3, v40
v_bfe_u32 v45, v40, 2, 3
s_mov_b32 s50, 0x3db8aa3b
s_mov_b32 s51, 0x41000000
v_lshlrev_b32 v1, 5, v45
v_lshl_add_u32 v1, v44, 3, v1
v_lshl_add_u32 v1, v43, 9, v1
v_lshl_add_u32 v224, v42, 12, v1
v_lshl_add_u32 v8, v42, 11, v1
v_xor_b32 v225, 32, v224
v_xor_b32 v9, 32, v8
v_xor_b32 v226, 64, v224
v_xor_b32 v10, 64, v8
v_xor_b32 v227, 96, v224
v_xor_b32 v11, 96, v8
v_xor_b32 v228, 128, v224
v_xor_b32 v12, 128, v8
v_xor_b32 v229, 160, v224
v_xor_b32 v13, 160, v8
v_xor_b32 v230, 192, v224
v_xor_b32 v14, 192, v8
v_xor_b32 v231, 224, v224
v_xor_b32 v15, 224, v8
v_lshrrev_b32 v1, 1, v41
v_xor_b32 v1, v1, v42
v_lshlrev_b32 v1, 4, v1
v_lshl_add_u32 v1, v41, 7, v1
v_add_u32 v1, s3, v1
v_add_u32 v24, 65536, v1
v_xor_b32 v25, 64, v24
v_add_u32 v26, 49152, v24
v_add_u32 v27, 49152, v25
v_and_b32 v1, 7, v41
v_lshlrev_b32 v1, 1, v1
v_xor_b32 v1, v1, v42
v_lshlrev_b32 v1, 4, v1
v_lshl_add_u32 v4, v41, 9, v1
v_xor_b32 v5, 64, v4
v_xor_b32 v6, 128, v4
v_xor_b32 v7, 192, v4
v_mov_b32 v1, 0x3f803f80
v_accvgpr_write_b32 a204, v1
v_accvgpr_write_b32 a205, v1
v_accvgpr_write_b32 a206, v1
v_accvgpr_write_b32 a207, v1
s_add_u32 m0, s3, 90112
s_nop 0
buffer_load_dwordx4 v234, s[20:23], s65 offen lds
buffer_load_dwordx4 v235, s[20:23], s65 offen offset:1024 lds
buffer_load_dwordx4 v236, s[20:23], s65 offen offset:2048 lds
buffer_load_dwordx4 v237, s[20:23], s65 offen offset:3072 lds
s_add_u32 m0, s3, 94208
s_nop 0
buffer_load_dwordx4 v238, s[20:23], s65 offen lds
buffer_load_dwordx4 v239, s[20:23], s65 offen offset:1024 lds
s_add_u32 m0, s48, 32768
s_lshl_b32 s49, s65, 12
buffer_load_dwordx4 v20, s[32:35], s49 offen lds
buffer_load_dwordx4 v21, s[32:35], s49 offen offset:1024 lds
buffer_load_dwordx4 v22, s[32:35], s49 offen offset:2048 lds
buffer_load_dwordx4 v23, s[32:35], s49 offen offset:3072 lds
s_and_b32 s72, s54, 1
s_and_b32 s73, s55, 1
s_lshr_b32 s52, s55, 1
s_lshr_b32 s75, s54, 1
v_bfe_u32 v1, v40, 3, 2
v_lshlrev_b32 v1, 5, v1
v_lshl_add_u32 v1, v44, 3, v1
v_lshrrev_b32 v2, 2, v40
v_lshl_add_u32 v1, v2, 7, v1
s_lshl_b32 s60, s52, 6
v_xor_b32 v232, s60, v1
v_xor_b32 v233, 32, v232
v_lshlrev_b32 v1, 1, v42
v_xor_b32 v1, v1, v49
v_lshlrev_b32 v1, 4, v1
s_mul_i32 s60, s55, 28672
v_add3_u32 v248, v48, v1, s60
v_add_u32 v249, 6144, v248
v_add_u32 v250, 12288, v248
v_add_u32 v251, 18432, v248
s_mul_i32 s60, s75, 458752
s_add_u32 s36, s12, s60
s_addc_u32 s37, s13, 0
s_and_b32 s37, s37, 0xffff
s_mov_b32 s38, 458752
s_mov_b32 s39, 0x20000
s_mul_i32 s60, s53, 1376256
s_lshl_b32 s61, s75, 10
s_add_u32 s60, s60, s61
s_add_u32 s40, s18, s60
s_addc_u32 s41, s19, 0
s_and_b32 s41, s41, 0xffff
s_mov_b32 s42, 1376256
s_mov_b32 s43, 0x20000
s_sub_u32 s42, s42, s61
v_lshlrev_b32 v240, 4, v40
s_lshl_b32 s60, s72, 1
s_add_u32 s60, s60, s73
s_lshl_b32 s61, s52, 2
s_add_u32 s61, s61, s60
s_mul_i32 s61, s61, 24576
v_add_u32 v28, s61, v240
s_mul_i32 s61, s60, 24576
v_add_u32 v29, s61, v240
s_mul_i32 s56, s73, 24576
s_add_u32 s56, s56, 114688
v_add_u32 v31, s56, v240
s_mul_i32 s61, s52, 12288
s_add_u32 s56, s56, s61
s_xor_b32 s74, s60, 2
s_mul_i32 s74, s74, 24576
s_add_u32 s74, s74, s61
s_lshl_b32 s61, s53, 3
s_add_u32 s61, s61, s75
s_mul_i32 s61, s61, 98304
s_add_u32 s61, s61, 33554432
s_add_u32 s76, s18, s61
s_addc_u32 s77, s19, 0
s_and_b32 s77, s77, 0xffff
s_mov_b32 s78, 98304
s_mov_b32 s79, 0x20000
v_lshlrev_b32 v1, 24, v40
s_lshl_b32 s61, s72, 2
s_add_u32 s61, s61, s55
s_lshl_b32 s61, s61, 9
s_lshl_b32 s75, s75, 2
s_add_u32 s61, s61, s75
v_add_u32 v241, s61, v1
s_lshl_b32 s61, s54, 2
s_add_u32 s61, s61, s55
s_lshl_b32 s61, s61, 6
s_add_u32 s61, s61, 8192
v_add_u32 v242, s61, v1
s_xor_b32 s75, s54, 1
s_lshl_b32 s75, s75, 2
s_add_u32 s75, s75, s60
s_lshl_b32 s75, s75, 6
s_add_u32 s75, s75, 8192
v_lshlrev_b32 v243, 2, v49
v_mul_u32_u24 v245, 896, v41
v_lshl_add_u32 v245, v42, 4, v245
s_mul_i32 s60, s72, 229376
v_and_b32 v1, 1, v41
v_lshlrev_b32 v1, 4, v1
v_mov_b32 v2, 0x3f80
v_lshlrev_b32 v1, v1, v2
v_bfe_u32 v2, v41, 2, 1
v_lshlrev_b32 v2, 1, v2
v_sub_u32 v2, v42, v2
v_lshrrev_b32 v3, 3, v41
v_lshlrev_b32 v3, 1, v3
v_bfe_u32 v48, v41, 1, 1
v_add_u32 v3, v3, v48
v_lshl_add_u32 v2, v2, 2, v3
v_cmp_eq_u32 vcc, 0, v2
s_nop 1
v_cndmask_b32 v3, v252, v1, vcc
v_accvgpr_write_b32 a240, v3
v_cmp_eq_u32 vcc, 1, v2
s_nop 1
v_cndmask_b32 v3, v252, v1, vcc
v_accvgpr_write_b32 a241, v3
v_cmp_eq_u32 vcc, 2, v2
s_nop 1
v_cndmask_b32 v3, v252, v1, vcc
v_accvgpr_write_b32 a242, v3
v_cmp_eq_u32 vcc, 3, v2
s_nop 1
v_cndmask_b32 v3, v252, v1, vcc
v_accvgpr_write_b32 a243, v3
v_cmp_eq_u32 vcc, 4, v2
s_nop 1
v_cndmask_b32 v3, v252, v1, vcc
v_accvgpr_write_b32 a244, v3
v_cmp_eq_u32 vcc, 5, v2
s_nop 1
v_cndmask_b32 v3, v252, v1, vcc
v_accvgpr_write_b32 a245, v3
v_cmp_eq_u32 vcc, 6, v2
s_nop 1
v_cndmask_b32 v3, v252, v1, vcc
v_accvgpr_write_b32 a246, v3
v_cmp_eq_u32 vcc, 7, v2
s_nop 1
v_cndmask_b32 v3, v252, v1, vcc
v_accvgpr_write_b32 a247, v3
s_waitcnt vmcnt(15)
s_barrier
ds_read_b128 a[0:3], v24 offset:0
ds_read_b128 a[4:7], v24 offset:2048
ds_read_b128 a[8:11], v24 offset:4096
ds_read_b128 a[12:15], v25 offset:0
ds_read_b128 a[16:19], v25 offset:2048
ds_read_b128 a[20:23], v25 offset:4096
s_cmp_lg_u32 s71, 0
s_cbranch_scc1 L_nl1
s_lshl_b32 s73, s53, 2
v_mov_b32 v1, s73
v_mov_b32 v2, 1
s_waitcnt vmcnt(0)
global_store_dword v1, v2, s[16:17] offset:64 sc1
L_nl1:
ds_read_b64_tr_b16 a[208:209], v224 offset:0
ds_read_b64_tr_b16 a[210:211], v224 offset:2048
ds_read_b64_tr_b16 a[212:213], v225 offset:0
ds_read_b64_tr_b16 a[214:215], v225 offset:2048
ds_read_b64_tr_b16 a[216:217], v226 offset:0
ds_read_b64_tr_b16 a[218:219], v226 offset:2048
ds_read_b64_tr_b16 a[220:221], v227 offset:0
ds_read_b64_tr_b16 a[222:223], v227 offset:2048
ds_read_b64_tr_b16 a[224:225], v228 offset:0
s_waitcnt lgkmcnt(14)
ds_read_b64_tr_b16 a[226:227], v228 offset:2048
s_waitcnt lgkmcnt(8)
v_mfma_f32_16x16x32_bf16 v[32:35], a[208:211], a[0:3], 0
s_add_u32 m0, s3, 114688
ds_read_b64_tr_b16 a[228:229], v229 offset:0
v_mfma_f32_16x16x32_bf16 v[40:43], a[208:211], a[4:7], 0
ds_read_b64_tr_b16 a[230:231], v229 offset:2048
v_mfma_f32_16x16x32_bf16 v[48:51], a[208:211], a[8:11], 0
s_waitcnt lgkmcnt(8)
buffer_load_dwordx4 v234, s[20:23], s66 offen lds
v_mfma_f32_16x16x32_bf16 v[52:55], a[212:215], a[8:11], 0
ds_read_b64_tr_b16 a[208:209], v230 offset:0
v_mfma_f32_16x16x32_bf16 v[44:47], a[212:215], a[4:7], 0
ds_read_b64_tr_b16 a[210:211], v230 offset:2048
v_mfma_f32_16x16x32_bf16 v[36:39], a[212:215], a[0:3], 0
s_waitcnt lgkmcnt(8)
buffer_load_dwordx4 v235, s[20:23], s66 offen offset:1024 lds
v_mfma_f32_16x16x32_bf16 v[56:59], a[216:219], a[0:3], 0
ds_read_b64_tr_b16 a[212:213], v231 offset:0
v_mfma_f32_16x16x32_bf16 v[64:67], a[216:219], a[4:7], 0
ds_read_b64_tr_b16 a[214:215], v231 offset:2048
v_mfma_f32_16x16x32_bf16 v[72:75], a[216:219], a[8:11], 0
s_waitcnt lgkmcnt(8)
v_mfma_f32_16x16x32_bf16 v[76:79], a[220:223], a[8:11], 0
ds_read_b64_tr_b16 a[216:217], v224 offset:256
v_mfma_f32_16x16x32_bf16 v[68:71], a[220:223], a[4:7], 0
ds_read_b64_tr_b16 a[218:219], v224 offset:2304
v_mfma_f32_16x16x32_bf16 v[60:63], a[220:223], a[0:3], 0
s_waitcnt lgkmcnt(8)
buffer_load_dwordx4 v236, s[20:23], s66 offen offset:2048 lds
v_mfma_f32_16x16x32_bf16 v[80:83], a[224:227], a[0:3], 0
ds_read_b64_tr_b16 a[220:221], v225 offset:256
v_mfma_f32_16x16x32_bf16 v[88:91], a[224:227], a[4:7], 0
ds_read_b64_tr_b16 a[222:223], v225 offset:2304
v_mfma_f32_16x16x32_bf16 v[96:99], a[224:227], a[8:11], 0
s_waitcnt lgkmcnt(8)
buffer_load_dwordx4 v237, s[20:23], s66 offen offset:3072 lds
v_mfma_f32_16x16x32_bf16 v[100:103], a[228:231], a[8:11], 0
s_add_u32 m0, s3, 118784
ds_read_b64_tr_b16 a[224:225], v226 offset:256
v_mfma_f32_16x16x32_bf16 v[92:95], a[228:231], a[4:7], 0
ds_read_b64_tr_b16 a[226:227], v226 offset:2304
v_mfma_f32_16x16x32_bf16 v[84:87], a[228:231], a[0:3], 0
s_waitcnt lgkmcnt(8)
v_mfma_f32_16x16x32_bf16 v[104:107], a[208:211], a[0:3], 0
ds_read_b64_tr_b16 a[228:229], v227 offset:256
v_mfma_f32_16x16x32_bf16 v[112:115], a[208:211], a[4:7], 0
ds_read_b64_tr_b16 a[230:231], v227 offset:2304
v_mfma_f32_16x16x32_bf16 v[120:123], a[208:211], a[8:11], 0
s_waitcnt lgkmcnt(8)
buffer_load_dwordx4 v238, s[20:23], s66 offen lds
v_mfma_f32_16x16x32_bf16 v[124:127], a[212:215], a[8:11], 0
ds_read_b64_tr_b16 a[208:209], v228 offset:256
v_mfma_f32_16x16x32_bf16 v[116:119], a[212:215], a[4:7], 0
ds_read_b64_tr_b16 a[210:211], v228 offset:2304
v_mfma_f32_16x16x32_bf16 v[108:111], a[212:215], a[0:3], 0
s_waitcnt lgkmcnt(8)
buffer_load_dwordx4 v239, s[20:23], s66 offen offset:1024 lds
v_mfma_f32_16x16x32_bf16 v[128:131], a[216:219], a[0:3], 0
ds_read_b64_tr_b16 a[212:213], v229 offset:256
v_mfma_f32_16x16x32_bf16 v[136:139], a[216:219], a[4:7], 0
ds_read_b64_tr_b16 a[214:215], v229 offset:2304
v_mfma_f32_16x16x32_bf16 v[144:147], a[216:219], a[8:11], 0
s_waitcnt lgkmcnt(8)
v_mfma_f32_16x16x32_bf16 v[148:151], a[220:223], a[8:11], 0
ds_read_b64_tr_b16 a[216:217], v230 offset:256
v_mfma_f32_16x16x32_bf16 v[140:143], a[220:223], a[4:7], 0
ds_read_b64_tr_b16 a[218:219], v230 offset:2304
v_mfma_f32_16x16x32_bf16 v[132:135], a[220:223], a[0:3], 0
s_waitcnt lgkmcnt(8)
v_mfma_f32_16x16x32_bf16 v[152:155], a[224:227], a[0:3], 0
ds_read_b64_tr_b16 a[220:221], v231 offset:256
v_mfma_f32_16x16x32_bf16 v[160:163], a[224:227], a[4:7], 0
ds_read_b64_tr_b16 a[222:223], v231 offset:2304
v_mfma_f32_16x16x32_bf16 v[168:171], a[224:227], a[8:11], 0
s_waitcnt lgkmcnt(8)
v_mfma_f32_16x16x32_bf16 v[172:175], a[228:231], a[8:11], 0
s_waitcnt vmcnt(17)
s_barrier
ds_read_b64_tr_b16 a[224:225], v224 offset:16384
v_mfma_f32_16x16x32_bf16 v[164:167], a[228:231], a[4:7], 0
s_add_u32 m0, s48, 49152
ds_read_b64_tr_b16 a[226:227], v224 offset:18432
s_lshl_b32 s49, s65, 12
v_mfma_f32_16x16x32_bf16 v[156:159], a[228:231], a[0:3], 0
s_waitcnt lgkmcnt(8)
s_add_u32 s49, s49, 262144
v_mfma_f32_16x16x32_bf16 v[176:179], a[208:211], a[0:3], 0
ds_read_b64_tr_b16 a[228:229], v225 offset:16384
v_mfma_f32_16x16x32_bf16 v[184:187], a[208:211], a[4:7], 0
ds_read_b64_tr_b16 a[230:231], v225 offset:18432
v_mfma_f32_16x16x32_bf16 v[192:195], a[208:211], a[8:11], 0
s_waitcnt lgkmcnt(8)
buffer_load_dwordx4 v20, s[32:35], s49 offen lds
v_mfma_f32_16x16x32_bf16 v[196:199], a[212:215], a[8:11], 0
ds_read_b64_tr_b16 a[208:209], v226 offset:16384
v_mfma_f32_16x16x32_bf16 v[188:191], a[212:215], a[4:7], 0
ds_read_b64_tr_b16 a[210:211], v226 offset:18432
v_mfma_f32_16x16x32_bf16 v[180:183], a[212:215], a[0:3], 0
s_waitcnt lgkmcnt(8)
buffer_load_dwordx4 v21, s[32:35], s49 offen offset:1024 lds
v_mfma_f32_16x16x32_bf16 v[200:203], a[216:219], a[0:3], 0
ds_read_b64_tr_b16 a[212:213], v227 offset:16384
v_mfma_f32_16x16x32_bf16 v[208:211], a[216:219], a[4:7], 0
ds_read_b64_tr_b16 a[214:215], v227 offset:18432
v_mfma_f32_16x16x32_bf16 v[216:219], a[216:219], a[8:11], 0
s_waitcnt lgkmcnt(8)
v_mfma_f32_16x16x32_bf16 v[220:223], a[220:223], a[8:11], 0
ds_read_b64_tr_b16 a[216:217], v228 offset:16384
v_mfma_f32_16x16x32_bf16 v[212:215], a[220:223], a[4:7], 0
ds_read_b64_tr_b16 a[218:219], v228 offset:18432
v_mfma_f32_16x16x32_bf16 v[204:207], a[220:223], a[0:3], 0
s_waitcnt lgkmcnt(8)
buffer_load_dwordx4 v22, s[32:35], s49 offen offset:2048 lds
v_mfma_f32_16x16x32_bf16 v[32:35], a[224:227], a[12:15], v[32:35]
ds_read_b64_tr_b16 a[220:221], v229 offset:16384
v_mfma_f32_16x16x32_bf16 v[40:43], a[224:227], a[16:19], v[40:43]
ds_read_b64_tr_b16 a[222:223], v229 offset:18432
v_mfma_f32_16x16x32_bf16 v[48:51], a[224:227], a[20:23], v[48:51]
s_waitcnt lgkmcnt(8)
buffer_load_dwordx4 v23, s[32:35], s49 offen offset:3072 lds
v_mfma_f32_16x16x32_bf16 v[52:55], a[228:231], a[20:23], v[52:55]
s_add_u32 m0, s3, 139264
ds_read_b64_tr_b16 a[224:225], v230 offset:16384
v_mfma_f32_16x16x32_bf16 v[44:47], a[228:231], a[16:19], v[44:47]
ds_read_b64_tr_b16 a[226:227], v230 offset:18432
v_mfma_f32_16x16x32_bf16 v[36:39], a[228:231], a[12:15], v[36:39]
s_waitcnt lgkmcnt(8)
v_mfma_f32_16x16x32_bf16 v[56:59], a[208:211], a[12:15], v[56:59]
ds_read_b64_tr_b16 a[228:229], v231 offset:16384
v_mfma_f32_16x16x32_bf16 v[64:67], a[208:211], a[16:19], v[64:67]
ds_read_b64_tr_b16 a[230:231], v231 offset:18432
v_mfma_f32_16x16x32_bf16 v[72:75], a[208:211], a[20:23], v[72:75]
s_waitcnt lgkmcnt(8)
buffer_load_dwordx4 v234, s[20:23], s67 offen lds
v_mfma_f32_16x16x32_bf16 v[76:79], a[212:215], a[20:23], v[76:79]
ds_read_b64_tr_b16 a[208:209], v224 offset:16640
v_mfma_f32_16x16x32_bf16 v[68:71], a[212:215], a[16:19], v[68:71]
ds_read_b64_tr_b16 a[210:211], v224 offset:18688
v_mfma_f32_16x16x32_bf16 v[60:63], a[212:215], a[12:15], v[60:63]
s_waitcnt lgkmcnt(8)
buffer_load_dwordx4 v235, s[20:23], s67 offen offset:1024 lds
v_mfma_f32_16x16x32_bf16 v[80:83], a[216:219], a[12:15], v[80:83]
ds_read_b64_tr_b16 a[212:213], v225 offset:16640
v_mfma_f32_16x16x32_bf16 v[88:91], a[216:219], a[16:19], v[88:91]
ds_read_b64_tr_b16 a[214:215], v225 offset:18688
v_mfma_f32_16x16x32_bf16 v[96:99], a[216:219], a[20:23], v[96:99]
s_waitcnt lgkmcnt(8)
v_mfma_f32_16x16x32_bf16 v[100:103], a[220:223], a[20:23], v[100:103]
ds_read_b64_tr_b16 a[216:217], v226 offset:16640
v_mfma_f32_16x16x32_bf16 v[92:95], a[220:223], a[16:19], v[92:95]
ds_read_b64_tr_b16 a[218:219], v226 offset:18688
v_mfma_f32_16x16x32_bf16 v[84:87], a[220:223], a[12:15], v[84:87]
s_waitcnt lgkmcnt(8)
buffer_load_dwordx4 v236, s[20:23], s67 offen offset:2048 lds
v_mfma_f32_16x16x32_bf16 v[104:107], a[224:227], a[12:15], v[104:107]
ds_read_b64_tr_b16 a[220:221], v227 offset:16640
v_mfma_f32_16x16x32_bf16 v[112:115], a[224:227], a[16:19], v[112:115]
ds_read_b64_tr_b16 a[222:223], v227 offset:18688
v_mfma_f32_16x16x32_bf16 v[120:123], a[224:227], a[20:23], v[120:123]
s_waitcnt lgkmcnt(8)
buffer_load_dwordx4 v237, s[20:23], s67 offen offset:3072 lds
v_mfma_f32_16x16x32_bf16 v[124:127], a[228:231], a[20:23], v[124:127]
s_add_u32 m0, s3, 143360
ds_read_b64_tr_b16 a[224:225], v228 offset:16640
v_mfma_f32_16x16x32_bf16 v[116:119], a[228:231], a[16:19], v[116:119]
ds_read_b64_tr_b16 a[226:227], v228 offset:18688
v_mfma_f32_16x16x32_bf16 v[108:111], a[228:231], a[12:15], v[108:111]
s_waitcnt lgkmcnt(8)
v_mfma_f32_16x16x32_bf16 v[128:131], a[208:211], a[12:15], v[128:131]
ds_read_b64_tr_b16 a[228:229], v229 offset:16640
v_mfma_f32_16x16x32_bf16 v[136:139], a[208:211], a[16:19], v[136:139]
ds_read_b64_tr_b16 a[230:231], v229 offset:18688
v_mfma_f32_16x16x32_bf16 v[144:147], a[208:211], a[20:23], v[144:147]
s_waitcnt lgkmcnt(8)
buffer_load_dwordx4 v238, s[20:23], s67 offen lds
v_mfma_f32_16x16x32_bf16 v[148:151], a[212:215], a[20:23], v[148:151]
ds_read_b64_tr_b16 a[208:209], v230 offset:16640
v_mfma_f32_16x16x32_bf16 v[140:143], a[212:215], a[16:19], v[140:143]
ds_read_b64_tr_b16 a[210:211], v230 offset:18688
v_mfma_f32_16x16x32_bf16 v[132:135], a[212:215], a[12:15], v[132:135]
s_waitcnt lgkmcnt(8)
buffer_load_dwordx4 v239, s[20:23], s67 offen offset:1024 lds
v_mfma_f32_16x16x32_bf16 v[152:155], a[216:219], a[12:15], v[152:155]
ds_read_b64_tr_b16 a[212:213], v231 offset:16640
v_mfma_f32_16x16x32_bf16 v[160:163], a[216:219], a[16:19], v[160:163]
ds_read_b64_tr_b16 a[214:215], v231 offset:18688
v_mfma_f32_16x16x32_bf16 v[168:171], a[216:219], a[20:23], v[168:171]
s_waitcnt lgkmcnt(8)
v_mfma_f32_16x16x32_bf16 v[172:175], a[220:223], a[20:23], v[172:175]
s_waitcnt vmcnt(16)
s_barrier
ds_read_b64_tr_b16 a[216:217], v224 offset:32768
v_mfma_f32_16x16x32_bf16 v[164:167], a[220:223], a[16:19], v[164:167]
s_add_u32 m0, s48, 0
ds_read_b64_tr_b16 a[218:219], v224 offset:34816
s_lshl_b32 s49, s66, 12
v_mfma_f32_16x16x32_bf16 v[156:159], a[220:223], a[12:15], v[156:159]
s_waitcnt lgkmcnt(8)
buffer_load_dwordx4 v20, s[32:35], s49 offen lds
v_mfma_f32_16x16x32_bf16 v[176:179], a[224:227], a[12:15], v[176:179]
ds_read_b64_tr_b16 a[220:221], v225 offset:32768
v_mfma_f32_16x16x32_bf16 v[184:187], a[224:227], a[16:19], v[184:187]
ds_read_b64_tr_b16 a[222:223], v225 offset:34816
v_mfma_f32_16x16x32_bf16 v[192:195], a[224:227], a[20:23], v[192:195]
s_waitcnt lgkmcnt(8)
buffer_load_dwordx4 v21, s[32:35], s49 offen offset:1024 lds
v_mfma_f32_16x16x32_bf16 v[196:199], a[228:231], a[20:23], v[196:199]
ds_read_b64_tr_b16 a[224:225], v226 offset:32768
v_mfma_f32_16x16x32_bf16 v[188:191], a[228:231], a[16:19], v[188:191]
ds_read_b64_tr_b16 a[226:227], v226 offset:34816
v_mfma_f32_16x16x32_bf16 v[180:183], a[228:231], a[12:15], v[180:183]
s_waitcnt lgkmcnt(8)
ds_read_b128 a[24:27], v24 offset:24576
v_mfma_f32_16x16x32_bf16 v[200:203], a[208:211], a[12:15], v[200:203]
ds_read_b64_tr_b16 a[228:229], v227 offset:32768
v_mfma_f32_16x16x32_bf16 v[208:211], a[208:211], a[16:19], v[208:211]
ds_read_b64_tr_b16 a[230:231], v227 offset:34816
v_mfma_f32_16x16x32_bf16 v[216:219], a[208:211], a[20:23], v[216:219]
s_waitcnt lgkmcnt(9)
buffer_load_dwordx4 v22, s[32:35], s49 offen offset:2048 lds
v_mfma_f32_16x16x32_bf16 v[220:223], a[212:215], a[20:23], v[220:223]
ds_read_b64_tr_b16 a[208:209], v228 offset:32768
v_mfma_f32_16x16x32_bf16 v[212:215], a[212:215], a[16:19], v[212:215]
ds_read_b64_tr_b16 a[210:211], v228 offset:34816
v_mfma_f32_16x16x32_bf16 v[204:207], a[212:215], a[12:15], v[204:207]
s_waitcnt lgkmcnt(9)
buffer_load_dwordx4 v23, s[32:35], s49 offen offset:3072 lds
ds_read_b128 a[28:31], v24 offset:26624
ds_read_b128 a[32:35], v24 offset:28672
ds_read_b128 a[36:39], v25 offset:24576
ds_read_b128 a[40:43], v25 offset:26624
ds_read_b128 a[44:47], v25 offset:28672
s_waitcnt lgkmcnt(9)
v_mfma_f32_16x16x32_bf16 v[32:35], a[216:219], a[24:27], v[32:35]
s_add_u32 m0, s3, 65536
ds_read_b64_tr_b16 a[212:213], v229 offset:32768
s_waitcnt lgkmcnt(5)
v_mfma_f32_16x16x32_bf16 v[40:43], a[216:219], a[28:31], v[40:43]
ds_read_b64_tr_b16 a[214:215], v229 offset:34816
s_waitcnt lgkmcnt(5)
v_mfma_f32_16x16x32_bf16 v[48:51], a[216:219], a[32:35], v[48:51]
v_mfma_f32_16x16x32_bf16 v[52:55], a[220:223], a[32:35], v[52:55]
ds_read_b64_tr_b16 a[216:217], v230 offset:32768
v_mfma_f32_16x16x32_bf16 v[44:47], a[220:223], a[28:31], v[44:47]
ds_read_b64_tr_b16 a[218:219], v230 offset:34816
v_mfma_f32_16x16x32_bf16 v[36:39], a[220:223], a[24:27], v[36:39]
buffer_load_dwordx4 v234, s[20:23], s68 offen lds
v_mfma_f32_16x16x32_bf16 v[56:59], a[224:227], a[24:27], v[56:59]
ds_read_b64_tr_b16 a[220:221], v231 offset:32768
v_mfma_f32_16x16x32_bf16 v[64:67], a[224:227], a[28:31], v[64:67]
ds_read_b64_tr_b16 a[222:223], v231 offset:34816
v_mfma_f32_16x16x32_bf16 v[72:75], a[224:227], a[32:35], v[72:75]
buffer_load_dwordx4 v235, s[20:23], s68 offen offset:1024 lds
v_mfma_f32_16x16x32_bf16 v[76:79], a[228:231], a[32:35], v[76:79]
ds_read_b64_tr_b16 a[224:225], v224 offset:33024
v_mfma_f32_16x16x32_bf16 v[68:71], a[228:231], a[28:31], v[68:71]
ds_read_b64_tr_b16 a[226:227], v224 offset:35072
v_mfma_f32_16x16x32_bf16 v[60:63], a[228:231], a[24:27], v[60:63]
v_mfma_f32_16x16x32_bf16 v[80:83], a[208:211], a[24:27], v[80:83]
ds_read_b64_tr_b16 a[228:229], v225 offset:33024
v_mfma_f32_16x16x32_bf16 v[88:91], a[208:211], a[28:31], v[88:91]
ds_read_b64_tr_b16 a[230:231], v225 offset:35072
v_mfma_f32_16x16x32_bf16 v[96:99], a[208:211], a[32:35], v[96:99]
s_waitcnt lgkmcnt(8)
buffer_load_dwordx4 v236, s[20:23], s68 offen offset:2048 lds
v_mfma_f32_16x16x32_bf16 v[100:103], a[212:215], a[32:35], v[100:103]
ds_read_b64_tr_b16 a[208:209], v226 offset:33024
v_mfma_f32_16x16x32_bf16 v[92:95], a[212:215], a[28:31], v[92:95]
ds_read_b64_tr_b16 a[210:211], v226 offset:35072
v_mfma_f32_16x16x32_bf16 v[84:87], a[212:215], a[24:27], v[84:87]
s_waitcnt lgkmcnt(8)
buffer_load_dwordx4 v237, s[20:23], s68 offen offset:3072 lds
v_mfma_f32_16x16x32_bf16 v[104:107], a[216:219], a[24:27], v[104:107]
s_add_u32 m0, s3, 69632
ds_read_b64_tr_b16 a[212:213], v227 offset:33024
v_mfma_f32_16x16x32_bf16 v[112:115], a[216:219], a[28:31], v[112:115]
ds_read_b64_tr_b16 a[214:215], v227 offset:35072
v_mfma_f32_16x16x32_bf16 v[120:123], a[216:219], a[32:35], v[120:123]
s_waitcnt lgkmcnt(8)
v_mfma_f32_16x16x32_bf16 v[124:127], a[220:223], a[32:35], v[124:127]
ds_read_b64_tr_b16 a[216:217], v228 offset:33024
v_mfma_f32_16x16x32_bf16 v[116:119], a[220:223], a[28:31], v[116:119]
ds_read_b64_tr_b16 a[218:219], v228 offset:35072
v_mfma_f32_16x16x32_bf16 v[108:111], a[220:223], a[24:27], v[108:111]
s_waitcnt lgkmcnt(8)
buffer_load_dwordx4 v238, s[20:23], s68 offen lds
v_mfma_f32_16x16x32_bf16 v[128:131], a[224:227], a[24:27], v[128:131]
ds_read_b64_tr_b16 a[220:221], v229 offset:33024
v_mfma_f32_16x16x32_bf16 v[136:139], a[224:227], a[28:31], v[136:139]
ds_read_b64_tr_b16 a[222:223], v229 offset:35072
v_mfma_f32_16x16x32_bf16 v[144:147], a[224:227], a[32:35], v[144:147]
s_waitcnt lgkmcnt(8)
buffer_load_dwordx4 v239, s[20:23], s68 offen offset:1024 lds
v_mfma_f32_16x16x32_bf16 v[148:151], a[228:231], a[32:35], v[148:151]
ds_read_b64_tr_b16 a[224:225], v230 offset:33024
v_mfma_f32_16x16x32_bf16 v[140:143], a[228:231], a[28:31], v[140:143]
ds_read_b64_tr_b16 a[226:227], v230 offset:35072
v_mfma_f32_16x16x32_bf16 v[132:135], a[228:231], a[24:27], v[132:135]
s_waitcnt lgkmcnt(8)
v_mfma_f32_16x16x32_bf16 v[152:155], a[208:211], a[24:27], v[152:155]
ds_read_b64_tr_b16 a[228:229], v231 offset:33024
v_mfma_f32_16x16x32_bf16 v[160:163], a[208:211], a[28:31], v[160:163]
ds_read_b64_tr_b16 a[230:231], v231 offset:35072
v_mfma_f32_16x16x32_bf16 v[168:171], a[208:211], a[32:35], v[168:171]
s_waitcnt lgkmcnt(8)
v_mfma_f32_16x16x32_bf16 v[172:175], a[212:215], a[32:35], v[172:175]
s_waitcnt vmcnt(16)
s_barrier
ds_read_b64_tr_b16 a[208:209], v224 offset:49152
v_mfma_f32_16x16x32_bf16 v[164:167], a[212:215], a[28:31], v[164:167]
s_add_u32 m0, s48, 16384
ds_read_b64_tr_b16 a[210:211], v224 offset:51200
s_lshl_b32 s49, s66, 12
v_mfma_f32_16x16x32_bf16 v[156:159], a[212:215], a[24:27], v[156:159]
s_waitcnt lgkmcnt(8)
ds_read_b128 a[48:51], v26 offset:0
s_add_u32 s49, s49, 262144
v_mfma_f32_16x16x32_bf16 v[176:179], a[216:219], a[24:27], v[176:179]
ds_read_b64_tr_b16 a[212:213], v225 offset:49152
v_mfma_f32_16x16x32_bf16 v[184:187], a[216:219], a[28:31], v[184:187]
ds_read_b64_tr_b16 a[214:215], v225 offset:51200
v_mfma_f32_16x16x32_bf16 v[192:195], a[216:219], a[32:35], v[192:195]
s_waitcnt lgkmcnt(9)
buffer_load_dwordx4 v20, s[32:35], s49 offen lds
v_mfma_f32_16x16x32_bf16 v[196:199], a[220:223], a[32:35], v[196:199]
ds_read_b64_tr_b16 a[216:217], v226 offset:49152
v_mfma_f32_16x16x32_bf16 v[188:191], a[220:223], a[28:31], v[188:191]
ds_read_b64_tr_b16 a[218:219], v226 offset:51200
v_mfma_f32_16x16x32_bf16 v[180:183], a[220:223], a[24:27], v[180:183]
s_waitcnt lgkmcnt(9)
buffer_load_dwordx4 v21, s[32:35], s49 offen offset:1024 lds
v_mfma_f32_16x16x32_bf16 v[200:203], a[224:227], a[24:27], v[200:203]
ds_read_b64_tr_b16 a[220:221], v227 offset:49152
v_mfma_f32_16x16x32_bf16 v[208:211], a[224:227], a[28:31], v[208:211]
ds_read_b64_tr_b16 a[222:223], v227 offset:51200
v_mfma_f32_16x16x32_bf16 v[216:219], a[224:227], a[32:35], v[216:219]
s_waitcnt lgkmcnt(9)
ds_read_b128 a[52:55], v26 offset:2048
v_mfma_f32_16x16x32_bf16 v[220:223], a[228:231], a[32:35], v[220:223]
ds_read_b64_tr_b16 a[224:225], v228 offset:49152
v_mfma_f32_16x16x32_bf16 v[212:215], a[228:231], a[28:31], v[212:215]
ds_read_b64_tr_b16 a[226:227], v228 offset:51200
v_mfma_f32_16x16x32_bf16 v[204:207], a[228:231], a[24:27], v[204:207]
s_waitcnt lgkmcnt(10)
buffer_load_dwordx4 v22, s[32:35], s49 offen offset:2048 lds
v_mfma_f32_16x16x32_bf16 v[32:35], a[208:211], a[36:39], v[32:35]
ds_read_b64_tr_b16 a[228:229], v229 offset:49152
v_mfma_f32_16x16x32_bf16 v[40:43], a[208:211], a[40:43], v[40:43]
ds_read_b64_tr_b16 a[230:231], v229 offset:51200
v_mfma_f32_16x16x32_bf16 v[48:51], a[208:211], a[44:47], v[48:51]
s_waitcnt lgkmcnt(9)
buffer_load_dwordx4 v23, s[32:35], s49 offen offset:3072 lds
v_mfma_f32_16x16x32_bf16 v[52:55], a[212:215], a[44:47], v[52:55]
s_add_u32 m0, s3, 90112
ds_read_b64_tr_b16 a[208:209], v230 offset:49152
v_mfma_f32_16x16x32_bf16 v[44:47], a[212:215], a[40:43], v[44:47]
ds_read_b64_tr_b16 a[210:211], v230 offset:51200
v_mfma_f32_16x16x32_bf16 v[36:39], a[212:215], a[36:39], v[36:39]
s_waitcnt lgkmcnt(9)
ds_read_b128 a[56:59], v26 offset:4096
v_mfma_f32_16x16x32_bf16 v[56:59], a[216:219], a[36:39], v[56:59]
ds_read_b64_tr_b16 a[212:213], v231 offset:49152
v_mfma_f32_16x16x32_bf16 v[64:67], a[216:219], a[40:43], v[64:67]
ds_read_b64_tr_b16 a[214:215], v231 offset:51200
v_mfma_f32_16x16x32_bf16 v[72:75], a[216:219], a[44:47], v[72:75]
s_waitcnt lgkmcnt(10)
buffer_load_dwordx4 v234, s[20:23], s69 offen lds
v_mfma_f32_16x16x32_bf16 v[76:79], a[220:223], a[44:47], v[76:79]
ds_read_b64_tr_b16 a[216:217], v224 offset:49408
v_mfma_f32_16x16x32_bf16 v[68:71], a[220:223], a[40:43], v[68:71]
ds_read_b64_tr_b16 a[218:219], v224 offset:51456
v_mfma_f32_16x16x32_bf16 v[60:63], a[220:223], a[36:39], v[60:63]
s_waitcnt lgkmcnt(9)
buffer_load_dwordx4 v235, s[20:23], s69 offen offset:1024 lds
v_mfma_f32_16x16x32_bf16 v[80:83], a[224:227], a[36:39], v[80:83]
ds_read_b64_tr_b16 a[220:221], v225 offset:49408
v_mfma_f32_16x16x32_bf16 v[88:91], a[224:227], a[40:43], v[88:91]
ds_read_b64_tr_b16 a[222:223], v225 offset:51456
v_mfma_f32_16x16x32_bf16 v[96:99], a[224:227], a[44:47], v[96:99]
s_waitcnt lgkmcnt(9)
ds_read_b128 a[60:63], v27 offset:0
v_mfma_f32_16x16x32_bf16 v[100:103], a[228:231], a[44:47], v[100:103]
ds_read_b64_tr_b16 a[224:225], v226 offset:49408
v_mfma_f32_16x16x32_bf16 v[92:95], a[228:231], a[40:43], v[92:95]
ds_read_b64_tr_b16 a[226:227], v226 offset:51456
v_mfma_f32_16x16x32_bf16 v[84:87], a[228:231], a[36:39], v[84:87]
s_waitcnt lgkmcnt(10)
buffer_load_dwordx4 v236, s[20:23], s69 offen offset:2048 lds
v_mfma_f32_16x16x32_bf16 v[104:107], a[208:211], a[36:39], v[104:107]
ds_read_b64_tr_b16 a[228:229], v227 offset:49408
v_mfma_f32_16x16x32_bf16 v[112:115], a[208:211], a[40:43], v[112:115]
ds_read_b64_tr_b16 a[230:231], v227 offset:51456
v_mfma_f32_16x16x32_bf16 v[120:123], a[208:211], a[44:47], v[120:123]
s_waitcnt lgkmcnt(9)
buffer_load_dwordx4 v237, s[20:23], s69 offen offset:3072 lds
v_mfma_f32_16x16x32_bf16 v[124:127], a[212:215], a[44:47], v[124:127]
s_add_u32 m0, s3, 94208
ds_read_b64_tr_b16 a[208:209], v228 offset:49408
v_mfma_f32_16x16x32_bf16 v[116:119], a[212:215], a[40:43], v[116:119]
ds_read_b64_tr_b16 a[210:211], v228 offset:51456
v_mfma_f32_16x16x32_bf16 v[108:111], a[212:215], a[36:39], v[108:111]
s_waitcnt lgkmcnt(9)
ds_read_b128 a[64:67], v27 offset:2048
ds_read_b128 a[68:71], v27 offset:4096
v_mfma_f32_16x16x32_bf16 v[128:131], a[216:219], a[36:39], v[128:131]
ds_read_b64_tr_b16 a[212:213], v229 offset:49408
v_mfma_f32_16x16x32_bf16 v[136:139], a[216:219], a[40:43], v[136:139]
ds_read_b64_tr_b16 a[214:215], v229 offset:51456
v_mfma_f32_16x16x32_bf16 v[144:147], a[216:219], a[44:47], v[144:147]
s_waitcnt lgkmcnt(11)
buffer_load_dwordx4 v238, s[20:23], s69 offen lds
v_mfma_f32_16x16x32_bf16 v[148:151], a[220:223], a[44:47], v[148:151]
ds_read_b64_tr_b16 a[216:217], v230 offset:49408
v_mfma_f32_16x16x32_bf16 v[140:143], a[220:223], a[40:43], v[140:143]
ds_read_b64_tr_b16 a[218:219], v230 offset:51456
v_mfma_f32_16x16x32_bf16 v[132:135], a[220:223], a[36:39], v[132:135]
s_waitcnt lgkmcnt(10)
buffer_load_dwordx4 v239, s[20:23], s69 offen offset:1024 lds
v_mfma_f32_16x16x32_bf16 v[152:155], a[224:227], a[36:39], v[152:155]
ds_read_b64_tr_b16 a[220:221], v231 offset:49408
v_mfma_f32_16x16x32_bf16 v[160:163], a[224:227], a[40:43], v[160:163]
ds_read_b64_tr_b16 a[222:223], v231 offset:51456
v_mfma_f32_16x16x32_bf16 v[168:171], a[224:227], a[44:47], v[168:171]
s_waitcnt lgkmcnt(10)
v_mfma_f32_16x16x32_bf16 v[172:175], a[228:231], a[44:47], v[172:175]
s_waitcnt vmcnt(16)
s_barrier
ds_read_b64_tr_b16 a[224:225], v224 offset:0
v_mfma_f32_16x16x32_bf16 v[164:167], a[228:231], a[40:43], v[164:167]
s_add_u32 m0, s48, 32768
ds_read_b64_tr_b16 a[226:227], v224 offset:2048
s_lshl_b32 s49, s67, 12
v_mfma_f32_16x16x32_bf16 v[156:159], a[228:231], a[36:39], v[156:159]
s_waitcnt lgkmcnt(10)
buffer_load_dwordx4 v20, s[32:35], s49 offen lds
v_mfma_f32_16x16x32_bf16 v[176:179], a[208:211], a[36:39], v[176:179]
ds_read_b64_tr_b16 a[228:229], v225 offset:0
v_mfma_f32_16x16x32_bf16 v[184:187], a[208:211], a[40:43], v[184:187]
ds_read_b64_tr_b16 a[230:231], v225 offset:2048
v_mfma_f32_16x16x32_bf16 v[192:195], a[208:211], a[44:47], v[192:195]
s_waitcnt lgkmcnt(8)
buffer_load_dwordx4 v21, s[32:35], s49 offen offset:1024 lds
v_mfma_f32_16x16x32_bf16 v[196:199], a[212:215], a[44:47], v[196:199]
ds_read_b64_tr_b16 a[208:209], v226 offset:0
v_mfma_f32_16x16x32_bf16 v[188:191], a[212:215], a[40:43], v[188:191]
ds_read_b64_tr_b16 a[210:211], v226 offset:2048
v_mfma_f32_16x16x32_bf16 v[180:183], a[212:215], a[36:39], v[180:183]
s_waitcnt lgkmcnt(8)
ds_read_b128 a[72:75], v26 offset:24576
v_mfma_f32_16x16x32_bf16 v[200:203], a[216:219], a[36:39], v[200:203]
ds_read_b64_tr_b16 a[212:213], v227 offset:0
v_mfma_f32_16x16x32_bf16 v[208:211], a[216:219], a[40:43], v[208:211]
ds_read_b64_tr_b16 a[214:215], v227 offset:2048
v_mfma_f32_16x16x32_bf16 v[216:219], a[216:219], a[44:47], v[216:219]
s_waitcnt lgkmcnt(9)
buffer_load_dwordx4 v22, s[32:35], s49 offen offset:2048 lds
v_mfma_f32_16x16x32_bf16 v[220:223], a[220:223], a[44:47], v[220:223]
ds_read_b64_tr_b16 a[216:217], v228 offset:0
v_mfma_f32_16x16x32_bf16 v[212:215], a[220:223], a[40:43], v[212:215]
ds_read_b64_tr_b16 a[218:219], v228 offset:2048
v_mfma_f32_16x16x32_bf16 v[204:207], a[220:223], a[36:39], v[204:207]
s_waitcnt lgkmcnt(9)
buffer_load_dwordx4 v23, s[32:35], s49 offen offset:3072 lds
v_mfma_f32_16x16x32_bf16 v[32:35], a[224:227], a[48:51], v[32:35]
s_add_u32 m0, s3, 114688
ds_read_b64_tr_b16 a[220:221], v229 offset:0
v_mfma_f32_16x16x32_bf16 v[40:43], a[224:227], a[52:55], v[40:43]
ds_read_b64_tr_b16 a[222:223], v229 offset:2048
v_mfma_f32_16x16x32_bf16 v[48:51], a[224:227], a[56:59], v[48:51]
s_waitcnt lgkmcnt(9)
ds_read_b128 a[76:79], v26 offset:26624
v_mfma_f32_16x16x32_bf16 v[52:55], a[228:231], a[56:59], v[52:55]
ds_read_b64_tr_b16 a[224:225], v230 offset:0
v_mfma_f32_16x16x32_bf16 v[44:47], a[228:231], a[52:55], v[44:47]
ds_read_b64_tr_b16 a[226:227], v230 offset:2048
v_mfma_f32_16x16x32_bf16 v[36:39], a[228:231], a[48:51], v[36:39]
s_waitcnt lgkmcnt(10)
buffer_load_dwordx4 v234, s[20:23], s70 offen lds
v_mfma_f32_16x16x32_bf16 v[56:59], a[208:211], a[48:51], v[56:59]
ds_read_b64_tr_b16 a[228:229], v231 offset:0
v_mfma_f32_16x16x32_bf16 v[64:67], a[208:211], a[52:55], v[64:67]
ds_read_b64_tr_b16 a[230:231], v231 offset:2048
v_mfma_f32_16x16x32_bf16 v[72:75], a[208:211], a[56:59], v[72:75]
s_waitcnt lgkmcnt(9)
buffer_load_dwordx4 v235, s[20:23], s70 offen offset:1024 lds
v_mfma_f32_16x16x32_bf16 v[76:79], a[212:215], a[56:59], v[76:79]
ds_read_b64_tr_b16 a[208:209], v224 offset:256
v_mfma_f32_16x16x32_bf16 v[68:71], a[212:215], a[52:55], v[68:71]
ds_read_b64_tr_b16 a[210:211], v224 offset:2304
v_mfma_f32_16x16x32_bf16 v[60:63], a[212:215], a[48:51], v[60:63]
s_waitcnt lgkmcnt(9)
ds_read_b128 a[80:83], v26 offset:28672
v_mfma_f32_16x16x32_bf16 v[80:83], a[216:219], a[48:51], v[80:83]
ds_read_b64_tr_b16 a[212:213], v225 offset:256
v_mfma_f32_16x16x32_bf16 v[88:91], a[216:219], a[52:55], v[88:91]
ds_read_b64_tr_b16 a[214:215], v225 offset:2304
v_mfma_f32_16x16x32_bf16 v[96:99], a[216:219], a[56:59], v[96:99]
s_waitcnt lgkmcnt(10)
buffer_load_dwordx4 v236, s[20:23], s70 offen offset:2048 lds
v_mfma_f32_16x16x32_bf16 v[100:103], a[220:223], a[56:59], v[100:103]
ds_read_b64_tr_b16 a[216:217], v226 offset:256
v_mfma_f32_16x16x32_bf16 v[92:95], a[220:223], a[52:55], v[92:95]
ds_read_b64_tr_b16 a[218:219], v226 offset:2304
v_mfma_f32_16x16x32_bf16 v[84:87], a[220:223], a[48:51], v[84:87]
s_waitcnt lgkmcnt(9)
buffer_load_dwordx4 v237, s[20:23], s70 offen offset:3072 lds
v_mfma_f32_16x16x32_bf16 v[104:107], a[224:227], a[48:51], v[104:107]
s_add_u32 m0, s3, 118784
ds_read_b64_tr_b16 a[220:221], v227 offset:256
v_mfma_f32_16x16x32_bf16 v[112:115], a[224:227], a[52:55], v[112:115]
ds_read_b64_tr_b16 a[222:223], v227 offset:2304
v_mfma_f32_16x16x32_bf16 v[120:123], a[224:227], a[56:59], v[120:123]
s_waitcnt lgkmcnt(9)
ds_read_b128 a[84:87], v27 offset:24576
v_mfma_f32_16x16x32_bf16 v[124:127], a[228:231], a[56:59], v[124:127]
ds_read_b64_tr_b16 a[224:225], v228 offset:256
v_mfma_f32_16x16x32_bf16 v[116:119], a[228:231], a[52:55], v[116:119]
ds_read_b64_tr_b16 a[226:227], v228 offset:2304
v_mfma_f32_16x16x32_bf16 v[108:111], a[228:231], a[48:51], v[108:111]
s_waitcnt lgkmcnt(10)
buffer_load_dwordx4 v238, s[20:23], s70 offen lds
ds_read_b128 a[88:91], v27 offset:26624
ds_read_b128 a[92:95], v27 offset:28672
v_mfma_f32_16x16x32_bf16 v[128:131], a[208:211], a[48:51], v[128:131]
ds_read_b64_tr_b16 a[228:229], v229 offset:256
v_mfma_f32_16x16x32_bf16 v[136:139], a[208:211], a[52:55], v[136:139]
ds_read_b64_tr_b16 a[230:231], v229 offset:2304
v_mfma_f32_16x16x32_bf16 v[144:147], a[208:211], a[56:59], v[144:147]
s_waitcnt lgkmcnt(11)
buffer_load_dwordx4 v239, s[20:23], s70 offen offset:1024 lds
v_mfma_f32_16x16x32_bf16 v[148:151], a[212:215], a[56:59], v[148:151]
ds_read_b64_tr_b16 a[208:209], v230 offset:256
v_mfma_f32_16x16x32_bf16 v[140:143], a[212:215], a[52:55], v[140:143]
ds_read_b64_tr_b16 a[210:211], v230 offset:2304
v_mfma_f32_16x16x32_bf16 v[132:135], a[212:215], a[48:51], v[132:135]
s_waitcnt lgkmcnt(11)
v_mfma_f32_16x16x32_bf16 v[152:155], a[216:219], a[48:51], v[152:155]
ds_read_b64_tr_b16 a[212:213], v231 offset:256
v_mfma_f32_16x16x32_bf16 v[160:163], a[216:219], a[52:55], v[160:163]
ds_read_b64_tr_b16 a[214:215], v231 offset:2304
v_mfma_f32_16x16x32_bf16 v[168:171], a[216:219], a[56:59], v[168:171]
s_waitcnt lgkmcnt(11)
v_mfma_f32_16x16x32_bf16 v[172:175], a[220:223], a[56:59], v[172:175]
s_waitcnt lgkmcnt(6)
s_waitcnt vmcnt(16)
s_barrier
ds_read_b64_tr_b16 a[216:217], v224 offset:16384
v_mfma_f32_16x16x32_bf16 v[164:167], a[220:223], a[52:55], v[164:167]
s_add_u32 m0, s48, 49152
ds_read_b64_tr_b16 a[218:219], v224 offset:18432
s_lshl_b32 s49, s67, 12
v_mfma_f32_16x16x32_bf16 v[156:159], a[220:223], a[48:51], v[156:159]
ds_read_b128 a[96:99], v24 offset:0
s_add_u32 s49, s49, 262144
v_mfma_f32_16x16x32_bf16 v[176:179], a[224:227], a[48:51], v[176:179]
ds_read_b64_tr_b16 a[220:221], v225 offset:16384
v_mfma_f32_16x16x32_bf16 v[184:187], a[224:227], a[52:55], v[184:187]
ds_read_b64_tr_b16 a[222:223], v225 offset:18432
v_mfma_f32_16x16x32_bf16 v[192:195], a[224:227], a[56:59], v[192:195]
s_waitcnt lgkmcnt(9)
buffer_load_dwordx4 v20, s[32:35], s49 offen lds
v_mfma_f32_16x16x32_bf16 v[196:199], a[228:231], a[56:59], v[196:199]
ds_read_b64_tr_b16 a[224:225], v226 offset:16384
v_mfma_f32_16x16x32_bf16 v[188:191], a[228:231], a[52:55], v[188:191]
ds_read_b64_tr_b16 a[226:227], v226 offset:18432
v_mfma_f32_16x16x32_bf16 v[180:183], a[228:231], a[48:51], v[180:183]
s_waitcnt lgkmcnt(9)
buffer_load_dwordx4 v21, s[32:35], s49 offen offset:1024 lds
v_mfma_f32_16x16x32_bf16 v[200:203], a[208:211], a[48:51], v[200:203]
ds_read_b64_tr_b16 a[228:229], v227 offset:16384
v_mfma_f32_16x16x32_bf16 v[208:211], a[208:211], a[52:55], v[208:211]
ds_read_b64_tr_b16 a[230:231], v227 offset:18432
v_mfma_f32_16x16x32_bf16 v[216:219], a[208:211], a[56:59], v[216:219]
s_waitcnt lgkmcnt(9)
ds_read_b128 a[100:103], v24 offset:2048
v_mfma_f32_16x16x32_bf16 v[220:223], a[212:215], a[56:59], v[220:223]
ds_read_b64_tr_b16 a[208:209], v228 offset:16384
v_mfma_f32_16x16x32_bf16 v[212:215], a[212:215], a[52:55], v[212:215]
ds_read_b64_tr_b16 a[210:211], v228 offset:18432
v_mfma_f32_16x16x32_bf16 v[204:207], a[212:215], a[48:51], v[204:207]
s_waitcnt lgkmcnt(10)
buffer_load_dwordx4 v22, s[32:35], s49 offen offset:2048 lds
v_mfma_f32_16x16x32_bf16 v[32:35], a[216:219], a[60:63], v[32:35]
ds_read_b64_tr_b16 a[212:213], v229 offset:16384
v_mfma_f32_16x16x32_bf16 v[40:43], a[216:219], a[64:67], v[40:43]
ds_read_b64_tr_b16 a[214:215], v229 offset:18432
v_mfma_f32_16x16x32_bf16 v[48:51], a[216:219], a[68:71], v[48:51]
s_waitcnt lgkmcnt(9)
buffer_load_dwordx4 v23, s[32:35], s49 offen offset:3072 lds
v_mfma_f32_16x16x32_bf16 v[52:55], a[220:223], a[68:71], v[52:55]
s_add_u32 m0, s48, 147456
ds_read_b64_tr_b16 a[216:217], v230 offset:16384
s_mov_b32 s49, 0
v_mfma_f32_16x16x32_bf16 v[44:47], a[220:223], a[64:67], v[44:47]
ds_read_b64_tr_b16 a[218:219], v230 offset:18432
v_mfma_f32_16x16x32_bf16 v[36:39], a[220:223], a[60:63], v[36:39]
s_waitcnt lgkmcnt(9)
ds_read_b128 a[104:107], v24 offset:4096
v_mfma_f32_16x16x32_bf16 v[56:59], a[224:227], a[60:63], v[56:59]
ds_read_b64_tr_b16 a[220:221], v231 offset:16384
v_mfma_f32_16x16x32_bf16 v[64:67], a[224:227], a[64:67], v[64:67]
ds_read_b64_tr_b16 a[222:223], v231 offset:18432
v_mfma_f32_16x16x32_bf16 v[72:75], a[224:227], a[68:71], v[72:75]
s_waitcnt lgkmcnt(10)
buffer_load_dwordx4 v16, s[24:27], s49 offen nt lds
v_mfma_f32_16x16x32_bf16 v[76:79], a[228:231], a[68:71], v[76:79]
ds_read_b64_tr_b16 a[224:225], v224 offset:16640
v_mfma_f32_16x16x32_bf16 v[68:71], a[228:231], a[64:67], v[68:71]
ds_read_b64_tr_b16 a[226:227], v224 offset:18688
v_mfma_f32_16x16x32_bf16 v[60:63], a[228:231], a[60:63], v[60:63]
s_waitcnt lgkmcnt(9)
buffer_load_dwordx4 v17, s[24:27], s49 offen offset:1024 nt lds
v_mfma_f32_16x16x32_bf16 v[80:83], a[208:211], a[60:63], v[80:83]
ds_read_b64_tr_b16 a[228:229], v225 offset:16640
v_mfma_f32_16x16x32_bf16 v[88:91], a[208:211], a[64:67], v[88:91]
ds_read_b64_tr_b16 a[230:231], v225 offset:18688
v_mfma_f32_16x16x32_bf16 v[96:99], a[208:211], a[68:71], v[96:99]
s_waitcnt lgkmcnt(9)
ds_read_b128 a[108:111], v25 offset:0
v_mfma_f32_16x16x32_bf16 v[100:103], a[212:215], a[68:71], v[100:103]
ds_read_b64_tr_b16 a[208:209], v226 offset:16640
v_mfma_f32_16x16x32_bf16 v[92:95], a[212:215], a[64:67], v[92:95]
ds_read_b64_tr_b16 a[210:211], v226 offset:18688
v_mfma_f32_16x16x32_bf16 v[84:87], a[212:215], a[60:63], v[84:87]
s_waitcnt lgkmcnt(10)
buffer_load_dwordx4 v18, s[24:27], s49 offen offset:2048 nt lds
v_mfma_f32_16x16x32_bf16 v[104:107], a[216:219], a[60:63], v[104:107]
ds_read_b64_tr_b16 a[212:213], v227 offset:16640
v_mfma_f32_16x16x32_bf16 v[112:115], a[216:219], a[64:67], v[112:115]
ds_read_b64_tr_b16 a[214:215], v227 offset:18688
v_mfma_f32_16x16x32_bf16 v[120:123], a[216:219], a[68:71], v[120:123]
s_waitcnt lgkmcnt(9)
buffer_load_dwordx4 v19, s[24:27], s49 offen offset:3072 nt lds
v_mfma_f32_16x16x32_bf16 v[124:127], a[220:223], a[68:71], v[124:127]
ds_read_b64_tr_b16 a[216:217], v228 offset:16640
v_mfma_f32_16x16x32_bf16 v[116:119], a[220:223], a[64:67], v[116:119]
ds_read_b64_tr_b16 a[218:219], v228 offset:18688
v_mfma_f32_16x16x32_bf16 v[108:111], a[220:223], a[60:63], v[108:111]
s_waitcnt lgkmcnt(9)
ds_read_b128 a[112:115], v25 offset:2048
ds_read_b128 a[116:119], v25 offset:4096
v_mfma_f32_16x16x32_bf16 v[128:131], a[224:227], a[60:63], v[128:131]
ds_read_b64_tr_b16 a[220:221], v229 offset:16640
v_mfma_f32_16x16x32_bf16 v[136:139], a[224:227], a[64:67], v[136:139]
ds_read_b64_tr_b16 a[222:223], v229 offset:18688
v_mfma_f32_16x16x32_bf16 v[144:147], a[224:227], a[68:71], v[144:147]
s_waitcnt lgkmcnt(11)
v_mfma_f32_16x16x32_bf16 v[148:151], a[228:231], a[68:71], v[148:151]
ds_read_b64_tr_b16 a[224:225], v230 offset:16640
v_mfma_f32_16x16x32_bf16 v[140:143], a[228:231], a[64:67], v[140:143]
ds_read_b64_tr_b16 a[226:227], v230 offset:18688
v_mfma_f32_16x16x32_bf16 v[132:135], a[228:231], a[60:63], v[132:135]
s_waitcnt lgkmcnt(10)
v_mfma_f32_16x16x32_bf16 v[152:155], a[208:211], a[60:63], v[152:155]
ds_read_b64_tr_b16 a[228:229], v231 offset:16640
v_mfma_f32_16x16x32_bf16 v[160:163], a[208:211], a[64:67], v[160:163]
ds_read_b64_tr_b16 a[230:231], v231 offset:18688
v_mfma_f32_16x16x32_bf16 v[168:171], a[208:211], a[68:71], v[168:171]
s_waitcnt lgkmcnt(10)
v_mfma_f32_16x16x32_bf16 v[172:175], a[212:215], a[68:71], v[172:175]
s_waitcnt lgkmcnt(6)
s_waitcnt vmcnt(14)
s_barrier
ds_read_b64_tr_b16 a[208:209], v224 offset:32768
v_mfma_f32_16x16x32_bf16 v[164:167], a[212:215], a[64:67], v[164:167]
s_add_u32 m0, s48, 0
ds_read_b64_tr_b16 a[210:211], v224 offset:34816
s_lshl_b32 s49, s68, 12
v_mfma_f32_16x16x32_bf16 v[156:159], a[212:215], a[60:63], v[156:159]
buffer_load_dwordx4 v20, s[32:35], s49 offen lds
v_mfma_f32_16x16x32_bf16 v[176:179], a[216:219], a[60:63], v[176:179]
ds_read_b64_tr_b16 a[212:213], v225 offset:32768
v_mfma_f32_16x16x32_bf16 v[184:187], a[216:219], a[64:67], v[184:187]
ds_read_b64_tr_b16 a[214:215], v225 offset:34816
v_mfma_f32_16x16x32_bf16 v[192:195], a[216:219], a[68:71], v[192:195]
s_waitcnt lgkmcnt(8)
buffer_load_dwordx4 v21, s[32:35], s49 offen offset:1024 lds
v_mfma_f32_16x16x32_bf16 v[196:199], a[220:223], a[68:71], v[196:199]
ds_read_b64_tr_b16 a[216:217], v226 offset:32768
v_mfma_f32_16x16x32_bf16 v[188:191], a[220:223], a[64:67], v[188:191]
ds_read_b64_tr_b16 a[218:219], v226 offset:34816
v_mfma_f32_16x16x32_bf16 v[180:183], a[220:223], a[60:63], v[180:183]
s_waitcnt lgkmcnt(8)
ds_read_b128 a[120:123], v24 offset:24576
v_mfma_f32_16x16x32_bf16 v[200:203], a[224:227], a[60:63], v[200:203]
ds_read_b64_tr_b16 a[220:221], v227 offset:32768
v_mfma_f32_16x16x32_bf16 v[208:211], a[224:227], a[64:67], v[208:211]
ds_read_b64_tr_b16 a[222:223], v227 offset:34816
v_mfma_f32_16x16x32_bf16 v[216:219], a[224:227], a[68:71], v[216:219]
s_waitcnt lgkmcnt(9)
buffer_load_dwordx4 v22, s[32:35], s49 offen offset:2048 lds
v_mfma_f32_16x16x32_bf16 v[220:223], a[228:231], a[68:71], v[220:223]
ds_read_b64_tr_b16 a[224:225], v228 offset:32768
v_mfma_f32_16x16x32_bf16 v[212:215], a[228:231], a[64:67], v[212:215]
ds_read_b64_tr_b16 a[226:227], v228 offset:34816
v_mfma_f32_16x16x32_bf16 v[204:207], a[228:231], a[60:63], v[204:207]
s_waitcnt lgkmcnt(9)
buffer_load_dwordx4 v23, s[32:35], s49 offen offset:3072 lds
v_mfma_f32_16x16x32_bf16 v[32:35], a[208:211], a[72:75], v[32:35]
s_add_u32 m0, s48, 65536
ds_read_b64_tr_b16 a[228:229], v229 offset:32768
s_mov_b32 s49, 16384
v_mfma_f32_16x16x32_bf16 v[40:43], a[208:211], a[76:79], v[40:43]
ds_read_b64_tr_b16 a[230:231], v229 offset:34816
v_mfma_f32_16x16x32_bf16 v[48:51], a[208:211], a[80:83], v[48:51]
s_waitcnt lgkmcnt(9)
ds_read_b128 a[124:127], v24 offset:26624
v_mfma_f32_16x16x32_bf16 v[52:55], a[212:215], a[80:83], v[52:55]
ds_read_b64_tr_b16 a[208:209], v230 offset:32768
v_mfma_f32_16x16x32_bf16 v[44:47], a[212:215], a[76:79], v[44:47]
ds_read_b64_tr_b16 a[210:211], v230 offset:34816
v_mfma_f32_16x16x32_bf16 v[36:39], a[212:215], a[72:75], v[36:39]
s_waitcnt lgkmcnt(10)
buffer_load_dwordx4 v16, s[24:27], s49 offen nt lds
v_mfma_f32_16x16x32_bf16 v[56:59], a[216:219], a[72:75], v[56:59]
ds_read_b64_tr_b16 a[212:213], v231 offset:32768
v_mfma_f32_16x16x32_bf16 v[64:67], a[216:219], a[76:79], v[64:67]
ds_read_b64_tr_b16 a[214:215], v231 offset:34816
v_mfma_f32_16x16x32_bf16 v[72:75], a[216:219], a[80:83], v[72:75]
s_waitcnt lgkmcnt(9)
buffer_load_dwordx4 v17, s[24:27], s49 offen offset:1024 nt lds
v_mfma_f32_16x16x32_bf16 v[76:79], a[220:223], a[80:83], v[76:79]
ds_read_b64_tr_b16 a[216:217], v224 offset:33024
v_mfma_f32_16x16x32_bf16 v[68:71], a[220:223], a[76:79], v[68:71]
ds_read_b64_tr_b16 a[218:219], v224 offset:35072
v_mfma_f32_16x16x32_bf16 v[60:63], a[220:223], a[72:75], v[60:63]
s_waitcnt lgkmcnt(9)
ds_read_b128 a[128:131], v24 offset:28672
v_mfma_f32_16x16x32_bf16 v[80:83], a[224:227], a[72:75], v[80:83]
ds_read_b64_tr_b16 a[220:221], v225 offset:33024
v_mfma_f32_16x16x32_bf16 v[88:91], a[224:227], a[76:79], v[88:91]
ds_read_b64_tr_b16 a[222:223], v225 offset:35072
v_mfma_f32_16x16x32_bf16 v[96:99], a[224:227], a[80:83], v[96:99]
s_waitcnt lgkmcnt(10)
buffer_load_dwordx4 v18, s[24:27], s49 offen offset:2048 nt lds
v_mfma_f32_16x16x32_bf16 v[100:103], a[228:231], a[80:83], v[100:103]
ds_read_b64_tr_b16 a[224:225], v226 offset:33024
v_mfma_f32_16x16x32_bf16 v[92:95], a[228:231], a[76:79], v[92:95]
ds_read_b64_tr_b16 a[226:227], v226 offset:35072
v_mfma_f32_16x16x32_bf16 v[84:87], a[228:231], a[72:75], v[84:87]
s_waitcnt lgkmcnt(9)
buffer_load_dwordx4 v19, s[24:27], s49 offen offset:3072 nt lds
v_mfma_f32_16x16x32_bf16 v[104:107], a[208:211], a[72:75], v[104:107]
ds_read_b64_tr_b16 a[228:229], v227 offset:33024
v_mfma_f32_16x16x32_bf16 v[112:115], a[208:211], a[76:79], v[112:115]
ds_read_b64_tr_b16 a[230:231], v227 offset:35072
v_mfma_f32_16x16x32_bf16 v[120:123], a[208:211], a[80:83], v[120:123]
s_waitcnt lgkmcnt(9)
ds_read_b128 a[132:135], v25 offset:24576
v_mfma_f32_16x16x32_bf16 v[124:127], a[212:215], a[80:83], v[124:127]
ds_read_b64_tr_b16 a[208:209], v228 offset:33024
v_mfma_f32_16x16x32_bf16 v[116:119], a[212:215], a[76:79], v[116:119]
ds_read_b64_tr_b16 a[210:211], v228 offset:35072
v_mfma_f32_16x16x32_bf16 v[108:111], a[212:215], a[72:75], v[108:111]
s_waitcnt lgkmcnt(10)
ds_read_b128 a[136:139], v25 offset:26624
ds_read_b128 a[140:143], v25 offset:28672
v_mfma_f32_16x16x32_bf16 v[128:131], a[216:219], a[72:75], v[128:131]
ds_read_b64_tr_b16 a[212:213], v229 offset:33024
v_mfma_f32_16x16x32_bf16 v[136:139], a[216:219], a[76:79], v[136:139]
ds_read_b64_tr_b16 a[214:215], v229 offset:35072
v_mfma_f32_16x16x32_bf16 v[144:147], a[216:219], a[80:83], v[144:147]
s_waitcnt lgkmcnt(11)
v_mfma_f32_16x16x32_bf16 v[148:151], a[220:223], a[80:83], v[148:151]
ds_read_b64_tr_b16 a[216:217], v230 offset:33024
v_mfma_f32_16x16x32_bf16 v[140:143], a[220:223], a[76:79], v[140:143]
ds_read_b64_tr_b16 a[218:219], v230 offset:35072
v_mfma_f32_16x16x32_bf16 v[132:135], a[220:223], a[72:75], v[132:135]
s_waitcnt lgkmcnt(11)
v_mfma_f32_16x16x32_bf16 v[152:155], a[224:227], a[72:75], v[152:155]
ds_read_b64_tr_b16 a[220:221], v231 offset:33024
v_mfma_f32_16x16x32_bf16 v[160:163], a[224:227], a[76:79], v[160:163]
ds_read_b64_tr_b16 a[222:223], v231 offset:35072
v_mfma_f32_16x16x32_bf16 v[168:171], a[224:227], a[80:83], v[168:171]
s_waitcnt lgkmcnt(11)
v_mfma_f32_16x16x32_bf16 v[172:175], a[228:231], a[80:83], v[172:175]
s_waitcnt lgkmcnt(6)
s_waitcnt vmcnt(12)
s_barrier
ds_read_b64_tr_b16 a[224:225], v224 offset:49152
v_mfma_f32_16x16x32_bf16 v[164:167], a[228:231], a[76:79], v[164:167]
s_add_u32 m0, s48, 16384
ds_read_b64_tr_b16 a[226:227], v224 offset:51200
s_lshl_b32 s49, s68, 12
v_mfma_f32_16x16x32_bf16 v[156:159], a[228:231], a[72:75], v[156:159]
ds_read_b128 a[144:147], v26 offset:0
s_add_u32 s49, s49, 262144
v_mfma_f32_16x16x32_bf16 v[176:179], a[208:211], a[72:75], v[176:179]
ds_read_b64_tr_b16 a[228:229], v225 offset:49152
v_mfma_f32_16x16x32_bf16 v[184:187], a[208:211], a[76:79], v[184:187]
ds_read_b64_tr_b16 a[230:231], v225 offset:51200
v_mfma_f32_16x16x32_bf16 v[192:195], a[208:211], a[80:83], v[192:195]
s_waitcnt lgkmcnt(9)
buffer_load_dwordx4 v20, s[32:35], s49 offen lds
v_mfma_f32_16x16x32_bf16 v[196:199], a[212:215], a[80:83], v[196:199]
ds_read_b64_tr_b16 a[208:209], v226 offset:49152
v_mfma_f32_16x16x32_bf16 v[188:191], a[212:215], a[76:79], v[188:191]
ds_read_b64_tr_b16 a[210:211], v226 offset:51200
v_mfma_f32_16x16x32_bf16 v[180:183], a[212:215], a[72:75], v[180:183]
s_waitcnt lgkmcnt(9)
buffer_load_dwordx4 v21, s[32:35], s49 offen offset:1024 lds
v_mfma_f32_16x16x32_bf16 v[200:203], a[216:219], a[72:75], v[200:203]
ds_read_b64_tr_b16 a[212:213], v227 offset:49152
v_mfma_f32_16x16x32_bf16 v[208:211], a[216:219], a[76:79], v[208:211]
ds_read_b64_tr_b16 a[214:215], v227 offset:51200
v_mfma_f32_16x16x32_bf16 v[216:219], a[216:219], a[80:83], v[216:219]
s_waitcnt lgkmcnt(9)
ds_read_b128 a[148:151], v26 offset:2048
v_mfma_f32_16x16x32_bf16 v[220:223], a[220:223], a[80:83], v[220:223]
ds_read_b64_tr_b16 a[216:217], v228 offset:49152
v_mfma_f32_16x16x32_bf16 v[212:215], a[220:223], a[76:79], v[212:215]
ds_read_b64_tr_b16 a[218:219], v228 offset:51200
v_mfma_f32_16x16x32_bf16 v[204:207], a[220:223], a[72:75], v[204:207]
s_waitcnt lgkmcnt(10)
buffer_load_dwordx4 v22, s[32:35], s49 offen offset:2048 lds
v_mfma_f32_16x16x32_bf16 v[32:35], a[224:227], a[84:87], v[32:35]
ds_read_b64_tr_b16 a[220:221], v229 offset:49152
v_mfma_f32_16x16x32_bf16 v[40:43], a[224:227], a[88:91], v[40:43]
ds_read_b64_tr_b16 a[222:223], v229 offset:51200
v_mfma_f32_16x16x32_bf16 v[48:51], a[224:227], a[92:95], v[48:51]
s_waitcnt lgkmcnt(9)
buffer_load_dwordx4 v23, s[32:35], s49 offen offset:3072 lds
v_mfma_f32_16x16x32_bf16 v[52:55], a[228:231], a[92:95], v[52:55]
s_add_u32 m0, s48, 81920
ds_read_b64_tr_b16 a[224:225], v230 offset:49152
s_mov_b32 s49, 0
v_mfma_f32_16x16x32_bf16 v[44:47], a[228:231], a[88:91], v[44:47]
ds_read_b64_tr_b16 a[226:227], v230 offset:51200
v_mfma_f32_16x16x32_bf16 v[36:39], a[228:231], a[84:87], v[36:39]
s_waitcnt lgkmcnt(9)
ds_read_b128 a[152:155], v26 offset:4096
v_mfma_f32_16x16x32_bf16 v[56:59], a[208:211], a[84:87], v[56:59]
ds_read_b64_tr_b16 a[228:229], v231 offset:49152
v_mfma_f32_16x16x32_bf16 v[64:67], a[208:211], a[88:91], v[64:67]
ds_read_b64_tr_b16 a[230:231], v231 offset:51200
v_mfma_f32_16x16x32_bf16 v[72:75], a[208:211], a[92:95], v[72:75]
s_waitcnt lgkmcnt(10)
buffer_load_dwordx4 v16, s[28:31], s49 offen nt lds
v_mfma_f32_16x16x32_bf16 v[76:79], a[212:215], a[92:95], v[76:79]
ds_read_b64_tr_b16 a[208:209], v224 offset:49408
v_mfma_f32_16x16x32_bf16 v[68:71], a[212:215], a[88:91], v[68:71]
ds_read_b64_tr_b16 a[210:211], v224 offset:51456
v_mfma_f32_16x16x32_bf16 v[60:63], a[212:215], a[84:87], v[60:63]
s_waitcnt lgkmcnt(9)
buffer_load_dwordx4 v17, s[28:31], s49 offen offset:1024 nt lds
v_mfma_f32_16x16x32_bf16 v[80:83], a[216:219], a[84:87], v[80:83]
ds_read_b64_tr_b16 a[212:213], v225 offset:49408
v_mfma_f32_16x16x32_bf16 v[88:91], a[216:219], a[88:91], v[88:91]
ds_read_b64_tr_b16 a[214:215], v225 offset:51456
v_mfma_f32_16x16x32_bf16 v[96:99], a[216:219], a[92:95], v[96:99]
s_waitcnt lgkmcnt(9)
ds_read_b128 a[156:159], v27 offset:0
v_mfma_f32_16x16x32_bf16 v[100:103], a[220:223], a[92:95], v[100:103]
ds_read_b64_tr_b16 a[216:217], v226 offset:49408
v_mfma_f32_16x16x32_bf16 v[92:95], a[220:223], a[88:91], v[92:95]
ds_read_b64_tr_b16 a[218:219], v226 offset:51456
v_mfma_f32_16x16x32_bf16 v[84:87], a[220:223], a[84:87], v[84:87]
s_waitcnt lgkmcnt(10)
buffer_load_dwordx4 v18, s[28:31], s49 offen offset:2048 nt lds
v_mfma_f32_16x16x32_bf16 v[104:107], a[224:227], a[84:87], v[104:107]
ds_read_b64_tr_b16 a[220:221], v227 offset:49408
v_mfma_f32_16x16x32_bf16 v[112:115], a[224:227], a[88:91], v[112:115]
ds_read_b64_tr_b16 a[222:223], v227 offset:51456
v_mfma_f32_16x16x32_bf16 v[120:123], a[224:227], a[92:95], v[120:123]
s_waitcnt lgkmcnt(9)
buffer_load_dwordx4 v19, s[28:31], s49 offen offset:3072 nt lds
v_mfma_f32_16x16x32_bf16 v[124:127], a[228:231], a[92:95], v[124:127]
ds_read_b64_tr_b16 a[224:225], v228 offset:49408
v_mfma_f32_16x16x32_bf16 v[116:119], a[228:231], a[88:91], v[116:119]
ds_read_b64_tr_b16 a[226:227], v228 offset:51456
v_mfma_f32_16x16x32_bf16 v[108:111], a[228:231], a[84:87], v[108:111]
s_waitcnt lgkmcnt(9)
ds_read_b128 a[160:163], v27 offset:2048
ds_read_b128 a[164:167], v27 offset:4096
v_mfma_f32_16x16x32_bf16 v[128:131], a[208:211], a[84:87], v[128:131]
ds_read_b64_tr_b16 a[228:229], v229 offset:49408
v_mfma_f32_16x16x32_bf16 v[136:139], a[208:211], a[88:91], v[136:139]
ds_read_b64_tr_b16 a[230:231], v229 offset:51456
v_mfma_f32_16x16x32_bf16 v[144:147], a[208:211], a[92:95], v[144:147]
s_waitcnt lgkmcnt(11)
v_mfma_f32_16x16x32_bf16 v[148:151], a[212:215], a[92:95], v[148:151]
ds_read_b64_tr_b16 a[208:209], v230 offset:49408
v_mfma_f32_16x16x32_bf16 v[140:143], a[212:215], a[88:91], v[140:143]
ds_read_b64_tr_b16 a[210:211], v230 offset:51456
v_mfma_f32_16x16x32_bf16 v[132:135], a[212:215], a[84:87], v[132:135]
s_waitcnt lgkmcnt(10)
v_mfma_f32_16x16x32_bf16 v[152:155], a[216:219], a[84:87], v[152:155]
ds_read_b64_tr_b16 a[212:213], v231 offset:49408
v_mfma_f32_16x16x32_bf16 v[160:163], a[216:219], a[88:91], v[160:163]
ds_read_b64_tr_b16 a[214:215], v231 offset:51456
v_mfma_f32_16x16x32_bf16 v[168:171], a[216:219], a[92:95], v[168:171]
s_waitcnt lgkmcnt(10)
v_mfma_f32_16x16x32_bf16 v[172:175], a[220:223], a[92:95], v[172:175]
s_waitcnt lgkmcnt(6)
s_waitcnt vmcnt(12)
s_barrier
ds_read_b64_tr_b16 a[216:217], v224 offset:0
v_mfma_f32_16x16x32_bf16 v[164:167], a[220:223], a[88:91], v[164:167]
s_add_u32 m0, s48, 98304
ds_read_b64_tr_b16 a[218:219], v224 offset:2048
s_lshl_b32 s49, s69, 12
v_mfma_f32_16x16x32_bf16 v[156:159], a[220:223], a[84:87], v[156:159]
buffer_load_dwordx4 v20, s[32:35], s49 offen lds
v_mfma_f32_16x16x32_bf16 v[176:179], a[224:227], a[84:87], v[176:179]
ds_read_b64_tr_b16 a[220:221], v225 offset:0
v_mfma_f32_16x16x32_bf16 v[184:187], a[224:227], a[88:91], v[184:187]
ds_read_b64_tr_b16 a[222:223], v225 offset:2048
v_mfma_f32_16x16x32_bf16 v[192:195], a[224:227], a[92:95], v[192:195]
s_waitcnt lgkmcnt(8)
buffer_load_dwordx4 v21, s[32:35], s49 offen offset:1024 lds
v_mfma_f32_16x16x32_bf16 v[196:199], a[228:231], a[92:95], v[196:199]
ds_read_b64_tr_b16 a[224:225], v226 offset:0
v_mfma_f32_16x16x32_bf16 v[188:191], a[228:231], a[88:91], v[188:191]
ds_read_b64_tr_b16 a[226:227], v226 offset:2048
v_mfma_f32_16x16x32_bf16 v[180:183], a[228:231], a[84:87], v[180:183]
s_waitcnt lgkmcnt(8)
v_mfma_f32_16x16x32_bf16 v[200:203], a[208:211], a[84:87], v[200:203]
ds_read_b64_tr_b16 a[228:229], v227 offset:0
v_mfma_f32_16x16x32_bf16 v[208:211], a[208:211], a[88:91], v[208:211]
ds_read_b64_tr_b16 a[230:231], v227 offset:2048
v_mfma_f32_16x16x32_bf16 v[216:219], a[208:211], a[92:95], v[216:219]
s_waitcnt lgkmcnt(8)
buffer_load_dwordx4 v22, s[32:35], s49 offen offset:2048 lds
v_mfma_f32_16x16x32_bf16 v[220:223], a[212:215], a[92:95], v[220:223]
ds_read_b64_tr_b16 a[208:209], v228 offset:0
v_mfma_f32_16x16x32_bf16 v[212:215], a[212:215], a[88:91], v[212:215]
ds_read_b64_tr_b16 a[210:211], v228 offset:2048
v_mfma_f32_16x16x32_bf16 v[204:207], a[212:215], a[84:87], v[204:207]
s_waitcnt lgkmcnt(8)
buffer_load_dwordx4 v23, s[32:35], s49 offen offset:3072 lds
v_mfma_f32_16x16x32_bf16 v[32:35], a[216:219], a[96:99], v[32:35]
s_add_u32 m0, s48, 32768
ds_read_b64_tr_b16 a[212:213], v229 offset:0
s_mov_b32 s49, 32768
v_mfma_f32_16x16x32_bf16 v[40:43], a[216:219], a[100:103], v[40:43]
ds_read_b64_tr_b16 a[214:215], v229 offset:2048
v_mfma_f32_16x16x32_bf16 v[48:51], a[216:219], a[104:107], v[48:51]
s_waitcnt lgkmcnt(8)
v_mfma_f32_16x16x32_bf16 v[52:55], a[220:223], a[104:107], v[52:55]
ds_read_b64_tr_b16 a[216:217], v230 offset:0
v_mfma_f32_16x16x32_bf16 v[44:47], a[220:223], a[100:103], v[44:47]
ds_read_b64_tr_b16 a[218:219], v230 offset:2048
v_mfma_f32_16x16x32_bf16 v[36:39], a[220:223], a[96:99], v[36:39]
s_waitcnt lgkmcnt(8)
buffer_load_dwordx4 v16, s[24:27], s49 offen nt lds
v_mfma_f32_16x16x32_bf16 v[56:59], a[224:227], a[96:99], v[56:59]
ds_read_b64_tr_b16 a[220:221], v231 offset:0
v_mfma_f32_16x16x32_bf16 v[64:67], a[224:227], a[100:103], v[64:67]
ds_read_b64_tr_b16 a[222:223], v231 offset:2048
v_mfma_f32_16x16x32_bf16 v[72:75], a[224:227], a[104:107], v[72:75]
s_waitcnt lgkmcnt(8)
buffer_load_dwordx4 v17, s[24:27], s49 offen offset:1024 nt lds
v_mfma_f32_16x16x32_bf16 v[76:79], a[228:231], a[104:107], v[76:79]
ds_read_b64_tr_b16 a[224:225], v224 offset:256
v_mfma_f32_16x16x32_bf16 v[68:71], a[228:231], a[100:103], v[68:71]
ds_read_b64_tr_b16 a[226:227], v224 offset:2304
v_mfma_f32_16x16x32_bf16 v[60:63], a[228:231], a[96:99], v[60:63]
s_waitcnt lgkmcnt(8)
v_mfma_f32_16x16x32_bf16 v[80:83], a[208:211], a[96:99], v[80:83]
ds_read_b64_tr_b16 a[228:229], v225 offset:256
v_mfma_f32_16x16x32_bf16 v[88:91], a[208:211], a[100:103], v[88:91]
ds_read_b64_tr_b16 a[230:231], v225 offset:2304
v_mfma_f32_16x16x32_bf16 v[96:99], a[208:211], a[104:107], v[96:99]
s_waitcnt lgkmcnt(8)
buffer_load_dwordx4 v18, s[24:27], s49 offen offset:2048 nt lds
v_mfma_f32_16x16x32_bf16 v[100:103], a[212:215], a[104:107], v[100:103]
ds_read_b64_tr_b16 a[208:209], v226 offset:256
v_mfma_f32_16x16x32_bf16 v[92:95], a[212:215], a[100:103], v[92:95]
ds_read_b64_tr_b16 a[210:211], v226 offset:2304
v_mfma_f32_16x16x32_bf16 v[84:87], a[212:215], a[96:99], v[84:87]
s_waitcnt lgkmcnt(8)
buffer_load_dwordx4 v19, s[24:27], s49 offen offset:3072 nt lds
v_mfma_f32_16x16x32_bf16 v[104:107], a[216:219], a[96:99], v[104:107]
ds_read_b64_tr_b16 a[212:213], v227 offset:256
v_mfma_f32_16x16x32_bf16 v[112:115], a[216:219], a[100:103], v[112:115]
ds_read_b64_tr_b16 a[214:215], v227 offset:2304
v_mfma_f32_16x16x32_bf16 v[120:123], a[216:219], a[104:107], v[120:123]
s_waitcnt lgkmcnt(8)
v_mfma_f32_16x16x32_bf16 v[124:127], a[220:223], a[104:107], v[124:127]
ds_read_b64_tr_b16 a[216:217], v228 offset:256
v_mfma_f32_16x16x32_bf16 v[116:119], a[220:223], a[100:103], v[116:119]
ds_read_b64_tr_b16 a[218:219], v228 offset:2304
v_mfma_f32_16x16x32_bf16 v[108:111], a[220:223], a[96:99], v[108:111]
s_waitcnt lgkmcnt(8)
v_mfma_f32_16x16x32_bf16 v[128:131], a[224:227], a[96:99], v[128:131]
ds_read_b64_tr_b16 a[220:221], v229 offset:256
v_mfma_f32_16x16x32_bf16 v[136:139], a[224:227], a[100:103], v[136:139]
ds_read_b64_tr_b16 a[222:223], v229 offset:2304
v_mfma_f32_16x16x32_bf16 v[144:147], a[224:227], a[104:107], v[144:147]
s_waitcnt lgkmcnt(8)
v_mfma_f32_16x16x32_bf16 v[148:151], a[228:231], a[104:107], v[148:151]
ds_read_b64_tr_b16 a[224:225], v230 offset:256
v_mfma_f32_16x16x32_bf16 v[140:143], a[228:231], a[100:103], v[140:143]
ds_read_b64_tr_b16 a[226:227], v230 offset:2304
v_mfma_f32_16x16x32_bf16 v[132:135], a[228:231], a[96:99], v[132:135]
s_waitcnt lgkmcnt(8)
v_mfma_f32_16x16x32_bf16 v[152:155], a[208:211], a[96:99], v[152:155]
ds_read_b64_tr_b16 a[228:229], v231 offset:256
v_mfma_f32_16x16x32_bf16 v[160:163], a[208:211], a[100:103], v[160:163]
ds_read_b64_tr_b16 a[230:231], v231 offset:2304
v_mfma_f32_16x16x32_bf16 v[168:171], a[208:211], a[104:107], v[168:171]
s_waitcnt lgkmcnt(8)
v_mfma_f32_16x16x32_bf16 v[172:175], a[212:215], a[104:107], v[172:175]
s_waitcnt vmcnt(12)
s_barrier
ds_read_b64_tr_b16 a[208:209], v224 offset:16384
v_mfma_f32_16x16x32_bf16 v[164:167], a[212:215], a[100:103], v[164:167]
s_add_u32 m0, s48, 114688
ds_read_b64_tr_b16 a[210:211], v224 offset:18432
s_lshl_b32 s49, s69, 12
v_mfma_f32_16x16x32_bf16 v[156:159], a[212:215], a[96:99], v[156:159]
s_waitcnt lgkmcnt(8)
s_add_u32 s49, s49, 262144
v_mfma_f32_16x16x32_bf16 v[176:179], a[216:219], a[96:99], v[176:179]
ds_read_b64_tr_b16 a[212:213], v225 offset:16384
v_mfma_f32_16x16x32_bf16 v[184:187], a[216:219], a[100:103], v[184:187]
ds_read_b64_tr_b16 a[214:215], v225 offset:18432
v_mfma_f32_16x16x32_bf16 v[192:195], a[216:219], a[104:107], v[192:195]
s_waitcnt lgkmcnt(8)
buffer_load_dwordx4 v20, s[32:35], s49 offen lds
v_mfma_f32_16x16x32_bf16 v[196:199], a[220:223], a[104:107], v[196:199]
ds_read_b64_tr_b16 a[216:217], v226 offset:16384
v_mfma_f32_16x16x32_bf16 v[188:191], a[220:223], a[100:103], v[188:191]
ds_read_b64_tr_b16 a[218:219], v226 offset:18432
v_mfma_f32_16x16x32_bf16 v[180:183], a[220:223], a[96:99], v[180:183]
s_waitcnt lgkmcnt(8)
buffer_load_dwordx4 v21, s[32:35], s49 offen offset:1024 lds
v_mfma_f32_16x16x32_bf16 v[200:203], a[224:227], a[96:99], v[200:203]
ds_read_b64_tr_b16 a[220:221], v227 offset:16384
v_mfma_f32_16x16x32_bf16 v[208:211], a[224:227], a[100:103], v[208:211]
ds_read_b64_tr_b16 a[222:223], v227 offset:18432
v_mfma_f32_16x16x32_bf16 v[216:219], a[224:227], a[104:107], v[216:219]
s_waitcnt lgkmcnt(8)
v_mfma_f32_16x16x32_bf16 v[220:223], a[228:231], a[104:107], v[220:223]
ds_read_b64_tr_b16 a[224:225], v228 offset:16384
v_mfma_f32_16x16x32_bf16 v[212:215], a[228:231], a[100:103], v[212:215]
ds_read_b64_tr_b16 a[226:227], v228 offset:18432
v_mfma_f32_16x16x32_bf16 v[204:207], a[228:231], a[96:99], v[204:207]
s_waitcnt lgkmcnt(8)
buffer_load_dwordx4 v22, s[32:35], s49 offen offset:2048 lds
v_mfma_f32_16x16x32_bf16 v[32:35], a[208:211], a[108:111], v[32:35]
ds_read_b64_tr_b16 a[228:229], v229 offset:16384
v_mfma_f32_16x16x32_bf16 v[40:43], a[208:211], a[112:115], v[40:43]
ds_read_b64_tr_b16 a[230:231], v229 offset:18432
v_mfma_f32_16x16x32_bf16 v[48:51], a[208:211], a[116:119], v[48:51]
s_waitcnt lgkmcnt(8)
buffer_load_dwordx4 v23, s[32:35], s49 offen offset:3072 lds
v_mfma_f32_16x16x32_bf16 v[52:55], a[212:215], a[116:119], v[52:55]
s_add_u32 m0, s48, 131072
ds_read_b64_tr_b16 a[208:209], v230 offset:16384
s_mov_b32 s49, 16384
v_mfma_f32_16x16x32_bf16 v[44:47], a[212:215], a[112:115], v[44:47]
ds_read_b64_tr_b16 a[210:211], v230 offset:18432
v_mfma_f32_16x16x32_bf16 v[36:39], a[212:215], a[108:111], v[36:39]
s_waitcnt lgkmcnt(8)
v_mfma_f32_16x16x32_bf16 v[56:59], a[216:219], a[108:111], v[56:59]
ds_read_b64_tr_b16 a[212:213], v231 offset:16384
v_mfma_f32_16x16x32_bf16 v[64:67], a[216:219], a[112:115], v[64:67]
ds_read_b64_tr_b16 a[214:215], v231 offset:18432
v_mfma_f32_16x16x32_bf16 v[72:75], a[216:219], a[116:119], v[72:75]
s_waitcnt lgkmcnt(8)
buffer_load_dwordx4 v16, s[28:31], s49 offen nt lds
v_mfma_f32_16x16x32_bf16 v[76:79], a[220:223], a[116:119], v[76:79]
ds_read_b64_tr_b16 a[216:217], v224 offset:16640
v_mfma_f32_16x16x32_bf16 v[68:71], a[220:223], a[112:115], v[68:71]
ds_read_b64_tr_b16 a[218:219], v224 offset:18688
v_mfma_f32_16x16x32_bf16 v[60:63], a[220:223], a[108:111], v[60:63]
s_waitcnt lgkmcnt(8)
buffer_load_dwordx4 v17, s[28:31], s49 offen offset:1024 nt lds
v_mfma_f32_16x16x32_bf16 v[80:83], a[224:227], a[108:111], v[80:83]
ds_read_b64_tr_b16 a[220:221], v225 offset:16640
v_mfma_f32_16x16x32_bf16 v[88:91], a[224:227], a[112:115], v[88:91]
ds_read_b64_tr_b16 a[222:223], v225 offset:18688
v_mfma_f32_16x16x32_bf16 v[96:99], a[224:227], a[116:119], v[96:99]
s_waitcnt lgkmcnt(8)
v_mfma_f32_16x16x32_bf16 v[100:103], a[228:231], a[116:119], v[100:103]
ds_read_b64_tr_b16 a[224:225], v226 offset:16640
v_mfma_f32_16x16x32_bf16 v[92:95], a[228:231], a[112:115], v[92:95]
ds_read_b64_tr_b16 a[226:227], v226 offset:18688
v_mfma_f32_16x16x32_bf16 v[84:87], a[228:231], a[108:111], v[84:87]
s_waitcnt lgkmcnt(8)
buffer_load_dwordx4 v18, s[28:31], s49 offen offset:2048 nt lds
v_mfma_f32_16x16x32_bf16 v[104:107], a[208:211], a[108:111], v[104:107]
ds_read_b64_tr_b16 a[228:229], v227 offset:16640
v_mfma_f32_16x16x32_bf16 v[112:115], a[208:211], a[112:115], v[112:115]
ds_read_b64_tr_b16 a[230:231], v227 offset:18688
v_mfma_f32_16x16x32_bf16 v[120:123], a[208:211], a[116:119], v[120:123]
s_waitcnt lgkmcnt(8)
buffer_load_dwordx4 v19, s[28:31], s49 offen offset:3072 nt lds
v_mfma_f32_16x16x32_bf16 v[124:127], a[212:215], a[116:119], v[124:127]
ds_read_b64_tr_b16 a[208:209], v228 offset:16640
v_mfma_f32_16x16x32_bf16 v[116:119], a[212:215], a[112:115], v[116:119]
ds_read_b64_tr_b16 a[210:211], v228 offset:18688
v_mfma_f32_16x16x32_bf16 v[108:111], a[212:215], a[108:111], v[108:111]
s_waitcnt lgkmcnt(8)
v_mfma_f32_16x16x32_bf16 v[128:131], a[216:219], a[108:111], v[128:131]
ds_read_b64_tr_b16 a[212:213], v229 offset:16640
v_mfma_f32_16x16x32_bf16 v[136:139], a[216:219], a[112:115], v[136:139]
ds_read_b64_tr_b16 a[214:215], v229 offset:18688
v_mfma_f32_16x16x32_bf16 v[144:147], a[216:219], a[116:119], v[144:147]
s_waitcnt lgkmcnt(8)
v_mfma_f32_16x16x32_bf16 v[148:151], a[220:223], a[116:119], v[148:151]
ds_read_b64_tr_b16 a[216:217], v230 offset:16640
v_mfma_f32_16x16x32_bf16 v[140:143], a[220:223], a[112:115], v[140:143]
ds_read_b64_tr_b16 a[218:219], v230 offset:18688
v_mfma_f32_16x16x32_bf16 v[132:135], a[220:223], a[108:111], v[132:135]
s_waitcnt lgkmcnt(8)
v_mfma_f32_16x16x32_bf16 v[152:155], a[224:227], a[108:111], v[152:155]
ds_read_b64_tr_b16 a[220:221], v231 offset:16640
v_mfma_f32_16x16x32_bf16 v[160:163], a[224:227], a[112:115], v[160:163]
ds_read_b64_tr_b16 a[222:223], v231 offset:18688
v_mfma_f32_16x16x32_bf16 v[168:171], a[224:227], a[116:119], v[168:171]
s_waitcnt lgkmcnt(8)
v_mfma_f32_16x16x32_bf16 v[172:175], a[228:231], a[116:119], v[172:175]
s_waitcnt vmcnt(12)
s_barrier
v_add_u32 v224, 98304, v224
v_mfma_f32_16x16x32_bf16 v[164:167], a[228:231], a[112:115], v[164:167]
s_add_u32 m0, s48, 49152
ds_read_b64_tr_b16 a[224:225], v224 offset:0
s_lshl_b32 s49, s70, 12
v_mfma_f32_16x16x32_bf16 v[156:159], a[228:231], a[108:111], v[156:159]
s_waitcnt lgkmcnt(7)
ds_read_b64_tr_b16 a[226:227], v224 offset:2048
v_mfma_f32_16x16x32_bf16 v[176:179], a[208:211], a[108:111], v[176:179]
buffer_load_dwordx4 v20, s[32:35], s49 offen lds
v_mfma_f32_16x16x32_bf16 v[184:187], a[208:211], a[112:115], v[184:187]
v_add_u32 v225, 98304, v225
v_mfma_f32_16x16x32_bf16 v[192:195], a[208:211], a[116:119], v[192:195]
s_waitcnt lgkmcnt(6)
ds_read_b64_tr_b16 a[228:229], v225 offset:0
v_mfma_f32_16x16x32_bf16 v[196:199], a[212:215], a[116:119], v[196:199]
ds_read_b64_tr_b16 a[230:231], v225 offset:2048
v_add_u32 v226, 98304, v226
v_mfma_f32_16x16x32_bf16 v[188:191], a[212:215], a[112:115], v[188:191]
ds_read_b64_tr_b16 a[208:209], v226 offset:0
v_mfma_f32_16x16x32_bf16 v[180:183], a[212:215], a[108:111], v[180:183]
s_waitcnt lgkmcnt(7)
ds_read_b64_tr_b16 a[210:211], v226 offset:2048
v_mfma_f32_16x16x32_bf16 v[200:203], a[216:219], a[108:111], v[200:203]
buffer_load_dwordx4 v21, s[32:35], s49 offen offset:1024 lds
v_mfma_f32_16x16x32_bf16 v[208:211], a[216:219], a[112:115], v[208:211]
v_add_u32 v227, 98304, v227
v_mfma_f32_16x16x32_bf16 v[216:219], a[216:219], a[116:119], v[216:219]
s_waitcnt lgkmcnt(6)
ds_read_b64_tr_b16 a[212:213], v227 offset:0
v_mfma_f32_16x16x32_bf16 v[220:223], a[220:223], a[116:119], v[220:223]
ds_read_b64_tr_b16 a[214:215], v227 offset:2048
v_add_u32 v228, 98304, v228
v_mfma_f32_16x16x32_bf16 v[212:215], a[220:223], a[112:115], v[212:215]
ds_read_b64_tr_b16 a[216:217], v228 offset:0
v_mfma_f32_16x16x32_bf16 v[204:207], a[220:223], a[108:111], v[204:207]
s_waitcnt lgkmcnt(7)
ds_read_b64_tr_b16 a[218:219], v228 offset:2048
v_mfma_f32_16x16x32_bf16 v[32:35], a[224:227], a[120:123], v[32:35]
buffer_load_dwordx4 v22, s[32:35], s49 offen offset:2048 lds
v_mfma_f32_16x16x32_bf16 v[40:43], a[224:227], a[124:127], v[40:43]
v_add_u32 v229, 98304, v229
v_mfma_f32_16x16x32_bf16 v[48:51], a[224:227], a[128:131], v[48:51]
s_waitcnt lgkmcnt(6)
ds_read_b64_tr_b16 a[220:221], v229 offset:0
v_mfma_f32_16x16x32_bf16 v[52:55], a[228:231], a[128:131], v[52:55]
ds_read_b64_tr_b16 a[222:223], v229 offset:2048
v_add_u32 v230, 98304, v230
v_mfma_f32_16x16x32_bf16 v[44:47], a[228:231], a[124:127], v[44:47]
ds_read_b64_tr_b16 a[224:225], v230 offset:0
v_mfma_f32_16x16x32_bf16 v[36:39], a[228:231], a[120:123], v[36:39]
s_waitcnt lgkmcnt(7)
ds_read_b64_tr_b16 a[226:227], v230 offset:2048
v_mfma_f32_16x16x32_bf16 v[56:59], a[208:211], a[120:123], v[56:59]
buffer_load_dwordx4 v23, s[32:35], s49 offen offset:3072 lds
v_mfma_f32_16x16x32_bf16 v[64:67], a[208:211], a[124:127], v[64:67]
s_add_u32 m0, s48, 0
v_add_u32 v231, 98304, v231
s_mov_b32 s49, 49152
v_mfma_f32_16x16x32_bf16 v[72:75], a[208:211], a[128:131], v[72:75]
s_waitcnt lgkmcnt(6)
ds_read_b64_tr_b16 a[228:229], v231 offset:0
v_mfma_f32_16x16x32_bf16 v[76:79], a[212:215], a[128:131], v[76:79]
ds_read_b64_tr_b16 a[230:231], v231 offset:2048
ds_read_b64_tr_b16 a[208:209], v224 offset:256
v_mfma_f32_16x16x32_bf16 v[68:71], a[212:215], a[124:127], v[68:71]
ds_read_b64_tr_b16 a[210:211], v224 offset:2304
v_mfma_f32_16x16x32_bf16 v[60:63], a[212:215], a[120:123], v[60:63]
s_waitcnt lgkmcnt(8)
buffer_load_dwordx4 v16, s[24:27], s49 offen nt lds
v_mfma_f32_16x16x32_bf16 v[80:83], a[216:219], a[120:123], v[80:83]
ds_read_b64_tr_b16 a[212:213], v225 offset:256
v_mfma_f32_16x16x32_bf16 v[88:91], a[216:219], a[124:127], v[88:91]
ds_read_b64_tr_b16 a[214:215], v225 offset:2304
v_mfma_f32_16x16x32_bf16 v[96:99], a[216:219], a[128:131], v[96:99]
s_waitcnt lgkmcnt(8)
v_mfma_f32_16x16x32_bf16 v[100:103], a[220:223], a[128:131], v[100:103]
ds_read_b64_tr_b16 a[216:217], v226 offset:256
v_mfma_f32_16x16x32_bf16 v[92:95], a[220:223], a[124:127], v[92:95]
ds_read_b64_tr_b16 a[218:219], v226 offset:2304
v_mfma_f32_16x16x32_bf16 v[84:87], a[220:223], a[120:123], v[84:87]
s_waitcnt lgkmcnt(8)
buffer_load_dwordx4 v17, s[24:27], s49 offen offset:1024 nt lds
v_mfma_f32_16x16x32_bf16 v[104:107], a[224:227], a[120:123], v[104:107]
ds_read_b64_tr_b16 a[220:221], v227 offset:256
v_mfma_f32_16x16x32_bf16 v[112:115], a[224:227], a[124:127], v[112:115]
ds_read_b64_tr_b16 a[222:223], v227 offset:2304
v_mfma_f32_16x16x32_bf16 v[120:123], a[224:227], a[128:131], v[120:123]
s_waitcnt lgkmcnt(8)
buffer_load_dwordx4 v18, s[24:27], s49 offen offset:2048 nt lds
v_mfma_f32_16x16x32_bf16 v[124:127], a[228:231], a[128:131], v[124:127]
ds_read_b64_tr_b16 a[224:225], v228 offset:256
v_mfma_f32_16x16x32_bf16 v[116:119], a[228:231], a[124:127], v[116:119]
ds_read_b64_tr_b16 a[226:227], v228 offset:2304
v_mfma_f32_16x16x32_bf16 v[108:111], a[228:231], a[120:123], v[108:111]
s_waitcnt lgkmcnt(8)
v_mfma_f32_16x16x32_bf16 v[128:131], a[208:211], a[120:123], v[128:131]
ds_read_b64_tr_b16 a[228:229], v229 offset:256
v_mfma_f32_16x16x32_bf16 v[136:139], a[208:211], a[124:127], v[136:139]
ds_read_b64_tr_b16 a[230:231], v229 offset:2304
v_mfma_f32_16x16x32_bf16 v[144:147], a[208:211], a[128:131], v[144:147]
s_waitcnt lgkmcnt(8)
buffer_load_dwordx4 v19, s[24:27], s49 offen offset:3072 nt lds
v_mfma_f32_16x16x32_bf16 v[148:151], a[212:215], a[128:131], v[148:151]
ds_read_b64_tr_b16 a[208:209], v230 offset:256
v_mfma_f32_16x16x32_bf16 v[140:143], a[212:215], a[124:127], v[140:143]
ds_read_b64_tr_b16 a[210:211], v230 offset:2304
v_mfma_f32_16x16x32_bf16 v[132:135], a[212:215], a[120:123], v[132:135]
s_waitcnt lgkmcnt(8)
v_mfma_f32_16x16x32_bf16 v[152:155], a[216:219], a[120:123], v[152:155]
ds_read_b64_tr_b16 a[212:213], v231 offset:256
v_mfma_f32_16x16x32_bf16 v[160:163], a[216:219], a[124:127], v[160:163]
ds_read_b64_tr_b16 a[214:215], v231 offset:2304
v_mfma_f32_16x16x32_bf16 v[168:171], a[216:219], a[128:131], v[168:171]
s_waitcnt lgkmcnt(8)
v_mfma_f32_16x16x32_bf16 v[172:175], a[220:223], a[128:131], v[172:175]
s_waitcnt vmcnt(12)
s_barrier
ds_read_b64_tr_b16 a[216:217], v224 offset:16384
v_mfma_f32_16x16x32_bf16 v[164:167], a[220:223], a[124:127], v[164:167]
s_add_u32 m0, s48, 16384
ds_read_b64_tr_b16 a[218:219], v224 offset:18432
s_lshl_b32 s49, s70, 12
v_mfma_f32_16x16x32_bf16 v[156:159], a[220:223], a[120:123], v[156:159]
s_waitcnt lgkmcnt(8)
s_add_u32 s49, s49, 262144
v_mfma_f32_16x16x32_bf16 v[176:179], a[224:227], a[120:123], v[176:179]
ds_read_b64_tr_b16 a[220:221], v225 offset:16384
v_mfma_f32_16x16x32_bf16 v[184:187], a[224:227], a[124:127], v[184:187]
ds_read_b64_tr_b16 a[222:223], v225 offset:18432
v_mfma_f32_16x16x32_bf16 v[192:195], a[224:227], a[128:131], v[192:195]
s_waitcnt lgkmcnt(8)
buffer_load_dwordx4 v20, s[32:35], s49 offen lds
v_mfma_f32_16x16x32_bf16 v[196:199], a[228:231], a[128:131], v[196:199]
ds_read_b64_tr_b16 a[224:225], v226 offset:16384
v_mfma_f32_16x16x32_bf16 v[188:191], a[228:231], a[124:127], v[188:191]
ds_read_b64_tr_b16 a[226:227], v226 offset:18432
v_mfma_f32_16x16x32_bf16 v[180:183], a[228:231], a[120:123], v[180:183]
s_waitcnt lgkmcnt(8)
buffer_load_dwordx4 v21, s[32:35], s49 offen offset:1024 lds
v_mfma_f32_16x16x32_bf16 v[200:203], a[208:211], a[120:123], v[200:203]
ds_read_b64_tr_b16 a[228:229], v227 offset:16384
v_mfma_f32_16x16x32_bf16 v[208:211], a[208:211], a[124:127], v[208:211]
ds_read_b64_tr_b16 a[230:231], v227 offset:18432
v_mfma_f32_16x16x32_bf16 v[216:219], a[208:211], a[128:131], v[216:219]
s_waitcnt lgkmcnt(8)
v_mfma_f32_16x16x32_bf16 v[220:223], a[212:215], a[128:131], v[220:223]
ds_read_b64_tr_b16 a[208:209], v228 offset:16384
v_mfma_f32_16x16x32_bf16 v[212:215], a[212:215], a[124:127], v[212:215]
ds_read_b64_tr_b16 a[210:211], v228 offset:18432
v_mfma_f32_16x16x32_bf16 v[204:207], a[212:215], a[120:123], v[204:207]
s_waitcnt lgkmcnt(8)
buffer_load_dwordx4 v22, s[32:35], s49 offen offset:2048 lds
v_mfma_f32_16x16x32_bf16 v[32:35], a[216:219], a[132:135], v[32:35]
ds_read_b64_tr_b16 a[212:213], v229 offset:16384
v_mfma_f32_16x16x32_bf16 v[40:43], a[216:219], a[136:139], v[40:43]
ds_read_b64_tr_b16 a[214:215], v229 offset:18432
v_mfma_f32_16x16x32_bf16 v[48:51], a[216:219], a[140:143], v[48:51]
s_waitcnt lgkmcnt(8)
buffer_load_dwordx4 v23, s[32:35], s49 offen offset:3072 lds
v_mfma_f32_16x16x32_bf16 v[52:55], a[220:223], a[140:143], v[52:55]
ds_read_b64_tr_b16 a[216:217], v230 offset:16384
v_mfma_f32_16x16x32_bf16 v[44:47], a[220:223], a[136:139], v[44:47]
ds_read_b64_tr_b16 a[218:219], v230 offset:18432
v_mfma_f32_16x16x32_bf16 v[36:39], a[220:223], a[132:135], v[36:39]
s_waitcnt lgkmcnt(8)
v_mfma_f32_16x16x32_bf16 v[56:59], a[224:227], a[132:135], v[56:59]
ds_read_b64_tr_b16 a[220:221], v231 offset:16384
v_mfma_f32_16x16x32_bf16 v[64:67], a[224:227], a[136:139], v[64:67]
ds_read_b64_tr_b16 a[222:223], v231 offset:18432
v_mfma_f32_16x16x32_bf16 v[72:75], a[224:227], a[140:143], v[72:75]
s_waitcnt lgkmcnt(8)
v_mfma_f32_16x16x32_bf16 v[76:79], a[228:231], a[140:143], v[76:79]
ds_read_b64_tr_b16 a[224:225], v224 offset:16640
v_mfma_f32_16x16x32_bf16 v[68:71], a[228:231], a[136:139], v[68:71]
ds_read_b64_tr_b16 a[226:227], v224 offset:18688
v_mfma_f32_16x16x32_bf16 v[60:63], a[228:231], a[132:135], v[60:63]
s_waitcnt lgkmcnt(8)
v_mfma_f32_16x16x32_bf16 v[80:83], a[208:211], a[132:135], v[80:83]
ds_read_b64_tr_b16 a[228:229], v225 offset:16640
v_mfma_f32_16x16x32_bf16 v[88:91], a[208:211], a[136:139], v[88:91]
ds_read_b64_tr_b16 a[230:231], v225 offset:18688
v_mfma_f32_16x16x32_bf16 v[96:99], a[208:211], a[140:143], v[96:99]
s_waitcnt lgkmcnt(8)
v_mfma_f32_16x16x32_bf16 v[100:103], a[212:215], a[140:143], v[100:103]
ds_read_b64_tr_b16 a[208:209], v226 offset:16640
v_mfma_f32_16x16x32_bf16 v[92:95], a[212:215], a[136:139], v[92:95]
ds_read_b64_tr_b16 a[210:211], v226 offset:18688
v_mfma_f32_16x16x32_bf16 v[84:87], a[212:215], a[132:135], v[84:87]
s_waitcnt lgkmcnt(8)
v_mfma_f32_16x16x32_bf16 v[104:107], a[216:219], a[132:135], v[104:107]
ds_read_b64_tr_b16 a[212:213], v227 offset:16640
v_mfma_f32_16x16x32_bf16 v[112:115], a[216:219], a[136:139], v[112:115]
ds_read_b64_tr_b16 a[214:215], v227 offset:18688
v_mfma_f32_16x16x32_bf16 v[120:123], a[216:219], a[140:143], v[120:123]
s_waitcnt lgkmcnt(8)
v_mfma_f32_16x16x32_bf16 v[124:127], a[220:223], a[140:143], v[124:127]
ds_read_b64_tr_b16 a[216:217], v228 offset:16640
v_mfma_f32_16x16x32_bf16 v[116:119], a[220:223], a[136:139], v[116:119]
ds_read_b64_tr_b16 a[218:219], v228 offset:18688
v_mfma_f32_16x16x32_bf16 v[108:111], a[220:223], a[132:135], v[108:111]
s_waitcnt lgkmcnt(8)
v_mfma_f32_16x16x32_bf16 v[128:131], a[224:227], a[132:135], v[128:131]
ds_read_b64_tr_b16 a[220:221], v229 offset:16640
v_mfma_f32_16x16x32_bf16 v[136:139], a[224:227], a[136:139], v[136:139]
ds_read_b64_tr_b16 a[222:223], v229 offset:18688
v_mfma_f32_16x16x32_bf16 v[144:147], a[224:227], a[140:143], v[144:147]
s_waitcnt lgkmcnt(8)
v_mfma_f32_16x16x32_bf16 v[148:151], a[228:231], a[140:143], v[148:151]
ds_read_b64_tr_b16 a[224:225], v230 offset:16640
v_mfma_f32_16x16x32_bf16 v[140:143], a[228:231], a[136:139], v[140:143]
ds_read_b64_tr_b16 a[226:227], v230 offset:18688
v_mfma_f32_16x16x32_bf16 v[132:135], a[228:231], a[132:135], v[132:135]
s_waitcnt lgkmcnt(8)
v_mfma_f32_16x16x32_bf16 v[152:155], a[208:211], a[132:135], v[152:155]
ds_read_b64_tr_b16 a[228:229], v231 offset:16640
v_mfma_f32_16x16x32_bf16 v[160:163], a[208:211], a[136:139], v[160:163]
ds_read_b64_tr_b16 a[230:231], v231 offset:18688
v_mfma_f32_16x16x32_bf16 v[168:171], a[208:211], a[140:143], v[168:171]
s_waitcnt lgkmcnt(8)
v_mfma_f32_16x16x32_bf16 v[172:175], a[212:215], a[140:143], v[172:175]
s_waitcnt vmcnt(8)
s_barrier
v_add_u32 v224, 4294885376, v224
v_mfma_f32_16x16x32_bf16 v[164:167], a[212:215], a[136:139], v[164:167]
s_add_u32 m0, s48, 98304
ds_read_b64_tr_b16 a[208:209], v224 offset:32768
s_mov_b32 s49, 32768
v_mfma_f32_16x16x32_bf16 v[156:159], a[212:215], a[132:135], v[156:159]
s_waitcnt lgkmcnt(7)
ds_read_b64_tr_b16 a[210:211], v224 offset:34816
v_mfma_f32_16x16x32_bf16 v[176:179], a[216:219], a[132:135], v[176:179]
buffer_load_dwordx4 v16, s[28:31], s49 offen nt lds
v_mfma_f32_16x16x32_bf16 v[184:187], a[216:219], a[136:139], v[184:187]
v_add_u32 v225, 4294885376, v225
v_mfma_f32_16x16x32_bf16 v[192:195], a[216:219], a[140:143], v[192:195]
s_waitcnt lgkmcnt(6)
ds_read_b64_tr_b16 a[212:213], v225 offset:32768
v_mfma_f32_16x16x32_bf16 v[196:199], a[220:223], a[140:143], v[196:199]
ds_read_b64_tr_b16 a[214:215], v225 offset:34816
v_add_u32 v226, 4294885376, v226
v_mfma_f32_16x16x32_bf16 v[188:191], a[220:223], a[136:139], v[188:191]
ds_read_b64_tr_b16 a[216:217], v226 offset:32768
v_mfma_f32_16x16x32_bf16 v[180:183], a[220:223], a[132:135], v[180:183]
s_waitcnt lgkmcnt(7)
ds_read_b64_tr_b16 a[218:219], v226 offset:34816
v_mfma_f32_16x16x32_bf16 v[200:203], a[224:227], a[132:135], v[200:203]
buffer_load_dwordx4 v17, s[28:31], s49 offen offset:1024 nt lds
v_mfma_f32_16x16x32_bf16 v[208:211], a[224:227], a[136:139], v[208:211]
v_add_u32 v227, 4294885376, v227
v_mfma_f32_16x16x32_bf16 v[216:219], a[224:227], a[140:143], v[216:219]
s_waitcnt lgkmcnt(6)
ds_read_b64_tr_b16 a[220:221], v227 offset:32768
v_mfma_f32_16x16x32_bf16 v[220:223], a[228:231], a[140:143], v[220:223]
ds_read_b64_tr_b16 a[222:223], v227 offset:34816
v_add_u32 v228, 4294885376, v228
v_mfma_f32_16x16x32_bf16 v[212:215], a[228:231], a[136:139], v[212:215]
ds_read_b64_tr_b16 a[224:225], v228 offset:32768
v_mfma_f32_16x16x32_bf16 v[204:207], a[228:231], a[132:135], v[204:207]
s_waitcnt lgkmcnt(7)
ds_read_b64_tr_b16 a[226:227], v228 offset:34816
v_mfma_f32_16x16x32_bf16 v[32:35], a[208:211], a[144:147], v[32:35]
buffer_load_dwordx4 v18, s[28:31], s49 offen offset:2048 nt lds
v_mfma_f32_16x16x32_bf16 v[40:43], a[208:211], a[148:151], v[40:43]
v_add_u32 v229, 4294885376, v229
v_mfma_f32_16x16x32_bf16 v[48:51], a[208:211], a[152:155], v[48:51]
s_waitcnt lgkmcnt(6)
ds_read_b64_tr_b16 a[228:229], v229 offset:32768
v_mfma_f32_16x16x32_bf16 v[52:55], a[212:215], a[152:155], v[52:55]
ds_read_b64_tr_b16 a[230:231], v229 offset:34816
v_add_u32 v230, 4294885376, v230
v_mfma_f32_16x16x32_bf16 v[44:47], a[212:215], a[148:151], v[44:47]
ds_read_b64_tr_b16 a[208:209], v230 offset:32768
v_mfma_f32_16x16x32_bf16 v[36:39], a[212:215], a[144:147], v[36:39]
s_waitcnt lgkmcnt(7)
ds_read_b64_tr_b16 a[210:211], v230 offset:34816
v_mfma_f32_16x16x32_bf16 v[56:59], a[216:219], a[144:147], v[56:59]
buffer_load_dwordx4 v19, s[28:31], s49 offen offset:3072 nt lds
v_mfma_f32_16x16x32_bf16 v[64:67], a[216:219], a[148:151], v[64:67]
v_add_u32 v231, 4294885376, v231
v_mfma_f32_16x16x32_bf16 v[72:75], a[216:219], a[152:155], v[72:75]
s_waitcnt lgkmcnt(6)
ds_read_b64_tr_b16 a[212:213], v231 offset:32768
v_mfma_f32_16x16x32_bf16 v[76:79], a[220:223], a[152:155], v[76:79]
ds_read_b64_tr_b16 a[214:215], v231 offset:34816
ds_read_b64_tr_b16 a[216:217], v224 offset:33024
v_mfma_f32_16x16x32_bf16 v[68:71], a[220:223], a[148:151], v[68:71]
ds_read_b64_tr_b16 a[218:219], v224 offset:35072
v_mfma_f32_16x16x32_bf16 v[60:63], a[220:223], a[144:147], v[60:63]
s_waitcnt lgkmcnt(8)
v_mfma_f32_16x16x32_bf16 v[80:83], a[224:227], a[144:147], v[80:83]
ds_read_b64_tr_b16 a[220:221], v225 offset:33024
v_mfma_f32_16x16x32_bf16 v[88:91], a[224:227], a[148:151], v[88:91]
ds_read_b64_tr_b16 a[222:223], v225 offset:35072
v_mfma_f32_16x16x32_bf16 v[96:99], a[224:227], a[152:155], v[96:99]
s_waitcnt lgkmcnt(8)
v_mfma_f32_16x16x32_bf16 v[100:103], a[228:231], a[152:155], v[100:103]
ds_read_b64_tr_b16 a[224:225], v226 offset:33024
v_mfma_f32_16x16x32_bf16 v[92:95], a[228:231], a[148:151], v[92:95]
ds_read_b64_tr_b16 a[226:227], v226 offset:35072
v_mfma_f32_16x16x32_bf16 v[84:87], a[228:231], a[144:147], v[84:87]
s_waitcnt lgkmcnt(8)
v_mfma_f32_16x16x32_bf16 v[104:107], a[208:211], a[144:147], v[104:107]
ds_read_b64_tr_b16 a[228:229], v227 offset:33024
v_mfma_f32_16x16x32_bf16 v[112:115], a[208:211], a[148:151], v[112:115]
ds_read_b64_tr_b16 a[230:231], v227 offset:35072
v_mfma_f32_16x16x32_bf16 v[120:123], a[208:211], a[152:155], v[120:123]
s_waitcnt lgkmcnt(8)
v_mfma_f32_16x16x32_bf16 v[124:127], a[212:215], a[152:155], v[124:127]
ds_read_b64_tr_b16 a[208:209], v228 offset:33024
v_mfma_f32_16x16x32_bf16 v[116:119], a[212:215], a[148:151], v[116:119]
ds_read_b64_tr_b16 a[210:211], v228 offset:35072
v_mfma_f32_16x16x32_bf16 v[108:111], a[212:215], a[144:147], v[108:111]
s_waitcnt lgkmcnt(8)
v_mfma_f32_16x16x32_bf16 v[128:131], a[216:219], a[144:147], v[128:131]
ds_read_b64_tr_b16 a[212:213], v229 offset:33024
v_mfma_f32_16x16x32_bf16 v[136:139], a[216:219], a[148:151], v[136:139]
ds_read_b64_tr_b16 a[214:215], v229 offset:35072
v_mfma_f32_16x16x32_bf16 v[144:147], a[216:219], a[152:155], v[144:147]
s_waitcnt lgkmcnt(8)
v_mfma_f32_16x16x32_bf16 v[148:151], a[220:223], a[152:155], v[148:151]
ds_read_b64_tr_b16 a[216:217], v230 offset:33024
v_mfma_f32_16x16x32_bf16 v[140:143], a[220:223], a[148:151], v[140:143]
ds_read_b64_tr_b16 a[218:219], v230 offset:35072
v_mfma_f32_16x16x32_bf16 v[132:135], a[220:223], a[144:147], v[132:135]
s_waitcnt lgkmcnt(8)
v_mfma_f32_16x16x32_bf16 v[152:155], a[224:227], a[144:147], v[152:155]
ds_read_b64_tr_b16 a[220:221], v231 offset:33024
v_mfma_f32_16x16x32_bf16 v[160:163], a[224:227], a[148:151], v[160:163]
ds_read_b64_tr_b16 a[222:223], v231 offset:35072
v_mfma_f32_16x16x32_bf16 v[168:171], a[224:227], a[152:155], v[168:171]
s_waitcnt lgkmcnt(8)
v_mfma_f32_16x16x32_bf16 v[172:175], a[228:231], a[152:155], v[172:175]
s_waitcnt vmcnt(4)
s_barrier
ds_read_b64_tr_b16 a[224:225], v224 offset:0
v_mfma_f32_16x16x32_bf16 v[164:167], a[228:231], a[148:151], v[164:167]
s_add_u32 m0, s48, 114688
ds_read_b64_tr_b16 a[226:227], v224 offset:2048
s_mov_b32 s49, 65536
v_mfma_f32_16x16x32_bf16 v[156:159], a[228:231], a[144:147], v[156:159]
s_waitcnt lgkmcnt(8)
buffer_load_dwordx4 v16, s[24:27], s49 offen nt lds
v_mfma_f32_16x16x32_bf16 v[176:179], a[208:211], a[144:147], v[176:179]
ds_read_b64_tr_b16 a[228:229], v225 offset:0
v_mfma_f32_16x16x32_bf16 v[184:187], a[208:211], a[148:151], v[184:187]
ds_read_b64_tr_b16 a[230:231], v225 offset:2048
v_mfma_f32_16x16x32_bf16 v[192:195], a[208:211], a[152:155], v[192:195]
s_waitcnt lgkmcnt(8)
buffer_load_dwordx4 v17, s[24:27], s49 offen offset:1024 nt lds
v_mfma_f32_16x16x32_bf16 v[196:199], a[212:215], a[152:155], v[196:199]
ds_read_b64_tr_b16 a[208:209], v226 offset:0
v_mfma_f32_16x16x32_bf16 v[188:191], a[212:215], a[148:151], v[188:191]
ds_read_b64_tr_b16 a[210:211], v226 offset:2048
v_mfma_f32_16x16x32_bf16 v[180:183], a[212:215], a[144:147], v[180:183]
s_waitcnt lgkmcnt(8)
v_mfma_f32_16x16x32_bf16 v[200:203], a[216:219], a[144:147], v[200:203]
ds_read_b64_tr_b16 a[212:213], v227 offset:0
v_mfma_f32_16x16x32_bf16 v[208:211], a[216:219], a[148:151], v[208:211]
ds_read_b64_tr_b16 a[214:215], v227 offset:2048
v_mfma_f32_16x16x32_bf16 v[216:219], a[216:219], a[152:155], v[216:219]
s_waitcnt lgkmcnt(8)
buffer_load_dwordx4 v18, s[24:27], s49 offen offset:2048 nt lds
v_mfma_f32_16x16x32_bf16 v[220:223], a[220:223], a[152:155], v[220:223]
ds_read_b64_tr_b16 a[216:217], v228 offset:0
v_mfma_f32_16x16x32_bf16 v[212:215], a[220:223], a[148:151], v[212:215]
ds_read_b64_tr_b16 a[218:219], v228 offset:2048
v_mfma_f32_16x16x32_bf16 v[204:207], a[220:223], a[144:147], v[204:207]
s_waitcnt lgkmcnt(8)
buffer_load_dwordx4 v19, s[24:27], s49 offen offset:3072 nt lds
v_mfma_f32_16x16x32_bf16 v[32:35], a[224:227], a[156:159], v[32:35]
ds_read_b64_tr_b16 a[220:221], v229 offset:0
v_mfma_f32_16x16x32_bf16 v[40:43], a[224:227], a[160:163], v[40:43]
ds_read_b64_tr_b16 a[222:223], v229 offset:2048
v_mfma_f32_16x16x32_bf16 v[48:51], a[224:227], a[164:167], v[48:51]
s_waitcnt lgkmcnt(8)
v_mfma_f32_16x16x32_bf16 v[52:55], a[228:231], a[164:167], v[52:55]
ds_read_b64_tr_b16 a[224:225], v230 offset:0
v_mfma_f32_16x16x32_bf16 v[44:47], a[228:231], a[160:163], v[44:47]
ds_read_b64_tr_b16 a[226:227], v230 offset:2048
v_mfma_f32_16x16x32_bf16 v[36:39], a[228:231], a[156:159], v[36:39]
s_waitcnt lgkmcnt(8)
v_mfma_f32_16x16x32_bf16 v[56:59], a[208:211], a[156:159], v[56:59]
ds_read_b64_tr_b16 a[228:229], v231 offset:0
v_mfma_f32_16x16x32_bf16 v[64:67], a[208:211], a[160:163], v[64:67]
ds_read_b64_tr_b16 a[230:231], v231 offset:2048
v_mfma_f32_16x16x32_bf16 v[72:75], a[208:211], a[164:167], v[72:75]
s_waitcnt lgkmcnt(8)
v_mfma_f32_16x16x32_bf16 v[76:79], a[212:215], a[164:167], v[76:79]
ds_read_b64_tr_b16 a[208:209], v224 offset:256
v_cvt_pk_bf16_f32 v32, v32, v33
v_mfma_f32_16x16x32_bf16 v[68:71], a[212:215], a[160:163], v[68:71]
ds_read_b64_tr_b16 a[210:211], v224 offset:2304
v_cvt_pk_bf16_f32 v33, v34, v35
v_mfma_f32_16x16x32_bf16 v[60:63], a[212:215], a[156:159], v[60:63]
s_waitcnt lgkmcnt(8)
v_cvt_pk_bf16_f32 v34, v36, v37
v_cvt_pk_bf16_f32 v35, v38, v39
v_mfma_f32_16x16x32_bf16 v[80:83], a[216:219], a[156:159], v[80:83]
ds_read_b64_tr_b16 a[212:213], v225 offset:256
v_cvt_pk_bf16_f32 v40, v40, v41
v_mfma_f32_16x16x32_bf16 v[88:91], a[216:219], a[160:163], v[88:91]
ds_read_b64_tr_b16 a[214:215], v225 offset:2304
v_cvt_pk_bf16_f32 v41, v42, v43
v_mfma_f32_16x16x32_bf16 v[96:99], a[216:219], a[164:167], v[96:99]
s_waitcnt lgkmcnt(8)
v_cvt_pk_bf16_f32 v42, v44, v45
v_cvt_pk_bf16_f32 v43, v46, v47
v_mfma_f32_16x16x32_bf16 v[100:103], a[220:223], a[164:167], v[100:103]
ds_read_b64_tr_b16 a[216:217], v226 offset:256
v_cvt_pk_bf16_f32 v48, v48, v49
v_mfma_f32_16x16x32_bf16 v[92:95], a[220:223], a[160:163], v[92:95]
ds_read_b64_tr_b16 a[218:219], v226 offset:2304
v_cvt_pk_bf16_f32 v49, v50, v51
v_mfma_f32_16x16x32_bf16 v[84:87], a[220:223], a[156:159], v[84:87]
s_waitcnt lgkmcnt(8)
v_cvt_pk_bf16_f32 v50, v52, v53
v_cvt_pk_bf16_f32 v51, v54, v55
v_mfma_f32_16x16x32_bf16 v[104:107], a[224:227], a[156:159], v[104:107]
ds_read_b64_tr_b16 a[220:221], v227 offset:256
v_cvt_pk_bf16_f32 v56, v56, v57
v_mfma_f32_16x16x32_bf16 v[112:115], a[224:227], a[160:163], v[112:115]
ds_read_b64_tr_b16 a[222:223], v227 offset:2304
v_cvt_pk_bf16_f32 v57, v58, v59
v_mfma_f32_16x16x32_bf16 v[120:123], a[224:227], a[164:167], v[120:123]
s_waitcnt lgkmcnt(8)
v_permlane32_swap_b32 v32, v34
v_mfma_f32_16x16x32_bf16 v[124:127], a[228:231], a[164:167], v[124:127]
ds_read_b64_tr_b16 a[224:225], v228 offset:256
v_cvt_pk_bf16_f32 v58, v60, v61
v_mfma_f32_16x16x32_bf16 v[116:119], a[228:231], a[160:163], v[116:119]
ds_read_b64_tr_b16 a[226:227], v228 offset:2304
v_cvt_pk_bf16_f32 v59, v62, v63
v_mfma_f32_16x16x32_bf16 v[108:111], a[228:231], a[156:159], v[108:111]
s_waitcnt lgkmcnt(8)
v_permlane32_swap_b32 v33, v35
v_mfma_f32_16x16x32_bf16 v[128:131], a[208:211], a[156:159], v[128:131]
ds_read_b64_tr_b16 a[228:229], v229 offset:256
v_cvt_pk_bf16_f32 v64, v64, v65
v_mfma_f32_16x16x32_bf16 v[136:139], a[208:211], a[160:163], v[136:139]
ds_read_b64_tr_b16 a[230:231], v229 offset:2304
v_cvt_pk_bf16_f32 v65, v66, v67
v_mfma_f32_16x16x32_bf16 v[144:147], a[208:211], a[164:167], v[144:147]
s_waitcnt lgkmcnt(8)
v_permlane32_swap_b32 v40, v42
v_mfma_f32_16x16x32_bf16 v[148:151], a[212:215], a[164:167], v[148:151]
ds_read_b64_tr_b16 a[208:209], v230 offset:256
v_cvt_pk_bf16_f32 v66, v68, v69
v_mfma_f32_16x16x32_bf16 v[140:143], a[212:215], a[160:163], v[140:143]
ds_read_b64_tr_b16 a[210:211], v230 offset:2304
v_cvt_pk_bf16_f32 v67, v70, v71
v_mfma_f32_16x16x32_bf16 v[132:135], a[212:215], a[156:159], v[132:135]
s_waitcnt lgkmcnt(8)
v_permlane32_swap_b32 v41, v43
v_mfma_f32_16x16x32_bf16 v[152:155], a[216:219], a[156:159], v[152:155]
ds_read_b64_tr_b16 a[212:213], v231 offset:256
v_cvt_pk_bf16_f32 v72, v72, v73
v_mfma_f32_16x16x32_bf16 v[160:163], a[216:219], a[160:163], v[160:163]
ds_read_b64_tr_b16 a[214:215], v231 offset:2304
v_cvt_pk_bf16_f32 v73, v74, v75
v_mfma_f32_16x16x32_bf16 v[168:171], a[216:219], a[164:167], v[168:171]
s_waitcnt lgkmcnt(8)
v_permlane32_swap_b32 v48, v50
v_mfma_f32_16x16x32_bf16 v[172:175], a[220:223], a[164:167], v[172:175]
s_barrier
v_add_u32 v4, 98304, v4
v_mfma_f32_16x16x32_bf16 v[164:167], a[220:223], a[160:163], v[164:167]
s_add_u32 m0, s48, 49152
ds_read_b128 a[216:219], v4 offset:49152
s_mov_b32 s49, 49152
v_mfma_f32_16x16x32_bf16 v[156:159], a[220:223], a[156:159], v[156:159]
s_waitcnt lgkmcnt(7)
buffer_load_dwordx4 v16, s[28:31], s49 offen nt lds
v_mfma_f32_16x16x32_bf16 v[176:179], a[224:227], a[156:159], v[176:179]
ds_read_b128 a[220:223], v4 offset:57344
v_cvt_pk_bf16_f32 v74, v76, v77
v_mfma_f32_16x16x32_bf16 v[184:187], a[224:227], a[160:163], v[184:187]
v_permlane32_swap_b32 v49, v51
v_mfma_f32_16x16x32_bf16 v[192:195], a[224:227], a[164:167], v[192:195]
s_waitcnt lgkmcnt(6)
buffer_load_dwordx4 v17, s[28:31], s49 offen offset:1024 nt lds
v_mfma_f32_16x16x32_bf16 v[196:199], a[228:231], a[164:167], v[196:199]
v_add_u32 v5, 98304, v5
v_cvt_pk_bf16_f32 v75, v78, v79
v_mfma_f32_16x16x32_bf16 v[188:191], a[228:231], a[160:163], v[188:191]
ds_read_b128 a[224:227], v5 offset:49152
v_cvt_pk_bf16_f32 v80, v80, v81
v_mfma_f32_16x16x32_bf16 v[180:183], a[228:231], a[156:159], v[180:183]
s_waitcnt lgkmcnt(5)
v_permlane16_swap_b32 v32, v34
v_mfma_f32_16x16x32_bf16 v[200:203], a[208:211], a[156:159], v[200:203]
ds_read_b128 a[228:231], v5 offset:57344
v_cvt_pk_bf16_f32 v81, v82, v83
v_mfma_f32_16x16x32_bf16 v[208:211], a[208:211], a[160:163], v[208:211]
v_permlane16_swap_b32 v33, v35
v_mfma_f32_16x16x32_bf16 v[216:219], a[208:211], a[164:167], v[216:219]
s_waitcnt lgkmcnt(4)
buffer_load_dwordx4 v18, s[28:31], s49 offen offset:2048 nt lds
v_mfma_f32_16x16x32_bf16 v[220:223], a[212:215], a[164:167], v[220:223]
v_add_u32 v6, 98304, v6
v_cvt_pk_bf16_f32 v82, v84, v85
v_mfma_f32_16x16x32_bf16 v[212:215], a[212:215], a[160:163], v[212:215]
ds_read_b128 a[208:211], v6 offset:49152
v_cvt_pk_bf16_f32 v83, v86, v87
v_mfma_f32_16x16x32_bf16 v[204:207], a[212:215], a[156:159], v[204:207]
s_waitcnt lgkmcnt(4)
buffer_load_dwordx4 v19, s[28:31], s49 offen offset:3072 nt lds
v_permlane16_swap_b32 v40, v42
v_permlane16_swap_b32 v41, v43
v_permlane16_swap_b32 v48, v50
v_permlane16_swap_b32 v49, v51
v_mfma_f32_16x16x32_bf16 v[36:39], a[216:219], v[32:35], 0
ds_read_b128 a[212:215], v6 offset:57344
v_cvt_pk_bf16_f32 v88, v88, v89
v_mfma_f32_16x16x32_bf16 v[44:47], a[216:219], v[40:43], 0
v_permlane32_swap_b32 v56, v58
v_mfma_f32_16x16x32_bf16 v[52:55], a[216:219], v[48:51], 0
s_waitcnt lgkmcnt(4)
v_permlane32_swap_b32 v57, v59
v_permlane32_swap_b32 v64, v66
v_permlane32_swap_b32 v65, v67
v_permlane32_swap_b32 v72, v74
v_permlane32_swap_b32 v73, v75
v_permlane16_swap_b32 v56, v58
v_permlane16_swap_b32 v57, v59
v_permlane16_swap_b32 v64, v66
v_permlane16_swap_b32 v65, v67
v_permlane16_swap_b32 v72, v74
v_permlane16_swap_b32 v73, v75
v_mfma_f32_16x16x32_bf16 v[76:79], a[220:223], v[48:51], 0
v_add_u32 v7, 98304, v7
v_cvt_pk_bf16_f32 v89, v90, v91
v_mfma_f32_16x16x32_bf16 v[68:71], a[220:223], v[40:43], 0
ds_read_b128 a[216:219], v7 offset:49152
v_cvt_pk_bf16_f32 v90, v92, v93
v_mfma_f32_16x16x32_bf16 v[60:63], a[220:223], v[32:35], 0
s_waitcnt lgkmcnt(4)
v_cvt_pk_bf16_f32 v91, v94, v95
v_cvt_pk_bf16_f32 v96, v96, v97
v_mfma_f32_16x16x32_bf16 v[36:39], a[224:227], v[56:59], v[36:39]
ds_read_b128 a[220:223], v7 offset:57344
v_cvt_pk_bf16_f32 v97, v98, v99
v_mfma_f32_16x16x32_bf16 v[44:47], a[224:227], v[64:67], v[44:47]
v_cvt_pk_bf16_f32 v98, v100, v101
v_cvt_pk_bf16_f32 v99, v102, v103
v_mfma_f32_16x16x32_bf16 v[52:55], a[224:227], v[72:75], v[52:55]
s_waitcnt lgkmcnt(4)
v_permlane32_swap_b32 v80, v82
v_permlane32_swap_b32 v81, v83
v_permlane32_swap_b32 v88, v90
v_permlane32_swap_b32 v89, v91
v_permlane32_swap_b32 v96, v98
v_permlane32_swap_b32 v97, v99
v_permlane16_swap_b32 v80, v82
v_permlane16_swap_b32 v81, v83
v_permlane16_swap_b32 v88, v90
v_permlane16_swap_b32 v89, v91
v_permlane16_swap_b32 v96, v98
v_permlane16_swap_b32 v97, v99
v_mfma_f32_16x16x32_bf16 v[76:79], a[228:231], v[72:75], v[76:79]
ds_read_b128 a[224:227], v4 offset:49408
v_cvt_pk_bf16_f32 v104, v104, v105
v_mfma_f32_16x16x32_bf16 v[68:71], a[228:231], v[64:67], v[68:71]
v_cvt_pk_bf16_f32 v105, v106, v107
v_cvt_pk_bf16_f32 v106, v108, v109
v_mfma_f32_16x16x32_bf16 v[60:63], a[228:231], v[56:59], v[60:63]
s_waitcnt lgkmcnt(4)
v_cvt_pk_bf16_f32 v107, v110, v111
v_cvt_pk_bf16_f32 v112, v112, v113
v_mfma_f32_16x16x32_bf16 v[36:39], a[208:211], v[80:83], v[36:39]
ds_read_b128 a[228:231], v4 offset:57600
v_cvt_pk_bf16_f32 v113, v114, v115
v_mfma_f32_16x16x32_bf16 v[44:47], a[208:211], v[88:91], v[44:47]
v_cvt_pk_bf16_f32 v114, v116, v117
v_cvt_pk_bf16_f32 v115, v118, v119
v_mfma_f32_16x16x32_bf16 v[52:55], a[208:211], v[96:99], v[52:55]
s_waitcnt lgkmcnt(4)
v_cvt_pk_bf16_f32 v120, v120, v121
v_cvt_pk_bf16_f32 v121, v122, v123
v_cvt_pk_bf16_f32 v122, v124, v125
v_cvt_pk_bf16_f32 v123, v126, v127
v_permlane32_swap_b32 v104, v106
v_permlane32_swap_b32 v105, v107
v_permlane32_swap_b32 v112, v114
v_permlane32_swap_b32 v113, v115
v_permlane32_swap_b32 v120, v122
v_permlane32_swap_b32 v121, v123
v_permlane16_swap_b32 v104, v106
v_permlane16_swap_b32 v105, v107
v_permlane16_swap_b32 v112, v114
v_permlane16_swap_b32 v113, v115
v_permlane16_swap_b32 v120, v122
v_permlane16_swap_b32 v121, v123
v_mfma_f32_16x16x32_bf16 v[76:79], a[212:215], v[96:99], v[76:79]
ds_read_b128 a[208:211], v5 offset:49408
v_cvt_pk_bf16_f32 v128, v128, v129
v_mfma_f32_16x16x32_bf16 v[68:71], a[212:215], v[88:91], v[68:71]
v_cvt_pk_bf16_f32 v129, v130, v131
v_cvt_pk_bf16_f32 v130, v132, v133
v_mfma_f32_16x16x32_bf16 v[60:63], a[212:215], v[80:83], v[60:63]
s_waitcnt lgkmcnt(4)
v_cvt_pk_bf16_f32 v131, v134, v135
v_cvt_pk_bf16_f32 v136, v136, v137
v_mfma_f32_16x16x32_bf16 v[36:39], a[216:219], v[104:107], v[36:39]
ds_read_b128 a[212:215], v5 offset:57600
v_cvt_pk_bf16_f32 v137, v138, v139
v_mfma_f32_16x16x32_bf16 v[44:47], a[216:219], v[112:115], v[44:47]
v_cvt_pk_bf16_f32 v138, v140, v141
v_cvt_pk_bf16_f32 v139, v142, v143
v_mfma_f32_16x16x32_bf16 v[52:55], a[216:219], v[120:123], v[52:55]
s_waitcnt lgkmcnt(4)
v_cvt_pk_bf16_f32 v144, v144, v145
v_cvt_pk_bf16_f32 v145, v146, v147
v_cvt_pk_bf16_f32 v146, v148, v149
v_cvt_pk_bf16_f32 v147, v150, v151
v_permlane32_swap_b32 v128, v130
v_permlane32_swap_b32 v129, v131
v_permlane32_swap_b32 v136, v138
v_permlane32_swap_b32 v137, v139
v_permlane32_swap_b32 v144, v146
v_permlane32_swap_b32 v145, v147
v_permlane16_swap_b32 v128, v130
v_permlane16_swap_b32 v129, v131
v_permlane16_swap_b32 v136, v138
v_permlane16_swap_b32 v137, v139
v_permlane16_swap_b32 v144, v146
v_permlane16_swap_b32 v145, v147
v_mfma_f32_16x16x32_bf16 v[76:79], a[220:223], v[120:123], v[76:79]
ds_read_b128 a[216:219], v6 offset:49408
v_cvt_pk_bf16_f32 v152, v152, v153
v_mfma_f32_16x16x32_bf16 v[68:71], a[220:223], v[112:115], v[68:71]
v_cvt_pk_bf16_f32 v153, v154, v155
v_cvt_pk_bf16_f32 v154, v156, v157
v_mfma_f32_16x16x32_bf16 v[60:63], a[220:223], v[104:107], v[60:63]
s_waitcnt lgkmcnt(4)
v_cvt_pk_bf16_f32 v155, v158, v159
v_cvt_pk_bf16_f32 v160, v160, v161
v_mfma_f32_16x16x32_bf16 v[36:39], a[224:227], v[128:131], v[36:39]
ds_read_b128 a[220:223], v6 offset:57600
v_cvt_pk_bf16_f32 v161, v162, v163
v_mfma_f32_16x16x32_bf16 v[44:47], a[224:227], v[136:139], v[44:47]
v_cvt_pk_bf16_f32 v162, v164, v165
v_cvt_pk_bf16_f32 v163, v166, v167
v_mfma_f32_16x16x32_bf16 v[52:55], a[224:227], v[144:147], v[52:55]
s_waitcnt lgkmcnt(4)
v_cvt_pk_bf16_f32 v168, v168, v169
v_cvt_pk_bf16_f32 v169, v170, v171
v_cvt_pk_bf16_f32 v170, v172, v173
v_cvt_pk_bf16_f32 v171, v174, v175
v_permlane32_swap_b32 v152, v154
v_permlane32_swap_b32 v153, v155
v_permlane32_swap_b32 v160, v162
v_permlane32_swap_b32 v161, v163
v_permlane32_swap_b32 v168, v170
v_permlane32_swap_b32 v169, v171
v_permlane16_swap_b32 v152, v154
v_permlane16_swap_b32 v153, v155
v_permlane16_swap_b32 v160, v162
v_permlane16_swap_b32 v161, v163
v_permlane16_swap_b32 v168, v170
v_permlane16_swap_b32 v169, v171
v_mfma_f32_16x16x32_bf16 v[76:79], a[228:231], v[144:147], v[76:79]
ds_read_b128 a[224:227], v7 offset:49408
v_cvt_pk_bf16_f32 v176, v176, v177
v_mfma_f32_16x16x32_bf16 v[68:71], a[228:231], v[136:139], v[68:71]
v_cvt_pk_bf16_f32 v177, v178, v179
v_cvt_pk_bf16_f32 v178, v180, v181
v_mfma_f32_16x16x32_bf16 v[60:63], a[228:231], v[128:131], v[60:63]
s_waitcnt lgkmcnt(4)
v_cvt_pk_bf16_f32 v179, v182, v183
v_cvt_pk_bf16_f32 v184, v184, v185
v_mfma_f32_16x16x32_bf16 v[36:39], a[208:211], v[152:155], v[36:39]
ds_read_b128 a[228:231], v7 offset:57600
v_cvt_pk_bf16_f32 v185, v186, v187
v_mfma_f32_16x16x32_bf16 v[44:47], a[208:211], v[160:163], v[44:47]
v_cvt_pk_bf16_f32 v186, v188, v189
v_cvt_pk_bf16_f32 v187, v190, v191
v_mfma_f32_16x16x32_bf16 v[52:55], a[208:211], v[168:171], v[52:55]
s_waitcnt lgkmcnt(4)
v_cvt_pk_bf16_f32 v192, v192, v193
v_cvt_pk_bf16_f32 v193, v194, v195
v_cvt_pk_bf16_f32 v194, v196, v197
v_cvt_pk_bf16_f32 v195, v198, v199
v_permlane32_swap_b32 v176, v178
v_permlane32_swap_b32 v177, v179
v_permlane32_swap_b32 v184, v186
v_permlane32_swap_b32 v185, v187
v_permlane32_swap_b32 v192, v194
v_permlane32_swap_b32 v193, v195
v_permlane16_swap_b32 v176, v178
v_permlane16_swap_b32 v177, v179
v_permlane16_swap_b32 v184, v186
v_permlane16_swap_b32 v185, v187
v_permlane16_swap_b32 v192, v194
v_permlane16_swap_b32 v193, v195
v_mfma_f32_16x16x32_bf16 v[76:79], a[212:215], v[168:171], v[76:79]
s_barrier
v_add_u32 v4, 4294901760, v4
v_mfma_f32_16x16x32_bf16 v[68:71], a[212:215], v[160:163], v[68:71]
s_add_u32 m0, s48, 16384
ds_read_b128 a[208:211], v4 offset:32768
s_mov_b32 s49, 81920
v_mfma_f32_16x16x32_bf16 v[60:63], a[212:215], v[152:155], v[60:63]
s_waitcnt lgkmcnt(4)
buffer_load_dwordx4 v16, s[24:27], s49 offen nt lds
v_mfma_f32_16x16x32_bf16 v[36:39], a[216:219], v[176:179], v[36:39]
ds_read_b128 a[212:215], v4 offset:40960
v_cvt_pk_bf16_f32 v200, v200, v201
v_mfma_f32_16x16x32_bf16 v[44:47], a[216:219], v[184:187], v[44:47]
v_cvt_pk_bf16_f32 v201, v202, v203
v_cvt_pk_bf16_f32 v202, v204, v205
v_mfma_f32_16x16x32_bf16 v[52:55], a[216:219], v[192:195], v[52:55]
s_waitcnt lgkmcnt(4)
buffer_load_dwordx4 v17, s[24:27], s49 offen offset:1024 nt lds
v_cvt_pk_bf16_f32 v203, v206, v207
v_cvt_pk_bf16_f32 v208, v208, v209
v_cvt_pk_bf16_f32 v209, v210, v211
v_cvt_pk_bf16_f32 v210, v212, v213
v_cvt_pk_bf16_f32 v211, v214, v215
v_cvt_pk_bf16_f32 v216, v216, v217
v_cvt_pk_bf16_f32 v217, v218, v219
v_cvt_pk_bf16_f32 v218, v220, v221
v_cvt_pk_bf16_f32 v219, v222, v223
v_permlane32_swap_b32 v200, v202
v_permlane32_swap_b32 v201, v203
v_permlane32_swap_b32 v208, v210
v_permlane32_swap_b32 v209, v211
v_permlane32_swap_b32 v216, v218
v_permlane32_swap_b32 v217, v219
v_permlane16_swap_b32 v200, v202
v_permlane16_swap_b32 v201, v203
v_permlane16_swap_b32 v208, v210
v_permlane16_swap_b32 v209, v211
v_permlane16_swap_b32 v216, v218
v_permlane16_swap_b32 v217, v219
v_mfma_f32_16x16x32_bf16 v[76:79], a[220:223], v[192:195], v[76:79]
v_add_u32 v5, 4294901760, v5
v_mfma_f32_16x16x32_bf16 v[68:71], a[220:223], v[184:187], v[68:71]
ds_read_b128 a[216:219], v5 offset:32768
v_mfma_f32_16x16x32_bf16 v[60:63], a[220:223], v[176:179], v[60:63]
s_waitcnt lgkmcnt(4)
v_mfma_f32_16x16x32_bf16 v[36:39], a[224:227], v[200:203], v[36:39]
ds_read_b128 a[220:223], v5 offset:40960
v_mfma_f32_16x16x32_bf16 v[44:47], a[224:227], v[208:211], v[44:47]
v_mfma_f32_16x16x32_bf16 v[52:55], a[224:227], v[216:219], v[52:55]
s_waitcnt lgkmcnt(4)
buffer_load_dwordx4 v18, s[24:27], s49 offen offset:2048 nt lds
v_mfma_f32_16x16x32_bf16 v[76:79], a[228:231], v[216:219], v[76:79]
v_add_u32 v6, 4294901760, v6
v_mfma_f32_16x16x32_bf16 v[68:71], a[228:231], v[208:211], v[68:71]
ds_read_b128 a[224:227], v6 offset:32768
v_mfma_f32_16x16x32_bf16 v[60:63], a[228:231], v[200:203], v[60:63]
s_waitcnt lgkmcnt(4)
buffer_load_dwordx4 v19, s[24:27], s49 offen offset:3072 nt lds
v_mfma_f32_16x16x32_bf16 v[84:87], a[208:211], v[32:35], 0
ds_read_b128 a[228:231], v6 offset:40960
v_mfma_f32_16x16x32_bf16 v[92:95], a[208:211], v[40:43], 0
v_mfma_f32_16x16x32_bf16 v[100:103], a[208:211], v[48:51], 0
s_waitcnt lgkmcnt(4)
v_mfma_f32_16x16x32_bf16 v[124:127], a[212:215], v[48:51], 0
v_add_u32 v7, 4294901760, v7
v_max3_f32 v156, v36, v37, v38
v_mfma_f32_16x16x32_bf16 v[116:119], a[212:215], v[40:43], 0
ds_read_b128 a[208:211], v7 offset:32768
v_max3_f32 v157, v44, v45, v46
v_mfma_f32_16x16x32_bf16 v[108:111], a[212:215], v[32:35], 0
s_waitcnt lgkmcnt(4)
v_max3_f32 v158, v52, v53, v54
v_max3_f32 v156, v156, v39, v60
v_mfma_f32_16x16x32_bf16 v[84:87], a[216:219], v[56:59], v[84:87]
ds_read_b128 a[212:215], v7 offset:40960
v_max3_f32 v157, v157, v47, v68
v_mfma_f32_16x16x32_bf16 v[92:95], a[216:219], v[64:67], v[92:95]
v_max3_f32 v158, v158, v55, v76
v_max3_f32 v156, v156, v61, v62
v_mfma_f32_16x16x32_bf16 v[100:103], a[216:219], v[72:75], v[100:103]
s_waitcnt lgkmcnt(4)
v_max3_f32 v157, v157, v69, v70
v_max3_f32 v158, v158, v77, v78
v_mfma_f32_16x16x32_bf16 v[124:127], a[220:223], v[72:75], v[124:127]
ds_read_b128 a[216:219], v4 offset:33024
v_max_f32 v156, v156, v63
v_mfma_f32_16x16x32_bf16 v[116:119], a[220:223], v[64:67], v[116:119]
v_max_f32 v157, v157, v71
v_max_f32 v158, v158, v79
v_mfma_f32_16x16x32_bf16 v[108:111], a[220:223], v[56:59], v[108:111]
s_waitcnt lgkmcnt(4)
v_mov_b32 v164, v156
v_mov_b32 v165, v157
v_mfma_f32_16x16x32_bf16 v[84:87], a[224:227], v[80:83], v[84:87]
ds_read_b128 a[220:223], v4 offset:41216
v_mov_b32 v166, v158
v_mfma_f32_16x16x32_bf16 v[92:95], a[224:227], v[88:91], v[92:95]
v_permlane32_swap_b32 v164, v156
v_mfma_f32_16x16x32_bf16 v[100:103], a[224:227], v[96:99], v[100:103]
s_waitcnt lgkmcnt(4)
v_permlane32_swap_b32 v165, v157
v_mfma_f32_16x16x32_bf16 v[124:127], a[228:231], v[96:99], v[124:127]
ds_read_b128 a[224:227], v5 offset:33024
v_max_f32 v156, v156, v164
v_mfma_f32_16x16x32_bf16 v[116:119], a[228:231], v[88:91], v[116:119]
v_permlane32_swap_b32 v166, v158
v_mfma_f32_16x16x32_bf16 v[108:111], a[228:231], v[80:83], v[108:111]
s_waitcnt lgkmcnt(4)
v_max_f32 v157, v157, v165
v_max_f32 v158, v158, v166
v_mfma_f32_16x16x32_bf16 v[84:87], a[208:211], v[104:107], v[84:87]
ds_read_b128 a[228:231], v5 offset:41216
v_mov_b32 v164, v156
v_mfma_f32_16x16x32_bf16 v[92:95], a[208:211], v[112:115], v[92:95]
v_mov_b32 v165, v157
v_mov_b32 v166, v158
v_mfma_f32_16x16x32_bf16 v[100:103], a[208:211], v[120:123], v[100:103]
s_waitcnt lgkmcnt(4)
v_permlane16_swap_b32 v164, v156
v_mfma_f32_16x16x32_bf16 v[124:127], a[212:215], v[120:123], v[124:127]
ds_read_b128 a[208:211], v6 offset:33024
v_max_f32 v156, v156, v164
v_mfma_f32_16x16x32_bf16 v[116:119], a[212:215], v[112:115], v[116:119]
v_permlane16_swap_b32 v165, v157
v_mfma_f32_16x16x32_bf16 v[108:111], a[212:215], v[104:107], v[108:111]
s_waitcnt lgkmcnt(4)
v_permlane16_swap_b32 v166, v158
v_mfma_f32_16x16x32_bf16 v[84:87], a[216:219], v[128:131], v[84:87]
ds_read_b128 a[212:215], v6 offset:41216
v_max_f32 v157, v157, v165
v_mfma_f32_16x16x32_bf16 v[92:95], a[216:219], v[136:139], v[92:95]
v_max_f32 v158, v158, v166
v_mov_b32 v24, v156
v_mfma_f32_16x16x32_bf16 v[100:103], a[216:219], v[144:147], v[100:103]
s_waitcnt lgkmcnt(4)
v_mul_f32 v234, s50, v156
v_mov_b32 v25, v157
v_mfma_f32_16x16x32_bf16 v[124:127], a[220:223], v[144:147], v[124:127]
ds_read_b128 a[216:219], v7 offset:33024
v_mul_f32 v235, s50, v157
v_mfma_f32_16x16x32_bf16 v[116:119], a[220:223], v[136:139], v[116:119]
v_mov_b32 v26, v158
v_mul_f32 v236, s50, v158
v_mfma_f32_16x16x32_bf16 v[108:111], a[220:223], v[128:131], v[108:111]
s_waitcnt lgkmcnt(4)
v_sub_f32 v234, 0, v234
v_sub_f32 v235, 0, v235
v_mfma_f32_16x16x32_bf16 v[84:87], a[224:227], v[152:155], v[84:87]
ds_read_b128 a[220:223], v7 offset:41216
v_sub_f32 v236, 0, v236
v_mfma_f32_16x16x32_bf16 v[92:95], a[224:227], v[160:163], v[92:95]
v_fma_f32 v36, v36, s50, v234
v_fma_f32 v37, v37, s50, v234
v_mfma_f32_16x16x32_bf16 v[100:103], a[224:227], v[168:171], v[100:103]
s_waitcnt lgkmcnt(4)
v_fma_f32 v38, v38, s50, v234
v_fma_f32 v39, v39, s50, v234
v_mfma_f32_16x16x32_bf16 v[124:127], a[228:231], v[168:171], v[124:127]
s_barrier
v_add_u32 v8, 81920, v8
v_mfma_f32_16x16x32_bf16 v[116:119], a[228:231], v[160:163], v[116:119]
s_add_u32 m0, s48, 147456
ds_read_b64_tr_b16 a[224:225], v8 offset:0
s_mov_b32 s49, 65536
v_mfma_f32_16x16x32_bf16 v[108:111], a[228:231], v[152:155], v[108:111]
s_waitcnt lgkmcnt(4)
ds_read_b64_tr_b16 a[226:227], v8 offset:8192
v_fma_f32 v60, v60, s50, v234
v_mfma_f32_16x16x32_bf16 v[84:87], a[208:211], v[176:179], v[84:87]
buffer_load_dwordx4 v16, s[28:31], s49 offen nt lds
v_mfma_f32_16x16x32_bf16 v[92:95], a[208:211], v[184:187], v[92:95]
v_add_u32 v9, 81920, v9
v_fma_f32 v61, v61, s50, v234
v_mfma_f32_16x16x32_bf16 v[100:103], a[208:211], v[192:195], v[100:103]
s_waitcnt lgkmcnt(4)
ds_read_b64_tr_b16 a[228:229], v9 offset:0
v_fma_f32 v62, v62, s50, v234
v_mfma_f32_16x16x32_bf16 v[124:127], a[212:215], v[192:195], v[124:127]
ds_read_b64_tr_b16 a[230:231], v9 offset:8192
v_add_u32 v10, 81920, v10
v_mfma_f32_16x16x32_bf16 v[116:119], a[212:215], v[184:187], v[116:119]
ds_read_b64_tr_b16 a[208:209], v10 offset:0
v_fma_f32 v63, v63, s50, v234
v_mfma_f32_16x16x32_bf16 v[108:111], a[212:215], v[176:179], v[108:111]
s_waitcnt lgkmcnt(6)
ds_read_b64_tr_b16 a[210:211], v10 offset:8192
v_fma_f32 v44, v44, s50, v235
v_mfma_f32_16x16x32_bf16 v[84:87], a[216:219], v[200:203], v[84:87]
buffer_load_dwordx4 v17, s[28:31], s49 offen offset:1024 nt lds
v_mfma_f32_16x16x32_bf16 v[92:95], a[216:219], v[208:211], v[92:95]
v_add_u32 v11, 81920, v11
v_fma_f32 v45, v45, s50, v235
v_mfma_f32_16x16x32_bf16 v[100:103], a[216:219], v[216:219], v[100:103]
s_waitcnt lgkmcnt(6)
ds_read_b64_tr_b16 a[212:213], v11 offset:0
v_fma_f32 v46, v46, s50, v235
v_mfma_f32_16x16x32_bf16 v[124:127], a[220:223], v[216:219], v[124:127]
ds_read_b64_tr_b16 a[214:215], v11 offset:8192
v_add_u32 v12, 81920, v12
v_mfma_f32_16x16x32_bf16 v[116:119], a[220:223], v[208:211], v[116:119]
ds_read_b64_tr_b16 a[216:217], v12 offset:0
v_fma_f32 v47, v47, s50, v235
v_mfma_f32_16x16x32_bf16 v[108:111], a[220:223], v[200:203], v[108:111]
ds_read_b64_tr_b16 a[218:219], v12 offset:8192
v_fma_f32 v68, v68, s50, v235
v_exp_f32 v36, v36
v_exp_f32 v37, v37
v_exp_f32 v38, v38
v_exp_f32 v39, v39
v_exp_f32 v60, v60
v_exp_f32 v61, v61
v_exp_f32 v62, v62
v_exp_f32 v63, v63
v_exp_f32 v44, v44
v_exp_f32 v45, v45
v_exp_f32 v46, v46
v_exp_f32 v47, v47
v_fma_f32 v69, v69, s50, v235
v_fma_f32 v70, v70, s50, v235
v_fma_f32 v71, v71, s50, v235
v_exp_f32 v68, v68
v_exp_f32 v69, v69
v_exp_f32 v70, v70
v_exp_f32 v71, v71
v_fma_f32 v52, v52, s50, v236
v_fma_f32 v53, v53, s50, v236
v_fma_f32 v54, v54, s50, v236
v_fma_f32 v55, v55, s50, v236
v_exp_f32 v52, v52
v_exp_f32 v53, v53
v_exp_f32 v54, v54
v_exp_f32 v55, v55
v_fma_f32 v76, v76, s50, v236
v_fma_f32 v77, v77, s50, v236
v_fma_f32 v78, v78, s50, v236
v_fma_f32 v79, v79, s50, v236
v_exp_f32 v76, v76
v_exp_f32 v77, v77
v_exp_f32 v78, v78
v_exp_f32 v79, v79
v_cvt_pk_bf16_f32 v132, v36, v37
v_cvt_pk_bf16_f32 v133, v38, v39
v_cvt_pk_bf16_f32 v134, v60, v61
v_cvt_pk_bf16_f32 v135, v62, v63
v_cvt_pk_bf16_f32 v140, v44, v45
v_cvt_pk_bf16_f32 v141, v46, v47
v_cvt_pk_bf16_f32 v142, v68, v69
v_cvt_pk_bf16_f32 v143, v70, v71
v_cvt_pk_bf16_f32 v148, v52, v53
v_cvt_pk_bf16_f32 v149, v54, v55
v_cvt_pk_bf16_f32 v150, v76, v77
v_cvt_pk_bf16_f32 v151, v78, v79
v_mfma_f32_16x16x32_bf16 a[192:195], a[204:207], v[132:135], 0
buffer_load_dwordx4 v18, s[28:31], s49 offen offset:2048 nt lds
v_mfma_f32_16x16x32_bf16 a[196:199], a[204:207], v[140:143], 0
v_mfma_f32_16x16x32_bf16 a[200:203], a[204:207], v[148:151], 0
s_waitcnt lgkmcnt(8)
v_mfma_f32_16x16x32_bf16 a[0:3], a[224:227], v[132:135], 0
buffer_load_dwordx4 v19, s[28:31], s49 offen offset:3072 nt lds
v_mfma_f32_16x16x32_bf16 a[4:7], a[224:227], v[140:143], 0
v_add_u32 v13, 81920, v13
v_max3_f32 v156, v84, v85, v86
v_mfma_f32_16x16x32_bf16 a[8:11], a[224:227], v[148:151], 0
s_waitcnt lgkmcnt(6)
ds_read_b64_tr_b16 a[220:221], v13 offset:0
v_max3_f32 v157, v92, v93, v94
v_mfma_f32_16x16x32_bf16 a[20:23], a[228:231], v[148:151], 0
ds_read_b64_tr_b16 a[222:223], v13 offset:8192
v_add_u32 v14, 81920, v14
v_mfma_f32_16x16x32_bf16 a[16:19], a[228:231], v[140:143], 0
ds_read_b64_tr_b16 a[224:225], v14 offset:0
v_max3_f32 v158, v100, v101, v102
v_mfma_f32_16x16x32_bf16 a[12:15], a[228:231], v[132:135], 0
s_waitcnt lgkmcnt(7)
ds_read_b64_tr_b16 a[226:227], v14 offset:8192
v_max3_f32 v156, v156, v87, v108
v_mfma_f32_16x16x32_bf16 a[24:27], a[208:211], v[132:135], 0
v_add_u32 v15, 81920, v15
v_max3_f32 v157, v157, v95, v116
v_mfma_f32_16x16x32_bf16 a[28:31], a[208:211], v[140:143], 0
ds_read_b64_tr_b16 a[228:229], v15 offset:0
v_max3_f32 v158, v158, v103, v124
v_mfma_f32_16x16x32_bf16 a[32:35], a[208:211], v[148:151], 0
s_waitcnt lgkmcnt(7)
ds_read_b64_tr_b16 a[230:231], v15 offset:8192
v_max3_f32 v156, v156, v109, v110
v_mfma_f32_16x16x32_bf16 a[44:47], a[212:215], v[148:151], 0
ds_read_b64_tr_b16 a[208:209], v8 offset:256
v_max3_f32 v157, v157, v117, v118
v_mfma_f32_16x16x32_bf16 a[40:43], a[212:215], v[140:143], 0
ds_read_b64_tr_b16 a[210:211], v8 offset:8448
v_max3_f32 v158, v158, v125, v126
v_mfma_f32_16x16x32_bf16 a[36:39], a[212:215], v[132:135], 0
s_waitcnt lgkmcnt(8)
v_max_f32 v156, v156, v111
v_max_f32 v157, v157, v119
v_mfma_f32_16x16x32_bf16 a[48:51], a[216:219], v[132:135], 0
ds_read_b64_tr_b16 a[212:213], v9 offset:256
v_max_f32 v158, v158, v127
v_mfma_f32_16x16x32_bf16 a[52:55], a[216:219], v[140:143], 0
ds_read_b64_tr_b16 a[214:215], v9 offset:8448
v_fma_f32 v164, v156, s50, v234
v_mfma_f32_16x16x32_bf16 a[56:59], a[216:219], v[148:151], 0
s_waitcnt lgkmcnt(8)
v_fma_f32 v165, v157, s50, v235
v_fma_f32 v166, v158, s50, v236
v_mfma_f32_16x16x32_bf16 a[68:71], a[220:223], v[148:151], 0
ds_read_b64_tr_b16 a[216:217], v10 offset:256
v_max3_f32 v167, v164, v165, v166
v_mfma_f32_16x16x32_bf16 a[64:67], a[220:223], v[140:143], 0
ds_read_b64_tr_b16 a[218:219], v10 offset:8448
v_cmp_lt_f32 vcc, s51, v167
v_mfma_f32_16x16x32_bf16 a[60:63], a[220:223], v[132:135], 0
s_waitcnt lgkmcnt(8)
s_cbranch_vccnz L_ra0
L_skipa0:
v_fma_f32 v84, v84, s50, v234
v_mfma_f32_16x16x32_bf16 a[72:75], a[224:227], v[132:135], 0
ds_read_b64_tr_b16 a[220:221], v11 offset:256
v_fma_f32 v85, v85, s50, v234
v_mfma_f32_16x16x32_bf16 a[76:79], a[224:227], v[140:143], 0
ds_read_b64_tr_b16 a[222:223], v11 offset:8448
v_fma_f32 v86, v86, s50, v234
v_mfma_f32_16x16x32_bf16 a[80:83], a[224:227], v[148:151], 0
s_waitcnt lgkmcnt(8)
v_fma_f32 v87, v87, s50, v234
v_fma_f32 v108, v108, s50, v234
v_mfma_f32_16x16x32_bf16 a[92:95], a[228:231], v[148:151], 0
ds_read_b64_tr_b16 a[224:225], v12 offset:256
v_fma_f32 v109, v109, s50, v234
v_mfma_f32_16x16x32_bf16 a[88:91], a[228:231], v[140:143], 0
ds_read_b64_tr_b16 a[226:227], v12 offset:8448
v_fma_f32 v110, v110, s50, v234
v_mfma_f32_16x16x32_bf16 a[84:87], a[228:231], v[132:135], 0
s_waitcnt lgkmcnt(8)
v_exp_f32 v84, v84
v_mfma_f32_16x16x32_bf16 a[96:99], a[208:211], v[132:135], 0
ds_read_b64_tr_b16 a[228:229], v13 offset:256
v_fma_f32 v111, v111, s50, v234
v_mfma_f32_16x16x32_bf16 a[100:103], a[208:211], v[140:143], 0
ds_read_b64_tr_b16 a[230:231], v13 offset:8448
v_fma_f32 v92, v92, s50, v235
v_mfma_f32_16x16x32_bf16 a[104:107], a[208:211], v[148:151], 0
s_waitcnt lgkmcnt(8)
v_exp_f32 v85, v85
v_mfma_f32_16x16x32_bf16 a[116:119], a[212:215], v[148:151], 0
ds_read_b64_tr_b16 a[208:209], v14 offset:256
v_fma_f32 v93, v93, s50, v235
v_mfma_f32_16x16x32_bf16 a[112:115], a[212:215], v[140:143], 0
ds_read_b64_tr_b16 a[210:211], v14 offset:8448
v_fma_f32 v94, v94, s50, v235
v_mfma_f32_16x16x32_bf16 a[108:111], a[212:215], v[132:135], 0
s_waitcnt lgkmcnt(8)
v_exp_f32 v86, v86
v_mfma_f32_16x16x32_bf16 a[120:123], a[216:219], v[132:135], 0
ds_read_b64_tr_b16 a[212:213], v15 offset:256
v_fma_f32 v95, v95, s50, v235
v_mfma_f32_16x16x32_bf16 a[124:127], a[216:219], v[140:143], 0
ds_read_b64_tr_b16 a[214:215], v15 offset:8448
v_fma_f32 v116, v116, s50, v235
v_mfma_f32_16x16x32_bf16 a[128:131], a[216:219], v[148:151], 0
s_waitcnt lgkmcnt(8)
v_exp_f32 v87, v87
v_mfma_f32_16x16x32_bf16 a[140:143], a[220:223], v[148:151], 0
s_barrier
ds_read_b128 a[216:219], v4 offset:0
v_mfma_f32_16x16x32_bf16 a[136:139], a[220:223], v[140:143], 0
s_add_u32 m0, s48, 65536
s_mov_b32 s49, 98304
v_fma_f32 v117, v117, s50, v235
v_mfma_f32_16x16x32_bf16 a[132:135], a[220:223], v[132:135], 0
s_waitcnt lgkmcnt(7)
buffer_load_dwordx4 v16, s[24:27], s49 offen nt lds
v_mfma_f32_16x16x32_bf16 a[144:147], a[224:227], v[132:135], 0
ds_read_b128 a[220:223], v4 offset:8192
v_fma_f32 v118, v118, s50, v235
v_mfma_f32_16x16x32_bf16 a[148:151], a[224:227], v[140:143], 0
v_exp_f32 v108, v108
v_mfma_f32_16x16x32_bf16 a[152:155], a[224:227], v[148:151], 0
s_waitcnt lgkmcnt(6)
buffer_load_dwordx4 v17, s[24:27], s49 offen offset:1024 nt lds
v_mfma_f32_16x16x32_bf16 a[164:167], a[228:231], v[148:151], 0
ds_read_b128 a[224:227], v5 offset:0
v_fma_f32 v119, v119, s50, v235
v_mfma_f32_16x16x32_bf16 a[160:163], a[228:231], v[140:143], 0
v_exp_f32 v109, v109
v_mfma_f32_16x16x32_bf16 a[156:159], a[228:231], v[132:135], 0
s_waitcnt lgkmcnt(5)
v_exp_f32 v110, v110
v_mfma_f32_16x16x32_bf16 a[168:171], a[208:211], v[132:135], 0
ds_read_b128 a[228:231], v5 offset:8192
v_fma_f32 v100, v100, s50, v236
v_mfma_f32_16x16x32_bf16 a[172:175], a[208:211], v[140:143], 0
v_exp_f32 v111, v111
v_mfma_f32_16x16x32_bf16 a[176:179], a[208:211], v[148:151], 0
s_waitcnt lgkmcnt(4)
buffer_load_dwordx4 v18, s[24:27], s49 offen offset:2048 nt lds
v_mfma_f32_16x16x32_bf16 a[188:191], a[212:215], v[148:151], 0
ds_read_b128 a[208:211], v6 offset:0
v_fma_f32 v101, v101, s50, v236
v_mfma_f32_16x16x32_bf16 a[184:187], a[212:215], v[140:143], 0
v_exp_f32 v92, v92
v_mfma_f32_16x16x32_bf16 a[180:183], a[212:215], v[132:135], 0
s_cbranch_vccnz L_rb0
L_skipb0:
s_waitcnt lgkmcnt(4)
v_fma_f32 v102, v102, s50, v236
v_mfma_f32_16x16x32_bf16 v[36:39], a[216:219], v[32:35], 0
ds_read_b128 a[212:215], v6 offset:8192
v_fma_f32 v103, v103, s50, v236
v_mfma_f32_16x16x32_bf16 v[44:47], a[216:219], v[40:43], 0
buffer_load_dwordx4 v19, s[24:27], s49 offen offset:3072 nt lds
v_mfma_f32_16x16x32_bf16 v[52:55], a[216:219], v[48:51], 0
s_waitcnt lgkmcnt(4)
v_exp_f32 v93, v93
v_mfma_f32_16x16x32_bf16 v[76:79], a[220:223], v[48:51], 0
ds_read_b128 a[216:219], v7 offset:0
v_fma_f32 v124, v124, s50, v236
v_mfma_f32_16x16x32_bf16 v[68:71], a[220:223], v[40:43], 0
v_exp_f32 v94, v94
v_mfma_f32_16x16x32_bf16 v[60:63], a[220:223], v[32:35], 0
s_waitcnt lgkmcnt(4)
v_exp_f32 v95, v95
v_mfma_f32_16x16x32_bf16 v[36:39], a[224:227], v[56:59], v[36:39]
ds_read_b128 a[220:223], v7 offset:8192
v_fma_f32 v125, v125, s50, v236
v_mfma_f32_16x16x32_bf16 v[44:47], a[224:227], v[64:67], v[44:47]
v_exp_f32 v116, v116
v_mfma_f32_16x16x32_bf16 v[52:55], a[224:227], v[72:75], v[52:55]
s_waitcnt lgkmcnt(4)
v_exp_f32 v117, v117
v_mfma_f32_16x16x32_bf16 v[76:79], a[228:231], v[72:75], v[76:79]
ds_read_b128 a[224:227], v4 offset:256
v_fma_f32 v126, v126, s50, v236
v_mfma_f32_16x16x32_bf16 v[68:71], a[228:231], v[64:67], v[68:71]
v_exp_f32 v118, v118
v_mfma_f32_16x16x32_bf16 v[60:63], a[228:231], v[56:59], v[60:63]
s_waitcnt lgkmcnt(4)
v_exp_f32 v119, v119
v_mfma_f32_16x16x32_bf16 v[36:39], a[208:211], v[80:83], v[36:39]
ds_read_b128 a[228:231], v4 offset:8448
v_fma_f32 v127, v127, s50, v236
v_mfma_f32_16x16x32_bf16 v[44:47], a[208:211], v[88:91], v[44:47]
v_exp_f32 v100, v100
v_mfma_f32_16x16x32_bf16 v[52:55], a[208:211], v[96:99], v[52:55]
s_waitcnt lgkmcnt(4)
v_exp_f32 v101, v101
v_mfma_f32_16x16x32_bf16 v[76:79], a[212:215], v[96:99], v[76:79]
ds_read_b128 a[208:211], v5 offset:256
v_cvt_pk_bf16_f32 v132, v84, v85
v_mfma_f32_16x16x32_bf16 v[68:71], a[212:215], v[88:91], v[68:71]
v_exp_f32 v102, v102
v_mfma_f32_16x16x32_bf16 v[60:63], a[212:215], v[80:83], v[60:63]
s_waitcnt lgkmcnt(4)
v_exp_f32 v103, v103
v_mfma_f32_16x16x32_bf16 v[36:39], a[216:219], v[104:107], v[36:39]
ds_read_b128 a[212:215], v5 offset:8448
v_cvt_pk_bf16_f32 v133, v86, v87
v_mfma_f32_16x16x32_bf16 v[44:47], a[216:219], v[112:115], v[44:47]
v_exp_f32 v124, v124
v_mfma_f32_16x16x32_bf16 v[52:55], a[216:219], v[120:123], v[52:55]
s_waitcnt lgkmcnt(4)
v_exp_f32 v125, v125
v_mfma_f32_16x16x32_bf16 v[76:79], a[220:223], v[120:123], v[76:79]
ds_read_b128 a[216:219], v6 offset:256
v_cvt_pk_bf16_f32 v134, v108, v109
v_mfma_f32_16x16x32_bf16 v[68:71], a[220:223], v[112:115], v[68:71]
v_exp_f32 v126, v126
v_mfma_f32_16x16x32_bf16 v[60:63], a[220:223], v[104:107], v[60:63]
s_waitcnt lgkmcnt(4)
v_exp_f32 v127, v127
v_mfma_f32_16x16x32_bf16 v[36:39], a[224:227], v[128:131], v[36:39]
ds_read_b128 a[220:223], v6 offset:8448
v_cvt_pk_bf16_f32 v135, v110, v111
v_mfma_f32_16x16x32_bf16 v[44:47], a[224:227], v[136:139], v[44:47]
v_cvt_pk_bf16_f32 v140, v92, v93
v_cvt_pk_bf16_f32 v141, v94, v95
v_mfma_f32_16x16x32_bf16 v[52:55], a[224:227], v[144:147], v[52:55]
s_waitcnt lgkmcnt(4)
v_cvt_pk_bf16_f32 v142, v116, v117
v_cvt_pk_bf16_f32 v143, v118, v119
v_mfma_f32_16x16x32_bf16 v[76:79], a[228:231], v[144:147], v[76:79]
ds_read_b128 a[224:227], v7 offset:256
v_cvt_pk_bf16_f32 v148, v100, v101
v_mfma_f32_16x16x32_bf16 v[68:71], a[228:231], v[136:139], v[68:71]
v_cvt_pk_bf16_f32 v149, v102, v103
v_cvt_pk_bf16_f32 v150, v124, v125
v_mfma_f32_16x16x32_bf16 v[60:63], a[228:231], v[128:131], v[60:63]
s_waitcnt lgkmcnt(4)
v_cvt_pk_bf16_f32 v151, v126, v127
v_mfma_f32_16x16x32_bf16 v[36:39], a[208:211], v[152:155], v[36:39]
ds_read_b128 a[228:231], v7 offset:8448
v_mfma_f32_16x16x32_bf16 v[44:47], a[208:211], v[160:163], v[44:47]
v_mfma_f32_16x16x32_bf16 v[52:55], a[208:211], v[168:171], v[52:55]
s_waitcnt lgkmcnt(4)
v_mfma_f32_16x16x32_bf16 v[76:79], a[212:215], v[168:171], v[76:79]
s_barrier
ds_read_b64_tr_b16 a[208:209], v8 offset:49152
v_mfma_f32_16x16x32_bf16 v[68:71], a[212:215], v[160:163], v[68:71]
s_add_u32 m0, s48, 81920
ds_read_b64_tr_b16 a[210:211], v8 offset:57344
s_mov_b32 s49, 81920
v_mfma_f32_16x16x32_bf16 v[60:63], a[212:215], v[152:155], v[60:63]
s_waitcnt lgkmcnt(5)
buffer_load_dwordx4 v16, s[28:31], s49 offen nt lds
v_mfma_f32_16x16x32_bf16 v[36:39], a[216:219], v[176:179], v[36:39]
ds_read_b64_tr_b16 a[212:213], v9 offset:49152
v_mfma_f32_16x16x32_bf16 v[44:47], a[216:219], v[184:187], v[44:47]
ds_read_b64_tr_b16 a[214:215], v9 offset:57344
v_mfma_f32_16x16x32_bf16 v[52:55], a[216:219], v[192:195], v[52:55]
s_waitcnt lgkmcnt(6)
buffer_load_dwordx4 v17, s[28:31], s49 offen offset:1024 nt lds
v_mfma_f32_16x16x32_bf16 v[76:79], a[220:223], v[192:195], v[76:79]
ds_read_b64_tr_b16 a[216:217], v10 offset:49152
v_mfma_f32_16x16x32_bf16 v[68:71], a[220:223], v[184:187], v[68:71]
ds_read_b64_tr_b16 a[218:219], v10 offset:57344
v_mfma_f32_16x16x32_bf16 v[60:63], a[220:223], v[176:179], v[60:63]
s_waitcnt lgkmcnt(7)
v_mfma_f32_16x16x32_bf16 v[36:39], a[224:227], v[200:203], v[36:39]
ds_read_b64_tr_b16 a[220:221], v11 offset:49152
v_mfma_f32_16x16x32_bf16 v[44:47], a[224:227], v[208:211], v[44:47]
ds_read_b64_tr_b16 a[222:223], v11 offset:57344
v_mfma_f32_16x16x32_bf16 v[52:55], a[224:227], v[216:219], v[52:55]
s_waitcnt lgkmcnt(8)
buffer_load_dwordx4 v18, s[28:31], s49 offen offset:2048 nt lds
v_mfma_f32_16x16x32_bf16 v[76:79], a[228:231], v[216:219], v[76:79]
ds_read_b64_tr_b16 a[224:225], v12 offset:49152
v_mfma_f32_16x16x32_bf16 v[68:71], a[228:231], v[208:211], v[68:71]
ds_read_b64_tr_b16 a[226:227], v12 offset:57344
v_mfma_f32_16x16x32_bf16 v[60:63], a[228:231], v[200:203], v[60:63]
buffer_load_dwordx4 v19, s[28:31], s49 offen offset:3072 nt lds
v_mfma_f32_16x16x32_bf16 a[192:195], a[204:207], v[132:135], a[192:195]
s_and_b32 s0, s54, 1
s_mul_i32 s0, s0, 229376
s_sub_u32 s1, 229376, s0
v_mfma_f32_16x16x32_bf16 a[196:199], a[204:207], v[140:143], a[196:199]
s_lshl_b32 s64, s57, 7
s_add_u32 s65, s64, 128
s_cmp_ge_u32 s65, 896
s_cselect_b32 s65, 0, s65
v_mfma_f32_16x16x32_bf16 a[200:203], a[204:207], v[148:151], a[200:203]
s_waitcnt lgkmcnt(8)
s_add_u32 s66, s65, 128
s_cmp_ge_u32 s66, 896
s_cselect_b32 s66, 0, s66
v_mfma_f32_16x16x32_bf16 a[0:3], a[208:211], v[132:135], a[0:3]
ds_read_b64_tr_b16 a[228:229], v13 offset:49152
v_max3_f32 v156, v36, v37, v38
v_mfma_f32_16x16x32_bf16 a[4:7], a[208:211], v[140:143], a[4:7]
ds_read_b64_tr_b16 a[230:231], v13 offset:57344
v_max3_f32 v157, v44, v45, v46
v_mfma_f32_16x16x32_bf16 a[8:11], a[208:211], v[148:151], a[8:11]
s_waitcnt lgkmcnt(8)
s_add_u32 s67, s66, 128
s_cmp_ge_u32 s67, 896
s_cselect_b32 s67, 0, s67
v_mfma_f32_16x16x32_bf16 a[20:23], a[212:215], v[148:151], a[20:23]
ds_read_b64_tr_b16 a[208:209], v14 offset:49152
v_max3_f32 v158, v52, v53, v54
v_mfma_f32_16x16x32_bf16 a[16:19], a[212:215], v[140:143], a[16:19]
ds_read_b64_tr_b16 a[210:211], v14 offset:57344
v_max3_f32 v156, v156, v39, v60
v_mfma_f32_16x16x32_bf16 a[12:15], a[212:215], v[132:135], a[12:15]
s_waitcnt lgkmcnt(8)
s_add_u32 s68, s67, 128
s_cmp_ge_u32 s68, 896
s_cselect_b32 s68, 0, s68
v_mfma_f32_16x16x32_bf16 a[24:27], a[216:219], v[132:135], a[24:27]
ds_read_b64_tr_b16 a[212:213], v15 offset:49152
v_max3_f32 v157, v157, v47, v68
v_mfma_f32_16x16x32_bf16 a[28:31], a[216:219], v[140:143], a[28:31]
ds_read_b64_tr_b16 a[214:215], v15 offset:57344
v_max3_f32 v158, v158, v55, v76
v_mfma_f32_16x16x32_bf16 a[32:35], a[216:219], v[148:151], a[32:35]
s_waitcnt lgkmcnt(8)
s_add_u32 s69, s68, 128
s_cmp_ge_u32 s69, 896
s_cselect_b32 s69, 0, s69
v_mfma_f32_16x16x32_bf16 a[44:47], a[220:223], v[148:151], a[44:47]
ds_read_b64_tr_b16 a[216:217], v8 offset:49408
v_max3_f32 v156, v156, v61, v62
v_mfma_f32_16x16x32_bf16 a[40:43], a[220:223], v[140:143], a[40:43]
ds_read_b64_tr_b16 a[218:219], v8 offset:57600
v_max3_f32 v157, v157, v69, v70
v_mfma_f32_16x16x32_bf16 a[36:39], a[220:223], v[132:135], a[36:39]
s_waitcnt lgkmcnt(8)
s_add_u32 s70, s69, 128
s_cmp_ge_u32 s70, 896
s_cselect_b32 s70, 0, s70
v_mfma_f32_16x16x32_bf16 a[48:51], a[224:227], v[132:135], a[48:51]
s_lshr_b32 s71, s54, 1
ds_read_b64_tr_b16 a[220:221], v9 offset:49408
v_max3_f32 v158, v158, v77, v78
v_mfma_f32_16x16x32_bf16 a[52:55], a[224:227], v[140:143], a[52:55]
ds_read_b64_tr_b16 a[222:223], v9 offset:57600
v_max_f32 v156, v156, v63
v_mfma_f32_16x16x32_bf16 a[56:59], a[224:227], v[148:151], a[56:59]
s_waitcnt lgkmcnt(8)
s_add_u32 s32, s14, 0
s_addc_u32 s33, s15, 0
s_and_b32 s33, s33, 0xffff
s_mov_b32 s34, 2752512
s_mov_b32 s35, 0x20000
v_mfma_f32_16x16x32_bf16 a[68:71], a[228:231], v[148:151], a[68:71]
ds_read_b64_tr_b16 a[224:225], v10 offset:49408
v_max_f32 v157, v157, v71
v_mfma_f32_16x16x32_bf16 a[64:67], a[228:231], v[140:143], a[64:67]
ds_read_b64_tr_b16 a[226:227], v10 offset:57600
v_max_f32 v158, v158, v79
v_mfma_f32_16x16x32_bf16 a[60:63], a[228:231], v[132:135], a[60:63]
s_waitcnt lgkmcnt(8)
s_mul_i32 s73, s53, 1376256
s_add_u32 s20, s18, s73
s_addc_u32 s21, s19, 0
s_and_b32 s21, s21, 0xffff
s_mov_b32 s22, 1376256
s_mov_b32 s23, 0x20000
v_mfma_f32_16x16x32_bf16 a[72:75], a[208:211], v[132:135], a[72:75]
ds_read_b64_tr_b16 a[228:229], v11 offset:49408
v_fma_f32 v164, v156, s50, v234
v_mfma_f32_16x16x32_bf16 a[76:79], a[208:211], v[140:143], a[76:79]
ds_read_b64_tr_b16 a[230:231], v11 offset:57600
v_fma_f32 v165, v157, s50, v235
v_mfma_f32_16x16x32_bf16 a[80:83], a[208:211], v[148:151], a[80:83]
s_waitcnt lgkmcnt(8)
s_lshl_b32 s73, s53, 2
v_mov_b32 v246, s73
v_mfma_f32_16x16x32_bf16 a[92:95], a[212:215], v[148:151], a[92:95]
ds_read_b64_tr_b16 a[208:209], v12 offset:49408
v_fma_f32 v166, v158, s50, v236
v_mfma_f32_16x16x32_bf16 a[88:91], a[212:215], v[140:143], a[88:91]
ds_read_b64_tr_b16 a[210:211], v12 offset:57600
v_max3_f32 v167, v164, v165, v166
v_mfma_f32_16x16x32_bf16 a[84:87], a[212:215], v[132:135], a[84:87]
s_waitcnt lgkmcnt(8)
global_load_dword v247, v246, s[16:17] offset:64 sc1
v_mfma_f32_16x16x32_bf16 a[96:99], a[216:219], v[132:135], a[96:99]
ds_read_b64_tr_b16 a[212:213], v13 offset:49408
v_cmp_lt_f32 vcc, s51, v167
v_mfma_f32_16x16x32_bf16 a[100:103], a[216:219], v[140:143], a[100:103]
s_cbranch_vccnz L_ra1
L_skipa1:
ds_read_b64_tr_b16 a[214:215], v13 offset:57600
v_fma_f32 v36, v36, s50, v234
v_mfma_f32_16x16x32_bf16 a[104:107], a[216:219], v[148:151], a[104:107]
s_waitcnt lgkmcnt(8)
v_fma_f32 v37, v37, s50, v234
v_fma_f32 v38, v38, s50, v234
v_mfma_f32_16x16x32_bf16 a[116:119], a[220:223], v[148:151], a[116:119]
ds_read_b64_tr_b16 a[216:217], v14 offset:49408
v_fma_f32 v39, v39, s50, v234
v_mfma_f32_16x16x32_bf16 a[112:115], a[220:223], v[140:143], a[112:115]
ds_read_b64_tr_b16 a[218:219], v14 offset:57600
v_fma_f32 v60, v60, s50, v234
v_mfma_f32_16x16x32_bf16 a[108:111], a[220:223], v[132:135], a[108:111]
s_waitcnt lgkmcnt(8)
v_exp_f32 v36, v36
v_mfma_f32_16x16x32_bf16 a[120:123], a[224:227], v[132:135], a[120:123]
ds_read_b64_tr_b16 a[220:221], v15 offset:49408
v_fma_f32 v61, v61, s50, v234
v_mfma_f32_16x16x32_bf16 a[124:127], a[224:227], v[140:143], a[124:127]
ds_read_b64_tr_b16 a[222:223], v15 offset:57600
v_fma_f32 v62, v62, s50, v234
v_mfma_f32_16x16x32_bf16 a[128:131], a[224:227], v[148:151], a[128:131]
s_waitcnt lgkmcnt(8)
v_exp_f32 v37, v37
v_mfma_f32_16x16x32_bf16 a[140:143], a[228:231], v[148:151], a[140:143]
s_barrier
v_add_u32 v4, 4294934528, v4
v_mfma_f32_16x16x32_bf16 a[136:139], a[228:231], v[140:143], a[136:139]
s_add_u32 m0, s48, 32768
ds_read_b128 a[224:227], v4 offset:0
s_mov_b32 s49, 114688
v_mfma_f32_16x16x32_bf16 a[132:135], a[228:231], v[132:135], a[132:135]
s_waitcnt lgkmcnt(7)
buffer_load_dwordx4 v16, s[24:27], s49 offen nt lds
v_mfma_f32_16x16x32_bf16 a[144:147], a[208:211], v[132:135], a[144:147]
ds_read_b128 a[228:231], v4 offset:8192
v_fma_f32 v63, v63, s50, v234
v_mfma_f32_16x16x32_bf16 a[148:151], a[208:211], v[140:143], a[148:151]
v_exp_f32 v38, v38
v_mfma_f32_16x16x32_bf16 a[152:155], a[208:211], v[148:151], a[152:155]
s_waitcnt lgkmcnt(6)
buffer_load_dwordx4 v17, s[24:27], s49 offen offset:1024 nt lds
v_mfma_f32_16x16x32_bf16 a[164:167], a[212:215], v[148:151], a[164:167]
v_add_u32 v5, 4294934528, v5
v_fma_f32 v44, v44, s50, v235
v_mfma_f32_16x16x32_bf16 a[160:163], a[212:215], v[140:143], a[160:163]
ds_read_b128 a[208:211], v5 offset:0
v_fma_f32 v45, v45, s50, v235
v_mfma_f32_16x16x32_bf16 a[156:159], a[212:215], v[132:135], a[156:159]
s_waitcnt lgkmcnt(5)
v_exp_f32 v39, v39
v_mfma_f32_16x16x32_bf16 a[168:171], a[216:219], v[132:135], a[168:171]
ds_read_b128 a[212:215], v5 offset:8192
v_fma_f32 v46, v46, s50, v235
v_mfma_f32_16x16x32_bf16 a[172:175], a[216:219], v[140:143], a[172:175]
v_exp_f32 v60, v60
v_mfma_f32_16x16x32_bf16 a[176:179], a[216:219], v[148:151], a[176:179]
s_waitcnt lgkmcnt(4)
buffer_load_dwordx4 v18, s[24:27], s49 offen offset:2048 nt lds
v_mfma_f32_16x16x32_bf16 a[188:191], a[220:223], v[148:151], a[188:191]
v_add_u32 v6, 4294934528, v6
v_fma_f32 v47, v47, s50, v235
v_mfma_f32_16x16x32_bf16 a[184:187], a[220:223], v[140:143], a[184:187]
ds_read_b128 a[216:219], v6 offset:0
v_fma_f32 v68, v68, s50, v235
v_mfma_f32_16x16x32_bf16 a[180:183], a[220:223], v[132:135], a[180:183]
s_cbranch_vccnz L_rb1
L_skipb1:
s_waitcnt lgkmcnt(4)
v_fma_f32 v69, v69, s50, v235
v_mfma_f32_16x16x32_bf16 v[84:87], a[224:227], v[32:35], 0
ds_read_b128 a[220:223], v6 offset:8192
v_fma_f32 v70, v70, s50, v235
v_mfma_f32_16x16x32_bf16 v[92:95], a[224:227], v[40:43], 0
buffer_load_dwordx4 v19, s[24:27], s49 offen offset:3072 nt lds
v_mfma_f32_16x16x32_bf16 v[100:103], a[224:227], v[48:51], 0
s_waitcnt lgkmcnt(4)
v_exp_f32 v61, v61
v_mfma_f32_16x16x32_bf16 v[124:127], a[228:231], v[48:51], 0
v_add_u32 v7, 4294934528, v7
v_fma_f32 v71, v71, s50, v235
v_mfma_f32_16x16x32_bf16 v[116:119], a[228:231], v[40:43], 0
ds_read_b128 a[224:227], v7 offset:0
v_fma_f32 v52, v52, s50, v236
v_mfma_f32_16x16x32_bf16 v[108:111], a[228:231], v[32:35], 0
s_waitcnt lgkmcnt(4)
v_exp_f32 v62, v62
v_mfma_f32_16x16x32_bf16 v[84:87], a[208:211], v[56:59], v[84:87]
ds_read_b128 a[228:231], v7 offset:8192
v_fma_f32 v53, v53, s50, v236
v_mfma_f32_16x16x32_bf16 v[92:95], a[208:211], v[64:67], v[92:95]
v_exp_f32 v63, v63
v_mfma_f32_16x16x32_bf16 v[100:103], a[208:211], v[72:75], v[100:103]
s_waitcnt lgkmcnt(4)
v_exp_f32 v44, v44
v_mfma_f32_16x16x32_bf16 v[124:127], a[212:215], v[72:75], v[124:127]
ds_read_b128 a[208:211], v4 offset:256
v_fma_f32 v54, v54, s50, v236
v_mfma_f32_16x16x32_bf16 v[116:119], a[212:215], v[64:67], v[116:119]
v_exp_f32 v45, v45
v_mfma_f32_16x16x32_bf16 v[108:111], a[212:215], v[56:59], v[108:111]
s_waitcnt lgkmcnt(4)
v_exp_f32 v46, v46
v_mfma_f32_16x16x32_bf16 v[84:87], a[216:219], v[80:83], v[84:87]
ds_read_b128 a[212:215], v4 offset:8448
v_fma_f32 v55, v55, s50, v236
v_mfma_f32_16x16x32_bf16 v[92:95], a[216:219], v[88:91], v[92:95]
v_exp_f32 v47, v47
v_mfma_f32_16x16x32_bf16 v[100:103], a[216:219], v[96:99], v[100:103]
s_waitcnt lgkmcnt(4)
v_exp_f32 v68, v68
v_mfma_f32_16x16x32_bf16 v[124:127], a[220:223], v[96:99], v[124:127]
ds_read_b128 a[216:219], v5 offset:256
v_fma_f32 v76, v76, s50, v236
v_mfma_f32_16x16x32_bf16 v[116:119], a[220:223], v[88:91], v[116:119]
v_exp_f32 v69, v69
v_mfma_f32_16x16x32_bf16 v[108:111], a[220:223], v[80:83], v[108:111]
s_waitcnt lgkmcnt(4)
v_exp_f32 v70, v70
v_mfma_f32_16x16x32_bf16 v[84:87], a[224:227], v[104:107], v[84:87]
ds_read_b128 a[220:223], v5 offset:8448
v_fma_f32 v77, v77, s50, v236
v_mfma_f32_16x16x32_bf16 v[92:95], a[224:227], v[112:115], v[92:95]
v_exp_f32 v71, v71
v_mfma_f32_16x16x32_bf16 v[100:103], a[224:227], v[120:123], v[100:103]
s_waitcnt lgkmcnt(4)
v_exp_f32 v52, v52
v_mfma_f32_16x16x32_bf16 v[124:127], a[228:231], v[120:123], v[124:127]
ds_read_b128 a[224:227], v6 offset:256
v_fma_f32 v78, v78, s50, v236
v_mfma_f32_16x16x32_bf16 v[116:119], a[228:231], v[112:115], v[116:119]
v_exp_f32 v53, v53
v_mfma_f32_16x16x32_bf16 v[108:111], a[228:231], v[104:107], v[108:111]
s_waitcnt lgkmcnt(4)
v_exp_f32 v54, v54
v_mfma_f32_16x16x32_bf16 v[84:87], a[208:211], v[128:131], v[84:87]
ds_read_b128 a[228:231], v6 offset:8448
v_fma_f32 v79, v79, s50, v236
v_mfma_f32_16x16x32_bf16 v[92:95], a[208:211], v[136:139], v[92:95]
v_exp_f32 v55, v55
v_mfma_f32_16x16x32_bf16 v[100:103], a[208:211], v[144:147], v[100:103]
s_waitcnt lgkmcnt(4)
v_exp_f32 v76, v76
v_mfma_f32_16x16x32_bf16 v[124:127], a[212:215], v[144:147], v[124:127]
ds_read_b128 a[208:211], v7 offset:256
v_cvt_pk_bf16_f32 v132, v36, v37
v_mfma_f32_16x16x32_bf16 v[116:119], a[212:215], v[136:139], v[116:119]
v_exp_f32 v77, v77
v_mfma_f32_16x16x32_bf16 v[108:111], a[212:215], v[128:131], v[108:111]
s_waitcnt lgkmcnt(4)
v_exp_f32 v78, v78
v_mfma_f32_16x16x32_bf16 v[84:87], a[216:219], v[152:155], v[84:87]
ds_read_b128 a[212:215], v7 offset:8448
v_cvt_pk_bf16_f32 v133, v38, v39
v_mfma_f32_16x16x32_bf16 v[92:95], a[216:219], v[160:163], v[92:95]
v_exp_f32 v79, v79
v_mfma_f32_16x16x32_bf16 v[100:103], a[216:219], v[168:171], v[100:103]
s_waitcnt lgkmcnt(4)
v_cvt_pk_bf16_f32 v134, v60, v61
v_cvt_pk_bf16_f32 v135, v62, v63
v_mfma_f32_16x16x32_bf16 v[124:127], a[220:223], v[168:171], v[124:127]
s_waitcnt vmcnt(29)
s_barrier
ds_read_b64_tr_b16 a[216:217], v8 offset:16384
v_mfma_f32_16x16x32_bf16 v[116:119], a[220:223], v[160:163], v[116:119]
s_add_u32 m0, s48, 131072
ds_read_b64_tr_b16 a[218:219], v8 offset:24576
s_mov_b32 s49, 98304
v_mfma_f32_16x16x32_bf16 v[108:111], a[220:223], v[152:155], v[108:111]
s_waitcnt lgkmcnt(5)
buffer_load_dwordx4 v16, s[28:31], s49 offen nt lds
v_mfma_f32_16x16x32_bf16 v[84:87], a[224:227], v[176:179], v[84:87]
ds_read_b64_tr_b16 a[220:221], v9 offset:16384
v_cvt_pk_bf16_f32 v140, v44, v45
v_mfma_f32_16x16x32_bf16 v[92:95], a[224:227], v[184:187], v[92:95]
ds_read_b64_tr_b16 a[222:223], v9 offset:24576
v_cvt_pk_bf16_f32 v141, v46, v47
v_mfma_f32_16x16x32_bf16 v[100:103], a[224:227], v[192:195], v[100:103]
s_waitcnt lgkmcnt(6)
buffer_load_dwordx4 v17, s[28:31], s49 offen offset:1024 nt lds
v_mfma_f32_16x16x32_bf16 v[124:127], a[228:231], v[192:195], v[124:127]
ds_read_b64_tr_b16 a[224:225], v10 offset:16384
v_cvt_pk_bf16_f32 v142, v68, v69
v_mfma_f32_16x16x32_bf16 v[116:119], a[228:231], v[184:187], v[116:119]
ds_read_b64_tr_b16 a[226:227], v10 offset:24576
v_cvt_pk_bf16_f32 v143, v70, v71
v_mfma_f32_16x16x32_bf16 v[108:111], a[228:231], v[176:179], v[108:111]
s_waitcnt lgkmcnt(7)
v_cvt_pk_bf16_f32 v148, v52, v53
v_cvt_pk_bf16_f32 v149, v54, v55
v_mfma_f32_16x16x32_bf16 v[84:87], a[208:211], v[200:203], v[84:87]
ds_read_b64_tr_b16 a[228:229], v11 offset:16384
v_cvt_pk_bf16_f32 v150, v76, v77
v_mfma_f32_16x16x32_bf16 v[92:95], a[208:211], v[208:211], v[92:95]
ds_read_b64_tr_b16 a[230:231], v11 offset:24576
v_cvt_pk_bf16_f32 v151, v78, v79
v_mfma_f32_16x16x32_bf16 v[100:103], a[208:211], v[216:219], v[100:103]
s_waitcnt lgkmcnt(8)
buffer_load_dwordx4 v18, s[28:31], s49 offen offset:2048 nt lds
v_mfma_f32_16x16x32_bf16 v[124:127], a[212:215], v[216:219], v[124:127]
ds_read_b64_tr_b16 a[208:209], v12 offset:16384
v_mfma_f32_16x16x32_bf16 v[116:119], a[212:215], v[208:211], v[116:119]
ds_read_b64_tr_b16 a[210:211], v12 offset:24576
v_mfma_f32_16x16x32_bf16 v[108:111], a[212:215], v[200:203], v[108:111]
buffer_load_dwordx4 v19, s[28:31], s49 offen offset:3072 nt lds
v_mfma_f32_16x16x32_bf16 a[192:195], a[204:207], v[132:135], a[192:195]
v_mfma_f32_16x16x32_bf16 a[196:199], a[204:207], v[140:143], a[196:199]
v_mfma_f32_16x16x32_bf16 a[200:203], a[204:207], v[148:151], a[200:203]
s_waitcnt lgkmcnt(8)
v_mfma_f32_16x16x32_bf16 a[0:3], a[216:219], v[132:135], a[0:3]
ds_read_b64_tr_b16 a[212:213], v13 offset:16384
v_max3_f32 v156, v84, v85, v86
v_mfma_f32_16x16x32_bf16 a[4:7], a[216:219], v[140:143], a[4:7]
ds_read_b64_tr_b16 a[214:215], v13 offset:24576
v_max3_f32 v157, v92, v93, v94
v_mfma_f32_16x16x32_bf16 a[8:11], a[216:219], v[148:151], a[8:11]
s_waitcnt lgkmcnt(8)
v_max3_f32 v158, v100, v101, v102
v_max3_f32 v156, v156, v87, v108
v_mfma_f32_16x16x32_bf16 a[20:23], a[220:223], v[148:151], a[20:23]
ds_read_b64_tr_b16 a[216:217], v14 offset:16384
v_max3_f32 v157, v157, v95, v116
v_mfma_f32_16x16x32_bf16 a[16:19], a[220:223], v[140:143], a[16:19]
ds_read_b64_tr_b16 a[218:219], v14 offset:24576
v_max3_f32 v158, v158, v103, v124
v_mfma_f32_16x16x32_bf16 a[12:15], a[220:223], v[132:135], a[12:15]
s_waitcnt lgkmcnt(8)
v_max3_f32 v156, v156, v109, v110
v_max3_f32 v157, v157, v117, v118
v_mfma_f32_16x16x32_bf16 a[24:27], a[224:227], v[132:135], a[24:27]
ds_read_b64_tr_b16 a[220:221], v15 offset:16384
v_max3_f32 v158, v158, v125, v126
v_mfma_f32_16x16x32_bf16 a[28:31], a[224:227], v[140:143], a[28:31]
ds_read_b64_tr_b16 a[222:223], v15 offset:24576
v_max_f32 v156, v156, v111
v_mfma_f32_16x16x32_bf16 a[32:35], a[224:227], v[148:151], a[32:35]
s_waitcnt lgkmcnt(8)
v_max_f32 v157, v157, v119
v_max_f32 v158, v158, v127
v_mfma_f32_16x16x32_bf16 a[44:47], a[228:231], v[148:151], a[44:47]
ds_read_b64_tr_b16 a[224:225], v8 offset:16640
v_fma_f32 v164, v156, s50, v234
v_mfma_f32_16x16x32_bf16 a[40:43], a[228:231], v[140:143], a[40:43]
ds_read_b64_tr_b16 a[226:227], v8 offset:24832
v_fma_f32 v165, v157, s50, v235
v_mfma_f32_16x16x32_bf16 a[36:39], a[228:231], v[132:135], a[36:39]
s_waitcnt lgkmcnt(8)
v_fma_f32 v166, v158, s50, v236
v_max3_f32 v167, v164, v165, v166
v_mfma_f32_16x16x32_bf16 a[48:51], a[208:211], v[132:135], a[48:51]
ds_read_b64_tr_b16 a[228:229], v9 offset:16640
v_cmp_lt_f32 vcc, s51, v167
v_mfma_f32_16x16x32_bf16 a[52:55], a[208:211], v[140:143], a[52:55]
s_cbranch_vccnz L_ra2
L_skipa2:
ds_read_b64_tr_b16 a[230:231], v9 offset:24832
v_fma_f32 v84, v84, s50, v234
v_mfma_f32_16x16x32_bf16 a[56:59], a[208:211], v[148:151], a[56:59]
s_waitcnt lgkmcnt(8)
v_fma_f32 v85, v85, s50, v234
v_fma_f32 v86, v86, s50, v234
v_mfma_f32_16x16x32_bf16 a[68:71], a[212:215], v[148:151], a[68:71]
ds_read_b64_tr_b16 a[208:209], v10 offset:16640
v_fma_f32 v87, v87, s50, v234
v_mfma_f32_16x16x32_bf16 a[64:67], a[212:215], v[140:143], a[64:67]
ds_read_b64_tr_b16 a[210:211], v10 offset:24832
v_fma_f32 v108, v108, s50, v234
v_mfma_f32_16x16x32_bf16 a[60:63], a[212:215], v[132:135], a[60:63]
s_waitcnt lgkmcnt(8)
v_exp_f32 v84, v84
v_mfma_f32_16x16x32_bf16 a[72:75], a[216:219], v[132:135], a[72:75]
ds_read_b64_tr_b16 a[212:213], v11 offset:16640
v_fma_f32 v109, v109, s50, v234
v_mfma_f32_16x16x32_bf16 a[76:79], a[216:219], v[140:143], a[76:79]
ds_read_b64_tr_b16 a[214:215], v11 offset:24832
v_fma_f32 v110, v110, s50, v234
v_mfma_f32_16x16x32_bf16 a[80:83], a[216:219], v[148:151], a[80:83]
s_waitcnt lgkmcnt(8)
v_exp_f32 v85, v85
v_mfma_f32_16x16x32_bf16 a[92:95], a[220:223], v[148:151], a[92:95]
ds_read_b64_tr_b16 a[216:217], v12 offset:16640
v_fma_f32 v111, v111, s50, v234
v_mfma_f32_16x16x32_bf16 a[88:91], a[220:223], v[140:143], a[88:91]
ds_read_b64_tr_b16 a[218:219], v12 offset:24832
v_fma_f32 v92, v92, s50, v235
v_mfma_f32_16x16x32_bf16 a[84:87], a[220:223], v[132:135], a[84:87]
s_waitcnt lgkmcnt(8)
v_exp_f32 v86, v86
v_mfma_f32_16x16x32_bf16 a[96:99], a[224:227], v[132:135], a[96:99]
ds_read_b64_tr_b16 a[220:221], v13 offset:16640
v_fma_f32 v93, v93, s50, v235
v_mfma_f32_16x16x32_bf16 a[100:103], a[224:227], v[140:143], a[100:103]
ds_read_b64_tr_b16 a[222:223], v13 offset:24832
v_fma_f32 v94, v94, s50, v235
v_mfma_f32_16x16x32_bf16 a[104:107], a[224:227], v[148:151], a[104:107]
s_waitcnt lgkmcnt(8)
v_exp_f32 v87, v87
v_mfma_f32_16x16x32_bf16 a[116:119], a[228:231], v[148:151], a[116:119]
ds_read_b64_tr_b16 a[224:225], v14 offset:16640
v_fma_f32 v95, v95, s50, v235
v_mfma_f32_16x16x32_bf16 a[112:115], a[228:231], v[140:143], a[112:115]
ds_read_b64_tr_b16 a[226:227], v14 offset:24832
v_fma_f32 v116, v116, s50, v235
v_mfma_f32_16x16x32_bf16 a[108:111], a[228:231], v[132:135], a[108:111]
s_waitcnt lgkmcnt(8)
v_exp_f32 v108, v108
v_mfma_f32_16x16x32_bf16 a[120:123], a[208:211], v[132:135], a[120:123]
ds_read_b64_tr_b16 a[228:229], v15 offset:16640
v_fma_f32 v117, v117, s50, v235
v_mfma_f32_16x16x32_bf16 a[124:127], a[208:211], v[140:143], a[124:127]
ds_read_b64_tr_b16 a[230:231], v15 offset:24832
v_fma_f32 v118, v118, s50, v235
v_mfma_f32_16x16x32_bf16 a[128:131], a[208:211], v[148:151], a[128:131]
s_waitcnt lgkmcnt(8)
v_exp_f32 v109, v109
v_mfma_f32_16x16x32_bf16 a[140:143], a[212:215], v[148:151], a[140:143]
s_waitcnt vmcnt(29)
s_barrier
v_add_u32 v4, 98304, v4
v_mfma_f32_16x16x32_bf16 a[136:139], a[212:215], v[140:143], a[136:139]
s_add_u32 m0, s48, 0
ds_read_b128 a[208:211], v4 offset:16384
s_mov_b32 s49, 131072
v_mfma_f32_16x16x32_bf16 a[132:135], a[212:215], v[132:135], a[132:135]
s_waitcnt lgkmcnt(7)
buffer_load_dwordx4 v16, s[24:27], s49 offen nt lds
v_mfma_f32_16x16x32_bf16 a[144:147], a[216:219], v[132:135], a[144:147]
ds_read_b128 a[212:215], v4 offset:24576
v_fma_f32 v119, v119, s50, v235
v_mfma_f32_16x16x32_bf16 a[148:151], a[216:219], v[140:143], a[148:151]
v_exp_f32 v110, v110
v_mfma_f32_16x16x32_bf16 a[152:155], a[216:219], v[148:151], a[152:155]
s_waitcnt lgkmcnt(6)
buffer_load_dwordx4 v17, s[24:27], s49 offen offset:1024 nt lds
v_mfma_f32_16x16x32_bf16 a[164:167], a[220:223], v[148:151], a[164:167]
v_add_u32 v5, 98304, v5
v_fma_f32 v100, v100, s50, v236
v_mfma_f32_16x16x32_bf16 a[160:163], a[220:223], v[140:143], a[160:163]
ds_read_b128 a[216:219], v5 offset:16384
v_fma_f32 v101, v101, s50, v236
v_mfma_f32_16x16x32_bf16 a[156:159], a[220:223], v[132:135], a[156:159]
s_waitcnt lgkmcnt(5)
v_exp_f32 v111, v111
v_mfma_f32_16x16x32_bf16 a[168:171], a[224:227], v[132:135], a[168:171]
ds_read_b128 a[220:223], v5 offset:24576
v_fma_f32 v102, v102, s50, v236
v_mfma_f32_16x16x32_bf16 a[172:175], a[224:227], v[140:143], a[172:175]
v_exp_f32 v92, v92
v_mfma_f32_16x16x32_bf16 a[176:179], a[224:227], v[148:151], a[176:179]
s_waitcnt lgkmcnt(4)
buffer_load_dwordx4 v18, s[24:27], s49 offen offset:2048 nt lds
v_mfma_f32_16x16x32_bf16 a[188:191], a[228:231], v[148:151], a[188:191]
v_add_u32 v6, 98304, v6
v_fma_f32 v103, v103, s50, v236
v_mfma_f32_16x16x32_bf16 a[184:187], a[228:231], v[140:143], a[184:187]
ds_read_b128 a[224:227], v6 offset:16384
v_fma_f32 v124, v124, s50, v236
v_mfma_f32_16x16x32_bf16 a[180:183], a[228:231], v[132:135], a[180:183]
s_cbranch_vccnz L_rb2
L_skipb2:
s_waitcnt lgkmcnt(4)
v_fma_f32 v125, v125, s50, v236
v_mfma_f32_16x16x32_bf16 v[36:39], a[208:211], v[32:35], 0
ds_read_b128 a[228:231], v6 offset:24576
v_fma_f32 v126, v126, s50, v236
v_mfma_f32_16x16x32_bf16 v[44:47], a[208:211], v[40:43], 0
buffer_load_dwordx4 v19, s[24:27], s49 offen offset:3072 nt lds
v_mfma_f32_16x16x32_bf16 v[52:55], a[208:211], v[48:51], 0
s_waitcnt lgkmcnt(4)
v_exp_f32 v93, v93
v_mfma_f32_16x16x32_bf16 v[76:79], a[212:215], v[48:51], 0
v_add_u32 v7, 98304, v7
v_fma_f32 v127, v127, s50, v236
v_mfma_f32_16x16x32_bf16 v[68:71], a[212:215], v[40:43], 0
ds_read_b128 a[208:211], v7 offset:16384
v_cvt_pk_bf16_f32 v132, v84, v85
v_mfma_f32_16x16x32_bf16 v[60:63], a[212:215], v[32:35], 0
s_waitcnt lgkmcnt(4)
v_exp_f32 v94, v94
v_mfma_f32_16x16x32_bf16 v[36:39], a[216:219], v[56:59], v[36:39]
ds_read_b128 a[212:215], v7 offset:24576
v_cvt_pk_bf16_f32 v133, v86, v87
v_mfma_f32_16x16x32_bf16 v[44:47], a[216:219], v[64:67], v[44:47]
v_exp_f32 v95, v95
v_mfma_f32_16x16x32_bf16 v[52:55], a[216:219], v[72:75], v[52:55]
s_waitcnt lgkmcnt(4)
v_exp_f32 v116, v116
v_mfma_f32_16x16x32_bf16 v[76:79], a[220:223], v[72:75], v[76:79]
ds_read_b128 a[216:219], v4 offset:16640
v_cvt_pk_bf16_f32 v134, v108, v109
v_mfma_f32_16x16x32_bf16 v[68:71], a[220:223], v[64:67], v[68:71]
v_exp_f32 v117, v117
v_mfma_f32_16x16x32_bf16 v[60:63], a[220:223], v[56:59], v[60:63]
s_waitcnt lgkmcnt(4)
v_exp_f32 v118, v118
v_mfma_f32_16x16x32_bf16 v[36:39], a[224:227], v[80:83], v[36:39]
ds_read_b128 a[220:223], v4 offset:24832
v_cvt_pk_bf16_f32 v135, v110, v111
v_mfma_f32_16x16x32_bf16 v[44:47], a[224:227], v[88:91], v[44:47]
v_exp_f32 v119, v119
v_mfma_f32_16x16x32_bf16 v[52:55], a[224:227], v[96:99], v[52:55]
s_waitcnt lgkmcnt(4)
v_exp_f32 v100, v100
v_mfma_f32_16x16x32_bf16 v[76:79], a[228:231], v[96:99], v[76:79]
ds_read_b128 a[224:227], v5 offset:16640
v_cvt_pk_bf16_f32 v140, v92, v93
v_mfma_f32_16x16x32_bf16 v[68:71], a[228:231], v[88:91], v[68:71]
v_exp_f32 v101, v101
v_mfma_f32_16x16x32_bf16 v[60:63], a[228:231], v[80:83], v[60:63]
s_waitcnt lgkmcnt(4)
v_exp_f32 v102, v102
v_mfma_f32_16x16x32_bf16 v[36:39], a[208:211], v[104:107], v[36:39]
ds_read_b128 a[228:231], v5 offset:24832
v_cvt_pk_bf16_f32 v141, v94, v95
v_mfma_f32_16x16x32_bf16 v[44:47], a[208:211], v[112:115], v[44:47]
v_exp_f32 v103, v103
v_mfma_f32_16x16x32_bf16 v[52:55], a[208:211], v[120:123], v[52:55]
s_waitcnt lgkmcnt(4)
v_exp_f32 v124, v124
v_mfma_f32_16x16x32_bf16 v[76:79], a[212:215], v[120:123], v[76:79]
ds_read_b128 a[208:211], v6 offset:16640
v_cvt_pk_bf16_f32 v142, v116, v117
v_mfma_f32_16x16x32_bf16 v[68:71], a[212:215], v[112:115], v[68:71]
v_exp_f32 v125, v125
v_mfma_f32_16x16x32_bf16 v[60:63], a[212:215], v[104:107], v[60:63]
s_waitcnt lgkmcnt(4)
v_exp_f32 v126, v126
v_mfma_f32_16x16x32_bf16 v[36:39], a[216:219], v[128:131], v[36:39]
ds_read_b128 a[212:215], v6 offset:24832
v_cvt_pk_bf16_f32 v143, v118, v119
v_mfma_f32_16x16x32_bf16 v[44:47], a[216:219], v[136:139], v[44:47]
v_exp_f32 v127, v127
v_mfma_f32_16x16x32_bf16 v[52:55], a[216:219], v[144:147], v[52:55]
s_waitcnt lgkmcnt(4)
v_cvt_pk_bf16_f32 v148, v100, v101
v_cvt_pk_bf16_f32 v149, v102, v103
v_mfma_f32_16x16x32_bf16 v[76:79], a[220:223], v[144:147], v[76:79]
ds_read_b128 a[216:219], v7 offset:16640
v_cvt_pk_bf16_f32 v150, v124, v125
v_mfma_f32_16x16x32_bf16 v[68:71], a[220:223], v[136:139], v[68:71]
v_cvt_pk_bf16_f32 v151, v126, v127
v_mfma_f32_16x16x32_bf16 v[60:63], a[220:223], v[128:131], v[60:63]
s_waitcnt lgkmcnt(4)
v_mfma_f32_16x16x32_bf16 v[36:39], a[224:227], v[152:155], v[36:39]
ds_read_b128 a[220:223], v7 offset:24832
v_mfma_f32_16x16x32_bf16 v[44:47], a[224:227], v[160:163], v[44:47]
v_mfma_f32_16x16x32_bf16 v[52:55], a[224:227], v[168:171], v[52:55]
s_waitcnt lgkmcnt(4)
v_mfma_f32_16x16x32_bf16 v[76:79], a[228:231], v[168:171], v[76:79]
s_waitcnt vmcnt(29)
s_barrier
v_add_u32 v8, 4294934528, v8
v_mfma_f32_16x16x32_bf16 v[68:71], a[228:231], v[160:163], v[68:71]
s_add_u32 m0, s48, 98304
ds_read_b64_tr_b16 a[224:225], v8 offset:0
s_mov_b32 s49, 114688
v_mfma_f32_16x16x32_bf16 v[60:63], a[228:231], v[152:155], v[60:63]
s_waitcnt lgkmcnt(4)
ds_read_b64_tr_b16 a[226:227], v8 offset:8192
v_mfma_f32_16x16x32_bf16 v[36:39], a[208:211], v[176:179], v[36:39]
buffer_load_dwordx4 v16, s[28:31], s49 offen nt lds
v_mfma_f32_16x16x32_bf16 v[44:47], a[208:211], v[184:187], v[44:47]
v_add_u32 v9, 4294934528, v9
v_mfma_f32_16x16x32_bf16 v[52:55], a[208:211], v[192:195], v[52:55]
s_waitcnt lgkmcnt(4)
ds_read_b64_tr_b16 a[228:229], v9 offset:0
v_mfma_f32_16x16x32_bf16 v[76:79], a[212:215], v[192:195], v[76:79]
ds_read_b64_tr_b16 a[230:231], v9 offset:8192
v_add_u32 v10, 4294934528, v10
v_mfma_f32_16x16x32_bf16 v[68:71], a[212:215], v[184:187], v[68:71]
ds_read_b64_tr_b16 a[208:209], v10 offset:0
v_mfma_f32_16x16x32_bf16 v[60:63], a[212:215], v[176:179], v[60:63]
s_waitcnt lgkmcnt(6)
ds_read_b64_tr_b16 a[210:211], v10 offset:8192
v_mfma_f32_16x16x32_bf16 v[36:39], a[216:219], v[200:203], v[36:39]
buffer_load_dwordx4 v17, s[28:31], s49 offen offset:1024 nt lds
v_mfma_f32_16x16x32_bf16 v[44:47], a[216:219], v[208:211], v[44:47]
v_add_u32 v11, 4294934528, v11
v_mfma_f32_16x16x32_bf16 v[52:55], a[216:219], v[216:219], v[52:55]
s_waitcnt lgkmcnt(6)
ds_read_b64_tr_b16 a[212:213], v11 offset:0
v_mfma_f32_16x16x32_bf16 v[76:79], a[220:223], v[216:219], v[76:79]
ds_read_b64_tr_b16 a[214:215], v11 offset:8192
v_add_u32 v12, 4294934528, v12
v_mfma_f32_16x16x32_bf16 v[68:71], a[220:223], v[208:211], v[68:71]
ds_read_b64_tr_b16 a[216:217], v12 offset:0
v_mfma_f32_16x16x32_bf16 v[60:63], a[220:223], v[200:203], v[60:63]
ds_read_b64_tr_b16 a[218:219], v12 offset:8192
v_mfma_f32_16x16x32_bf16 a[192:195], a[204:207], v[132:135], a[192:195]
buffer_load_dwordx4 v18, s[28:31], s49 offen offset:2048 nt lds
v_mfma_f32_16x16x32_bf16 a[196:199], a[204:207], v[140:143], a[196:199]
v_mfma_f32_16x16x32_bf16 a[200:203], a[204:207], v[148:151], a[200:203]
s_waitcnt lgkmcnt(8)
v_mfma_f32_16x16x32_bf16 a[0:3], a[224:227], v[132:135], a[0:3]
buffer_load_dwordx4 v19, s[28:31], s49 offen offset:3072 nt lds
v_mfma_f32_16x16x32_bf16 a[4:7], a[224:227], v[140:143], a[4:7]
v_add_u32 v13, 4294934528, v13
v_max3_f32 v156, v36, v37, v38
v_mfma_f32_16x16x32_bf16 a[8:11], a[224:227], v[148:151], a[8:11]
s_waitcnt lgkmcnt(6)
ds_read_b64_tr_b16 a[220:221], v13 offset:0
v_max3_f32 v157, v44, v45, v46
v_mfma_f32_16x16x32_bf16 a[20:23], a[228:231], v[148:151], a[20:23]
ds_read_b64_tr_b16 a[222:223], v13 offset:8192
v_add_u32 v14, 4294934528, v14
v_mfma_f32_16x16x32_bf16 a[16:19], a[228:231], v[140:143], a[16:19]
ds_read_b64_tr_b16 a[224:225], v14 offset:0
v_max3_f32 v158, v52, v53, v54
v_mfma_f32_16x16x32_bf16 a[12:15], a[228:231], v[132:135], a[12:15]
s_waitcnt lgkmcnt(7)
ds_read_b64_tr_b16 a[226:227], v14 offset:8192
v_max3_f32 v156, v156, v39, v60
v_mfma_f32_16x16x32_bf16 a[24:27], a[208:211], v[132:135], a[24:27]
v_add_u32 v15, 4294934528, v15
v_max3_f32 v157, v157, v47, v68
v_mfma_f32_16x16x32_bf16 a[28:31], a[208:211], v[140:143], a[28:31]
ds_read_b64_tr_b16 a[228:229], v15 offset:0
v_max3_f32 v158, v158, v55, v76
v_mfma_f32_16x16x32_bf16 a[32:35], a[208:211], v[148:151], a[32:35]
s_waitcnt lgkmcnt(7)
ds_read_b64_tr_b16 a[230:231], v15 offset:8192
v_max3_f32 v156, v156, v61, v62
v_mfma_f32_16x16x32_bf16 a[44:47], a[212:215], v[148:151], a[44:47]
ds_read_b64_tr_b16 a[208:209], v8 offset:256
v_max3_f32 v157, v157, v69, v70
v_mfma_f32_16x16x32_bf16 a[40:43], a[212:215], v[140:143], a[40:43]
ds_read_b64_tr_b16 a[210:211], v8 offset:8448
v_max3_f32 v158, v158, v77, v78
v_mfma_f32_16x16x32_bf16 a[36:39], a[212:215], v[132:135], a[36:39]
s_waitcnt lgkmcnt(8)
v_max_f32 v156, v156, v63
v_max_f32 v157, v157, v71
v_mfma_f32_16x16x32_bf16 a[48:51], a[216:219], v[132:135], a[48:51]
ds_read_b64_tr_b16 a[212:213], v9 offset:256
v_max_f32 v158, v158, v79
v_mfma_f32_16x16x32_bf16 a[52:55], a[216:219], v[140:143], a[52:55]
ds_read_b64_tr_b16 a[214:215], v9 offset:8448
v_fma_f32 v164, v156, s50, v234
v_mfma_f32_16x16x32_bf16 a[56:59], a[216:219], v[148:151], a[56:59]
s_waitcnt lgkmcnt(8)
v_fma_f32 v165, v157, s50, v235
v_fma_f32 v166, v158, s50, v236
v_mfma_f32_16x16x32_bf16 a[68:71], a[220:223], v[148:151], a[68:71]
ds_read_b64_tr_b16 a[216:217], v10 offset:256
v_max3_f32 v167, v164, v165, v166
v_mfma_f32_16x16x32_bf16 a[64:67], a[220:223], v[140:143], a[64:67]
ds_read_b64_tr_b16 a[218:219], v10 offset:8448
v_cmp_lt_f32 vcc, s51, v167
v_mfma_f32_16x16x32_bf16 a[60:63], a[220:223], v[132:135], a[60:63]
s_waitcnt lgkmcnt(8)
s_cbranch_vccnz L_ra3
L_skipa3:
v_fma_f32 v36, v36, s50, v234
v_mfma_f32_16x16x32_bf16 a[72:75], a[224:227], v[132:135], a[72:75]
ds_read_b64_tr_b16 a[220:221], v11 offset:256
v_fma_f32 v37, v37, s50, v234
v_mfma_f32_16x16x32_bf16 a[76:79], a[224:227], v[140:143], a[76:79]
ds_read_b64_tr_b16 a[222:223], v11 offset:8448
v_fma_f32 v38, v38, s50, v234
v_mfma_f32_16x16x32_bf16 a[80:83], a[224:227], v[148:151], a[80:83]
s_waitcnt lgkmcnt(8)
v_fma_f32 v39, v39, s50, v234
v_fma_f32 v60, v60, s50, v234
v_mfma_f32_16x16x32_bf16 a[92:95], a[228:231], v[148:151], a[92:95]
ds_read_b64_tr_b16 a[224:225], v12 offset:256
v_fma_f32 v61, v61, s50, v234
v_mfma_f32_16x16x32_bf16 a[88:91], a[228:231], v[140:143], a[88:91]
ds_read_b64_tr_b16 a[226:227], v12 offset:8448
v_fma_f32 v62, v62, s50, v234
v_mfma_f32_16x16x32_bf16 a[84:87], a[228:231], v[132:135], a[84:87]
s_waitcnt lgkmcnt(8)
v_exp_f32 v36, v36
v_mfma_f32_16x16x32_bf16 a[96:99], a[208:211], v[132:135], a[96:99]
ds_read_b64_tr_b16 a[228:229], v13 offset:256
v_fma_f32 v63, v63, s50, v234
v_mfma_f32_16x16x32_bf16 a[100:103], a[208:211], v[140:143], a[100:103]
ds_read_b64_tr_b16 a[230:231], v13 offset:8448
v_fma_f32 v44, v44, s50, v235
v_mfma_f32_16x16x32_bf16 a[104:107], a[208:211], v[148:151], a[104:107]
s_waitcnt lgkmcnt(8)
v_exp_f32 v37, v37
v_mfma_f32_16x16x32_bf16 a[116:119], a[212:215], v[148:151], a[116:119]
ds_read_b64_tr_b16 a[208:209], v14 offset:256
v_fma_f32 v45, v45, s50, v235
v_mfma_f32_16x16x32_bf16 a[112:115], a[212:215], v[140:143], a[112:115]
ds_read_b64_tr_b16 a[210:211], v14 offset:8448
v_fma_f32 v46, v46, s50, v235
v_mfma_f32_16x16x32_bf16 a[108:111], a[212:215], v[132:135], a[108:111]
s_waitcnt lgkmcnt(8)
v_exp_f32 v38, v38
v_mfma_f32_16x16x32_bf16 a[120:123], a[216:219], v[132:135], a[120:123]
ds_read_b64_tr_b16 a[212:213], v15 offset:256
v_fma_f32 v47, v47, s50, v235
v_mfma_f32_16x16x32_bf16 a[124:127], a[216:219], v[140:143], a[124:127]
ds_read_b64_tr_b16 a[214:215], v15 offset:8448
v_fma_f32 v68, v68, s50, v235
v_mfma_f32_16x16x32_bf16 a[128:131], a[216:219], v[148:151], a[128:131]
s_waitcnt lgkmcnt(8)
v_exp_f32 v39, v39
v_mfma_f32_16x16x32_bf16 a[140:143], a[220:223], v[148:151], a[140:143]
s_waitcnt vmcnt(29)
s_barrier
v_add_u32 v4, 4294885376, v4
v_mfma_f32_16x16x32_bf16 a[136:139], a[220:223], v[140:143], a[136:139]
s_add_u32 m0, s48, 114688
ds_read_b128 a[216:219], v4 offset:0
s_mov_b32 s49, 147456
v_mfma_f32_16x16x32_bf16 a[132:135], a[220:223], v[132:135], a[132:135]
s_waitcnt lgkmcnt(7)
buffer_load_dwordx4 v16, s[24:27], s49 offen nt lds
v_mfma_f32_16x16x32_bf16 a[144:147], a[224:227], v[132:135], a[144:147]
ds_read_b128 a[220:223], v4 offset:8192
v_fma_f32 v69, v69, s50, v235
v_mfma_f32_16x16x32_bf16 a[148:151], a[224:227], v[140:143], a[148:151]
v_exp_f32 v60, v60
v_mfma_f32_16x16x32_bf16 a[152:155], a[224:227], v[148:151], a[152:155]
s_waitcnt lgkmcnt(6)
buffer_load_dwordx4 v17, s[24:27], s49 offen offset:1024 nt lds
v_mfma_f32_16x16x32_bf16 a[164:167], a[228:231], v[148:151], a[164:167]
v_add_u32 v5, 4294885376, v5
v_fma_f32 v70, v70, s50, v235
v_mfma_f32_16x16x32_bf16 a[160:163], a[228:231], v[140:143], a[160:163]
ds_read_b128 a[224:227], v5 offset:0
v_fma_f32 v71, v71, s50, v235
v_mfma_f32_16x16x32_bf16 a[156:159], a[228:231], v[132:135], a[156:159]
s_waitcnt lgkmcnt(5)
v_exp_f32 v61, v61
v_mfma_f32_16x16x32_bf16 a[168:171], a[208:211], v[132:135], a[168:171]
ds_read_b128 a[228:231], v5 offset:8192
v_fma_f32 v52, v52, s50, v236
v_mfma_f32_16x16x32_bf16 a[172:175], a[208:211], v[140:143], a[172:175]
v_exp_f32 v62, v62
v_mfma_f32_16x16x32_bf16 a[176:179], a[208:211], v[148:151], a[176:179]
s_waitcnt lgkmcnt(4)
buffer_load_dwordx4 v18, s[24:27], s49 offen offset:2048 nt lds
v_mfma_f32_16x16x32_bf16 a[188:191], a[212:215], v[148:151], a[188:191]
v_add_u32 v6, 4294885376, v6
v_fma_f32 v53, v53, s50, v236
v_mfma_f32_16x16x32_bf16 a[184:187], a[212:215], v[140:143], a[184:187]
ds_read_b128 a[208:211], v6 offset:0
v_fma_f32 v54, v54, s50, v236
v_mfma_f32_16x16x32_bf16 a[180:183], a[212:215], v[132:135], a[180:183]
s_cbranch_vccnz L_rb3
L_skipb3:
s_waitcnt lgkmcnt(4)
v_fma_f32 v55, v55, s50, v236
v_mfma_f32_16x16x32_bf16 v[84:87], a[216:219], v[32:35], 0
ds_read_b128 a[212:215], v6 offset:8192
v_fma_f32 v76, v76, s50, v236
v_mfma_f32_16x16x32_bf16 v[92:95], a[216:219], v[40:43], 0
buffer_load_dwordx4 v19, s[24:27], s49 offen offset:3072 nt lds
v_mfma_f32_16x16x32_bf16 v[100:103], a[216:219], v[48:51], 0
s_waitcnt lgkmcnt(4)
v_exp_f32 v63, v63
v_mfma_f32_16x16x32_bf16 v[124:127], a[220:223], v[48:51], 0
v_add_u32 v7, 4294885376, v7
v_fma_f32 v77, v77, s50, v236
v_mfma_f32_16x16x32_bf16 v[116:119], a[220:223], v[40:43], 0
ds_read_b128 a[216:219], v7 offset:0
v_fma_f32 v78, v78, s50, v236
v_mfma_f32_16x16x32_bf16 v[108:111], a[220:223], v[32:35], 0
s_waitcnt lgkmcnt(4)
v_exp_f32 v44, v44
v_mfma_f32_16x16x32_bf16 v[84:87], a[224:227], v[56:59], v[84:87]
ds_read_b128 a[220:223], v7 offset:8192
v_fma_f32 v79, v79, s50, v236
v_mfma_f32_16x16x32_bf16 v[92:95], a[224:227], v[64:67], v[92:95]
v_exp_f32 v45, v45
v_mfma_f32_16x16x32_bf16 v[100:103], a[224:227], v[72:75], v[100:103]
s_waitcnt lgkmcnt(4)
v_exp_f32 v46, v46
v_mfma_f32_16x16x32_bf16 v[124:127], a[228:231], v[72:75], v[124:127]
ds_read_b128 a[224:227], v4 offset:256
v_cvt_pk_bf16_f32 v132, v36, v37
v_mfma_f32_16x16x32_bf16 v[116:119], a[228:231], v[64:67], v[116:119]
v_exp_f32 v47, v47
v_mfma_f32_16x16x32_bf16 v[108:111], a[228:231], v[56:59], v[108:111]
s_waitcnt lgkmcnt(4)
v_exp_f32 v68, v68
v_mfma_f32_16x16x32_bf16 v[84:87], a[208:211], v[80:83], v[84:87]
ds_read_b128 a[228:231], v4 offset:8448
v_cvt_pk_bf16_f32 v133, v38, v39
v_mfma_f32_16x16x32_bf16 v[92:95], a[208:211], v[88:91], v[92:95]
v_exp_f32 v69, v69
v_mfma_f32_16x16x32_bf16 v[100:103], a[208:211], v[96:99], v[100:103]
s_waitcnt lgkmcnt(4)
v_exp_f32 v70, v70
v_mfma_f32_16x16x32_bf16 v[124:127], a[212:215], v[96:99], v[124:127]
ds_read_b128 a[208:211], v5 offset:256
v_cvt_pk_bf16_f32 v134, v60, v61
v_mfma_f32_16x16x32_bf16 v[116:119], a[212:215], v[88:91], v[116:119]
v_exp_f32 v71, v71
v_mfma_f32_16x16x32_bf16 v[108:111], a[212:215], v[80:83], v[108:111]
s_waitcnt lgkmcnt(4)
v_exp_f32 v52, v52
v_mfma_f32_16x16x32_bf16 v[84:87], a[216:219], v[104:107], v[84:87]
ds_read_b128 a[212:215], v5 offset:8448
v_cvt_pk_bf16_f32 v135, v62, v63
v_mfma_f32_16x16x32_bf16 v[92:95], a[216:219], v[112:115], v[92:95]
v_exp_f32 v53, v53
v_mfma_f32_16x16x32_bf16 v[100:103], a[216:219], v[120:123], v[100:103]
s_waitcnt lgkmcnt(4)
v_exp_f32 v54, v54
v_mfma_f32_16x16x32_bf16 v[124:127], a[220:223], v[120:123], v[124:127]
ds_read_b128 a[216:219], v6 offset:256
v_cvt_pk_bf16_f32 v140, v44, v45
v_mfma_f32_16x16x32_bf16 v[116:119], a[220:223], v[112:115], v[116:119]
v_exp_f32 v55, v55
v_mfma_f32_16x16x32_bf16 v[108:111], a[220:223], v[104:107], v[108:111]
s_waitcnt lgkmcnt(4)
v_exp_f32 v76, v76
v_mfma_f32_16x16x32_bf16 v[84:87], a[224:227], v[128:131], v[84:87]
ds_read_b128 a[220:223], v6 offset:8448
v_cvt_pk_bf16_f32 v141, v46, v47
v_mfma_f32_16x16x32_bf16 v[92:95], a[224:227], v[136:139], v[92:95]
v_exp_f32 v77, v77
v_mfma_f32_16x16x32_bf16 v[100:103], a[224:227], v[144:147], v[100:103]
s_waitcnt lgkmcnt(4)
v_exp_f32 v78, v78
v_mfma_f32_16x16x32_bf16 v[124:127], a[228:231], v[144:147], v[124:127]
ds_read_b128 a[224:227], v7 offset:256
v_cvt_pk_bf16_f32 v142, v68, v69
v_mfma_f32_16x16x32_bf16 v[116:119], a[228:231], v[136:139], v[116:119]
v_exp_f32 v79, v79
v_mfma_f32_16x16x32_bf16 v[108:111], a[228:231], v[128:131], v[108:111]
s_waitcnt lgkmcnt(4)
v_cvt_pk_bf16_f32 v143, v70, v71
v_cvt_pk_bf16_f32 v148, v52, v53
v_mfma_f32_16x16x32_bf16 v[84:87], a[208:211], v[152:155], v[84:87]
ds_read_b128 a[228:231], v7 offset:8448
v_cvt_pk_bf16_f32 v149, v54, v55
v_mfma_f32_16x16x32_bf16 v[92:95], a[208:211], v[160:163], v[92:95]
v_cvt_pk_bf16_f32 v150, v76, v77
v_cvt_pk_bf16_f32 v151, v78, v79
v_mfma_f32_16x16x32_bf16 v[100:103], a[208:211], v[168:171], v[100:103]
s_waitcnt lgkmcnt(4)
v_mfma_f32_16x16x32_bf16 v[124:127], a[212:215], v[168:171], v[124:127]
s_waitcnt vmcnt(29)
s_barrier
v_add_u32 v8, 49152, v8
v_mfma_f32_16x16x32_bf16 v[116:119], a[212:215], v[160:163], v[116:119]
s_add_u32 m0, s48, 49152
ds_read_b64_tr_b16 a[208:209], v8 offset:49152
s_mov_b32 s49, 131072
v_mfma_f32_16x16x32_bf16 v[108:111], a[212:215], v[152:155], v[108:111]
s_waitcnt lgkmcnt(4)
ds_read_b64_tr_b16 a[210:211], v8 offset:57344
v_mfma_f32_16x16x32_bf16 v[84:87], a[216:219], v[176:179], v[84:87]
buffer_load_dwordx4 v16, s[28:31], s49 offen nt lds
v_mfma_f32_16x16x32_bf16 v[92:95], a[216:219], v[184:187], v[92:95]
v_add_u32 v9, 49152, v9
v_mfma_f32_16x16x32_bf16 v[100:103], a[216:219], v[192:195], v[100:103]
s_waitcnt lgkmcnt(4)
ds_read_b64_tr_b16 a[212:213], v9 offset:49152
v_mfma_f32_16x16x32_bf16 v[124:127], a[220:223], v[192:195], v[124:127]
ds_read_b64_tr_b16 a[214:215], v9 offset:57344
v_add_u32 v10, 49152, v10
v_mfma_f32_16x16x32_bf16 v[116:119], a[220:223], v[184:187], v[116:119]
ds_read_b64_tr_b16 a[216:217], v10 offset:49152
v_mfma_f32_16x16x32_bf16 v[108:111], a[220:223], v[176:179], v[108:111]
s_waitcnt lgkmcnt(6)
ds_read_b64_tr_b16 a[218:219], v10 offset:57344
v_mfma_f32_16x16x32_bf16 v[84:87], a[224:227], v[200:203], v[84:87]
buffer_load_dwordx4 v17, s[28:31], s49 offen offset:1024 nt lds
v_mfma_f32_16x16x32_bf16 v[92:95], a[224:227], v[208:211], v[92:95]
v_add_u32 v11, 49152, v11
v_mfma_f32_16x16x32_bf16 v[100:103], a[224:227], v[216:219], v[100:103]
s_waitcnt lgkmcnt(6)
ds_read_b64_tr_b16 a[220:221], v11 offset:49152
v_mfma_f32_16x16x32_bf16 v[124:127], a[228:231], v[216:219], v[124:127]
ds_read_b64_tr_b16 a[222:223], v11 offset:57344
v_add_u32 v12, 49152, v12
v_mfma_f32_16x16x32_bf16 v[116:119], a[228:231], v[208:211], v[116:119]
ds_read_b64_tr_b16 a[224:225], v12 offset:49152
v_mfma_f32_16x16x32_bf16 v[108:111], a[228:231], v[200:203], v[108:111]
ds_read_b64_tr_b16 a[226:227], v12 offset:57344
v_mfma_f32_16x16x32_bf16 a[192:195], a[204:207], v[132:135], a[192:195]
buffer_load_dwordx4 v18, s[28:31], s49 offen offset:2048 nt lds
v_mfma_f32_16x16x32_bf16 a[196:199], a[204:207], v[140:143], a[196:199]
v_mfma_f32_16x16x32_bf16 a[200:203], a[204:207], v[148:151], a[200:203]
s_waitcnt lgkmcnt(8)
v_mfma_f32_16x16x32_bf16 a[0:3], a[208:211], v[132:135], a[0:3]
buffer_load_dwordx4 v19, s[28:31], s49 offen offset:3072 nt lds
v_mfma_f32_16x16x32_bf16 a[4:7], a[208:211], v[140:143], a[4:7]
v_add_u32 v13, 49152, v13
v_max3_f32 v156, v84, v85, v86
v_mfma_f32_16x16x32_bf16 a[8:11], a[208:211], v[148:151], a[8:11]
s_waitcnt lgkmcnt(6)
ds_read_b64_tr_b16 a[228:229], v13 offset:49152
v_max3_f32 v157, v92, v93, v94
v_mfma_f32_16x16x32_bf16 a[20:23], a[212:215], v[148:151], a[20:23]
ds_read_b64_tr_b16 a[230:231], v13 offset:57344
v_add_u32 v14, 49152, v14
v_mfma_f32_16x16x32_bf16 a[16:19], a[212:215], v[140:143], a[16:19]
ds_read_b64_tr_b16 a[208:209], v14 offset:49152
v_max3_f32 v158, v100, v101, v102
v_mfma_f32_16x16x32_bf16 a[12:15], a[212:215], v[132:135], a[12:15]
s_waitcnt lgkmcnt(7)
ds_read_b64_tr_b16 a[210:211], v14 offset:57344
v_max3_f32 v156, v156, v87, v108
v_mfma_f32_16x16x32_bf16 a[24:27], a[216:219], v[132:135], a[24:27]
v_add_u32 v15, 49152, v15
v_max3_f32 v157, v157, v95, v116
v_mfma_f32_16x16x32_bf16 a[28:31], a[216:219], v[140:143], a[28:31]
ds_read_b64_tr_b16 a[212:213], v15 offset:49152
v_max3_f32 v158, v158, v103, v124
v_mfma_f32_16x16x32_bf16 a[32:35], a[216:219], v[148:151], a[32:35]
s_waitcnt lgkmcnt(7)
ds_read_b64_tr_b16 a[214:215], v15 offset:57344
v_max3_f32 v156, v156, v109, v110
v_mfma_f32_16x16x32_bf16 a[44:47], a[220:223], v[148:151], a[44:47]
ds_read_b64_tr_b16 a[216:217], v8 offset:49408
v_max3_f32 v157, v157, v117, v118
v_mfma_f32_16x16x32_bf16 a[40:43], a[220:223], v[140:143], a[40:43]
ds_read_b64_tr_b16 a[218:219], v8 offset:57600
v_max3_f32 v158, v158, v125, v126
v_mfma_f32_16x16x32_bf16 a[36:39], a[220:223], v[132:135], a[36:39]
s_waitcnt lgkmcnt(8)
v_max_f32 v156, v156, v111
v_max_f32 v157, v157, v119
v_mfma_f32_16x16x32_bf16 a[48:51], a[224:227], v[132:135], a[48:51]
ds_read_b64_tr_b16 a[220:221], v9 offset:49408
v_max_f32 v158, v158, v127
v_mfma_f32_16x16x32_bf16 a[52:55], a[224:227], v[140:143], a[52:55]
ds_read_b64_tr_b16 a[222:223], v9 offset:57600
v_fma_f32 v164, v156, s50, v234
v_mfma_f32_16x16x32_bf16 a[56:59], a[224:227], v[148:151], a[56:59]
s_waitcnt lgkmcnt(8)
v_fma_f32 v165, v157, s50, v235
v_fma_f32 v166, v158, s50, v236
v_mfma_f32_16x16x32_bf16 a[68:71], a[228:231], v[148:151], a[68:71]
ds_read_b64_tr_b16 a[224:225], v10 offset:49408
v_max3_f32 v167, v164, v165, v166
v_mfma_f32_16x16x32_bf16 a[64:67], a[228:231], v[140:143], a[64:67]
ds_read_b64_tr_b16 a[226:227], v10 offset:57600
v_cmp_lt_f32 vcc, s51, v167
v_mfma_f32_16x16x32_bf16 a[60:63], a[228:231], v[132:135], a[60:63]
s_waitcnt lgkmcnt(8)
s_cbranch_vccnz L_ra4
L_skipa4:
v_fma_f32 v84, v84, s50, v234
v_mfma_f32_16x16x32_bf16 a[72:75], a[208:211], v[132:135], a[72:75]
ds_read_b64_tr_b16 a[228:229], v11 offset:49408
v_fma_f32 v85, v85, s50, v234
v_mfma_f32_16x16x32_bf16 a[76:79], a[208:211], v[140:143], a[76:79]
ds_read_b64_tr_b16 a[230:231], v11 offset:57600
v_fma_f32 v86, v86, s50, v234
v_mfma_f32_16x16x32_bf16 a[80:83], a[208:211], v[148:151], a[80:83]
s_waitcnt lgkmcnt(8)
v_fma_f32 v87, v87, s50, v234
v_fma_f32 v108, v108, s50, v234
v_mfma_f32_16x16x32_bf16 a[92:95], a[212:215], v[148:151], a[92:95]
ds_read_b64_tr_b16 a[208:209], v12 offset:49408
v_fma_f32 v109, v109, s50, v234
v_mfma_f32_16x16x32_bf16 a[88:91], a[212:215], v[140:143], a[88:91]
ds_read_b64_tr_b16 a[210:211], v12 offset:57600
v_fma_f32 v110, v110, s50, v234
v_mfma_f32_16x16x32_bf16 a[84:87], a[212:215], v[132:135], a[84:87]
s_waitcnt lgkmcnt(8)
v_exp_f32 v84, v84
v_mfma_f32_16x16x32_bf16 a[96:99], a[216:219], v[132:135], a[96:99]
ds_read_b64_tr_b16 a[212:213], v13 offset:49408
v_fma_f32 v111, v111, s50, v234
v_mfma_f32_16x16x32_bf16 a[100:103], a[216:219], v[140:143], a[100:103]
ds_read_b64_tr_b16 a[214:215], v13 offset:57600
v_fma_f32 v92, v92, s50, v235
v_mfma_f32_16x16x32_bf16 a[104:107], a[216:219], v[148:151], a[104:107]
s_waitcnt lgkmcnt(8)
v_exp_f32 v85, v85
v_mfma_f32_16x16x32_bf16 a[116:119], a[220:223], v[148:151], a[116:119]
ds_read_b64_tr_b16 a[216:217], v14 offset:49408
v_fma_f32 v93, v93, s50, v235
v_mfma_f32_16x16x32_bf16 a[112:115], a[220:223], v[140:143], a[112:115]
ds_read_b64_tr_b16 a[218:219], v14 offset:57600
v_fma_f32 v94, v94, s50, v235
v_mfma_f32_16x16x32_bf16 a[108:111], a[220:223], v[132:135], a[108:111]
s_waitcnt lgkmcnt(8)
v_exp_f32 v86, v86
v_mfma_f32_16x16x32_bf16 a[120:123], a[224:227], v[132:135], a[120:123]
ds_read_b64_tr_b16 a[220:221], v15 offset:49408
v_fma_f32 v95, v95, s50, v235
v_mfma_f32_16x16x32_bf16 a[124:127], a[224:227], v[140:143], a[124:127]
ds_read_b64_tr_b16 a[222:223], v15 offset:57600
v_fma_f32 v116, v116, s50, v235
v_mfma_f32_16x16x32_bf16 a[128:131], a[224:227], v[148:151], a[128:131]
s_waitcnt lgkmcnt(8)
v_exp_f32 v87, v87
v_mfma_f32_16x16x32_bf16 a[140:143], a[228:231], v[148:151], a[140:143]
s_waitcnt vmcnt(29)
s_barrier
ds_read_b128 a[224:227], v4 offset:49152
v_mfma_f32_16x16x32_bf16 a[136:139], a[228:231], v[140:143], a[136:139]
s_add_u32 m0, s48, 16384
s_mov_b32 s49, 163840
v_fma_f32 v117, v117, s50, v235
v_mfma_f32_16x16x32_bf16 a[132:135], a[228:231], v[132:135], a[132:135]
s_waitcnt lgkmcnt(7)
buffer_load_dwordx4 v16, s[24:27], s49 offen nt lds
v_mfma_f32_16x16x32_bf16 a[144:147], a[208:211], v[132:135], a[144:147]
ds_read_b128 a[228:231], v4 offset:57344
v_fma_f32 v118, v118, s50, v235
v_mfma_f32_16x16x32_bf16 a[148:151], a[208:211], v[140:143], a[148:151]
v_exp_f32 v108, v108
v_mfma_f32_16x16x32_bf16 a[152:155], a[208:211], v[148:151], a[152:155]
s_waitcnt lgkmcnt(6)
buffer_load_dwordx4 v17, s[24:27], s49 offen offset:1024 nt lds
v_mfma_f32_16x16x32_bf16 a[164:167], a[212:215], v[148:151], a[164:167]
ds_read_b128 a[208:211], v5 offset:49152
v_fma_f32 v119, v119, s50, v235
v_mfma_f32_16x16x32_bf16 a[160:163], a[212:215], v[140:143], a[160:163]
v_exp_f32 v109, v109
v_mfma_f32_16x16x32_bf16 a[156:159], a[212:215], v[132:135], a[156:159]
s_waitcnt lgkmcnt(5)
v_exp_f32 v110, v110
v_mfma_f32_16x16x32_bf16 a[168:171], a[216:219], v[132:135], a[168:171]
ds_read_b128 a[212:215], v5 offset:57344
v_fma_f32 v100, v100, s50, v236
v_mfma_f32_16x16x32_bf16 a[172:175], a[216:219], v[140:143], a[172:175]
v_exp_f32 v111, v111
v_mfma_f32_16x16x32_bf16 a[176:179], a[216:219], v[148:151], a[176:179]
s_waitcnt lgkmcnt(4)
buffer_load_dwordx4 v18, s[24:27], s49 offen offset:2048 nt lds
v_mfma_f32_16x16x32_bf16 a[188:191], a[220:223], v[148:151], a[188:191]
ds_read_b128 a[216:219], v6 offset:49152
v_fma_f32 v101, v101, s50, v236
v_mfma_f32_16x16x32_bf16 a[184:187], a[220:223], v[140:143], a[184:187]
v_exp_f32 v92, v92
v_mfma_f32_16x16x32_bf16 a[180:183], a[220:223], v[132:135], a[180:183]
s_cbranch_vccnz L_rb4
L_skipb4:
s_waitcnt lgkmcnt(4)
v_fma_f32 v102, v102, s50, v236
v_mfma_f32_16x16x32_bf16 v[36:39], a[224:227], v[32:35], 0
ds_read_b128 a[220:223], v6 offset:57344
v_fma_f32 v103, v103, s50, v236
v_mfma_f32_16x16x32_bf16 v[44:47], a[224:227], v[40:43], 0
buffer_load_dwordx4 v19, s[24:27], s49 offen offset:3072 nt lds
v_mfma_f32_16x16x32_bf16 v[52:55], a[224:227], v[48:51], 0
s_waitcnt lgkmcnt(4)
v_exp_f32 v93, v93
v_mfma_f32_16x16x32_bf16 v[76:79], a[228:231], v[48:51], 0
ds_read_b128 a[224:227], v7 offset:49152
v_fma_f32 v124, v124, s50, v236
v_mfma_f32_16x16x32_bf16 v[68:71], a[228:231], v[40:43], 0
v_exp_f32 v94, v94
v_mfma_f32_16x16x32_bf16 v[60:63], a[228:231], v[32:35], 0
s_waitcnt lgkmcnt(4)
v_exp_f32 v95, v95
v_mfma_f32_16x16x32_bf16 v[36:39], a[208:211], v[56:59], v[36:39]
ds_read_b128 a[228:231], v7 offset:57344
v_fma_f32 v125, v125, s50, v236
v_mfma_f32_16x16x32_bf16 v[44:47], a[208:211], v[64:67], v[44:47]
v_exp_f32 v116, v116
v_mfma_f32_16x16x32_bf16 v[52:55], a[208:211], v[72:75], v[52:55]
s_waitcnt lgkmcnt(4)
v_exp_f32 v117, v117
v_mfma_f32_16x16x32_bf16 v[76:79], a[212:215], v[72:75], v[76:79]
ds_read_b128 a[208:211], v4 offset:49408
v_fma_f32 v126, v126, s50, v236
v_mfma_f32_16x16x32_bf16 v[68:71], a[212:215], v[64:67], v[68:71]
v_exp_f32 v118, v118
v_mfma_f32_16x16x32_bf16 v[60:63], a[212:215], v[56:59], v[60:63]
s_waitcnt lgkmcnt(4)
v_exp_f32 v119, v119
v_mfma_f32_16x16x32_bf16 v[36:39], a[216:219], v[80:83], v[36:39]
ds_read_b128 a[212:215], v4 offset:57600
v_fma_f32 v127, v127, s50, v236
v_mfma_f32_16x16x32_bf16 v[44:47], a[216:219], v[88:91], v[44:47]
v_exp_f32 v100, v100
v_mfma_f32_16x16x32_bf16 v[52:55], a[216:219], v[96:99], v[52:55]
s_waitcnt lgkmcnt(4)
v_exp_f32 v101, v101
v_mfma_f32_16x16x32_bf16 v[76:79], a[220:223], v[96:99], v[76:79]
ds_read_b128 a[216:219], v5 offset:49408
v_cvt_pk_bf16_f32 v132, v84, v85
v_mfma_f32_16x16x32_bf16 v[68:71], a[220:223], v[88:91], v[68:71]
v_exp_f32 v102, v102
v_mfma_f32_16x16x32_bf16 v[60:63], a[220:223], v[80:83], v[60:63]
s_waitcnt lgkmcnt(4)
v_exp_f32 v103, v103
v_mfma_f32_16x16x32_bf16 v[36:39], a[224:227], v[104:107], v[36:39]
ds_read_b128 a[220:223], v5 offset:57600
v_cvt_pk_bf16_f32 v133, v86, v87
v_mfma_f32_16x16x32_bf16 v[44:47], a[224:227], v[112:115], v[44:47]
v_exp_f32 v124, v124
v_mfma_f32_16x16x32_bf16 v[52:55], a[224:227], v[120:123], v[52:55]
s_waitcnt lgkmcnt(4)
v_exp_f32 v125, v125
v_mfma_f32_16x16x32_bf16 v[76:79], a[228:231], v[120:123], v[76:79]
ds_read_b128 a[224:227], v6 offset:49408
v_cvt_pk_bf16_f32 v134, v108, v109
v_mfma_f32_16x16x32_bf16 v[68:71], a[228:231], v[112:115], v[68:71]
v_exp_f32 v126, v126
v_mfma_f32_16x16x32_bf16 v[60:63], a[228:231], v[104:107], v[60:63]
s_waitcnt lgkmcnt(4)
v_exp_f32 v127, v127
v_mfma_f32_16x16x32_bf16 v[36:39], a[208:211], v[128:131], v[36:39]
ds_read_b128 a[228:231], v6 offset:57600
v_cvt_pk_bf16_f32 v135, v110, v111
v_mfma_f32_16x16x32_bf16 v[44:47], a[208:211], v[136:139], v[44:47]
v_cvt_pk_bf16_f32 v140, v92, v93
v_cvt_pk_bf16_f32 v141, v94, v95
v_mfma_f32_16x16x32_bf16 v[52:55], a[208:211], v[144:147], v[52:55]
s_waitcnt lgkmcnt(4)
v_cvt_pk_bf16_f32 v142, v116, v117
v_cvt_pk_bf16_f32 v143, v118, v119
v_mfma_f32_16x16x32_bf16 v[76:79], a[212:215], v[144:147], v[76:79]
ds_read_b128 a[208:211], v7 offset:49408
v_cvt_pk_bf16_f32 v148, v100, v101
v_mfma_f32_16x16x32_bf16 v[68:71], a[212:215], v[136:139], v[68:71]
v_cvt_pk_bf16_f32 v149, v102, v103
v_cvt_pk_bf16_f32 v150, v124, v125
v_mfma_f32_16x16x32_bf16 v[60:63], a[212:215], v[128:131], v[60:63]
s_waitcnt lgkmcnt(4)
v_cvt_pk_bf16_f32 v151, v126, v127
v_mfma_f32_16x16x32_bf16 v[36:39], a[216:219], v[152:155], v[36:39]
ds_read_b128 a[212:215], v7 offset:57600
v_mfma_f32_16x16x32_bf16 v[44:47], a[216:219], v[160:163], v[44:47]
v_mfma_f32_16x16x32_bf16 v[52:55], a[216:219], v[168:171], v[52:55]
s_waitcnt lgkmcnt(4)
v_mfma_f32_16x16x32_bf16 v[76:79], a[220:223], v[168:171], v[76:79]
s_waitcnt vmcnt(29)
s_barrier
v_add_u32 v8, 4294950912, v8
v_mfma_f32_16x16x32_bf16 v[68:71], a[220:223], v[160:163], v[68:71]
s_add_u32 m0, s48, 147456
ds_read_b64_tr_b16 a[216:217], v8 offset:0
s_mov_b32 s49, 147456
v_mfma_f32_16x16x32_bf16 v[60:63], a[220:223], v[152:155], v[60:63]
s_waitcnt lgkmcnt(4)
ds_read_b64_tr_b16 a[218:219], v8 offset:8192
v_mfma_f32_16x16x32_bf16 v[36:39], a[224:227], v[176:179], v[36:39]
buffer_load_dwordx4 v16, s[28:31], s49 offen nt lds
v_mfma_f32_16x16x32_bf16 v[44:47], a[224:227], v[184:187], v[44:47]
v_add_u32 v9, 4294950912, v9
v_mfma_f32_16x16x32_bf16 v[52:55], a[224:227], v[192:195], v[52:55]
s_waitcnt lgkmcnt(4)
ds_read_b64_tr_b16 a[220:221], v9 offset:0
v_mfma_f32_16x16x32_bf16 v[76:79], a[228:231], v[192:195], v[76:79]
ds_read_b64_tr_b16 a[222:223], v9 offset:8192
v_add_u32 v10, 4294950912, v10
v_mfma_f32_16x16x32_bf16 v[68:71], a[228:231], v[184:187], v[68:71]
ds_read_b64_tr_b16 a[224:225], v10 offset:0
v_mfma_f32_16x16x32_bf16 v[60:63], a[228:231], v[176:179], v[60:63]
s_waitcnt lgkmcnt(6)
ds_read_b64_tr_b16 a[226:227], v10 offset:8192
v_mfma_f32_16x16x32_bf16 v[36:39], a[208:211], v[200:203], v[36:39]
buffer_load_dwordx4 v17, s[28:31], s49 offen offset:1024 nt lds
v_mfma_f32_16x16x32_bf16 v[44:47], a[208:211], v[208:211], v[44:47]
v_add_u32 v11, 4294950912, v11
v_mfma_f32_16x16x32_bf16 v[52:55], a[208:211], v[216:219], v[52:55]
s_waitcnt lgkmcnt(6)
ds_read_b64_tr_b16 a[228:229], v11 offset:0
v_mfma_f32_16x16x32_bf16 v[76:79], a[212:215], v[216:219], v[76:79]
ds_read_b64_tr_b16 a[230:231], v11 offset:8192
v_add_u32 v12, 4294950912, v12
v_mfma_f32_16x16x32_bf16 v[68:71], a[212:215], v[208:211], v[68:71]
ds_read_b64_tr_b16 a[208:209], v12 offset:0
v_mfma_f32_16x16x32_bf16 v[60:63], a[212:215], v[200:203], v[60:63]
ds_read_b64_tr_b16 a[210:211], v12 offset:8192
v_mfma_f32_16x16x32_bf16 a[192:195], a[204:207], v[132:135], a[192:195]
buffer_load_dwordx4 v18, s[28:31], s49 offen offset:2048 nt lds
v_mfma_f32_16x16x32_bf16 a[196:199], a[204:207], v[140:143], a[196:199]
v_mfma_f32_16x16x32_bf16 a[200:203], a[204:207], v[148:151], a[200:203]
s_waitcnt lgkmcnt(8)
v_mfma_f32_16x16x32_bf16 a[0:3], a[216:219], v[132:135], a[0:3]
buffer_load_dwordx4 v19, s[28:31], s49 offen offset:3072 nt lds
v_mfma_f32_16x16x32_bf16 a[4:7], a[216:219], v[140:143], a[4:7]
v_add_u32 v13, 4294950912, v13
v_max3_f32 v156, v36, v37, v38
v_mfma_f32_16x16x32_bf16 a[8:11], a[216:219], v[148:151], a[8:11]
s_waitcnt lgkmcnt(6)
ds_read_b64_tr_b16 a[212:213], v13 offset:0
v_max3_f32 v157, v44, v45, v46
v_mfma_f32_16x16x32_bf16 a[20:23], a[220:223], v[148:151], a[20:23]
ds_read_b64_tr_b16 a[214:215], v13 offset:8192
v_add_u32 v14, 4294950912, v14
v_mfma_f32_16x16x32_bf16 a[16:19], a[220:223], v[140:143], a[16:19]
ds_read_b64_tr_b16 a[216:217], v14 offset:0
v_max3_f32 v158, v52, v53, v54
v_mfma_f32_16x16x32_bf16 a[12:15], a[220:223], v[132:135], a[12:15]
s_waitcnt lgkmcnt(7)
ds_read_b64_tr_b16 a[218:219], v14 offset:8192
v_max3_f32 v156, v156, v39, v60
v_mfma_f32_16x16x32_bf16 a[24:27], a[224:227], v[132:135], a[24:27]
v_add_u32 v15, 4294950912, v15
v_max3_f32 v157, v157, v47, v68
v_mfma_f32_16x16x32_bf16 a[28:31], a[224:227], v[140:143], a[28:31]
ds_read_b64_tr_b16 a[220:221], v15 offset:0
v_max3_f32 v158, v158, v55, v76
v_mfma_f32_16x16x32_bf16 a[32:35], a[224:227], v[148:151], a[32:35]
s_waitcnt lgkmcnt(7)
ds_read_b64_tr_b16 a[222:223], v15 offset:8192
v_max3_f32 v156, v156, v61, v62
v_mfma_f32_16x16x32_bf16 a[44:47], a[228:231], v[148:151], a[44:47]
ds_read_b64_tr_b16 a[224:225], v8 offset:256
v_max3_f32 v157, v157, v69, v70
v_mfma_f32_16x16x32_bf16 a[40:43], a[228:231], v[140:143], a[40:43]
ds_read_b64_tr_b16 a[226:227], v8 offset:8448
v_max3_f32 v158, v158, v77, v78
v_mfma_f32_16x16x32_bf16 a[36:39], a[228:231], v[132:135], a[36:39]
s_waitcnt lgkmcnt(8)
v_max_f32 v156, v156, v63
v_max_f32 v157, v157, v71
v_mfma_f32_16x16x32_bf16 a[48:51], a[208:211], v[132:135], a[48:51]
ds_read_b64_tr_b16 a[228:229], v9 offset:256
v_max_f32 v158, v158, v79
v_mfma_f32_16x16x32_bf16 a[52:55], a[208:211], v[140:143], a[52:55]
ds_read_b64_tr_b16 a[230:231], v9 offset:8448
v_fma_f32 v164, v156, s50, v234
v_mfma_f32_16x16x32_bf16 a[56:59], a[208:211], v[148:151], a[56:59]
s_waitcnt lgkmcnt(8)
v_fma_f32 v165, v157, s50, v235
v_fma_f32 v166, v158, s50, v236
v_mfma_f32_16x16x32_bf16 a[68:71], a[212:215], v[148:151], a[68:71]
ds_read_b64_tr_b16 a[208:209], v10 offset:256
v_max3_f32 v167, v164, v165, v166
v_mfma_f32_16x16x32_bf16 a[64:67], a[212:215], v[140:143], a[64:67]
ds_read_b64_tr_b16 a[210:211], v10 offset:8448
v_cmp_lt_f32 vcc, s51, v167
v_mfma_f32_16x16x32_bf16 a[60:63], a[212:215], v[132:135], a[60:63]
s_waitcnt lgkmcnt(8)
s_cbranch_vccnz L_ra5
L_skipa5:
v_fma_f32 v36, v36, s50, v234
v_mfma_f32_16x16x32_bf16 a[72:75], a[216:219], v[132:135], a[72:75]
ds_read_b64_tr_b16 a[212:213], v11 offset:256
v_fma_f32 v37, v37, s50, v234
v_mfma_f32_16x16x32_bf16 a[76:79], a[216:219], v[140:143], a[76:79]
ds_read_b64_tr_b16 a[214:215], v11 offset:8448
v_fma_f32 v38, v38, s50, v234
v_mfma_f32_16x16x32_bf16 a[80:83], a[216:219], v[148:151], a[80:83]
s_waitcnt lgkmcnt(8)
v_fma_f32 v39, v39, s50, v234
v_fma_f32 v60, v60, s50, v234
v_mfma_f32_16x16x32_bf16 a[92:95], a[220:223], v[148:151], a[92:95]
ds_read_b64_tr_b16 a[216:217], v12 offset:256
v_fma_f32 v61, v61, s50, v234
v_mfma_f32_16x16x32_bf16 a[88:91], a[220:223], v[140:143], a[88:91]
ds_read_b64_tr_b16 a[218:219], v12 offset:8448
v_fma_f32 v62, v62, s50, v234
v_mfma_f32_16x16x32_bf16 a[84:87], a[220:223], v[132:135], a[84:87]
s_waitcnt lgkmcnt(8)
v_exp_f32 v36, v36
v_mfma_f32_16x16x32_bf16 a[96:99], a[224:227], v[132:135], a[96:99]
ds_read_b64_tr_b16 a[220:221], v13 offset:256
v_fma_f32 v63, v63, s50, v234
v_mfma_f32_16x16x32_bf16 a[100:103], a[224:227], v[140:143], a[100:103]
ds_read_b64_tr_b16 a[222:223], v13 offset:8448
v_fma_f32 v44, v44, s50, v235
v_mfma_f32_16x16x32_bf16 a[104:107], a[224:227], v[148:151], a[104:107]
s_waitcnt lgkmcnt(8)
v_exp_f32 v37, v37
v_mfma_f32_16x16x32_bf16 a[116:119], a[228:231], v[148:151], a[116:119]
ds_read_b64_tr_b16 a[224:225], v14 offset:256
v_fma_f32 v45, v45, s50, v235
v_mfma_f32_16x16x32_bf16 a[112:115], a[228:231], v[140:143], a[112:115]
ds_read_b64_tr_b16 a[226:227], v14 offset:8448
v_fma_f32 v46, v46, s50, v235
v_mfma_f32_16x16x32_bf16 a[108:111], a[228:231], v[132:135], a[108:111]
s_waitcnt lgkmcnt(8)
v_exp_f32 v38, v38
v_mfma_f32_16x16x32_bf16 a[120:123], a[208:211], v[132:135], a[120:123]
ds_read_b64_tr_b16 a[228:229], v15 offset:256
v_fma_f32 v47, v47, s50, v235
v_mfma_f32_16x16x32_bf16 a[124:127], a[208:211], v[140:143], a[124:127]
ds_read_b64_tr_b16 a[230:231], v15 offset:8448
v_fma_f32 v68, v68, s50, v235
v_mfma_f32_16x16x32_bf16 a[128:131], a[208:211], v[148:151], a[128:131]
s_waitcnt lgkmcnt(8)
v_exp_f32 v39, v39
v_mfma_f32_16x16x32_bf16 a[140:143], a[212:215], v[148:151], a[140:143]
s_waitcnt vmcnt(28)
s_barrier
ds_read_b128 a[208:211], v4 offset:16384
v_mfma_f32_16x16x32_bf16 a[136:139], a[212:215], v[140:143], a[136:139]
s_add_u32 m0, s48, 65536
s_mov_b32 s49, 180224
v_fma_f32 v69, v69, s50, v235
v_mfma_f32_16x16x32_bf16 a[132:135], a[212:215], v[132:135], a[132:135]
s_waitcnt lgkmcnt(7)
buffer_load_dwordx4 v16, s[24:27], s49 offen nt lds
v_mfma_f32_16x16x32_bf16 a[144:147], a[216:219], v[132:135], a[144:147]
ds_read_b128 a[212:215], v4 offset:24576
v_fma_f32 v70, v70, s50, v235
v_mfma_f32_16x16x32_bf16 a[148:151], a[216:219], v[140:143], a[148:151]
v_exp_f32 v60, v60
v_mfma_f32_16x16x32_bf16 a[152:155], a[216:219], v[148:151], a[152:155]
s_waitcnt lgkmcnt(6)
buffer_load_dwordx4 v17, s[24:27], s49 offen offset:1024 nt lds
v_mfma_f32_16x16x32_bf16 a[164:167], a[220:223], v[148:151], a[164:167]
ds_read_b128 a[216:219], v5 offset:16384
v_fma_f32 v71, v71, s50, v235
v_mfma_f32_16x16x32_bf16 a[160:163], a[220:223], v[140:143], a[160:163]
v_exp_f32 v61, v61
v_mfma_f32_16x16x32_bf16 a[156:159], a[220:223], v[132:135], a[156:159]
s_waitcnt lgkmcnt(5)
v_exp_f32 v62, v62
v_mfma_f32_16x16x32_bf16 a[168:171], a[224:227], v[132:135], a[168:171]
ds_read_b128 a[220:223], v5 offset:24576
v_fma_f32 v52, v52, s50, v236
v_mfma_f32_16x16x32_bf16 a[172:175], a[224:227], v[140:143], a[172:175]
v_exp_f32 v63, v63
v_mfma_f32_16x16x32_bf16 a[176:179], a[224:227], v[148:151], a[176:179]
s_waitcnt lgkmcnt(4)
buffer_load_dwordx4 v18, s[24:27], s49 offen offset:2048 nt lds
v_mfma_f32_16x16x32_bf16 a[188:191], a[228:231], v[148:151], a[188:191]
ds_read_b128 a[224:227], v6 offset:16384
v_fma_f32 v53, v53, s50, v236
v_mfma_f32_16x16x32_bf16 a[184:187], a[228:231], v[140:143], a[184:187]
v_exp_f32 v44, v44
v_mfma_f32_16x16x32_bf16 a[180:183], a[228:231], v[132:135], a[180:183]
s_cbranch_vccnz L_rb5
L_skipb5:
s_waitcnt lgkmcnt(4)
v_fma_f32 v54, v54, s50, v236
v_mfma_f32_16x16x32_bf16 v[84:87], a[208:211], v[32:35], 0
ds_read_b128 a[228:231], v6 offset:24576
v_fma_f32 v55, v55, s50, v236
v_mfma_f32_16x16x32_bf16 v[92:95], a[208:211], v[40:43], 0
buffer_load_dwordx4 v19, s[24:27], s49 offen offset:3072 nt lds
v_mfma_f32_16x16x32_bf16 v[100:103], a[208:211], v[48:51], 0
s_waitcnt lgkmcnt(4)
v_exp_f32 v45, v45
v_mfma_f32_16x16x32_bf16 v[124:127], a[212:215], v[48:51], 0
ds_read_b128 a[208:211], v7 offset:16384
v_fma_f32 v76, v76, s50, v236
v_mfma_f32_16x16x32_bf16 v[116:119], a[212:215], v[40:43], 0
v_exp_f32 v46, v46
v_mfma_f32_16x16x32_bf16 v[108:111], a[212:215], v[32:35], 0
s_waitcnt lgkmcnt(4)
v_exp_f32 v47, v47
v_mfma_f32_16x16x32_bf16 v[84:87], a[216:219], v[56:59], v[84:87]
ds_read_b128 a[212:215], v7 offset:24576
v_fma_f32 v77, v77, s50, v236
v_mfma_f32_16x16x32_bf16 v[92:95], a[216:219], v[64:67], v[92:95]
v_exp_f32 v68, v68
v_mfma_f32_16x16x32_bf16 v[100:103], a[216:219], v[72:75], v[100:103]
s_waitcnt lgkmcnt(4)
v_exp_f32 v69, v69
v_mfma_f32_16x16x32_bf16 v[124:127], a[220:223], v[72:75], v[124:127]
ds_read_b128 a[216:219], v4 offset:16640
v_fma_f32 v78, v78, s50, v236
v_mfma_f32_16x16x32_bf16 v[116:119], a[220:223], v[64:67], v[116:119]
v_exp_f32 v70, v70
v_mfma_f32_16x16x32_bf16 v[108:111], a[220:223], v[56:59], v[108:111]
s_waitcnt lgkmcnt(4)
v_exp_f32 v71, v71
v_mfma_f32_16x16x32_bf16 v[84:87], a[224:227], v[80:83], v[84:87]
ds_read_b128 a[220:223], v4 offset:24832
v_fma_f32 v79, v79, s50, v236
v_mfma_f32_16x16x32_bf16 v[92:95], a[224:227], v[88:91], v[92:95]
v_exp_f32 v52, v52
v_mfma_f32_16x16x32_bf16 v[100:103], a[224:227], v[96:99], v[100:103]
s_waitcnt lgkmcnt(4)
v_exp_f32 v53, v53
v_mfma_f32_16x16x32_bf16 v[124:127], a[228:231], v[96:99], v[124:127]
ds_read_b128 a[224:227], v5 offset:16640
v_cvt_pk_bf16_f32 v132, v36, v37
v_mfma_f32_16x16x32_bf16 v[116:119], a[228:231], v[88:91], v[116:119]
v_exp_f32 v54, v54
v_mfma_f32_16x16x32_bf16 v[108:111], a[228:231], v[80:83], v[108:111]
s_waitcnt lgkmcnt(4)
v_exp_f32 v55, v55
v_mfma_f32_16x16x32_bf16 v[84:87], a[208:211], v[104:107], v[84:87]
ds_read_b128 a[228:231], v5 offset:24832
v_cvt_pk_bf16_f32 v133, v38, v39
v_mfma_f32_16x16x32_bf16 v[92:95], a[208:211], v[112:115], v[92:95]
v_exp_f32 v76, v76
v_mfma_f32_16x16x32_bf16 v[100:103], a[208:211], v[120:123], v[100:103]
s_waitcnt lgkmcnt(4)
v_exp_f32 v77, v77
v_mfma_f32_16x16x32_bf16 v[124:127], a[212:215], v[120:123], v[124:127]
ds_read_b128 a[208:211], v6 offset:16640
v_cvt_pk_bf16_f32 v134, v60, v61
v_mfma_f32_16x16x32_bf16 v[116:119], a[212:215], v[112:115], v[116:119]
v_exp_f32 v78, v78
v_mfma_f32_16x16x32_bf16 v[108:111], a[212:215], v[104:107], v[108:111]
s_waitcnt lgkmcnt(4)
v_exp_f32 v79, v79
v_mfma_f32_16x16x32_bf16 v[84:87], a[216:219], v[128:131], v[84:87]
ds_read_b128 a[212:215], v6 offset:24832
v_cvt_pk_bf16_f32 v135, v62, v63
v_mfma_f32_16x16x32_bf16 v[92:95], a[216:219], v[136:139], v[92:95]
v_cvt_pk_bf16_f32 v140, v44, v45
v_cvt_pk_bf16_f32 v141, v46, v47
v_mfma_f32_16x16x32_bf16 v[100:103], a[216:219], v[144:147], v[100:103]
s_waitcnt lgkmcnt(4)
v_cvt_pk_bf16_f32 v142, v68, v69
v_cvt_pk_bf16_f32 v143, v70, v71
v_mfma_f32_16x16x32_bf16 v[124:127], a[220:223], v[144:147], v[124:127]
ds_read_b128 a[216:219], v7 offset:16640
v_cvt_pk_bf16_f32 v148, v52, v53
v_mfma_f32_16x16x32_bf16 v[116:119], a[220:223], v[136:139], v[116:119]
v_cvt_pk_bf16_f32 v149, v54, v55
v_cvt_pk_bf16_f32 v150, v76, v77
v_mfma_f32_16x16x32_bf16 v[108:111], a[220:223], v[128:131], v[108:111]
s_waitcnt lgkmcnt(4)
v_cvt_pk_bf16_f32 v151, v78, v79
v_mfma_f32_16x16x32_bf16 v[84:87], a[224:227], v[152:155], v[84:87]
ds_read_b128 a[220:223], v7 offset:24832
v_mfma_f32_16x16x32_bf16 v[92:95], a[224:227], v[160:163], v[92:95]
v_mfma_f32_16x16x32_bf16 v[100:103], a[224:227], v[168:171], v[100:103]
s_waitcnt lgkmcnt(4)
v_mfma_f32_16x16x32_bf16 v[124:127], a[228:231], v[168:171], v[124:127]
s_waitcnt vmcnt(28)
s_barrier
ds_read_b64_tr_b16 a[224:225], v8 offset:49152
v_mfma_f32_16x16x32_bf16 v[116:119], a[228:231], v[160:163], v[116:119]
s_add_u32 m0, s48, 81920
ds_read_b64_tr_b16 a[226:227], v8 offset:57344
s_mov_b32 s49, 163840
v_mfma_f32_16x16x32_bf16 v[108:111], a[228:231], v[152:155], v[108:111]
s_waitcnt lgkmcnt(5)
buffer_load_dwordx4 v16, s[28:31], s49 offen nt lds
v_mfma_f32_16x16x32_bf16 v[84:87], a[208:211], v[176:179], v[84:87]
ds_read_b64_tr_b16 a[228:229], v9 offset:49152
v_mfma_f32_16x16x32_bf16 v[92:95], a[208:211], v[184:187], v[92:95]
ds_read_b64_tr_b16 a[230:231], v9 offset:57344
v_mfma_f32_16x16x32_bf16 v[100:103], a[208:211], v[192:195], v[100:103]
s_waitcnt lgkmcnt(6)
buffer_load_dwordx4 v17, s[28:31], s49 offen offset:1024 nt lds
v_mfma_f32_16x16x32_bf16 v[124:127], a[212:215], v[192:195], v[124:127]
ds_read_b64_tr_b16 a[208:209], v10 offset:49152
v_mfma_f32_16x16x32_bf16 v[116:119], a[212:215], v[184:187], v[116:119]
ds_read_b64_tr_b16 a[210:211], v10 offset:57344
v_mfma_f32_16x16x32_bf16 v[108:111], a[212:215], v[176:179], v[108:111]
s_waitcnt lgkmcnt(7)
v_mfma_f32_16x16x32_bf16 v[84:87], a[216:219], v[200:203], v[84:87]
ds_read_b64_tr_b16 a[212:213], v11 offset:49152
v_mfma_f32_16x16x32_bf16 v[92:95], a[216:219], v[208:211], v[92:95]
ds_read_b64_tr_b16 a[214:215], v11 offset:57344
v_mfma_f32_16x16x32_bf16 v[100:103], a[216:219], v[216:219], v[100:103]
s_waitcnt lgkmcnt(8)
buffer_load_dwordx4 v18, s[28:31], s49 offen offset:2048 nt lds
v_mfma_f32_16x16x32_bf16 v[124:127], a[220:223], v[216:219], v[124:127]
ds_read_b64_tr_b16 a[216:217], v12 offset:49152
v_mfma_f32_16x16x32_bf16 v[116:119], a[220:223], v[208:211], v[116:119]
ds_read_b64_tr_b16 a[218:219], v12 offset:57344
v_mfma_f32_16x16x32_bf16 v[108:111], a[220:223], v[200:203], v[108:111]
buffer_load_dwordx4 v19, s[28:31], s49 offen offset:3072 nt lds
v_mfma_f32_16x16x32_bf16 a[192:195], a[204:207], v[132:135], a[192:195]
v_mfma_f32_16x16x32_bf16 a[196:199], a[204:207], v[140:143], a[196:199]
v_mfma_f32_16x16x32_bf16 a[200:203], a[204:207], v[148:151], a[200:203]
s_waitcnt lgkmcnt(8)
v_mfma_f32_16x16x32_bf16 a[0:3], a[224:227], v[132:135], a[0:3]
ds_read_b64_tr_b16 a[220:221], v13 offset:49152
v_max3_f32 v156, v84, v85, v86
v_mfma_f32_16x16x32_bf16 a[4:7], a[224:227], v[140:143], a[4:7]
ds_read_b64_tr_b16 a[222:223], v13 offset:57344
v_max3_f32 v157, v92, v93, v94
v_mfma_f32_16x16x32_bf16 a[8:11], a[224:227], v[148:151], a[8:11]
s_waitcnt lgkmcnt(8)
v_max3_f32 v158, v100, v101, v102
v_max3_f32 v156, v156, v87, v108
v_mfma_f32_16x16x32_bf16 a[20:23], a[228:231], v[148:151], a[20:23]
ds_read_b64_tr_b16 a[224:225], v14 offset:49152
v_max3_f32 v157, v157, v95, v116
v_mfma_f32_16x16x32_bf16 a[16:19], a[228:231], v[140:143], a[16:19]
ds_read_b64_tr_b16 a[226:227], v14 offset:57344
v_max3_f32 v158, v158, v103, v124
v_mfma_f32_16x16x32_bf16 a[12:15], a[228:231], v[132:135], a[12:15]
s_waitcnt lgkmcnt(8)
v_max3_f32 v156, v156, v109, v110
v_max3_f32 v157, v157, v117, v118
v_mfma_f32_16x16x32_bf16 a[24:27], a[208:211], v[132:135], a[24:27]
ds_read_b64_tr_b16 a[228:229], v15 offset:49152
v_max3_f32 v158, v158, v125, v126
v_mfma_f32_16x16x32_bf16 a[28:31], a[208:211], v[140:143], a[28:31]
ds_read_b64_tr_b16 a[230:231], v15 offset:57344
v_max_f32 v156, v156, v111
v_mfma_f32_16x16x32_bf16 a[32:35], a[208:211], v[148:151], a[32:35]
s_waitcnt lgkmcnt(8)
v_max_f32 v157, v157, v119
v_max_f32 v158, v158, v127
v_mfma_f32_16x16x32_bf16 a[44:47], a[212:215], v[148:151], a[44:47]
ds_read_b64_tr_b16 a[208:209], v8 offset:49408
v_fma_f32 v164, v156, s50, v234
v_mfma_f32_16x16x32_bf16 a[40:43], a[212:215], v[140:143], a[40:43]
ds_read_b64_tr_b16 a[210:211], v8 offset:57600
v_fma_f32 v165, v157, s50, v235
v_mfma_f32_16x16x32_bf16 a[36:39], a[212:215], v[132:135], a[36:39]
s_waitcnt lgkmcnt(8)
v_fma_f32 v166, v158, s50, v236
v_max3_f32 v167, v164, v165, v166
v_mfma_f32_16x16x32_bf16 a[48:51], a[216:219], v[132:135], a[48:51]
ds_read_b64_tr_b16 a[212:213], v9 offset:49408
v_cmp_lt_f32 vcc, s51, v167
v_mfma_f32_16x16x32_bf16 a[52:55], a[216:219], v[140:143], a[52:55]
s_cbranch_vccnz L_ra6
L_skipa6:
ds_read_b64_tr_b16 a[214:215], v9 offset:57600
v_fma_f32 v84, v84, s50, v234
v_mfma_f32_16x16x32_bf16 a[56:59], a[216:219], v[148:151], a[56:59]
s_waitcnt lgkmcnt(8)
v_fma_f32 v85, v85, s50, v234
v_fma_f32 v86, v86, s50, v234
v_mfma_f32_16x16x32_bf16 a[68:71], a[220:223], v[148:151], a[68:71]
ds_read_b64_tr_b16 a[216:217], v10 offset:49408
v_fma_f32 v87, v87, s50, v234
v_mfma_f32_16x16x32_bf16 a[64:67], a[220:223], v[140:143], a[64:67]
ds_read_b64_tr_b16 a[218:219], v10 offset:57600
v_fma_f32 v108, v108, s50, v234
v_mfma_f32_16x16x32_bf16 a[60:63], a[220:223], v[132:135], a[60:63]
s_waitcnt lgkmcnt(8)
v_exp_f32 v84, v84
v_mfma_f32_16x16x32_bf16 a[72:75], a[224:227], v[132:135], a[72:75]
ds_read_b64_tr_b16 a[220:221], v11 offset:49408
v_fma_f32 v109, v109, s50, v234
v_mfma_f32_16x16x32_bf16 a[76:79], a[224:227], v[140:143], a[76:79]
ds_read_b64_tr_b16 a[222:223], v11 offset:57600
v_fma_f32 v110, v110, s50, v234
v_mfma_f32_16x16x32_bf16 a[80:83], a[224:227], v[148:151], a[80:83]
s_waitcnt lgkmcnt(8)
v_exp_f32 v85, v85
v_mfma_f32_16x16x32_bf16 a[92:95], a[228:231], v[148:151], a[92:95]
ds_read_b64_tr_b16 a[224:225], v12 offset:49408
v_fma_f32 v111, v111, s50, v234
v_mfma_f32_16x16x32_bf16 a[88:91], a[228:231], v[140:143], a[88:91]
ds_read_b64_tr_b16 a[226:227], v12 offset:57600
v_fma_f32 v92, v92, s50, v235
v_mfma_f32_16x16x32_bf16 a[84:87], a[228:231], v[132:135], a[84:87]
s_waitcnt lgkmcnt(8)
v_exp_f32 v86, v86
v_mfma_f32_16x16x32_bf16 a[96:99], a[208:211], v[132:135], a[96:99]
ds_read_b64_tr_b16 a[228:229], v13 offset:49408
v_fma_f32 v93, v93, s50, v235
v_mfma_f32_16x16x32_bf16 a[100:103], a[208:211], v[140:143], a[100:103]
ds_read_b64_tr_b16 a[230:231], v13 offset:57600
v_fma_f32 v94, v94, s50, v235
v_mfma_f32_16x16x32_bf16 a[104:107], a[208:211], v[148:151], a[104:107]
s_waitcnt lgkmcnt(8)
v_exp_f32 v87, v87
v_mfma_f32_16x16x32_bf16 a[116:119], a[212:215], v[148:151], a[116:119]
ds_read_b64_tr_b16 a[208:209], v14 offset:49408
v_fma_f32 v95, v95, s50, v235
v_mfma_f32_16x16x32_bf16 a[112:115], a[212:215], v[140:143], a[112:115]
ds_read_b64_tr_b16 a[210:211], v14 offset:57600
v_fma_f32 v116, v116, s50, v235
v_mfma_f32_16x16x32_bf16 a[108:111], a[212:215], v[132:135], a[108:111]
s_waitcnt lgkmcnt(8)
v_exp_f32 v108, v108
v_mfma_f32_16x16x32_bf16 a[120:123], a[216:219], v[132:135], a[120:123]
ds_read_b64_tr_b16 a[212:213], v15 offset:49408
v_fma_f32 v117, v117, s50, v235
v_mfma_f32_16x16x32_bf16 a[124:127], a[216:219], v[140:143], a[124:127]
ds_read_b64_tr_b16 a[214:215], v15 offset:57600
v_fma_f32 v118, v118, s50, v235
v_mfma_f32_16x16x32_bf16 a[128:131], a[216:219], v[148:151], a[128:131]
s_waitcnt lgkmcnt(8)
v_exp_f32 v109, v109
v_mfma_f32_16x16x32_bf16 a[140:143], a[220:223], v[148:151], a[140:143]
s_waitcnt vmcnt(28)
s_barrier
v_add_u32 v4, 4294950912, v4
v_mfma_f32_16x16x32_bf16 a[136:139], a[220:223], v[140:143], a[136:139]
s_add_u32 m0, s48, 32768
ds_read_b128 a[216:219], v4 offset:0
s_mov_b32 s49, 196608
v_mfma_f32_16x16x32_bf16 a[132:135], a[220:223], v[132:135], a[132:135]
s_waitcnt lgkmcnt(7)
buffer_load_dwordx4 v16, s[24:27], s49 offen nt lds
v_mfma_f32_16x16x32_bf16 a[144:147], a[224:227], v[132:135], a[144:147]
ds_read_b128 a[220:223], v4 offset:8192
v_fma_f32 v119, v119, s50, v235
v_mfma_f32_16x16x32_bf16 a[148:151], a[224:227], v[140:143], a[148:151]
v_exp_f32 v110, v110
v_mfma_f32_16x16x32_bf16 a[152:155], a[224:227], v[148:151], a[152:155]
s_waitcnt lgkmcnt(6)
buffer_load_dwordx4 v17, s[24:27], s49 offen offset:1024 nt lds
v_mfma_f32_16x16x32_bf16 a[164:167], a[228:231], v[148:151], a[164:167]
v_add_u32 v5, 4294950912, v5
v_fma_f32 v100, v100, s50, v236
v_mfma_f32_16x16x32_bf16 a[160:163], a[228:231], v[140:143], a[160:163]
ds_read_b128 a[224:227], v5 offset:0
v_fma_f32 v101, v101, s50, v236
v_mfma_f32_16x16x32_bf16 a[156:159], a[228:231], v[132:135], a[156:159]
s_waitcnt lgkmcnt(5)
v_exp_f32 v111, v111
v_mfma_f32_16x16x32_bf16 a[168:171], a[208:211], v[132:135], a[168:171]
ds_read_b128 a[228:231], v5 offset:8192
v_fma_f32 v102, v102, s50, v236
v_mfma_f32_16x16x32_bf16 a[172:175], a[208:211], v[140:143], a[172:175]
v_exp_f32 v92, v92
v_mfma_f32_16x16x32_bf16 a[176:179], a[208:211], v[148:151], a[176:179]
s_waitcnt lgkmcnt(4)
buffer_load_dwordx4 v18, s[24:27], s49 offen offset:2048 nt lds
v_mfma_f32_16x16x32_bf16 a[188:191], a[212:215], v[148:151], a[188:191]
v_add_u32 v6, 4294950912, v6
v_fma_f32 v103, v103, s50, v236
v_mfma_f32_16x16x32_bf16 a[184:187], a[212:215], v[140:143], a[184:187]
ds_read_b128 a[208:211], v6 offset:0
v_fma_f32 v124, v124, s50, v236
v_mfma_f32_16x16x32_bf16 a[180:183], a[212:215], v[132:135], a[180:183]
s_cbranch_vccnz L_rb6
L_skipb6:
s_waitcnt lgkmcnt(4)
v_fma_f32 v125, v125, s50, v236
v_mfma_f32_16x16x32_bf16 v[36:39], a[216:219], v[32:35], 0
ds_read_b128 a[212:215], v6 offset:8192
v_fma_f32 v126, v126, s50, v236
v_mfma_f32_16x16x32_bf16 v[44:47], a[216:219], v[40:43], 0
buffer_load_dwordx4 v19, s[24:27], s49 offen offset:3072 nt lds
v_mfma_f32_16x16x32_bf16 v[52:55], a[216:219], v[48:51], 0
s_waitcnt lgkmcnt(4)
v_exp_f32 v93, v93
v_mfma_f32_16x16x32_bf16 v[76:79], a[220:223], v[48:51], 0
v_add_u32 v7, 4294950912, v7
v_fma_f32 v127, v127, s50, v236
v_mfma_f32_16x16x32_bf16 v[68:71], a[220:223], v[40:43], 0
ds_read_b128 a[216:219], v7 offset:0
v_cvt_pk_bf16_f32 v132, v84, v85
v_mfma_f32_16x16x32_bf16 v[60:63], a[220:223], v[32:35], 0
s_waitcnt lgkmcnt(4)
v_exp_f32 v94, v94
v_mfma_f32_16x16x32_bf16 v[36:39], a[224:227], v[56:59], v[36:39]
ds_read_b128 a[220:223], v7 offset:8192
v_cvt_pk_bf16_f32 v133, v86, v87
v_mfma_f32_16x16x32_bf16 v[44:47], a[224:227], v[64:67], v[44:47]
v_exp_f32 v95, v95
v_mfma_f32_16x16x32_bf16 v[52:55], a[224:227], v[72:75], v[52:55]
s_waitcnt lgkmcnt(4)
v_exp_f32 v116, v116
v_mfma_f32_16x16x32_bf16 v[76:79], a[228:231], v[72:75], v[76:79]
ds_read_b128 a[224:227], v4 offset:256
v_cvt_pk_bf16_f32 v134, v108, v109
v_mfma_f32_16x16x32_bf16 v[68:71], a[228:231], v[64:67], v[68:71]
v_exp_f32 v117, v117
v_mfma_f32_16x16x32_bf16 v[60:63], a[228:231], v[56:59], v[60:63]
s_waitcnt lgkmcnt(4)
v_exp_f32 v118, v118
v_mfma_f32_16x16x32_bf16 v[36:39], a[208:211], v[80:83], v[36:39]
ds_read_b128 a[228:231], v4 offset:8448
v_cvt_pk_bf16_f32 v135, v110, v111
v_mfma_f32_16x16x32_bf16 v[44:47], a[208:211], v[88:91], v[44:47]
v_cmp_eq_u32 vcc, 0, v247
s_cbranch_vccnz L_rdy_slow
L_rdy_ok:
s_lshr_b32 s3, s55, 1
s_xor_b32 s3, s3, s54
s_and_b32 s3, s3, 1
v_mfma_f32_16x16x32_bf16 v[52:55], a[208:211], v[96:99], v[52:55]
s_waitcnt lgkmcnt(4)
v_exp_f32 v119, v119
v_mfma_f32_16x16x32_bf16 v[76:79], a[212:215], v[96:99], v[76:79]
ds_read_b128 a[208:211], v5 offset:256
v_cvt_pk_bf16_f32 v140, v92, v93
v_mfma_f32_16x16x32_bf16 v[68:71], a[212:215], v[88:91], v[68:71]
v_exp_f32 v100, v100
v_mfma_f32_16x16x32_bf16 v[60:63], a[212:215], v[80:83], v[60:63]
s_waitcnt lgkmcnt(4)
v_exp_f32 v101, v101
v_mfma_f32_16x16x32_bf16 v[36:39], a[216:219], v[104:107], v[36:39]
ds_read_b128 a[212:215], v5 offset:8448
v_cvt_pk_bf16_f32 v141, v94, v95
v_mfma_f32_16x16x32_bf16 v[44:47], a[216:219], v[112:115], v[44:47]
v_exp_f32 v102, v102
v_mfma_f32_16x16x32_bf16 v[52:55], a[216:219], v[120:123], v[52:55]
s_waitcnt lgkmcnt(4)
v_exp_f32 v103, v103
v_mfma_f32_16x16x32_bf16 v[76:79], a[220:223], v[120:123], v[76:79]
ds_read_b128 a[216:219], v6 offset:256
v_cvt_pk_bf16_f32 v142, v116, v117
v_mfma_f32_16x16x32_bf16 v[68:71], a[220:223], v[112:115], v[68:71]
v_exp_f32 v124, v124
v_mfma_f32_16x16x32_bf16 v[60:63], a[220:223], v[104:107], v[60:63]
s_waitcnt lgkmcnt(4)
v_exp_f32 v125, v125
v_mfma_f32_16x16x32_bf16 v[36:39], a[224:227], v[128:131], v[36:39]
ds_read_b128 a[220:223], v6 offset:8448
v_cvt_pk_bf16_f32 v143, v118, v119
v_mfma_f32_16x16x32_bf16 v[44:47], a[224:227], v[136:139], v[44:47]
v_exp_f32 v126, v126
v_mfma_f32_16x16x32_bf16 v[52:55], a[224:227], v[144:147], v[52:55]
s_waitcnt lgkmcnt(4)
v_exp_f32 v127, v127
v_mfma_f32_16x16x32_bf16 v[76:79], a[228:231], v[144:147], v[76:79]
ds_read_b128 a[224:227], v7 offset:256
v_cvt_pk_bf16_f32 v148, v100, v101
v_mfma_f32_16x16x32_bf16 v[68:71], a[228:231], v[136:139], v[68:71]
v_cvt_pk_bf16_f32 v149, v102, v103
v_cvt_pk_bf16_f32 v150, v124, v125
v_mfma_f32_16x16x32_bf16 v[60:63], a[228:231], v[128:131], v[60:63]
s_waitcnt lgkmcnt(4)
v_cvt_pk_bf16_f32 v151, v126, v127
v_mfma_f32_16x16x32_bf16 v[36:39], a[208:211], v[152:155], v[36:39]
ds_read_b128 a[228:231], v7 offset:8448
v_mfma_f32_16x16x32_bf16 v[44:47], a[208:211], v[160:163], v[44:47]
v_mfma_f32_16x16x32_bf16 v[52:55], a[208:211], v[168:171], v[52:55]
s_waitcnt lgkmcnt(4)
v_mfma_f32_16x16x32_bf16 v[76:79], a[212:215], v[168:171], v[76:79]
s_waitcnt vmcnt(28)
s_barrier
ds_read_b64_tr_b16 a[208:209], v8 offset:16384
v_mfma_f32_16x16x32_bf16 v[68:71], a[212:215], v[160:163], v[68:71]
s_add_u32 m0, s48, 131072
ds_read_b64_tr_b16 a[210:211], v8 offset:24576
s_mov_b32 s49, 180224
v_mfma_f32_16x16x32_bf16 v[60:63], a[212:215], v[152:155], v[60:63]
s_waitcnt lgkmcnt(5)
buffer_load_dwordx4 v16, s[28:31], s49 offen nt lds
v_mfma_f32_16x16x32_bf16 v[36:39], a[216:219], v[176:179], v[36:39]
ds_read_b64_tr_b16 a[212:213], v9 offset:16384
v_mfma_f32_16x16x32_bf16 v[44:47], a[216:219], v[184:187], v[44:47]
ds_read_b64_tr_b16 a[214:215], v9 offset:24576
v_mfma_f32_16x16x32_bf16 v[52:55], a[216:219], v[192:195], v[52:55]
s_waitcnt lgkmcnt(6)
buffer_load_dwordx4 v17, s[28:31], s49 offen offset:1024 nt lds
v_mfma_f32_16x16x32_bf16 v[76:79], a[220:223], v[192:195], v[76:79]
ds_read_b64_tr_b16 a[216:217], v10 offset:16384
v_mfma_f32_16x16x32_bf16 v[68:71], a[220:223], v[184:187], v[68:71]
ds_read_b64_tr_b16 a[218:219], v10 offset:24576
v_mfma_f32_16x16x32_bf16 v[60:63], a[220:223], v[176:179], v[60:63]
s_waitcnt lgkmcnt(7)
v_mfma_f32_16x16x32_bf16 v[36:39], a[224:227], v[200:203], v[36:39]
ds_read_b64_tr_b16 a[220:221], v11 offset:16384
v_mfma_f32_16x16x32_bf16 v[44:47], a[224:227], v[208:211], v[44:47]
ds_read_b64_tr_b16 a[222:223], v11 offset:24576
v_mfma_f32_16x16x32_bf16 v[52:55], a[224:227], v[216:219], v[52:55]
s_waitcnt lgkmcnt(8)
buffer_load_dwordx4 v18, s[28:31], s49 offen offset:2048 nt lds
v_mfma_f32_16x16x32_bf16 v[76:79], a[228:231], v[216:219], v[76:79]
ds_read_b64_tr_b16 a[224:225], v12 offset:16384
v_mfma_f32_16x16x32_bf16 v[68:71], a[228:231], v[208:211], v[68:71]
ds_read_b64_tr_b16 a[226:227], v12 offset:24576
v_mfma_f32_16x16x32_bf16 v[60:63], a[228:231], v[200:203], v[60:63]
buffer_load_dwordx4 v19, s[28:31], s49 offen offset:3072 nt lds
v_mfma_f32_16x16x32_bf16 a[192:195], a[204:207], v[132:135], a[192:195]
v_mfma_f32_16x16x32_bf16 a[196:199], a[204:207], v[140:143], a[196:199]
v_mfma_f32_16x16x32_bf16 a[200:203], a[204:207], v[148:151], a[200:203]
s_waitcnt lgkmcnt(8)
v_mfma_f32_16x16x32_bf16 a[0:3], a[208:211], v[132:135], a[0:3]
ds_read_b64_tr_b16 a[228:229], v13 offset:16384
v_max3_f32 v156, v36, v37, v38
v_mfma_f32_16x16x32_bf16 a[4:7], a[208:211], v[140:143], a[4:7]
ds_read_b64_tr_b16 a[230:231], v13 offset:24576
v_max3_f32 v157, v44, v45, v46
v_mfma_f32_16x16x32_bf16 a[8:11], a[208:211], v[148:151], a[8:11]
s_waitcnt lgkmcnt(8)
v_max3_f32 v158, v52, v53, v54
v_max3_f32 v156, v156, v39, v60
v_mfma_f32_16x16x32_bf16 a[20:23], a[212:215], v[148:151], a[20:23]
ds_read_b64_tr_b16 a[208:209], v14 offset:16384
v_max3_f32 v157, v157, v47, v68
v_mfma_f32_16x16x32_bf16 a[16:19], a[212:215], v[140:143], a[16:19]
ds_read_b64_tr_b16 a[210:211], v14 offset:24576
v_max3_f32 v158, v158, v55, v76
v_mfma_f32_16x16x32_bf16 a[12:15], a[212:215], v[132:135], a[12:15]
s_waitcnt lgkmcnt(8)
v_max3_f32 v156, v156, v61, v62
v_max3_f32 v157, v157, v69, v70
v_mfma_f32_16x16x32_bf16 a[24:27], a[216:219], v[132:135], a[24:27]
ds_read_b64_tr_b16 a[212:213], v15 offset:16384
v_max3_f32 v158, v158, v77, v78
v_mfma_f32_16x16x32_bf16 a[28:31], a[216:219], v[140:143], a[28:31]
ds_read_b64_tr_b16 a[214:215], v15 offset:24576
v_max_f32 v156, v156, v63
v_mfma_f32_16x16x32_bf16 a[32:35], a[216:219], v[148:151], a[32:35]
s_waitcnt lgkmcnt(8)
v_max_f32 v157, v157, v71
v_max_f32 v158, v158, v79
v_mfma_f32_16x16x32_bf16 a[44:47], a[220:223], v[148:151], a[44:47]
ds_read_b64_tr_b16 a[216:217], v8 offset:16640
v_fma_f32 v164, v156, s50, v234
v_mfma_f32_16x16x32_bf16 a[40:43], a[220:223], v[140:143], a[40:43]
ds_read_b64_tr_b16 a[218:219], v8 offset:24832
v_fma_f32 v165, v157, s50, v235
v_mfma_f32_16x16x32_bf16 a[36:39], a[220:223], v[132:135], a[36:39]
s_waitcnt lgkmcnt(8)
v_fma_f32 v166, v158, s50, v236
v_max3_f32 v167, v164, v165, v166
v_mfma_f32_16x16x32_bf16 a[48:51], a[224:227], v[132:135], a[48:51]
ds_read_b64_tr_b16 a[220:221], v9 offset:16640
v_cmp_lt_f32 vcc, s51, v167
v_mfma_f32_16x16x32_bf16 a[52:55], a[224:227], v[140:143], a[52:55]
s_cbranch_vccnz L_ra7
L_skipa7:
ds_read_b64_tr_b16 a[222:223], v9 offset:24832
v_fma_f32 v36, v36, s50, v234
v_mfma_f32_16x16x32_bf16 a[56:59], a[224:227], v[148:151], a[56:59]
s_waitcnt lgkmcnt(8)
v_fma_f32 v37, v37, s50, v234
v_fma_f32 v38, v38, s50, v234
v_mfma_f32_16x16x32_bf16 a[68:71], a[228:231], v[148:151], a[68:71]
ds_read_b64_tr_b16 a[224:225], v10 offset:16640
v_fma_f32 v39, v39, s50, v234
v_mfma_f32_16x16x32_bf16 a[64:67], a[228:231], v[140:143], a[64:67]
ds_read_b64_tr_b16 a[226:227], v10 offset:24832
v_fma_f32 v60, v60, s50, v234
v_mfma_f32_16x16x32_bf16 a[60:63], a[228:231], v[132:135], a[60:63]
s_waitcnt lgkmcnt(8)
v_exp_f32 v36, v36
v_mfma_f32_16x16x32_bf16 a[72:75], a[208:211], v[132:135], a[72:75]
ds_read_b64_tr_b16 a[228:229], v11 offset:16640
v_fma_f32 v61, v61, s50, v234
v_mfma_f32_16x16x32_bf16 a[76:79], a[208:211], v[140:143], a[76:79]
ds_read_b64_tr_b16 a[230:231], v11 offset:24832
v_fma_f32 v62, v62, s50, v234
v_mfma_f32_16x16x32_bf16 a[80:83], a[208:211], v[148:151], a[80:83]
s_waitcnt lgkmcnt(8)
v_exp_f32 v37, v37
v_mfma_f32_16x16x32_bf16 a[92:95], a[212:215], v[148:151], a[92:95]
ds_read_b64_tr_b16 a[208:209], v12 offset:16640
v_fma_f32 v63, v63, s50, v234
v_mfma_f32_16x16x32_bf16 a[88:91], a[212:215], v[140:143], a[88:91]
ds_read_b64_tr_b16 a[210:211], v12 offset:24832
v_fma_f32 v44, v44, s50, v235
v_mfma_f32_16x16x32_bf16 a[84:87], a[212:215], v[132:135], a[84:87]
s_waitcnt lgkmcnt(8)
v_exp_f32 v38, v38
v_mfma_f32_16x16x32_bf16 a[96:99], a[216:219], v[132:135], a[96:99]
ds_read_b64_tr_b16 a[212:213], v13 offset:16640
v_fma_f32 v45, v45, s50, v235
v_mfma_f32_16x16x32_bf16 a[100:103], a[216:219], v[140:143], a[100:103]
ds_read_b64_tr_b16 a[214:215], v13 offset:24832
v_fma_f32 v46, v46, s50, v235
v_mfma_f32_16x16x32_bf16 a[104:107], a[216:219], v[148:151], a[104:107]
s_waitcnt lgkmcnt(8)
v_exp_f32 v39, v39
v_mfma_f32_16x16x32_bf16 a[116:119], a[220:223], v[148:151], a[116:119]
ds_read_b64_tr_b16 a[216:217], v14 offset:16640
v_fma_f32 v47, v47, s50, v235
v_mfma_f32_16x16x32_bf16 a[112:115], a[220:223], v[140:143], a[112:115]
ds_read_b64_tr_b16 a[218:219], v14 offset:24832
v_fma_f32 v68, v68, s50, v235
v_mfma_f32_16x16x32_bf16 a[108:111], a[220:223], v[132:135], a[108:111]
s_waitcnt lgkmcnt(8)
v_exp_f32 v60, v60
v_mfma_f32_16x16x32_bf16 a[120:123], a[224:227], v[132:135], a[120:123]
ds_read_b64_tr_b16 a[220:221], v15 offset:16640
v_fma_f32 v69, v69, s50, v235
v_mfma_f32_16x16x32_bf16 a[124:127], a[224:227], v[140:143], a[124:127]
ds_read_b64_tr_b16 a[222:223], v15 offset:24832
v_fma_f32 v70, v70, s50, v235
v_mfma_f32_16x16x32_bf16 a[128:131], a[224:227], v[148:151], a[128:131]
s_waitcnt lgkmcnt(8)
v_exp_f32 v61, v61
v_mfma_f32_16x16x32_bf16 a[140:143], a[228:231], v[148:151], a[140:143]
s_waitcnt vmcnt(28)
s_barrier
v_add_u32 v4, 98304, v4
v_mfma_f32_16x16x32_bf16 a[136:139], a[228:231], v[140:143], a[136:139]
s_add_u32 m0, s48, 0
ds_read_b128 a[224:227], v4 offset:16384
s_mov_b32 s49, 212992
v_mfma_f32_16x16x32_bf16 a[132:135], a[228:231], v[132:135], a[132:135]
s_waitcnt lgkmcnt(7)
buffer_load_dwordx4 v16, s[24:27], s49 offen nt lds
v_mfma_f32_16x16x32_bf16 a[144:147], a[208:211], v[132:135], a[144:147]
ds_read_b128 a[228:231], v4 offset:24576
v_fma_f32 v71, v71, s50, v235
v_mfma_f32_16x16x32_bf16 a[148:151], a[208:211], v[140:143], a[148:151]
v_exp_f32 v62, v62
v_mfma_f32_16x16x32_bf16 a[152:155], a[208:211], v[148:151], a[152:155]
s_waitcnt lgkmcnt(6)
buffer_load_dwordx4 v17, s[24:27], s49 offen offset:1024 nt lds
v_mfma_f32_16x16x32_bf16 a[164:167], a[212:215], v[148:151], a[164:167]
v_add_u32 v5, 98304, v5
v_fma_f32 v52, v52, s50, v236
v_mfma_f32_16x16x32_bf16 a[160:163], a[212:215], v[140:143], a[160:163]
ds_read_b128 a[208:211], v5 offset:16384
v_fma_f32 v53, v53, s50, v236
v_mfma_f32_16x16x32_bf16 a[156:159], a[212:215], v[132:135], a[156:159]
s_waitcnt lgkmcnt(5)
v_exp_f32 v63, v63
v_mfma_f32_16x16x32_bf16 a[168:171], a[216:219], v[132:135], a[168:171]
ds_read_b128 a[212:215], v5 offset:24576
v_fma_f32 v54, v54, s50, v236
v_mfma_f32_16x16x32_bf16 a[172:175], a[216:219], v[140:143], a[172:175]
v_exp_f32 v44, v44
v_mfma_f32_16x16x32_bf16 a[176:179], a[216:219], v[148:151], a[176:179]
s_waitcnt lgkmcnt(4)
buffer_load_dwordx4 v18, s[24:27], s49 offen offset:2048 nt lds
v_mfma_f32_16x16x32_bf16 a[188:191], a[220:223], v[148:151], a[188:191]
v_add_u32 v6, 98304, v6
v_fma_f32 v55, v55, s50, v236
v_mfma_f32_16x16x32_bf16 a[184:187], a[220:223], v[140:143], a[184:187]
ds_read_b128 a[216:219], v6 offset:16384
v_fma_f32 v76, v76, s50, v236
v_mfma_f32_16x16x32_bf16 a[180:183], a[220:223], v[132:135], a[180:183]
s_cbranch_vccnz L_rb7
L_skipb7:
s_waitcnt lgkmcnt(4)
v_fma_f32 v77, v77, s50, v236
v_mfma_f32_16x16x32_bf16 v[84:87], a[224:227], v[32:35], 0
ds_read_b128 a[220:223], v6 offset:24576
v_fma_f32 v78, v78, s50, v236
v_mfma_f32_16x16x32_bf16 v[92:95], a[224:227], v[40:43], 0
buffer_load_dwordx4 v19, s[24:27], s49 offen offset:3072 nt lds
v_mfma_f32_16x16x32_bf16 v[100:103], a[224:227], v[48:51], 0
s_waitcnt lgkmcnt(4)
v_exp_f32 v45, v45
v_mfma_f32_16x16x32_bf16 v[124:127], a[228:231], v[48:51], 0
v_add_u32 v7, 98304, v7
v_fma_f32 v79, v79, s50, v236
v_mfma_f32_16x16x32_bf16 v[116:119], a[228:231], v[40:43], 0
ds_read_b128 a[224:227], v7 offset:16384
v_cvt_pk_bf16_f32 v132, v36, v37
v_mfma_f32_16x16x32_bf16 v[108:111], a[228:231], v[32:35], 0
s_waitcnt lgkmcnt(4)
v_exp_f32 v46, v46
v_mfma_f32_16x16x32_bf16 v[84:87], a[208:211], v[56:59], v[84:87]
ds_read_b128 a[228:231], v7 offset:24576
v_cvt_pk_bf16_f32 v133, v38, v39
v_mfma_f32_16x16x32_bf16 v[92:95], a[208:211], v[64:67], v[92:95]
v_exp_f32 v47, v47
v_mfma_f32_16x16x32_bf16 v[100:103], a[208:211], v[72:75], v[100:103]
s_waitcnt lgkmcnt(4)
v_exp_f32 v68, v68
v_mfma_f32_16x16x32_bf16 v[124:127], a[212:215], v[72:75], v[124:127]
ds_read_b128 a[208:211], v4 offset:16640
v_cvt_pk_bf16_f32 v134, v60, v61
v_mfma_f32_16x16x32_bf16 v[116:119], a[212:215], v[64:67], v[116:119]
v_exp_f32 v69, v69
v_mfma_f32_16x16x32_bf16 v[108:111], a[212:215], v[56:59], v[108:111]
s_waitcnt lgkmcnt(4)
v_exp_f32 v70, v70
v_mfma_f32_16x16x32_bf16 v[84:87], a[216:219], v[80:83], v[84:87]
ds_read_b128 a[212:215], v4 offset:24832
v_cvt_pk_bf16_f32 v135, v62, v63
v_mfma_f32_16x16x32_bf16 v[92:95], a[216:219], v[88:91], v[92:95]
v_exp_f32 v71, v71
v_mfma_f32_16x16x32_bf16 v[100:103], a[216:219], v[96:99], v[100:103]
s_waitcnt lgkmcnt(4)
v_exp_f32 v52, v52
v_mfma_f32_16x16x32_bf16 v[124:127], a[220:223], v[96:99], v[124:127]
ds_read_b128 a[216:219], v5 offset:16640
v_cvt_pk_bf16_f32 v140, v44, v45
v_mfma_f32_16x16x32_bf16 v[116:119], a[220:223], v[88:91], v[116:119]
v_exp_f32 v53, v53
v_mfma_f32_16x16x32_bf16 v[108:111], a[220:223], v[80:83], v[108:111]
s_waitcnt lgkmcnt(4)
v_exp_f32 v54, v54
v_mfma_f32_16x16x32_bf16 v[84:87], a[224:227], v[104:107], v[84:87]
ds_read_b128 a[220:223], v5 offset:24832
v_cvt_pk_bf16_f32 v141, v46, v47
v_mfma_f32_16x16x32_bf16 v[92:95], a[224:227], v[112:115], v[92:95]
v_exp_f32 v55, v55
v_mfma_f32_16x16x32_bf16 v[100:103], a[224:227], v[120:123], v[100:103]
s_waitcnt lgkmcnt(4)
v_exp_f32 v76, v76
v_mfma_f32_16x16x32_bf16 v[124:127], a[228:231], v[120:123], v[124:127]
ds_read_b128 a[224:227], v6 offset:16640
v_cvt_pk_bf16_f32 v142, v68, v69
v_mfma_f32_16x16x32_bf16 v[116:119], a[228:231], v[112:115], v[116:119]
v_exp_f32 v77, v77
v_mfma_f32_16x16x32_bf16 v[108:111], a[228:231], v[104:107], v[108:111]
s_waitcnt lgkmcnt(4)
v_exp_f32 v78, v78
v_mfma_f32_16x16x32_bf16 v[84:87], a[208:211], v[128:131], v[84:87]
ds_read_b128 a[228:231], v6 offset:24832
v_cvt_pk_bf16_f32 v143, v70, v71
v_mfma_f32_16x16x32_bf16 v[92:95], a[208:211], v[136:139], v[92:95]
v_exp_f32 v79, v79
v_mfma_f32_16x16x32_bf16 v[100:103], a[208:211], v[144:147], v[100:103]
s_waitcnt lgkmcnt(4)
v_cvt_pk_bf16_f32 v148, v52, v53
v_cvt_pk_bf16_f32 v149, v54, v55
v_mfma_f32_16x16x32_bf16 v[124:127], a[212:215], v[144:147], v[124:127]
ds_read_b128 a[208:211], v7 offset:16640
v_cvt_pk_bf16_f32 v150, v76, v77
v_mfma_f32_16x16x32_bf16 v[116:119], a[212:215], v[136:139], v[116:119]
v_cvt_pk_bf16_f32 v151, v78, v79
v_mfma_f32_16x16x32_bf16 v[108:111], a[212:215], v[128:131], v[108:111]
s_waitcnt lgkmcnt(4)
v_mfma_f32_16x16x32_bf16 v[84:87], a[216:219], v[152:155], v[84:87]
ds_read_b128 a[212:215], v7 offset:24832
v_mfma_f32_16x16x32_bf16 v[92:95], a[216:219], v[160:163], v[92:95]
v_mfma_f32_16x16x32_bf16 v[100:103], a[216:219], v[168:171], v[100:103]
s_waitcnt lgkmcnt(4)
v_mfma_f32_16x16x32_bf16 v[124:127], a[220:223], v[168:171], v[124:127]
s_waitcnt vmcnt(28)
s_barrier
v_add_u32 v8, 4294934528, v8
v_mfma_f32_16x16x32_bf16 v[116:119], a[220:223], v[160:163], v[116:119]
s_add_u32 m0, s48, 98304
ds_read_b64_tr_b16 a[216:217], v8 offset:0
s_mov_b32 s49, 196608
v_mfma_f32_16x16x32_bf16 v[108:111], a[220:223], v[152:155], v[108:111]
s_waitcnt lgkmcnt(4)
ds_read_b64_tr_b16 a[218:219], v8 offset:8192
v_mfma_f32_16x16x32_bf16 v[84:87], a[224:227], v[176:179], v[84:87]
buffer_load_dwordx4 v16, s[28:31], s49 offen nt lds
v_mfma_f32_16x16x32_bf16 v[92:95], a[224:227], v[184:187], v[92:95]
v_add_u32 v9, 4294934528, v9
v_mfma_f32_16x16x32_bf16 v[100:103], a[224:227], v[192:195], v[100:103]
s_waitcnt lgkmcnt(4)
ds_read_b64_tr_b16 a[220:221], v9 offset:0
v_mfma_f32_16x16x32_bf16 v[124:127], a[228:231], v[192:195], v[124:127]
ds_read_b64_tr_b16 a[222:223], v9 offset:8192
v_add_u32 v10, 4294934528, v10
v_mfma_f32_16x16x32_bf16 v[116:119], a[228:231], v[184:187], v[116:119]
ds_read_b64_tr_b16 a[224:225], v10 offset:0
v_mfma_f32_16x16x32_bf16 v[108:111], a[228:231], v[176:179], v[108:111]
s_waitcnt lgkmcnt(6)
ds_read_b64_tr_b16 a[226:227], v10 offset:8192
v_mfma_f32_16x16x32_bf16 v[84:87], a[208:211], v[200:203], v[84:87]
buffer_load_dwordx4 v17, s[28:31], s49 offen offset:1024 nt lds
v_mfma_f32_16x16x32_bf16 v[92:95], a[208:211], v[208:211], v[92:95]
v_add_u32 v11, 4294934528, v11
v_mfma_f32_16x16x32_bf16 v[100:103], a[208:211], v[216:219], v[100:103]
s_waitcnt lgkmcnt(6)
ds_read_b64_tr_b16 a[228:229], v11 offset:0
v_mfma_f32_16x16x32_bf16 v[124:127], a[212:215], v[216:219], v[124:127]
ds_read_b64_tr_b16 a[230:231], v11 offset:8192
v_add_u32 v12, 4294934528, v12
v_mfma_f32_16x16x32_bf16 v[116:119], a[212:215], v[208:211], v[116:119]
ds_read_b64_tr_b16 a[208:209], v12 offset:0
v_mfma_f32_16x16x32_bf16 v[108:111], a[212:215], v[200:203], v[108:111]
ds_read_b64_tr_b16 a[210:211], v12 offset:8192
v_mfma_f32_16x16x32_bf16 a[192:195], a[204:207], v[132:135], a[192:195]
buffer_load_dwordx4 v18, s[28:31], s49 offen offset:2048 nt lds
v_mfma_f32_16x16x32_bf16 a[196:199], a[204:207], v[140:143], a[196:199]
v_mfma_f32_16x16x32_bf16 a[200:203], a[204:207], v[148:151], a[200:203]
s_waitcnt lgkmcnt(8)
v_mfma_f32_16x16x32_bf16 a[0:3], a[216:219], v[132:135], a[0:3]
buffer_load_dwordx4 v19, s[28:31], s49 offen offset:3072 nt lds
v_mfma_f32_16x16x32_bf16 a[4:7], a[216:219], v[140:143], a[4:7]
v_add_u32 v13, 4294934528, v13
v_max3_f32 v156, v84, v85, v86
v_mfma_f32_16x16x32_bf16 a[8:11], a[216:219], v[148:151], a[8:11]
s_waitcnt lgkmcnt(6)
ds_read_b64_tr_b16 a[212:213], v13 offset:0
v_max3_f32 v157, v92, v93, v94
v_mfma_f32_16x16x32_bf16 a[20:23], a[220:223], v[148:151], a[20:23]
ds_read_b64_tr_b16 a[214:215], v13 offset:8192
v_add_u32 v14, 4294934528, v14
v_mfma_f32_16x16x32_bf16 a[16:19], a[220:223], v[140:143], a[16:19]
ds_read_b64_tr_b16 a[216:217], v14 offset:0
v_max3_f32 v158, v100, v101, v102
v_mfma_f32_16x16x32_bf16 a[12:15], a[220:223], v[132:135], a[12:15]
s_waitcnt lgkmcnt(7)
ds_read_b64_tr_b16 a[218:219], v14 offset:8192
v_max3_f32 v156, v156, v87, v108
v_mfma_f32_16x16x32_bf16 a[24:27], a[224:227], v[132:135], a[24:27]
v_add_u32 v15, 4294934528, v15
v_max3_f32 v157, v157, v95, v116
v_mfma_f32_16x16x32_bf16 a[28:31], a[224:227], v[140:143], a[28:31]
ds_read_b64_tr_b16 a[220:221], v15 offset:0
v_max3_f32 v158, v158, v103, v124
v_mfma_f32_16x16x32_bf16 a[32:35], a[224:227], v[148:151], a[32:35]
s_waitcnt lgkmcnt(7)
ds_read_b64_tr_b16 a[222:223], v15 offset:8192
v_max3_f32 v156, v156, v109, v110
v_mfma_f32_16x16x32_bf16 a[44:47], a[228:231], v[148:151], a[44:47]
ds_read_b64_tr_b16 a[224:225], v8 offset:256
v_max3_f32 v157, v157, v117, v118
v_mfma_f32_16x16x32_bf16 a[40:43], a[228:231], v[140:143], a[40:43]
ds_read_b64_tr_b16 a[226:227], v8 offset:8448
v_max3_f32 v158, v158, v125, v126
v_mfma_f32_16x16x32_bf16 a[36:39], a[228:231], v[132:135], a[36:39]
s_waitcnt lgkmcnt(8)
v_max_f32 v156, v156, v111
v_max_f32 v157, v157, v119
v_mfma_f32_16x16x32_bf16 a[48:51], a[208:211], v[132:135], a[48:51]
ds_read_b64_tr_b16 a[228:229], v9 offset:256
v_max_f32 v158, v158, v127
v_mfma_f32_16x16x32_bf16 a[52:55], a[208:211], v[140:143], a[52:55]
ds_read_b64_tr_b16 a[230:231], v9 offset:8448
v_fma_f32 v164, v156, s50, v234
v_mfma_f32_16x16x32_bf16 a[56:59], a[208:211], v[148:151], a[56:59]
s_waitcnt lgkmcnt(8)
v_fma_f32 v165, v157, s50, v235
v_fma_f32 v166, v158, s50, v236
v_mfma_f32_16x16x32_bf16 a[68:71], a[212:215], v[148:151], a[68:71]
ds_read_b64_tr_b16 a[208:209], v10 offset:256
v_max3_f32 v167, v164, v165, v166
v_mfma_f32_16x16x32_bf16 a[64:67], a[212:215], v[140:143], a[64:67]
ds_read_b64_tr_b16 a[210:211], v10 offset:8448
v_cmp_lt_f32 vcc, s51, v167
v_mfma_f32_16x16x32_bf16 a[60:63], a[212:215], v[132:135], a[60:63]
s_waitcnt lgkmcnt(8)
s_cbranch_vccnz L_ra8
L_skipa8:
v_fma_f32 v84, v84, s50, v234
v_mfma_f32_16x16x32_bf16 a[72:75], a[216:219], v[132:135], a[72:75]
ds_read_b64_tr_b16 a[212:213], v11 offset:256
v_fma_f32 v85, v85, s50, v234
v_mfma_f32_16x16x32_bf16 a[76:79], a[216:219], v[140:143], a[76:79]
ds_read_b64_tr_b16 a[214:215], v11 offset:8448
v_fma_f32 v86, v86, s50, v234
v_mfma_f32_16x16x32_bf16 a[80:83], a[216:219], v[148:151], a[80:83]
s_waitcnt lgkmcnt(8)
v_fma_f32 v87, v87, s50, v234
v_fma_f32 v108, v108, s50, v234
v_mfma_f32_16x16x32_bf16 a[92:95], a[220:223], v[148:151], a[92:95]
ds_read_b64_tr_b16 a[216:217], v12 offset:256
v_fma_f32 v109, v109, s50, v234
v_mfma_f32_16x16x32_bf16 a[88:91], a[220:223], v[140:143], a[88:91]
ds_read_b64_tr_b16 a[218:219], v12 offset:8448
v_fma_f32 v110, v110, s50, v234
v_mfma_f32_16x16x32_bf16 a[84:87], a[220:223], v[132:135], a[84:87]
s_waitcnt lgkmcnt(8)
v_exp_f32 v84, v84
v_mfma_f32_16x16x32_bf16 a[96:99], a[224:227], v[132:135], a[96:99]
ds_read_b64_tr_b16 a[220:221], v13 offset:256
v_fma_f32 v111, v111, s50, v234
v_mfma_f32_16x16x32_bf16 a[100:103], a[224:227], v[140:143], a[100:103]
ds_read_b64_tr_b16 a[222:223], v13 offset:8448
v_fma_f32 v92, v92, s50, v235
v_mfma_f32_16x16x32_bf16 a[104:107], a[224:227], v[148:151], a[104:107]
s_waitcnt lgkmcnt(8)
v_exp_f32 v85, v85
v_mfma_f32_16x16x32_bf16 a[116:119], a[228:231], v[148:151], a[116:119]
ds_read_b64_tr_b16 a[224:225], v14 offset:256
v_fma_f32 v93, v93, s50, v235
v_mfma_f32_16x16x32_bf16 a[112:115], a[228:231], v[140:143], a[112:115]
ds_read_b64_tr_b16 a[226:227], v14 offset:8448
v_fma_f32 v94, v94, s50, v235
v_mfma_f32_16x16x32_bf16 a[108:111], a[228:231], v[132:135], a[108:111]
s_waitcnt lgkmcnt(8)
v_exp_f32 v86, v86
v_mfma_f32_16x16x32_bf16 a[120:123], a[208:211], v[132:135], a[120:123]
ds_read_b64_tr_b16 a[228:229], v15 offset:256
v_fma_f32 v95, v95, s50, v235
v_mfma_f32_16x16x32_bf16 a[124:127], a[208:211], v[140:143], a[124:127]
ds_read_b64_tr_b16 a[230:231], v15 offset:8448
v_fma_f32 v116, v116, s50, v235
v_mfma_f32_16x16x32_bf16 a[128:131], a[208:211], v[148:151], a[128:131]
s_waitcnt lgkmcnt(8)
v_exp_f32 v87, v87
v_mfma_f32_16x16x32_bf16 a[140:143], a[212:215], v[148:151], a[140:143]
s_waitcnt vmcnt(28)
s_barrier
v_add_u32 v4, 4294885376, v4
v_mfma_f32_16x16x32_bf16 a[136:139], a[212:215], v[140:143], a[136:139]
s_add_u32 m0, s48, 114688
ds_read_b128 a[208:211], v4 offset:0
s_mov_b32 s49, 229376
v_mfma_f32_16x16x32_bf16 a[132:135], a[212:215], v[132:135], a[132:135]
s_waitcnt lgkmcnt(7)
buffer_load_dwordx4 v16, s[24:27], s49 offen nt lds
v_mfma_f32_16x16x32_bf16 a[144:147], a[216:219], v[132:135], a[144:147]
ds_read_b128 a[212:215], v4 offset:8192
v_fma_f32 v117, v117, s50, v235
v_mfma_f32_16x16x32_bf16 a[148:151], a[216:219], v[140:143], a[148:151]
v_exp_f32 v108, v108
v_mfma_f32_16x16x32_bf16 a[152:155], a[216:219], v[148:151], a[152:155]
s_waitcnt lgkmcnt(6)
buffer_load_dwordx4 v17, s[24:27], s49 offen offset:1024 nt lds
v_mfma_f32_16x16x32_bf16 a[164:167], a[220:223], v[148:151], a[164:167]
v_add_u32 v5, 4294885376, v5
v_fma_f32 v118, v118, s50, v235
v_mfma_f32_16x16x32_bf16 a[160:163], a[220:223], v[140:143], a[160:163]
ds_read_b128 a[216:219], v5 offset:0
v_fma_f32 v119, v119, s50, v235
v_mfma_f32_16x16x32_bf16 a[156:159], a[220:223], v[132:135], a[156:159]
s_waitcnt lgkmcnt(5)
v_exp_f32 v109, v109
v_mfma_f32_16x16x32_bf16 a[168:171], a[224:227], v[132:135], a[168:171]
ds_read_b128 a[220:223], v5 offset:8192
v_fma_f32 v100, v100, s50, v236
v_mfma_f32_16x16x32_bf16 a[172:175], a[224:227], v[140:143], a[172:175]
v_exp_f32 v110, v110
v_mfma_f32_16x16x32_bf16 a[176:179], a[224:227], v[148:151], a[176:179]
s_waitcnt lgkmcnt(4)
buffer_load_dwordx4 v18, s[24:27], s49 offen offset:2048 nt lds
v_mfma_f32_16x16x32_bf16 a[188:191], a[228:231], v[148:151], a[188:191]
v_add_u32 v6, 4294885376, v6
v_fma_f32 v101, v101, s50, v236
v_mfma_f32_16x16x32_bf16 a[184:187], a[228:231], v[140:143], a[184:187]
ds_read_b128 a[224:227], v6 offset:0
v_fma_f32 v102, v102, s50, v236
v_mfma_f32_16x16x32_bf16 a[180:183], a[228:231], v[132:135], a[180:183]
s_cbranch_vccnz L_rb8
L_skipb8:
s_waitcnt lgkmcnt(4)
v_fma_f32 v103, v103, s50, v236
v_mfma_f32_16x16x32_bf16 v[36:39], a[208:211], v[32:35], 0
ds_read_b128 a[228:231], v6 offset:8192
v_fma_f32 v124, v124, s50, v236
v_mfma_f32_16x16x32_bf16 v[44:47], a[208:211], v[40:43], 0
buffer_load_dwordx4 v19, s[24:27], s49 offen offset:3072 nt lds
v_mfma_f32_16x16x32_bf16 v[52:55], a[208:211], v[48:51], 0
s_waitcnt lgkmcnt(4)
v_exp_f32 v111, v111
v_mfma_f32_16x16x32_bf16 v[76:79], a[212:215], v[48:51], 0
v_add_u32 v7, 4294885376, v7
v_fma_f32 v125, v125, s50, v236
v_mfma_f32_16x16x32_bf16 v[68:71], a[212:215], v[40:43], 0
ds_read_b128 a[208:211], v7 offset:0
v_fma_f32 v126, v126, s50, v236
v_mfma_f32_16x16x32_bf16 v[60:63], a[212:215], v[32:35], 0
s_waitcnt lgkmcnt(4)
v_exp_f32 v92, v92
v_mfma_f32_16x16x32_bf16 v[36:39], a[216:219], v[56:59], v[36:39]
ds_read_b128 a[212:215], v7 offset:8192
v_fma_f32 v127, v127, s50, v236
v_mfma_f32_16x16x32_bf16 v[44:47], a[216:219], v[64:67], v[44:47]
v_exp_f32 v93, v93
v_mfma_f32_16x16x32_bf16 v[52:55], a[216:219], v[72:75], v[52:55]
s_waitcnt lgkmcnt(4)
v_exp_f32 v94, v94
v_mfma_f32_16x16x32_bf16 v[76:79], a[220:223], v[72:75], v[76:79]
ds_read_b128 a[216:219], v4 offset:256
v_cvt_pk_bf16_f32 v132, v84, v85
v_mfma_f32_16x16x32_bf16 v[68:71], a[220:223], v[64:67], v[68:71]
v_exp_f32 v95, v95
v_mfma_f32_16x16x32_bf16 v[60:63], a[220:223], v[56:59], v[60:63]
s_waitcnt lgkmcnt(4)
v_exp_f32 v116, v116
v_mfma_f32_16x16x32_bf16 v[36:39], a[224:227], v[80:83], v[36:39]
ds_read_b128 a[220:223], v4 offset:8448
v_cvt_pk_bf16_f32 v133, v86, v87
v_mfma_f32_16x16x32_bf16 v[44:47], a[224:227], v[88:91], v[44:47]
v_exp_f32 v117, v117
v_mfma_f32_16x16x32_bf16 v[52:55], a[224:227], v[96:99], v[52:55]
s_waitcnt lgkmcnt(4)
v_exp_f32 v118, v118
v_mfma_f32_16x16x32_bf16 v[76:79], a[228:231], v[96:99], v[76:79]
ds_read_b128 a[224:227], v5 offset:256
v_cvt_pk_bf16_f32 v134, v108, v109
v_mfma_f32_16x16x32_bf16 v[68:71], a[228:231], v[88:91], v[68:71]
v_exp_f32 v119, v119
v_mfma_f32_16x16x32_bf16 v[60:63], a[228:231], v[80:83], v[60:63]
s_waitcnt lgkmcnt(4)
v_exp_f32 v100, v100
v_mfma_f32_16x16x32_bf16 v[36:39], a[208:211], v[104:107], v[36:39]
ds_read_b128 a[228:231], v5 offset:8448
v_cvt_pk_bf16_f32 v135, v110, v111
v_mfma_f32_16x16x32_bf16 v[44:47], a[208:211], v[112:115], v[44:47]
v_exp_f32 v101, v101
v_mfma_f32_16x16x32_bf16 v[52:55], a[208:211], v[120:123], v[52:55]
s_waitcnt lgkmcnt(4)
v_exp_f32 v102, v102
v_mfma_f32_16x16x32_bf16 v[76:79], a[212:215], v[120:123], v[76:79]
ds_read_b128 a[208:211], v6 offset:256
v_cvt_pk_bf16_f32 v140, v92, v93
v_mfma_f32_16x16x32_bf16 v[68:71], a[212:215], v[112:115], v[68:71]
v_exp_f32 v103, v103
v_mfma_f32_16x16x32_bf16 v[60:63], a[212:215], v[104:107], v[60:63]
s_waitcnt lgkmcnt(4)
v_exp_f32 v124, v124
v_mfma_f32_16x16x32_bf16 v[36:39], a[216:219], v[128:131], v[36:39]
ds_read_b128 a[212:215], v6 offset:8448
v_cvt_pk_bf16_f32 v141, v94, v95
v_mfma_f32_16x16x32_bf16 v[44:47], a[216:219], v[136:139], v[44:47]
v_exp_f32 v125, v125
v_mfma_f32_16x16x32_bf16 v[52:55], a[216:219], v[144:147], v[52:55]
s_waitcnt lgkmcnt(4)
v_exp_f32 v126, v126
v_mfma_f32_16x16x32_bf16 v[76:79], a[220:223], v[144:147], v[76:79]
ds_read_b128 a[216:219], v7 offset:256
v_cvt_pk_bf16_f32 v142, v116, v117
v_mfma_f32_16x16x32_bf16 v[68:71], a[220:223], v[136:139], v[68:71]
v_exp_f32 v127, v127
v_mfma_f32_16x16x32_bf16 v[60:63], a[220:223], v[128:131], v[60:63]
s_waitcnt lgkmcnt(4)
v_cvt_pk_bf16_f32 v143, v118, v119
v_cvt_pk_bf16_f32 v148, v100, v101
v_mfma_f32_16x16x32_bf16 v[36:39], a[224:227], v[152:155], v[36:39]
ds_read_b128 a[220:223], v7 offset:8448
v_cvt_pk_bf16_f32 v149, v102, v103
v_mfma_f32_16x16x32_bf16 v[44:47], a[224:227], v[160:163], v[44:47]
v_cvt_pk_bf16_f32 v150, v124, v125
v_cvt_pk_bf16_f32 v151, v126, v127
v_mfma_f32_16x16x32_bf16 v[52:55], a[224:227], v[168:171], v[52:55]
s_waitcnt lgkmcnt(4)
v_mfma_f32_16x16x32_bf16 v[76:79], a[228:231], v[168:171], v[76:79]
s_waitcnt vmcnt(28)
s_barrier
v_add_u32 v8, 49152, v8
v_mfma_f32_16x16x32_bf16 v[68:71], a[228:231], v[160:163], v[68:71]
s_add_u32 m0, s48, 49152
ds_read_b64_tr_b16 a[224:225], v8 offset:49152
s_mov_b32 s49, 212992
v_mfma_f32_16x16x32_bf16 v[60:63], a[228:231], v[152:155], v[60:63]
s_waitcnt lgkmcnt(4)
ds_read_b64_tr_b16 a[226:227], v8 offset:57344
v_mfma_f32_16x16x32_bf16 v[36:39], a[208:211], v[176:179], v[36:39]
buffer_load_dwordx4 v16, s[28:31], s49 offen nt lds
v_mfma_f32_16x16x32_bf16 v[44:47], a[208:211], v[184:187], v[44:47]
v_add_u32 v9, 49152, v9
v_mfma_f32_16x16x32_bf16 v[52:55], a[208:211], v[192:195], v[52:55]
s_waitcnt lgkmcnt(4)
ds_read_b64_tr_b16 a[228:229], v9 offset:49152
v_mfma_f32_16x16x32_bf16 v[76:79], a[212:215], v[192:195], v[76:79]
ds_read_b64_tr_b16 a[230:231], v9 offset:57344
v_add_u32 v10, 49152, v10
v_mfma_f32_16x16x32_bf16 v[68:71], a[212:215], v[184:187], v[68:71]
ds_read_b64_tr_b16 a[208:209], v10 offset:49152
v_mfma_f32_16x16x32_bf16 v[60:63], a[212:215], v[176:179], v[60:63]
s_waitcnt lgkmcnt(6)
ds_read_b64_tr_b16 a[210:211], v10 offset:57344
v_mfma_f32_16x16x32_bf16 v[36:39], a[216:219], v[200:203], v[36:39]
buffer_load_dwordx4 v17, s[28:31], s49 offen offset:1024 nt lds
v_mfma_f32_16x16x32_bf16 v[44:47], a[216:219], v[208:211], v[44:47]
v_add_u32 v11, 49152, v11
v_mfma_f32_16x16x32_bf16 v[52:55], a[216:219], v[216:219], v[52:55]
s_waitcnt lgkmcnt(6)
ds_read_b64_tr_b16 a[212:213], v11 offset:49152
v_mfma_f32_16x16x32_bf16 v[76:79], a[220:223], v[216:219], v[76:79]
ds_read_b64_tr_b16 a[214:215], v11 offset:57344
v_add_u32 v12, 49152, v12
v_mfma_f32_16x16x32_bf16 v[68:71], a[220:223], v[208:211], v[68:71]
ds_read_b64_tr_b16 a[216:217], v12 offset:49152
v_mfma_f32_16x16x32_bf16 v[60:63], a[220:223], v[200:203], v[60:63]
ds_read_b64_tr_b16 a[218:219], v12 offset:57344
v_mfma_f32_16x16x32_bf16 a[192:195], a[204:207], v[132:135], a[192:195]
buffer_load_dwordx4 v18, s[28:31], s49 offen offset:2048 nt lds
v_mfma_f32_16x16x32_bf16 a[196:199], a[204:207], v[140:143], a[196:199]
v_mfma_f32_16x16x32_bf16 a[200:203], a[204:207], v[148:151], a[200:203]
s_waitcnt lgkmcnt(8)
v_mfma_f32_16x16x32_bf16 a[0:3], a[224:227], v[132:135], a[0:3]
buffer_load_dwordx4 v19, s[28:31], s49 offen offset:3072 nt lds
v_mfma_f32_16x16x32_bf16 a[4:7], a[224:227], v[140:143], a[4:7]
v_add_u32 v13, 49152, v13
v_max3_f32 v156, v36, v37, v38
v_mfma_f32_16x16x32_bf16 a[8:11], a[224:227], v[148:151], a[8:11]
s_waitcnt lgkmcnt(6)
ds_read_b64_tr_b16 a[220:221], v13 offset:49152
v_max3_f32 v157, v44, v45, v46
v_mfma_f32_16x16x32_bf16 a[20:23], a[228:231], v[148:151], a[20:23]
ds_read_b64_tr_b16 a[222:223], v13 offset:57344
v_add_u32 v14, 49152, v14
v_mfma_f32_16x16x32_bf16 a[16:19], a[228:231], v[140:143], a[16:19]
ds_read_b64_tr_b16 a[224:225], v14 offset:49152
v_max3_f32 v158, v52, v53, v54
v_mfma_f32_16x16x32_bf16 a[12:15], a[228:231], v[132:135], a[12:15]
s_waitcnt lgkmcnt(7)
ds_read_b64_tr_b16 a[226:227], v14 offset:57344
v_max3_f32 v156, v156, v39, v60
v_mfma_f32_16x16x32_bf16 a[24:27], a[208:211], v[132:135], a[24:27]
v_add_u32 v15, 49152, v15
v_max3_f32 v157, v157, v47, v68
v_mfma_f32_16x16x32_bf16 a[28:31], a[208:211], v[140:143], a[28:31]
ds_read_b64_tr_b16 a[228:229], v15 offset:49152
v_max3_f32 v158, v158, v55, v76
v_mfma_f32_16x16x32_bf16 a[32:35], a[208:211], v[148:151], a[32:35]
s_waitcnt lgkmcnt(7)
ds_read_b64_tr_b16 a[230:231], v15 offset:57344
v_max3_f32 v156, v156, v61, v62
v_mfma_f32_16x16x32_bf16 a[44:47], a[212:215], v[148:151], a[44:47]
ds_read_b64_tr_b16 a[208:209], v8 offset:49408
v_max3_f32 v157, v157, v69, v70
v_mfma_f32_16x16x32_bf16 a[40:43], a[212:215], v[140:143], a[40:43]
ds_read_b64_tr_b16 a[210:211], v8 offset:57600
v_max3_f32 v158, v158, v77, v78
v_mfma_f32_16x16x32_bf16 a[36:39], a[212:215], v[132:135], a[36:39]
s_waitcnt lgkmcnt(8)
v_max_f32 v156, v156, v63
v_max_f32 v157, v157, v71
v_mfma_f32_16x16x32_bf16 a[48:51], a[216:219], v[132:135], a[48:51]
ds_read_b64_tr_b16 a[212:213], v9 offset:49408
v_max_f32 v158, v158, v79
v_mfma_f32_16x16x32_bf16 a[52:55], a[216:219], v[140:143], a[52:55]
ds_read_b64_tr_b16 a[214:215], v9 offset:57600
v_fma_f32 v164, v156, s50, v234
v_mfma_f32_16x16x32_bf16 a[56:59], a[216:219], v[148:151], a[56:59]
s_waitcnt lgkmcnt(8)
v_fma_f32 v165, v157, s50, v235
v_fma_f32 v166, v158, s50, v236
v_mfma_f32_16x16x32_bf16 a[68:71], a[220:223], v[148:151], a[68:71]
ds_read_b64_tr_b16 a[216:217], v10 offset:49408
v_max3_f32 v167, v164, v165, v166
v_mfma_f32_16x16x32_bf16 a[64:67], a[220:223], v[140:143], a[64:67]
ds_read_b64_tr_b16 a[218:219], v10 offset:57600
v_cmp_lt_f32 vcc, s51, v167
v_mfma_f32_16x16x32_bf16 a[60:63], a[220:223], v[132:135], a[60:63]
s_waitcnt lgkmcnt(8)
s_cbranch_vccnz L_ra9
L_skipa9:
v_fma_f32 v36, v36, s50, v234
v_mfma_f32_16x16x32_bf16 a[72:75], a[224:227], v[132:135], a[72:75]
ds_read_b64_tr_b16 a[220:221], v11 offset:49408
v_fma_f32 v37, v37, s50, v234
v_mfma_f32_16x16x32_bf16 a[76:79], a[224:227], v[140:143], a[76:79]
ds_read_b64_tr_b16 a[222:223], v11 offset:57600
v_fma_f32 v38, v38, s50, v234
v_mfma_f32_16x16x32_bf16 a[80:83], a[224:227], v[148:151], a[80:83]
s_waitcnt lgkmcnt(8)
v_fma_f32 v39, v39, s50, v234
v_fma_f32 v60, v60, s50, v234
v_mfma_f32_16x16x32_bf16 a[92:95], a[228:231], v[148:151], a[92:95]
ds_read_b64_tr_b16 a[224:225], v12 offset:49408
v_fma_f32 v61, v61, s50, v234
v_mfma_f32_16x16x32_bf16 a[88:91], a[228:231], v[140:143], a[88:91]
ds_read_b64_tr_b16 a[226:227], v12 offset:57600
v_fma_f32 v62, v62, s50, v234
v_mfma_f32_16x16x32_bf16 a[84:87], a[228:231], v[132:135], a[84:87]
s_waitcnt lgkmcnt(8)
v_exp_f32 v36, v36
v_mfma_f32_16x16x32_bf16 a[96:99], a[208:211], v[132:135], a[96:99]
ds_read_b64_tr_b16 a[228:229], v13 offset:49408
v_fma_f32 v63, v63, s50, v234
v_mfma_f32_16x16x32_bf16 a[100:103], a[208:211], v[140:143], a[100:103]
ds_read_b64_tr_b16 a[230:231], v13 offset:57600
v_fma_f32 v44, v44, s50, v235
v_mfma_f32_16x16x32_bf16 a[104:107], a[208:211], v[148:151], a[104:107]
s_waitcnt lgkmcnt(8)
v_exp_f32 v37, v37
v_mfma_f32_16x16x32_bf16 a[116:119], a[212:215], v[148:151], a[116:119]
ds_read_b64_tr_b16 a[208:209], v14 offset:49408
v_fma_f32 v45, v45, s50, v235
v_mfma_f32_16x16x32_bf16 a[112:115], a[212:215], v[140:143], a[112:115]
ds_read_b64_tr_b16 a[210:211], v14 offset:57600
v_fma_f32 v46, v46, s50, v235
v_mfma_f32_16x16x32_bf16 a[108:111], a[212:215], v[132:135], a[108:111]
s_waitcnt lgkmcnt(8)
v_exp_f32 v38, v38
v_mfma_f32_16x16x32_bf16 a[120:123], a[216:219], v[132:135], a[120:123]
ds_read_b64_tr_b16 a[212:213], v15 offset:49408
v_fma_f32 v47, v47, s50, v235
v_mfma_f32_16x16x32_bf16 a[124:127], a[216:219], v[140:143], a[124:127]
ds_read_b64_tr_b16 a[214:215], v15 offset:57600
v_fma_f32 v68, v68, s50, v235
v_mfma_f32_16x16x32_bf16 a[128:131], a[216:219], v[148:151], a[128:131]
s_waitcnt lgkmcnt(8)
v_exp_f32 v39, v39
v_mfma_f32_16x16x32_bf16 a[140:143], a[220:223], v[148:151], a[140:143]
s_waitcnt vmcnt(28)
s_barrier
ds_read_b128 a[216:219], v4 offset:49152
v_mfma_f32_16x16x32_bf16 a[136:139], a[220:223], v[140:143], a[136:139]
s_add_u32 m0, s48, 16384
s_mov_b32 s49, 245760
v_fma_f32 v69, v69, s50, v235
v_mfma_f32_16x16x32_bf16 a[132:135], a[220:223], v[132:135], a[132:135]
s_waitcnt lgkmcnt(7)
buffer_load_dwordx4 v16, s[24:27], s49 offen nt lds
v_mfma_f32_16x16x32_bf16 a[144:147], a[224:227], v[132:135], a[144:147]
ds_read_b128 a[220:223], v4 offset:57344
v_fma_f32 v70, v70, s50, v235
v_mfma_f32_16x16x32_bf16 a[148:151], a[224:227], v[140:143], a[148:151]
v_exp_f32 v60, v60
v_mfma_f32_16x16x32_bf16 a[152:155], a[224:227], v[148:151], a[152:155]
s_waitcnt lgkmcnt(6)
buffer_load_dwordx4 v17, s[24:27], s49 offen offset:1024 nt lds
v_mfma_f32_16x16x32_bf16 a[164:167], a[228:231], v[148:151], a[164:167]
ds_read_b128 a[224:227], v5 offset:49152
v_fma_f32 v71, v71, s50, v235
v_mfma_f32_16x16x32_bf16 a[160:163], a[228:231], v[140:143], a[160:163]
v_exp_f32 v61, v61
v_mfma_f32_16x16x32_bf16 a[156:159], a[228:231], v[132:135], a[156:159]
s_waitcnt lgkmcnt(5)
v_exp_f32 v62, v62
v_mfma_f32_16x16x32_bf16 a[168:171], a[208:211], v[132:135], a[168:171]
ds_read_b128 a[228:231], v5 offset:57344
v_fma_f32 v52, v52, s50, v236
v_mfma_f32_16x16x32_bf16 a[172:175], a[208:211], v[140:143], a[172:175]
v_exp_f32 v63, v63
v_mfma_f32_16x16x32_bf16 a[176:179], a[208:211], v[148:151], a[176:179]
s_waitcnt lgkmcnt(4)
buffer_load_dwordx4 v18, s[24:27], s49 offen offset:2048 nt lds
v_mfma_f32_16x16x32_bf16 a[188:191], a[212:215], v[148:151], a[188:191]
ds_read_b128 a[208:211], v6 offset:49152
v_fma_f32 v53, v53, s50, v236
v_mfma_f32_16x16x32_bf16 a[184:187], a[212:215], v[140:143], a[184:187]
v_exp_f32 v44, v44
v_mfma_f32_16x16x32_bf16 a[180:183], a[212:215], v[132:135], a[180:183]
s_cbranch_vccnz L_rb9
L_skipb9:
s_waitcnt lgkmcnt(4)
v_fma_f32 v54, v54, s50, v236
v_mfma_f32_16x16x32_bf16 v[84:87], a[216:219], v[32:35], 0
ds_read_b128 a[212:215], v6 offset:57344
v_fma_f32 v55, v55, s50, v236
v_mfma_f32_16x16x32_bf16 v[92:95], a[216:219], v[40:43], 0
buffer_load_dwordx4 v19, s[24:27], s49 offen offset:3072 nt lds
v_mfma_f32_16x16x32_bf16 v[100:103], a[216:219], v[48:51], 0
s_waitcnt lgkmcnt(4)
v_exp_f32 v45, v45
v_mfma_f32_16x16x32_bf16 v[124:127], a[220:223], v[48:51], 0
ds_read_b128 a[216:219], v7 offset:49152
v_fma_f32 v76, v76, s50, v236
v_mfma_f32_16x16x32_bf16 v[116:119], a[220:223], v[40:43], 0
v_exp_f32 v46, v46
v_mfma_f32_16x16x32_bf16 v[108:111], a[220:223], v[32:35], 0
s_waitcnt lgkmcnt(4)
v_exp_f32 v47, v47
v_mfma_f32_16x16x32_bf16 v[84:87], a[224:227], v[56:59], v[84:87]
ds_read_b128 a[220:223], v7 offset:57344
v_fma_f32 v77, v77, s50, v236
v_mfma_f32_16x16x32_bf16 v[92:95], a[224:227], v[64:67], v[92:95]
v_exp_f32 v68, v68
v_mfma_f32_16x16x32_bf16 v[100:103], a[224:227], v[72:75], v[100:103]
s_waitcnt lgkmcnt(4)
v_exp_f32 v69, v69
v_mfma_f32_16x16x32_bf16 v[124:127], a[228:231], v[72:75], v[124:127]
ds_read_b128 a[224:227], v4 offset:49408
v_fma_f32 v78, v78, s50, v236
v_mfma_f32_16x16x32_bf16 v[116:119], a[228:231], v[64:67], v[116:119]
v_exp_f32 v70, v70
v_mfma_f32_16x16x32_bf16 v[108:111], a[228:231], v[56:59], v[108:111]
s_waitcnt lgkmcnt(4)
v_exp_f32 v71, v71
v_mfma_f32_16x16x32_bf16 v[84:87], a[208:211], v[80:83], v[84:87]
ds_read_b128 a[228:231], v4 offset:57600
v_fma_f32 v79, v79, s50, v236
v_mfma_f32_16x16x32_bf16 v[92:95], a[208:211], v[88:91], v[92:95]
v_exp_f32 v52, v52
v_mfma_f32_16x16x32_bf16 v[100:103], a[208:211], v[96:99], v[100:103]
s_waitcnt lgkmcnt(4)
v_exp_f32 v53, v53
v_mfma_f32_16x16x32_bf16 v[124:127], a[212:215], v[96:99], v[124:127]
ds_read_b128 a[208:211], v5 offset:49408
v_cvt_pk_bf16_f32 v132, v36, v37
v_mfma_f32_16x16x32_bf16 v[116:119], a[212:215], v[88:91], v[116:119]
v_exp_f32 v54, v54
v_mfma_f32_16x16x32_bf16 v[108:111], a[212:215], v[80:83], v[108:111]
s_waitcnt lgkmcnt(4)
v_exp_f32 v55, v55
v_mfma_f32_16x16x32_bf16 v[84:87], a[216:219], v[104:107], v[84:87]
ds_read_b128 a[212:215], v5 offset:57600
v_cvt_pk_bf16_f32 v133, v38, v39
v_mfma_f32_16x16x32_bf16 v[92:95], a[216:219], v[112:115], v[92:95]
v_exp_f32 v76, v76
v_mfma_f32_16x16x32_bf16 v[100:103], a[216:219], v[120:123], v[100:103]
s_waitcnt lgkmcnt(4)
v_exp_f32 v77, v77
v_mfma_f32_16x16x32_bf16 v[124:127], a[220:223], v[120:123], v[124:127]
ds_read_b128 a[216:219], v6 offset:49408
v_cvt_pk_bf16_f32 v134, v60, v61
v_mfma_f32_16x16x32_bf16 v[116:119], a[220:223], v[112:115], v[116:119]
v_exp_f32 v78, v78
v_mfma_f32_16x16x32_bf16 v[108:111], a[220:223], v[104:107], v[108:111]
s_waitcnt lgkmcnt(4)
v_exp_f32 v79, v79
v_mfma_f32_16x16x32_bf16 v[84:87], a[224:227], v[128:131], v[84:87]
ds_read_b128 a[220:223], v6 offset:57600
v_cvt_pk_bf16_f32 v135, v62, v63
v_mfma_f32_16x16x32_bf16 v[92:95], a[224:227], v[136:139], v[92:95]
v_cvt_pk_bf16_f32 v140, v44, v45
v_cvt_pk_bf16_f32 v141, v46, v47
v_mfma_f32_16x16x32_bf16 v[100:103], a[224:227], v[144:147], v[100:103]
s_waitcnt lgkmcnt(4)
v_cvt_pk_bf16_f32 v142, v68, v69
v_cvt_pk_bf16_f32 v143, v70, v71
v_mfma_f32_16x16x32_bf16 v[124:127], a[228:231], v[144:147], v[124:127]
ds_read_b128 a[224:227], v7 offset:49408
v_cvt_pk_bf16_f32 v148, v52, v53
v_mfma_f32_16x16x32_bf16 v[116:119], a[228:231], v[136:139], v[116:119]
v_cvt_pk_bf16_f32 v149, v54, v55
v_cvt_pk_bf16_f32 v150, v76, v77
v_mfma_f32_16x16x32_bf16 v[108:111], a[228:231], v[128:131], v[108:111]
s_waitcnt lgkmcnt(4)
v_cvt_pk_bf16_f32 v151, v78, v79
v_mfma_f32_16x16x32_bf16 v[84:87], a[208:211], v[152:155], v[84:87]
ds_read_b128 a[228:231], v7 offset:57600
v_mfma_f32_16x16x32_bf16 v[92:95], a[208:211], v[160:163], v[92:95]
v_mfma_f32_16x16x32_bf16 v[100:103], a[208:211], v[168:171], v[100:103]
s_waitcnt lgkmcnt(4)
v_mfma_f32_16x16x32_bf16 v[124:127], a[212:215], v[168:171], v[124:127]
s_waitcnt vmcnt(28)
s_barrier
v_add_u32 v8, 4294950912, v8
v_mfma_f32_16x16x32_bf16 v[116:119], a[212:215], v[160:163], v[116:119]
ds_read_b64_tr_b16 a[208:209], v8 offset:0
v_mfma_f32_16x16x32_bf16 v[108:111], a[212:215], v[152:155], v[108:111]
s_waitcnt lgkmcnt(4)
ds_read_b64_tr_b16 a[210:211], v8 offset:8192
v_mfma_f32_16x16x32_bf16 v[84:87], a[216:219], v[176:179], v[84:87]
v_add_u32 v9, 4294950912, v9
v_mfma_f32_16x16x32_bf16 v[92:95], a[216:219], v[184:187], v[92:95]
ds_read_b64_tr_b16 a[212:213], v9 offset:0
v_mfma_f32_16x16x32_bf16 v[100:103], a[216:219], v[192:195], v[100:103]
s_waitcnt lgkmcnt(5)
ds_read_b64_tr_b16 a[214:215], v9 offset:8192
v_mfma_f32_16x16x32_bf16 v[124:127], a[220:223], v[192:195], v[124:127]
v_add_u32 v10, 4294950912, v10
v_mfma_f32_16x16x32_bf16 v[116:119], a[220:223], v[184:187], v[116:119]
ds_read_b64_tr_b16 a[216:217], v10 offset:0
v_mfma_f32_16x16x32_bf16 v[108:111], a[220:223], v[176:179], v[108:111]
s_waitcnt lgkmcnt(6)
ds_read_b64_tr_b16 a[218:219], v10 offset:8192
v_mfma_f32_16x16x32_bf16 v[84:87], a[224:227], v[200:203], v[84:87]
v_add_u32 v11, 4294950912, v11
v_mfma_f32_16x16x32_bf16 v[92:95], a[224:227], v[208:211], v[92:95]
ds_read_b64_tr_b16 a[220:221], v11 offset:0
v_mfma_f32_16x16x32_bf16 v[100:103], a[224:227], v[216:219], v[100:103]
s_waitcnt lgkmcnt(7)
ds_read_b64_tr_b16 a[222:223], v11 offset:8192
v_mfma_f32_16x16x32_bf16 v[124:127], a[228:231], v[216:219], v[124:127]
v_add_u32 v12, 4294950912, v12
v_mfma_f32_16x16x32_bf16 v[116:119], a[228:231], v[208:211], v[116:119]
ds_read_b64_tr_b16 a[224:225], v12 offset:0
v_mfma_f32_16x16x32_bf16 v[108:111], a[228:231], v[200:203], v[108:111]
ds_read_b64_tr_b16 a[226:227], v12 offset:8192
v_mfma_f32_16x16x32_bf16 a[192:195], a[204:207], v[132:135], a[192:195]
v_mfma_f32_16x16x32_bf16 a[196:199], a[204:207], v[140:143], a[196:199]
v_mfma_f32_16x16x32_bf16 a[200:203], a[204:207], v[148:151], a[200:203]
s_waitcnt lgkmcnt(8)
v_mfma_f32_16x16x32_bf16 a[0:3], a[208:211], v[132:135], a[0:3]
v_add_u32 v13, 4294950912, v13
v_max3_f32 v156, v84, v85, v86
v_mfma_f32_16x16x32_bf16 a[4:7], a[208:211], v[140:143], a[4:7]
ds_read_b64_tr_b16 a[228:229], v13 offset:0
v_max3_f32 v157, v92, v93, v94
v_mfma_f32_16x16x32_bf16 a[8:11], a[208:211], v[148:151], a[8:11]
s_waitcnt lgkmcnt(7)
ds_read_b64_tr_b16 a[230:231], v13 offset:8192
v_max3_f32 v158, v100, v101, v102
v_mfma_f32_16x16x32_bf16 a[20:23], a[212:215], v[148:151], a[20:23]
v_add_u32 v14, 4294950912, v14
v_max3_f32 v156, v156, v87, v108
v_mfma_f32_16x16x32_bf16 a[16:19], a[212:215], v[140:143], a[16:19]
ds_read_b64_tr_b16 a[208:209], v14 offset:0
v_max3_f32 v157, v157, v95, v116
v_mfma_f32_16x16x32_bf16 a[12:15], a[212:215], v[132:135], a[12:15]
s_waitcnt lgkmcnt(7)
ds_read_b64_tr_b16 a[210:211], v14 offset:8192
v_max3_f32 v158, v158, v103, v124
v_mfma_f32_16x16x32_bf16 a[24:27], a[216:219], v[132:135], a[24:27]
v_add_u32 v15, 4294950912, v15
v_max3_f32 v156, v156, v109, v110
v_mfma_f32_16x16x32_bf16 a[28:31], a[216:219], v[140:143], a[28:31]
ds_read_b64_tr_b16 a[212:213], v15 offset:0
v_max3_f32 v157, v157, v117, v118
v_mfma_f32_16x16x32_bf16 a[32:35], a[216:219], v[148:151], a[32:35]
s_waitcnt lgkmcnt(7)
ds_read_b64_tr_b16 a[214:215], v15 offset:8192
v_max3_f32 v158, v158, v125, v126
v_mfma_f32_16x16x32_bf16 a[44:47], a[220:223], v[148:151], a[44:47]
ds_read_b64_tr_b16 a[216:217], v8 offset:256
v_max_f32 v156, v156, v111
v_mfma_f32_16x16x32_bf16 a[40:43], a[220:223], v[140:143], a[40:43]
ds_read_b64_tr_b16 a[218:219], v8 offset:8448
v_max_f32 v157, v157, v119
v_mfma_f32_16x16x32_bf16 a[36:39], a[220:223], v[132:135], a[36:39]
s_waitcnt lgkmcnt(8)
v_max_f32 v158, v158, v127
v_fma_f32 v164, v156, s50, v234
v_mfma_f32_16x16x32_bf16 a[48:51], a[224:227], v[132:135], a[48:51]
ds_read_b64_tr_b16 a[220:221], v9 offset:256
v_fma_f32 v165, v157, s50, v235
v_mfma_f32_16x16x32_bf16 a[52:55], a[224:227], v[140:143], a[52:55]
ds_read_b64_tr_b16 a[222:223], v9 offset:8448
v_fma_f32 v166, v158, s50, v236
v_mfma_f32_16x16x32_bf16 a[56:59], a[224:227], v[148:151], a[56:59]
s_waitcnt lgkmcnt(8)
v_max3_f32 v167, v164, v165, v166
v_cmp_lt_f32 vcc, s51, v167
v_mfma_f32_16x16x32_bf16 a[68:71], a[228:231], v[148:151], a[68:71]
s_cbranch_vccnz L_ra10
L_skipa10:
ds_read_b64_tr_b16 a[224:225], v10 offset:256
v_fma_f32 v84, v84, s50, v234
v_mfma_f32_16x16x32_bf16 a[64:67], a[228:231], v[140:143], a[64:67]
ds_read_b64_tr_b16 a[226:227], v10 offset:8448
v_fma_f32 v85, v85, s50, v234
v_mfma_f32_16x16x32_bf16 a[60:63], a[228:231], v[132:135], a[60:63]
s_waitcnt lgkmcnt(8)
v_fma_f32 v86, v86, s50, v234
v_fma_f32 v87, v87, s50, v234
v_mfma_f32_16x16x32_bf16 a[72:75], a[208:211], v[132:135], a[72:75]
ds_read_b64_tr_b16 a[228:229], v11 offset:256
v_fma_f32 v108, v108, s50, v234
v_mfma_f32_16x16x32_bf16 a[76:79], a[208:211], v[140:143], a[76:79]
ds_read_b64_tr_b16 a[230:231], v11 offset:8448
v_fma_f32 v109, v109, s50, v234
v_mfma_f32_16x16x32_bf16 a[80:83], a[208:211], v[148:151], a[80:83]
s_waitcnt lgkmcnt(8)
v_exp_f32 v84, v84
v_mfma_f32_16x16x32_bf16 a[92:95], a[212:215], v[148:151], a[92:95]
ds_read_b64_tr_b16 a[208:209], v12 offset:256
v_fma_f32 v110, v110, s50, v234
v_mfma_f32_16x16x32_bf16 a[88:91], a[212:215], v[140:143], a[88:91]
ds_read_b64_tr_b16 a[210:211], v12 offset:8448
v_fma_f32 v111, v111, s50, v234
v_mfma_f32_16x16x32_bf16 a[84:87], a[212:215], v[132:135], a[84:87]
s_waitcnt lgkmcnt(8)
v_exp_f32 v85, v85
v_mfma_f32_16x16x32_bf16 a[96:99], a[216:219], v[132:135], a[96:99]
ds_read_b64_tr_b16 a[212:213], v13 offset:256
v_fma_f32 v92, v92, s50, v235
v_mfma_f32_16x16x32_bf16 a[100:103], a[216:219], v[140:143], a[100:103]
ds_read_b64_tr_b16 a[214:215], v13 offset:8448
v_fma_f32 v93, v93, s50, v235
v_mfma_f32_16x16x32_bf16 a[104:107], a[216:219], v[148:151], a[104:107]
s_waitcnt lgkmcnt(8)
v_exp_f32 v86, v86
v_mfma_f32_16x16x32_bf16 a[116:119], a[220:223], v[148:151], a[116:119]
ds_read_b64_tr_b16 a[216:217], v14 offset:256
v_fma_f32 v94, v94, s50, v235
v_mfma_f32_16x16x32_bf16 a[112:115], a[220:223], v[140:143], a[112:115]
ds_read_b64_tr_b16 a[218:219], v14 offset:8448
v_fma_f32 v95, v95, s50, v235
v_mfma_f32_16x16x32_bf16 a[108:111], a[220:223], v[132:135], a[108:111]
s_waitcnt lgkmcnt(8)
v_exp_f32 v87, v87
v_mfma_f32_16x16x32_bf16 a[120:123], a[224:227], v[132:135], a[120:123]
ds_read_b64_tr_b16 a[220:221], v15 offset:256
v_fma_f32 v116, v116, s50, v235
v_mfma_f32_16x16x32_bf16 a[124:127], a[224:227], v[140:143], a[124:127]
ds_read_b64_tr_b16 a[222:223], v15 offset:8448
v_fma_f32 v117, v117, s50, v235
v_mfma_f32_16x16x32_bf16 a[128:131], a[224:227], v[148:151], a[128:131]
s_waitcnt lgkmcnt(8)
v_exp_f32 v108, v108
v_mfma_f32_16x16x32_bf16 a[140:143], a[228:231], v[148:151], a[140:143]
s_waitcnt vmcnt(24)
s_barrier
ds_read_b128 a[224:227], v4 offset:16384
v_mfma_f32_16x16x32_bf16 a[136:139], a[228:231], v[140:143], a[136:139]
s_add_u32 m0, s48, 65536
s_mov_b32 s49, 229376
v_fma_f32 v118, v118, s50, v235
v_mfma_f32_16x16x32_bf16 a[132:135], a[228:231], v[132:135], a[132:135]
s_waitcnt lgkmcnt(7)
buffer_load_dwordx4 v16, s[28:31], s49 offen nt lds
v_mfma_f32_16x16x32_bf16 a[144:147], a[208:211], v[132:135], a[144:147]
ds_read_b128 a[228:231], v4 offset:24576
v_fma_f32 v119, v119, s50, v235
v_mfma_f32_16x16x32_bf16 a[148:151], a[208:211], v[140:143], a[148:151]
v_exp_f32 v109, v109
v_mfma_f32_16x16x32_bf16 a[152:155], a[208:211], v[148:151], a[152:155]
s_waitcnt lgkmcnt(6)
buffer_load_dwordx4 v17, s[28:31], s49 offen offset:1024 nt lds
v_mfma_f32_16x16x32_bf16 a[164:167], a[212:215], v[148:151], a[164:167]
ds_read_b128 a[208:211], v5 offset:16384
v_fma_f32 v100, v100, s50, v236
v_mfma_f32_16x16x32_bf16 a[160:163], a[212:215], v[140:143], a[160:163]
v_exp_f32 v110, v110
v_mfma_f32_16x16x32_bf16 a[156:159], a[212:215], v[132:135], a[156:159]
s_waitcnt lgkmcnt(5)
v_exp_f32 v111, v111
v_mfma_f32_16x16x32_bf16 a[168:171], a[216:219], v[132:135], a[168:171]
ds_read_b128 a[212:215], v5 offset:24576
v_fma_f32 v101, v101, s50, v236
v_mfma_f32_16x16x32_bf16 a[172:175], a[216:219], v[140:143], a[172:175]
v_exp_f32 v92, v92
v_mfma_f32_16x16x32_bf16 a[176:179], a[216:219], v[148:151], a[176:179]
s_waitcnt lgkmcnt(4)
buffer_load_dwordx4 v18, s[28:31], s49 offen offset:2048 nt lds
v_mfma_f32_16x16x32_bf16 a[188:191], a[220:223], v[148:151], a[188:191]
ds_read_b128 a[216:219], v6 offset:16384
v_fma_f32 v102, v102, s50, v236
v_mfma_f32_16x16x32_bf16 a[184:187], a[220:223], v[140:143], a[184:187]
v_exp_f32 v93, v93
v_mfma_f32_16x16x32_bf16 a[180:183], a[220:223], v[132:135], a[180:183]
s_cbranch_vccnz L_rb10
L_skipb10:
s_waitcnt lgkmcnt(4)
v_fma_f32 v103, v103, s50, v236
v_mfma_f32_16x16x32_bf16 v[36:39], a[224:227], v[32:35], 0
ds_read_b128 a[220:223], v6 offset:24576
v_fma_f32 v124, v124, s50, v236
v_mfma_f32_16x16x32_bf16 v[44:47], a[224:227], v[40:43], 0
buffer_load_dwordx4 v19, s[28:31], s49 offen offset:3072 nt lds
v_mfma_f32_16x16x32_bf16 v[52:55], a[224:227], v[48:51], 0
s_waitcnt lgkmcnt(4)
v_exp_f32 v94, v94
v_mfma_f32_16x16x32_bf16 v[76:79], a[228:231], v[48:51], 0
ds_read_b128 a[224:227], v7 offset:16384
v_fma_f32 v125, v125, s50, v236
v_mfma_f32_16x16x32_bf16 v[68:71], a[228:231], v[40:43], 0
v_exp_f32 v95, v95
v_mfma_f32_16x16x32_bf16 v[60:63], a[228:231], v[32:35], 0
s_waitcnt lgkmcnt(4)
v_exp_f32 v116, v116
v_mfma_f32_16x16x32_bf16 v[36:39], a[208:211], v[56:59], v[36:39]
ds_read_b128 a[228:231], v7 offset:24576
v_fma_f32 v126, v126, s50, v236
v_mfma_f32_16x16x32_bf16 v[44:47], a[208:211], v[64:67], v[44:47]
v_exp_f32 v117, v117
v_mfma_f32_16x16x32_bf16 v[52:55], a[208:211], v[72:75], v[52:55]
s_waitcnt lgkmcnt(4)
v_exp_f32 v118, v118
v_mfma_f32_16x16x32_bf16 v[76:79], a[212:215], v[72:75], v[76:79]
ds_read_b128 a[208:211], v4 offset:16640
v_fma_f32 v127, v127, s50, v236
v_mfma_f32_16x16x32_bf16 v[68:71], a[212:215], v[64:67], v[68:71]
v_exp_f32 v119, v119
v_mfma_f32_16x16x32_bf16 v[60:63], a[212:215], v[56:59], v[60:63]
s_waitcnt lgkmcnt(4)
v_exp_f32 v100, v100
v_mfma_f32_16x16x32_bf16 v[36:39], a[216:219], v[80:83], v[36:39]
ds_read_b128 a[212:215], v4 offset:24832
v_cvt_pk_bf16_f32 v132, v84, v85
v_mfma_f32_16x16x32_bf16 v[44:47], a[216:219], v[88:91], v[44:47]
v_exp_f32 v101, v101
v_mfma_f32_16x16x32_bf16 v[52:55], a[216:219], v[96:99], v[52:55]
s_waitcnt lgkmcnt(4)
v_exp_f32 v102, v102
v_mfma_f32_16x16x32_bf16 v[76:79], a[220:223], v[96:99], v[76:79]
ds_read_b128 a[216:219], v5 offset:16640
v_cvt_pk_bf16_f32 v133, v86, v87
v_mfma_f32_16x16x32_bf16 v[68:71], a[220:223], v[88:91], v[68:71]
v_exp_f32 v103, v103
v_mfma_f32_16x16x32_bf16 v[60:63], a[220:223], v[80:83], v[60:63]
s_waitcnt lgkmcnt(4)
v_exp_f32 v124, v124
v_mfma_f32_16x16x32_bf16 v[36:39], a[224:227], v[104:107], v[36:39]
ds_read_b128 a[220:223], v5 offset:24832
v_cvt_pk_bf16_f32 v134, v108, v109
v_mfma_f32_16x16x32_bf16 v[44:47], a[224:227], v[112:115], v[44:47]
v_exp_f32 v125, v125
v_mfma_f32_16x16x32_bf16 v[52:55], a[224:227], v[120:123], v[52:55]
s_waitcnt lgkmcnt(4)
v_exp_f32 v126, v126
v_mfma_f32_16x16x32_bf16 v[76:79], a[228:231], v[120:123], v[76:79]
ds_read_b128 a[224:227], v6 offset:16640
v_cvt_pk_bf16_f32 v135, v110, v111
v_mfma_f32_16x16x32_bf16 v[68:71], a[228:231], v[112:115], v[68:71]
v_exp_f32 v127, v127
v_mfma_f32_16x16x32_bf16 v[60:63], a[228:231], v[104:107], v[60:63]
s_waitcnt lgkmcnt(4)
v_cvt_pk_bf16_f32 v140, v92, v93
v_cvt_pk_bf16_f32 v141, v94, v95
v_mfma_f32_16x16x32_bf16 v[36:39], a[208:211], v[128:131], v[36:39]
ds_read_b128 a[228:231], v6 offset:24832
v_cvt_pk_bf16_f32 v142, v116, v117
v_mfma_f32_16x16x32_bf16 v[44:47], a[208:211], v[136:139], v[44:47]
v_cvt_pk_bf16_f32 v143, v118, v119
v_cvt_pk_bf16_f32 v148, v100, v101
v_mfma_f32_16x16x32_bf16 v[52:55], a[208:211], v[144:147], v[52:55]
s_waitcnt lgkmcnt(4)
v_cvt_pk_bf16_f32 v149, v102, v103
v_cvt_pk_bf16_f32 v150, v124, v125
v_mfma_f32_16x16x32_bf16 v[76:79], a[212:215], v[144:147], v[76:79]
ds_read_b128 a[208:211], v7 offset:16640
v_cvt_pk_bf16_f32 v151, v126, v127
v_mfma_f32_16x16x32_bf16 v[68:71], a[212:215], v[136:139], v[68:71]
v_mfma_f32_16x16x32_bf16 v[60:63], a[212:215], v[128:131], v[60:63]
s_waitcnt lgkmcnt(4)
v_mfma_f32_16x16x32_bf16 v[36:39], a[216:219], v[152:155], v[36:39]
ds_read_b128 a[212:215], v7 offset:24832
v_mfma_f32_16x16x32_bf16 v[44:47], a[216:219], v[160:163], v[44:47]
v_mfma_f32_16x16x32_bf16 v[52:55], a[216:219], v[168:171], v[52:55]
s_waitcnt lgkmcnt(4)
v_mfma_f32_16x16x32_bf16 v[76:79], a[220:223], v[168:171], v[76:79]
s_waitcnt vmcnt(24)
s_barrier
ds_read_b64_tr_b16 a[216:217], v8 offset:49152
v_mfma_f32_16x16x32_bf16 v[68:71], a[220:223], v[160:163], v[68:71]
s_add_u32 m0, s48, 81920
ds_read_b64_tr_b16 a[218:219], v8 offset:57344
s_mov_b32 s49, 245760
v_mfma_f32_16x16x32_bf16 v[60:63], a[220:223], v[152:155], v[60:63]
s_waitcnt lgkmcnt(5)
buffer_load_dwordx4 v16, s[28:31], s49 offen nt lds
v_mfma_f32_16x16x32_bf16 v[36:39], a[224:227], v[176:179], v[36:39]
ds_read_b64_tr_b16 a[220:221], v9 offset:49152
v_mfma_f32_16x16x32_bf16 v[44:47], a[224:227], v[184:187], v[44:47]
ds_read_b64_tr_b16 a[222:223], v9 offset:57344
v_mfma_f32_16x16x32_bf16 v[52:55], a[224:227], v[192:195], v[52:55]
s_waitcnt lgkmcnt(6)
buffer_load_dwordx4 v17, s[28:31], s49 offen offset:1024 nt lds
v_mfma_f32_16x16x32_bf16 v[76:79], a[228:231], v[192:195], v[76:79]
ds_read_b64_tr_b16 a[224:225], v10 offset:49152
v_mfma_f32_16x16x32_bf16 v[68:71], a[228:231], v[184:187], v[68:71]
ds_read_b64_tr_b16 a[226:227], v10 offset:57344
v_mfma_f32_16x16x32_bf16 v[60:63], a[228:231], v[176:179], v[60:63]
s_waitcnt lgkmcnt(7)
v_mfma_f32_16x16x32_bf16 v[36:39], a[208:211], v[200:203], v[36:39]
ds_read_b64_tr_b16 a[228:229], v11 offset:49152
v_mfma_f32_16x16x32_bf16 v[44:47], a[208:211], v[208:211], v[44:47]
ds_read_b64_tr_b16 a[230:231], v11 offset:57344
v_mfma_f32_16x16x32_bf16 v[52:55], a[208:211], v[216:219], v[52:55]
s_waitcnt lgkmcnt(8)
buffer_load_dwordx4 v18, s[28:31], s49 offen offset:2048 nt lds
v_mfma_f32_16x16x32_bf16 v[76:79], a[212:215], v[216:219], v[76:79]
ds_read_b64_tr_b16 a[208:209], v12 offset:49152
v_mfma_f32_16x16x32_bf16 v[68:71], a[212:215], v[208:211], v[68:71]
ds_read_b64_tr_b16 a[210:211], v12 offset:57344
v_mfma_f32_16x16x32_bf16 v[60:63], a[212:215], v[200:203], v[60:63]
buffer_load_dwordx4 v19, s[28:31], s49 offen offset:3072 nt lds
v_mfma_f32_16x16x32_bf16 a[192:195], a[204:207], v[132:135], a[192:195]
v_mfma_f32_16x16x32_bf16 a[196:199], a[204:207], v[140:143], a[196:199]
v_mfma_f32_16x16x32_bf16 a[200:203], a[204:207], v[148:151], a[200:203]
s_waitcnt lgkmcnt(8)
v_mfma_f32_16x16x32_bf16 a[0:3], a[216:219], v[132:135], a[0:3]
ds_read_b64_tr_b16 a[212:213], v13 offset:49152
v_max3_f32 v156, v36, v37, v38
v_mfma_f32_16x16x32_bf16 a[4:7], a[216:219], v[140:143], a[4:7]
ds_read_b64_tr_b16 a[214:215], v13 offset:57344
v_max3_f32 v157, v44, v45, v46
v_mfma_f32_16x16x32_bf16 a[8:11], a[216:219], v[148:151], a[8:11]
s_waitcnt lgkmcnt(8)
v_max3_f32 v158, v52, v53, v54
v_max3_f32 v156, v156, v39, v60
v_mfma_f32_16x16x32_bf16 a[20:23], a[220:223], v[148:151], a[20:23]
ds_read_b64_tr_b16 a[216:217], v14 offset:49152
v_max3_f32 v157, v157, v47, v68
v_mfma_f32_16x16x32_bf16 a[16:19], a[220:223], v[140:143], a[16:19]
ds_read_b64_tr_b16 a[218:219], v14 offset:57344
v_max3_f32 v158, v158, v55, v76
v_mfma_f32_16x16x32_bf16 a[12:15], a[220:223], v[132:135], a[12:15]
s_waitcnt lgkmcnt(8)
v_max3_f32 v156, v156, v61, v62
v_max3_f32 v157, v157, v69, v70
v_mfma_f32_16x16x32_bf16 a[24:27], a[224:227], v[132:135], a[24:27]
ds_read_b64_tr_b16 a[220:221], v15 offset:49152
v_max3_f32 v158, v158, v77, v78
v_mfma_f32_16x16x32_bf16 a[28:31], a[224:227], v[140:143], a[28:31]
ds_read_b64_tr_b16 a[222:223], v15 offset:57344
v_max_f32 v156, v156, v63
v_mfma_f32_16x16x32_bf16 a[32:35], a[224:227], v[148:151], a[32:35]
s_waitcnt lgkmcnt(8)
v_max_f32 v157, v157, v71
v_max_f32 v158, v158, v79
v_mfma_f32_16x16x32_bf16 a[44:47], a[228:231], v[148:151], a[44:47]
ds_read_b64_tr_b16 a[224:225], v8 offset:49408
v_fma_f32 v164, v156, s50, v234
v_mfma_f32_16x16x32_bf16 a[40:43], a[228:231], v[140:143], a[40:43]
ds_read_b64_tr_b16 a[226:227], v8 offset:57600
v_fma_f32 v165, v157, s50, v235
v_mfma_f32_16x16x32_bf16 a[36:39], a[228:231], v[132:135], a[36:39]
s_waitcnt lgkmcnt(8)
v_fma_f32 v166, v158, s50, v236
v_max3_f32 v167, v164, v165, v166
v_mfma_f32_16x16x32_bf16 a[48:51], a[208:211], v[132:135], a[48:51]
ds_read_b64_tr_b16 a[228:229], v9 offset:49408
v_cmp_lt_f32 vcc, s51, v167
v_mfma_f32_16x16x32_bf16 a[52:55], a[208:211], v[140:143], a[52:55]
s_cbranch_vccnz L_ra11
L_skipa11:
ds_read_b64_tr_b16 a[230:231], v9 offset:57600
v_fma_f32 v36, v36, s50, v234
v_mfma_f32_16x16x32_bf16 a[56:59], a[208:211], v[148:151], a[56:59]
s_waitcnt lgkmcnt(8)
v_fma_f32 v37, v37, s50, v234
v_fma_f32 v38, v38, s50, v234
v_mfma_f32_16x16x32_bf16 a[68:71], a[212:215], v[148:151], a[68:71]
ds_read_b64_tr_b16 a[208:209], v10 offset:49408
v_fma_f32 v39, v39, s50, v234
v_mfma_f32_16x16x32_bf16 a[64:67], a[212:215], v[140:143], a[64:67]
ds_read_b64_tr_b16 a[210:211], v10 offset:57600
v_fma_f32 v60, v60, s50, v234
v_mfma_f32_16x16x32_bf16 a[60:63], a[212:215], v[132:135], a[60:63]
s_waitcnt lgkmcnt(8)
v_exp_f32 v36, v36
v_mfma_f32_16x16x32_bf16 a[72:75], a[216:219], v[132:135], a[72:75]
ds_read_b64_tr_b16 a[212:213], v11 offset:49408
v_fma_f32 v61, v61, s50, v234
v_mfma_f32_16x16x32_bf16 a[76:79], a[216:219], v[140:143], a[76:79]
ds_read_b64_tr_b16 a[214:215], v11 offset:57600
v_fma_f32 v62, v62, s50, v234
v_mfma_f32_16x16x32_bf16 a[80:83], a[216:219], v[148:151], a[80:83]
s_waitcnt lgkmcnt(8)
v_exp_f32 v37, v37
v_mfma_f32_16x16x32_bf16 a[92:95], a[220:223], v[148:151], a[92:95]
ds_read_b64_tr_b16 a[216:217], v12 offset:49408
v_fma_f32 v63, v63, s50, v234
v_mfma_f32_16x16x32_bf16 a[88:91], a[220:223], v[140:143], a[88:91]
ds_read_b64_tr_b16 a[218:219], v12 offset:57600
v_fma_f32 v44, v44, s50, v235
v_mfma_f32_16x16x32_bf16 a[84:87], a[220:223], v[132:135], a[84:87]
s_waitcnt lgkmcnt(8)
v_exp_f32 v38, v38
v_mfma_f32_16x16x32_bf16 a[96:99], a[224:227], v[132:135], a[96:99]
ds_read_b64_tr_b16 a[220:221], v13 offset:49408
v_fma_f32 v45, v45, s50, v235
v_mfma_f32_16x16x32_bf16 a[100:103], a[224:227], v[140:143], a[100:103]
ds_read_b64_tr_b16 a[222:223], v13 offset:57600
v_fma_f32 v46, v46, s50, v235
v_mfma_f32_16x16x32_bf16 a[104:107], a[224:227], v[148:151], a[104:107]
s_waitcnt lgkmcnt(8)
v_exp_f32 v39, v39
v_mfma_f32_16x16x32_bf16 a[116:119], a[228:231], v[148:151], a[116:119]
ds_read_b64_tr_b16 a[224:225], v14 offset:49408
v_fma_f32 v47, v47, s50, v235
v_mfma_f32_16x16x32_bf16 a[112:115], a[228:231], v[140:143], a[112:115]
ds_read_b64_tr_b16 a[226:227], v14 offset:57600
v_fma_f32 v68, v68, s50, v235
v_mfma_f32_16x16x32_bf16 a[108:111], a[228:231], v[132:135], a[108:111]
s_waitcnt lgkmcnt(8)
v_exp_f32 v60, v60
v_mfma_f32_16x16x32_bf16 a[120:123], a[208:211], v[132:135], a[120:123]
ds_read_b64_tr_b16 a[228:229], v15 offset:49408
v_fma_f32 v69, v69, s50, v235
v_mfma_f32_16x16x32_bf16 a[124:127], a[208:211], v[140:143], a[124:127]
ds_read_b64_tr_b16 a[230:231], v15 offset:57600
v_fma_f32 v70, v70, s50, v235
v_mfma_f32_16x16x32_bf16 a[128:131], a[208:211], v[148:151], a[128:131]
s_waitcnt lgkmcnt(8)
v_exp_f32 v61, v61
v_mfma_f32_16x16x32_bf16 a[140:143], a[212:215], v[148:151], a[140:143]
s_waitcnt vmcnt(24)
s_barrier
v_add_u32 v4, 4294950912, v4
v_mfma_f32_16x16x32_bf16 a[136:139], a[212:215], v[140:143], a[136:139]
ds_read_b128 a[208:211], v4 offset:0
v_fma_f32 v71, v71, s50, v235
v_mfma_f32_16x16x32_bf16 a[132:135], a[212:215], v[132:135], a[132:135]
s_waitcnt lgkmcnt(7)
v_exp_f32 v62, v62
v_mfma_f32_16x16x32_bf16 a[144:147], a[216:219], v[132:135], a[144:147]
ds_read_b128 a[212:215], v4 offset:8192
v_fma_f32 v52, v52, s50, v236
v_mfma_f32_16x16x32_bf16 a[148:151], a[216:219], v[140:143], a[148:151]
v_exp_f32 v63, v63
v_mfma_f32_16x16x32_bf16 a[152:155], a[216:219], v[148:151], a[152:155]
s_waitcnt lgkmcnt(6)
v_exp_f32 v44, v44
v_mfma_f32_16x16x32_bf16 a[164:167], a[220:223], v[148:151], a[164:167]
v_add_u32 v5, 4294950912, v5
v_fma_f32 v53, v53, s50, v236
v_mfma_f32_16x16x32_bf16 a[160:163], a[220:223], v[140:143], a[160:163]
ds_read_b128 a[216:219], v5 offset:0
v_fma_f32 v54, v54, s50, v236
v_mfma_f32_16x16x32_bf16 a[156:159], a[220:223], v[132:135], a[156:159]
s_waitcnt lgkmcnt(5)
v_exp_f32 v45, v45
v_mfma_f32_16x16x32_bf16 a[168:171], a[224:227], v[132:135], a[168:171]
ds_read_b128 a[220:223], v5 offset:8192
v_fma_f32 v55, v55, s50, v236
v_mfma_f32_16x16x32_bf16 a[172:175], a[224:227], v[140:143], a[172:175]
v_exp_f32 v46, v46
v_mfma_f32_16x16x32_bf16 a[176:179], a[224:227], v[148:151], a[176:179]
s_waitcnt lgkmcnt(4)
v_exp_f32 v47, v47
v_mfma_f32_16x16x32_bf16 a[188:191], a[228:231], v[148:151], a[188:191]
v_add_u32 v6, 4294950912, v6
v_fma_f32 v76, v76, s50, v236
v_mfma_f32_16x16x32_bf16 a[184:187], a[228:231], v[140:143], a[184:187]
ds_read_b128 a[224:227], v6 offset:0
v_fma_f32 v77, v77, s50, v236
v_mfma_f32_16x16x32_bf16 a[180:183], a[228:231], v[132:135], a[180:183]
s_cbranch_vccnz L_rb11
L_skipb11:
s_waitcnt lgkmcnt(4)
v_fma_f32 v78, v78, s50, v236
v_mfma_f32_16x16x32_bf16 v[84:87], a[208:211], v[32:35], 0
ds_read_b128 a[228:231], v6 offset:8192
v_fma_f32 v79, v79, s50, v236
v_mfma_f32_16x16x32_bf16 v[92:95], a[208:211], v[40:43], 0
v_exp_f32 v68, v68
v_mfma_f32_16x16x32_bf16 v[100:103], a[208:211], v[48:51], 0
s_waitcnt lgkmcnt(4)
v_exp_f32 v69, v69
v_mfma_f32_16x16x32_bf16 v[124:127], a[212:215], v[48:51], 0
v_add_u32 v7, 4294950912, v7
v_cvt_pk_bf16_f32 v132, v36, v37
v_mfma_f32_16x16x32_bf16 v[116:119], a[212:215], v[40:43], 0
ds_read_b128 a[208:211], v7 offset:0
v_cvt_pk_bf16_f32 v133, v38, v39
v_mfma_f32_16x16x32_bf16 v[108:111], a[212:215], v[32:35], 0
s_waitcnt lgkmcnt(4)
v_exp_f32 v70, v70
v_mfma_f32_16x16x32_bf16 v[84:87], a[216:219], v[56:59], v[84:87]
ds_read_b128 a[212:215], v7 offset:8192
v_cvt_pk_bf16_f32 v134, v60, v61
v_mfma_f32_16x16x32_bf16 v[92:95], a[216:219], v[64:67], v[92:95]
v_exp_f32 v71, v71
v_mfma_f32_16x16x32_bf16 v[100:103], a[216:219], v[72:75], v[100:103]
s_waitcnt lgkmcnt(4)
v_exp_f32 v52, v52
v_mfma_f32_16x16x32_bf16 v[124:127], a[220:223], v[72:75], v[124:127]
ds_read_b128 a[216:219], v4 offset:256
v_cvt_pk_bf16_f32 v135, v62, v63
v_mfma_f32_16x16x32_bf16 v[116:119], a[220:223], v[64:67], v[116:119]
v_exp_f32 v53, v53
v_mfma_f32_16x16x32_bf16 v[108:111], a[220:223], v[56:59], v[108:111]
s_waitcnt lgkmcnt(4)
v_exp_f32 v54, v54
v_mfma_f32_16x16x32_bf16 v[84:87], a[224:227], v[80:83], v[84:87]
ds_read_b128 a[220:223], v4 offset:8448
v_cvt_pk_bf16_f32 v140, v44, v45
v_mfma_f32_16x16x32_bf16 v[92:95], a[224:227], v[88:91], v[92:95]
v_exp_f32 v55, v55
v_mfma_f32_16x16x32_bf16 v[100:103], a[224:227], v[96:99], v[100:103]
s_waitcnt lgkmcnt(4)
v_exp_f32 v76, v76
v_mfma_f32_16x16x32_bf16 v[124:127], a[228:231], v[96:99], v[124:127]
ds_read_b128 a[224:227], v5 offset:256
v_cvt_pk_bf16_f32 v141, v46, v47
v_mfma_f32_16x16x32_bf16 v[116:119], a[228:231], v[88:91], v[116:119]
v_exp_f32 v77, v77
v_mfma_f32_16x16x32_bf16 v[108:111], a[228:231], v[80:83], v[108:111]
s_waitcnt lgkmcnt(4)
v_exp_f32 v78, v78
v_mfma_f32_16x16x32_bf16 v[84:87], a[208:211], v[104:107], v[84:87]
ds_read_b128 a[228:231], v5 offset:8448
v_cvt_pk_bf16_f32 v142, v68, v69
v_mfma_f32_16x16x32_bf16 v[92:95], a[208:211], v[112:115], v[92:95]
v_exp_f32 v79, v79
v_mfma_f32_16x16x32_bf16 v[100:103], a[208:211], v[120:123], v[100:103]
s_waitcnt lgkmcnt(4)
v_cvt_pk_bf16_f32 v143, v70, v71
v_cvt_pk_bf16_f32 v148, v52, v53
v_mfma_f32_16x16x32_bf16 v[124:127], a[212:215], v[120:123], v[124:127]
ds_read_b128 a[208:211], v6 offset:256
v_cvt_pk_bf16_f32 v149, v54, v55
v_mfma_f32_16x16x32_bf16 v[116:119], a[212:215], v[112:115], v[116:119]
v_cvt_pk_bf16_f32 v150, v76, v77
v_cvt_pk_bf16_f32 v151, v78, v79
v_mfma_f32_16x16x32_bf16 v[108:111], a[212:215], v[104:107], v[108:111]
s_waitcnt lgkmcnt(4)
v_mfma_f32_16x16x32_bf16 v[84:87], a[216:219], v[128:131], v[84:87]
ds_read_b128 a[212:215], v6 offset:8448
v_mfma_f32_16x16x32_bf16 v[92:95], a[216:219], v[136:139], v[92:95]
v_mfma_f32_16x16x32_bf16 v[100:103], a[216:219], v[144:147], v[100:103]
s_waitcnt lgkmcnt(4)
v_mfma_f32_16x16x32_bf16 v[124:127], a[220:223], v[144:147], v[124:127]
ds_read_b128 a[216:219], v7 offset:256
v_mfma_f32_16x16x32_bf16 v[116:119], a[220:223], v[136:139], v[116:119]
v_mfma_f32_16x16x32_bf16 v[108:111], a[220:223], v[128:131], v[108:111]
s_waitcnt lgkmcnt(4)
v_mfma_f32_16x16x32_bf16 v[84:87], a[224:227], v[152:155], v[84:87]
ds_read_b128 a[220:223], v7 offset:8448
v_mfma_f32_16x16x32_bf16 v[92:95], a[224:227], v[160:163], v[92:95]
v_mfma_f32_16x16x32_bf16 v[100:103], a[224:227], v[168:171], v[100:103]
s_waitcnt lgkmcnt(4)
v_mfma_f32_16x16x32_bf16 v[124:127], a[228:231], v[168:171], v[124:127]
s_waitcnt vmcnt(20)
s_barrier
ds_read_b64_tr_b16 a[224:225], v8 offset:16384
v_mfma_f32_16x16x32_bf16 v[116:119], a[228:231], v[160:163], v[116:119]
ds_read_b64_tr_b16 a[226:227], v8 offset:24576
v_mfma_f32_16x16x32_bf16 v[108:111], a[228:231], v[152:155], v[108:111]
s_waitcnt lgkmcnt(5)
v_mfma_f32_16x16x32_bf16 v[84:87], a[208:211], v[176:179], v[84:87]
ds_read_b64_tr_b16 a[228:229], v9 offset:16384
v_mfma_f32_16x16x32_bf16 v[92:95], a[208:211], v[184:187], v[92:95]
ds_read_b64_tr_b16 a[230:231], v9 offset:24576
v_mfma_f32_16x16x32_bf16 v[100:103], a[208:211], v[192:195], v[100:103]
s_waitcnt lgkmcnt(6)
v_mfma_f32_16x16x32_bf16 v[124:127], a[212:215], v[192:195], v[124:127]
ds_read_b64_tr_b16 a[208:209], v10 offset:16384
v_mfma_f32_16x16x32_bf16 v[116:119], a[212:215], v[184:187], v[116:119]
ds_read_b64_tr_b16 a[210:211], v10 offset:24576
v_mfma_f32_16x16x32_bf16 v[108:111], a[212:215], v[176:179], v[108:111]
s_waitcnt lgkmcnt(7)
v_mfma_f32_16x16x32_bf16 v[84:87], a[216:219], v[200:203], v[84:87]
ds_read_b64_tr_b16 a[212:213], v11 offset:16384
v_mfma_f32_16x16x32_bf16 v[92:95], a[216:219], v[208:211], v[92:95]
ds_read_b64_tr_b16 a[214:215], v11 offset:24576
v_mfma_f32_16x16x32_bf16 v[100:103], a[216:219], v[216:219], v[100:103]
s_waitcnt lgkmcnt(8)
v_mfma_f32_16x16x32_bf16 v[124:127], a[220:223], v[216:219], v[124:127]
ds_read_b64_tr_b16 a[216:217], v12 offset:16384
v_mfma_f32_16x16x32_bf16 v[116:119], a[220:223], v[208:211], v[116:119]
ds_read_b64_tr_b16 a[218:219], v12 offset:24576
v_mfma_f32_16x16x32_bf16 v[108:111], a[220:223], v[200:203], v[108:111]
v_mfma_f32_16x16x32_bf16 a[192:195], a[204:207], v[132:135], a[192:195]
v_mfma_f32_16x16x32_bf16 a[196:199], a[204:207], v[140:143], a[196:199]
v_mfma_f32_16x16x32_bf16 a[200:203], a[204:207], v[148:151], a[200:203]
s_waitcnt lgkmcnt(8)
v_mfma_f32_16x16x32_bf16 a[0:3], a[224:227], v[132:135], a[0:3]
ds_read_b64_tr_b16 a[220:221], v13 offset:16384
v_max3_f32 v156, v84, v85, v86
v_mfma_f32_16x16x32_bf16 a[4:7], a[224:227], v[140:143], a[4:7]
ds_read_b64_tr_b16 a[222:223], v13 offset:24576
v_max3_f32 v157, v92, v93, v94
v_mfma_f32_16x16x32_bf16 a[8:11], a[224:227], v[148:151], a[8:11]
s_waitcnt lgkmcnt(8)
v_max3_f32 v158, v100, v101, v102
v_max3_f32 v156, v156, v87, v108
v_mfma_f32_16x16x32_bf16 a[20:23], a[228:231], v[148:151], a[20:23]
ds_read_b64_tr_b16 a[224:225], v14 offset:16384
v_max3_f32 v157, v157, v95, v116
v_mfma_f32_16x16x32_bf16 a[16:19], a[228:231], v[140:143], a[16:19]
ds_read_b64_tr_b16 a[226:227], v14 offset:24576
v_max3_f32 v158, v158, v103, v124
v_mfma_f32_16x16x32_bf16 a[12:15], a[228:231], v[132:135], a[12:15]
s_waitcnt lgkmcnt(8)
v_max3_f32 v156, v156, v109, v110
v_max3_f32 v157, v157, v117, v118
v_mfma_f32_16x16x32_bf16 a[24:27], a[208:211], v[132:135], a[24:27]
ds_read_b64_tr_b16 a[228:229], v15 offset:16384
v_max3_f32 v158, v158, v125, v126
v_mfma_f32_16x16x32_bf16 a[28:31], a[208:211], v[140:143], a[28:31]
ds_read_b64_tr_b16 a[230:231], v15 offset:24576
v_max_f32 v156, v156, v111
v_mfma_f32_16x16x32_bf16 a[32:35], a[208:211], v[148:151], a[32:35]
s_waitcnt lgkmcnt(8)
v_max_f32 v157, v157, v119
v_max_f32 v158, v158, v127
v_mfma_f32_16x16x32_bf16 a[44:47], a[212:215], v[148:151], a[44:47]
ds_read_b64_tr_b16 a[208:209], v8 offset:16640
v_fma_f32 v164, v156, s50, v234
v_mfma_f32_16x16x32_bf16 a[40:43], a[212:215], v[140:143], a[40:43]
ds_read_b64_tr_b16 a[210:211], v8 offset:24832
v_fma_f32 v165, v157, s50, v235
v_mfma_f32_16x16x32_bf16 a[36:39], a[212:215], v[132:135], a[36:39]
s_waitcnt lgkmcnt(8)
v_fma_f32 v166, v158, s50, v236
v_max3_f32 v167, v164, v165, v166
v_mfma_f32_16x16x32_bf16 a[48:51], a[216:219], v[132:135], a[48:51]
ds_read_b64_tr_b16 a[212:213], v9 offset:16640
v_cmp_lt_f32 vcc, s51, v167
v_mfma_f32_16x16x32_bf16 a[52:55], a[216:219], v[140:143], a[52:55]
s_cbranch_vccnz L_ra12
L_skipa12:
ds_read_b64_tr_b16 a[214:215], v9 offset:24832
v_fma_f32 v84, v84, s50, v234
v_mfma_f32_16x16x32_bf16 a[56:59], a[216:219], v[148:151], a[56:59]
s_waitcnt lgkmcnt(8)
v_fma_f32 v85, v85, s50, v234
v_fma_f32 v86, v86, s50, v234
v_mfma_f32_16x16x32_bf16 a[68:71], a[220:223], v[148:151], a[68:71]
ds_read_b64_tr_b16 a[216:217], v10 offset:16640
v_fma_f32 v87, v87, s50, v234
v_mfma_f32_16x16x32_bf16 a[64:67], a[220:223], v[140:143], a[64:67]
ds_read_b64_tr_b16 a[218:219], v10 offset:24832
v_fma_f32 v108, v108, s50, v234
v_mfma_f32_16x16x32_bf16 a[60:63], a[220:223], v[132:135], a[60:63]
s_waitcnt lgkmcnt(8)
v_exp_f32 v84, v84
v_mfma_f32_16x16x32_bf16 a[72:75], a[224:227], v[132:135], a[72:75]
ds_read_b64_tr_b16 a[220:221], v11 offset:16640
v_fma_f32 v109, v109, s50, v234
v_mfma_f32_16x16x32_bf16 a[76:79], a[224:227], v[140:143], a[76:79]
ds_read_b64_tr_b16 a[222:223], v11 offset:24832
v_fma_f32 v110, v110, s50, v234
v_mfma_f32_16x16x32_bf16 a[80:83], a[224:227], v[148:151], a[80:83]
s_waitcnt lgkmcnt(8)
v_exp_f32 v85, v85
v_mfma_f32_16x16x32_bf16 a[92:95], a[228:231], v[148:151], a[92:95]
ds_read_b64_tr_b16 a[224:225], v12 offset:16640
v_fma_f32 v111, v111, s50, v234
v_mfma_f32_16x16x32_bf16 a[88:91], a[228:231], v[140:143], a[88:91]
ds_read_b64_tr_b16 a[226:227], v12 offset:24832
v_fma_f32 v92, v92, s50, v235
v_mfma_f32_16x16x32_bf16 a[84:87], a[228:231], v[132:135], a[84:87]
s_waitcnt lgkmcnt(8)
v_exp_f32 v86, v86
v_mfma_f32_16x16x32_bf16 a[96:99], a[208:211], v[132:135], a[96:99]
ds_read_b64_tr_b16 a[228:229], v13 offset:16640
v_fma_f32 v93, v93, s50, v235
v_mfma_f32_16x16x32_bf16 a[100:103], a[208:211], v[140:143], a[100:103]
ds_read_b64_tr_b16 a[230:231], v13 offset:24832
v_fma_f32 v94, v94, s50, v235
v_mfma_f32_16x16x32_bf16 a[104:107], a[208:211], v[148:151], a[104:107]
s_waitcnt lgkmcnt(8)
v_exp_f32 v87, v87
v_mfma_f32_16x16x32_bf16 a[116:119], a[212:215], v[148:151], a[116:119]
ds_read_b64_tr_b16 a[208:209], v14 offset:16640
v_fma_f32 v95, v95, s50, v235
v_mfma_f32_16x16x32_bf16 a[112:115], a[212:215], v[140:143], a[112:115]
ds_read_b64_tr_b16 a[210:211], v14 offset:24832
v_fma_f32 v116, v116, s50, v235
v_mfma_f32_16x16x32_bf16 a[108:111], a[212:215], v[132:135], a[108:111]
s_waitcnt lgkmcnt(8)
v_exp_f32 v108, v108
v_mfma_f32_16x16x32_bf16 a[120:123], a[216:219], v[132:135], a[120:123]
ds_read_b64_tr_b16 a[212:213], v15 offset:16640
v_fma_f32 v117, v117, s50, v235
v_mfma_f32_16x16x32_bf16 a[124:127], a[216:219], v[140:143], a[124:127]
ds_read_b64_tr_b16 a[214:215], v15 offset:24832
v_fma_f32 v118, v118, s50, v235
v_mfma_f32_16x16x32_bf16 a[128:131], a[216:219], v[148:151], a[128:131]
s_waitcnt lgkmcnt(8)
v_exp_f32 v109, v109
v_mfma_f32_16x16x32_bf16 a[140:143], a[220:223], v[148:151], a[140:143]
s_waitcnt vmcnt(16)
s_barrier
v_add_u32 v4, 98304, v4
v_mfma_f32_16x16x32_bf16 a[136:139], a[220:223], v[140:143], a[136:139]
s_add_u32 m0, s48, 32768
ds_read_b128 a[216:219], v4 offset:16384
s_add_u32 s49, s64, s0
v_mfma_f32_16x16x32_bf16 a[132:135], a[220:223], v[132:135], a[132:135]
s_waitcnt lgkmcnt(7)
buffer_load_dwordx4 v248, s[36:39], s49 offen lds
v_mfma_f32_16x16x32_bf16 a[144:147], a[224:227], v[132:135], a[144:147]
ds_read_b128 a[220:223], v4 offset:24576
v_fma_f32 v119, v119, s50, v235
v_mfma_f32_16x16x32_bf16 a[148:151], a[224:227], v[140:143], a[148:151]
v_exp_f32 v110, v110
v_mfma_f32_16x16x32_bf16 a[152:155], a[224:227], v[148:151], a[152:155]
s_waitcnt lgkmcnt(6)
buffer_load_dwordx4 v249, s[36:39], s49 offen offset:1024 lds
v_mfma_f32_16x16x32_bf16 a[164:167], a[228:231], v[148:151], a[164:167]
v_add_u32 v5, 98304, v5
v_fma_f32 v100, v100, s50, v236
v_mfma_f32_16x16x32_bf16 a[160:163], a[228:231], v[140:143], a[160:163]
ds_read_b128 a[224:227], v5 offset:16384
v_fma_f32 v101, v101, s50, v236
v_mfma_f32_16x16x32_bf16 a[156:159], a[228:231], v[132:135], a[156:159]
s_waitcnt lgkmcnt(5)
v_exp_f32 v111, v111
v_mfma_f32_16x16x32_bf16 a[168:171], a[208:211], v[132:135], a[168:171]
ds_read_b128 a[228:231], v5 offset:24576
v_fma_f32 v102, v102, s50, v236
v_mfma_f32_16x16x32_bf16 a[172:175], a[208:211], v[140:143], a[172:175]
v_exp_f32 v92, v92
v_mfma_f32_16x16x32_bf16 a[176:179], a[208:211], v[148:151], a[176:179]
s_waitcnt lgkmcnt(4)
buffer_load_dwordx4 v250, s[36:39], s49 offen offset:2048 lds
v_mfma_f32_16x16x32_bf16 a[188:191], a[212:215], v[148:151], a[188:191]
v_add_u32 v6, 98304, v6
v_fma_f32 v103, v103, s50, v236
v_mfma_f32_16x16x32_bf16 a[184:187], a[212:215], v[140:143], a[184:187]
ds_read_b128 a[208:211], v6 offset:16384
v_fma_f32 v124, v124, s50, v236
v_mfma_f32_16x16x32_bf16 a[180:183], a[212:215], v[132:135], a[180:183]
s_cbranch_vccnz L_rb12
L_skipb12:
s_waitcnt lgkmcnt(4)
v_fma_f32 v125, v125, s50, v236
v_mfma_f32_16x16x32_bf16 v[36:39], a[216:219], v[32:35], 0
ds_read_b128 a[212:215], v6 offset:24576
v_fma_f32 v126, v126, s50, v236
v_mfma_f32_16x16x32_bf16 v[44:47], a[216:219], v[40:43], 0
buffer_load_dwordx4 v251, s[36:39], s49 offen offset:3072 lds
v_mfma_f32_16x16x32_bf16 v[52:55], a[216:219], v[48:51], 0
s_waitcnt lgkmcnt(4)
s_add_u32 m0, s48, 0
s_add_u32 s49, s64, s0
v_mfma_f32_16x16x32_bf16 v[76:79], a[220:223], v[48:51], 0
s_add_u32 s49, s49, 114688
v_add_u32 v7, 98304, v7
v_fma_f32 v127, v127, s50, v236
v_mfma_f32_16x16x32_bf16 v[68:71], a[220:223], v[40:43], 0
ds_read_b128 a[216:219], v7 offset:16384
v_cvt_pk_bf16_f32 v132, v84, v85
v_mfma_f32_16x16x32_bf16 v[60:63], a[220:223], v[32:35], 0
s_waitcnt lgkmcnt(4)
buffer_load_dwordx4 v248, s[36:39], s49 offen lds
v_mfma_f32_16x16x32_bf16 v[36:39], a[224:227], v[56:59], v[36:39]
ds_read_b128 a[220:223], v7 offset:24576
v_cvt_pk_bf16_f32 v133, v86, v87
v_mfma_f32_16x16x32_bf16 v[44:47], a[224:227], v[64:67], v[44:47]
v_exp_f32 v93, v93
v_mfma_f32_16x16x32_bf16 v[52:55], a[224:227], v[72:75], v[52:55]
s_waitcnt lgkmcnt(4)
v_exp_f32 v94, v94
v_mfma_f32_16x16x32_bf16 v[76:79], a[228:231], v[72:75], v[76:79]
ds_read_b128 a[224:227], v4 offset:16640
v_cvt_pk_bf16_f32 v134, v108, v109
v_mfma_f32_16x16x32_bf16 v[68:71], a[228:231], v[64:67], v[68:71]
buffer_load_dwordx4 v249, s[36:39], s49 offen offset:1024 lds
v_mfma_f32_16x16x32_bf16 v[60:63], a[228:231], v[56:59], v[60:63]
s_waitcnt lgkmcnt(4)
v_exp_f32 v95, v95
v_mfma_f32_16x16x32_bf16 v[36:39], a[208:211], v[80:83], v[36:39]
ds_read_b128 a[228:231], v4 offset:24832
v_cvt_pk_bf16_f32 v135, v110, v111
v_mfma_f32_16x16x32_bf16 v[44:47], a[208:211], v[88:91], v[44:47]
v_exp_f32 v116, v116
v_mfma_f32_16x16x32_bf16 v[52:55], a[208:211], v[96:99], v[52:55]
s_waitcnt lgkmcnt(4)
buffer_load_dwordx4 v250, s[36:39], s49 offen offset:2048 lds
v_mfma_f32_16x16x32_bf16 v[76:79], a[212:215], v[96:99], v[76:79]
ds_read_b128 a[208:211], v5 offset:16640
v_cvt_pk_bf16_f32 v140, v92, v93
v_mfma_f32_16x16x32_bf16 v[68:71], a[212:215], v[88:91], v[68:71]
v_exp_f32 v117, v117
v_mfma_f32_16x16x32_bf16 v[60:63], a[212:215], v[80:83], v[60:63]
s_waitcnt lgkmcnt(4)
v_exp_f32 v118, v118
v_mfma_f32_16x16x32_bf16 v[36:39], a[216:219], v[104:107], v[36:39]
ds_read_b128 a[212:215], v5 offset:24832
v_cvt_pk_bf16_f32 v141, v94, v95
v_mfma_f32_16x16x32_bf16 v[44:47], a[216:219], v[112:115], v[44:47]
buffer_load_dwordx4 v251, s[36:39], s49 offen offset:3072 lds
v_mfma_f32_16x16x32_bf16 v[52:55], a[216:219], v[120:123], v[52:55]
s_waitcnt lgkmcnt(4)
v_exp_f32 v119, v119
v_mfma_f32_16x16x32_bf16 v[76:79], a[220:223], v[120:123], v[76:79]
ds_read_b128 a[216:219], v6 offset:16640
v_cvt_pk_bf16_f32 v142, v116, v117
v_mfma_f32_16x16x32_bf16 v[68:71], a[220:223], v[112:115], v[68:71]
v_exp_f32 v100, v100
v_mfma_f32_16x16x32_bf16 v[60:63], a[220:223], v[104:107], v[60:63]
s_waitcnt lgkmcnt(4)
v_exp_f32 v101, v101
v_mfma_f32_16x16x32_bf16 v[36:39], a[224:227], v[128:131], v[36:39]
ds_read_b128 a[220:223], v6 offset:24832
v_cvt_pk_bf16_f32 v143, v118, v119
v_mfma_f32_16x16x32_bf16 v[44:47], a[224:227], v[136:139], v[44:47]
v_exp_f32 v102, v102
v_mfma_f32_16x16x32_bf16 v[52:55], a[224:227], v[144:147], v[52:55]
s_waitcnt lgkmcnt(4)
v_exp_f32 v103, v103
v_mfma_f32_16x16x32_bf16 v[76:79], a[228:231], v[144:147], v[76:79]
ds_read_b128 a[224:227], v7 offset:16640
v_cvt_pk_bf16_f32 v148, v100, v101
v_mfma_f32_16x16x32_bf16 v[68:71], a[228:231], v[136:139], v[68:71]
v_exp_f32 v124, v124
v_mfma_f32_16x16x32_bf16 v[60:63], a[228:231], v[128:131], v[60:63]
s_waitcnt lgkmcnt(4)
v_exp_f32 v125, v125
v_mfma_f32_16x16x32_bf16 v[36:39], a[208:211], v[152:155], v[36:39]
ds_read_b128 a[228:231], v7 offset:24832
v_cvt_pk_bf16_f32 v149, v102, v103
v_mfma_f32_16x16x32_bf16 v[44:47], a[208:211], v[160:163], v[44:47]
v_exp_f32 v126, v126
v_mfma_f32_16x16x32_bf16 v[52:55], a[208:211], v[168:171], v[52:55]
s_waitcnt lgkmcnt(4)
v_exp_f32 v127, v127
v_mfma_f32_16x16x32_bf16 v[76:79], a[212:215], v[168:171], v[76:79]
s_waitcnt vmcnt(20)
s_barrier
v_add_u32 v8, 4294934528, v8
v_mfma_f32_16x16x32_bf16 v[68:71], a[212:215], v[160:163], v[68:71]
s_add_u32 m0, s48, 98304
ds_read_b64_tr_b16 a[208:209], v8 offset:0
s_add_u32 s49, s65, s0
v_mfma_f32_16x16x32_bf16 v[60:63], a[212:215], v[152:155], v[60:63]
s_waitcnt lgkmcnt(4)
ds_read_b64_tr_b16 a[210:211], v8 offset:8192
v_cvt_pk_bf16_f32 v150, v124, v125
v_mfma_f32_16x16x32_bf16 v[36:39], a[216:219], v[176:179], v[36:39]
buffer_load_dwordx4 v248, s[36:39], s49 offen lds
v_mfma_f32_16x16x32_bf16 v[44:47], a[216:219], v[184:187], v[44:47]
v_add_u32 v9, 4294934528, v9
v_cvt_pk_bf16_f32 v151, v126, v127
v_mfma_f32_16x16x32_bf16 v[52:55], a[216:219], v[192:195], v[52:55]
s_waitcnt lgkmcnt(4)
ds_read_b64_tr_b16 a[212:213], v9 offset:0
v_mfma_f32_16x16x32_bf16 v[76:79], a[220:223], v[192:195], v[76:79]
ds_read_b64_tr_b16 a[214:215], v9 offset:8192
v_add_u32 v10, 4294934528, v10
v_mfma_f32_16x16x32_bf16 v[68:71], a[220:223], v[184:187], v[68:71]
ds_read_b64_tr_b16 a[216:217], v10 offset:0
v_mfma_f32_16x16x32_bf16 v[60:63], a[220:223], v[176:179], v[60:63]
s_waitcnt lgkmcnt(6)
ds_read_b64_tr_b16 a[218:219], v10 offset:8192
v_mfma_f32_16x16x32_bf16 v[36:39], a[224:227], v[200:203], v[36:39]
buffer_load_dwordx4 v249, s[36:39], s49 offen offset:1024 lds
v_mfma_f32_16x16x32_bf16 v[44:47], a[224:227], v[208:211], v[44:47]
v_add_u32 v11, 4294934528, v11
v_mfma_f32_16x16x32_bf16 v[52:55], a[224:227], v[216:219], v[52:55]
s_waitcnt lgkmcnt(6)
ds_read_b64_tr_b16 a[220:221], v11 offset:0
v_mfma_f32_16x16x32_bf16 v[76:79], a[228:231], v[216:219], v[76:79]
ds_read_b64_tr_b16 a[222:223], v11 offset:8192
v_add_u32 v12, 4294934528, v12
v_mfma_f32_16x16x32_bf16 v[68:71], a[228:231], v[208:211], v[68:71]
ds_read_b64_tr_b16 a[224:225], v12 offset:0
v_mfma_f32_16x16x32_bf16 v[60:63], a[228:231], v[200:203], v[60:63]
ds_read_b64_tr_b16 a[226:227], v12 offset:8192
v_mfma_f32_16x16x32_bf16 a[192:195], a[204:207], v[132:135], a[192:195]
buffer_load_dwordx4 v250, s[36:39], s49 offen offset:2048 lds
v_mfma_f32_16x16x32_bf16 a[196:199], a[204:207], v[140:143], a[196:199]
v_mfma_f32_16x16x32_bf16 a[200:203], a[204:207], v[148:151], a[200:203]
s_waitcnt lgkmcnt(8)
v_mfma_f32_16x16x32_bf16 a[0:3], a[208:211], v[132:135], a[0:3]
buffer_load_dwordx4 v251, s[36:39], s49 offen offset:3072 lds
v_mfma_f32_16x16x32_bf16 a[4:7], a[208:211], v[140:143], a[4:7]
v_add_u32 v13, 4294934528, v13
v_max3_f32 v156, v36, v37, v38
v_mfma_f32_16x16x32_bf16 a[8:11], a[208:211], v[148:151], a[8:11]
s_waitcnt lgkmcnt(6)
ds_read_b64_tr_b16 a[228:229], v13 offset:0
v_max3_f32 v157, v44, v45, v46
v_mfma_f32_16x16x32_bf16 a[20:23], a[212:215], v[148:151], a[20:23]
ds_read_b64_tr_b16 a[230:231], v13 offset:8192
v_add_u32 v14, 4294934528, v14
v_mfma_f32_16x16x32_bf16 a[16:19], a[212:215], v[140:143], a[16:19]
ds_read_b64_tr_b16 a[208:209], v14 offset:0
v_max3_f32 v158, v52, v53, v54
v_mfma_f32_16x16x32_bf16 a[12:15], a[212:215], v[132:135], a[12:15]
s_waitcnt lgkmcnt(7)
ds_read_b64_tr_b16 a[210:211], v14 offset:8192
v_max3_f32 v156, v156, v39, v60
v_mfma_f32_16x16x32_bf16 a[24:27], a[216:219], v[132:135], a[24:27]
v_add_u32 v15, 4294934528, v15
v_max3_f32 v157, v157, v47, v68
v_mfma_f32_16x16x32_bf16 a[28:31], a[216:219], v[140:143], a[28:31]
ds_read_b64_tr_b16 a[212:213], v15 offset:0
v_max3_f32 v158, v158, v55, v76
v_mfma_f32_16x16x32_bf16 a[32:35], a[216:219], v[148:151], a[32:35]
s_waitcnt lgkmcnt(7)
ds_read_b64_tr_b16 a[214:215], v15 offset:8192
v_max3_f32 v156, v156, v61, v62
v_mfma_f32_16x16x32_bf16 a[44:47], a[220:223], v[148:151], a[44:47]
ds_read_b64_tr_b16 a[216:217], v8 offset:256
v_max3_f32 v157, v157, v69, v70
v_mfma_f32_16x16x32_bf16 a[40:43], a[220:223], v[140:143], a[40:43]
ds_read_b64_tr_b16 a[218:219], v8 offset:8448
v_max3_f32 v158, v158, v77, v78
v_mfma_f32_16x16x32_bf16 a[36:39], a[220:223], v[132:135], a[36:39]
s_waitcnt lgkmcnt(8)
v_max_f32 v156, v156, v63
v_max_f32 v157, v157, v71
v_mfma_f32_16x16x32_bf16 a[48:51], a[224:227], v[132:135], a[48:51]
ds_read_b64_tr_b16 a[220:221], v9 offset:256
v_max_f32 v158, v158, v79
v_mfma_f32_16x16x32_bf16 a[52:55], a[224:227], v[140:143], a[52:55]
ds_read_b64_tr_b16 a[222:223], v9 offset:8448
v_fma_f32 v164, v156, s50, v234
v_mfma_f32_16x16x32_bf16 a[56:59], a[224:227], v[148:151], a[56:59]
s_waitcnt lgkmcnt(8)
v_fma_f32 v165, v157, s50, v235
v_fma_f32 v166, v158, s50, v236
v_mfma_f32_16x16x32_bf16 a[68:71], a[228:231], v[148:151], a[68:71]
ds_read_b64_tr_b16 a[224:225], v10 offset:256
v_max3_f32 v167, v164, v165, v166
v_mfma_f32_16x16x32_bf16 a[64:67], a[228:231], v[140:143], a[64:67]
ds_read_b64_tr_b16 a[226:227], v10 offset:8448
v_cmp_lt_f32 vcc, s51, v167
v_mfma_f32_16x16x32_bf16 a[60:63], a[228:231], v[132:135], a[60:63]
s_waitcnt lgkmcnt(8)
s_cbranch_vccnz L_ra13
L_skipa13:
v_fma_f32 v36, v36, s50, v234
v_mfma_f32_16x16x32_bf16 a[72:75], a[208:211], v[132:135], a[72:75]
ds_read_b64_tr_b16 a[228:229], v11 offset:256
v_fma_f32 v37, v37, s50, v234
v_mfma_f32_16x16x32_bf16 a[76:79], a[208:211], v[140:143], a[76:79]
ds_read_b64_tr_b16 a[230:231], v11 offset:8448
v_fma_f32 v38, v38, s50, v234
v_mfma_f32_16x16x32_bf16 a[80:83], a[208:211], v[148:151], a[80:83]
s_waitcnt lgkmcnt(8)
v_fma_f32 v39, v39, s50, v234
v_fma_f32 v60, v60, s50, v234
v_mfma_f32_16x16x32_bf16 a[92:95], a[212:215], v[148:151], a[92:95]
ds_read_b64_tr_b16 a[208:209], v12 offset:256
v_fma_f32 v61, v61, s50, v234
v_mfma_f32_16x16x32_bf16 a[88:91], a[212:215], v[140:143], a[88:91]
ds_read_b64_tr_b16 a[210:211], v12 offset:8448
v_fma_f32 v62, v62, s50, v234
v_mfma_f32_16x16x32_bf16 a[84:87], a[212:215], v[132:135], a[84:87]
s_waitcnt lgkmcnt(8)
v_exp_f32 v36, v36
v_mfma_f32_16x16x32_bf16 a[96:99], a[216:219], v[132:135], a[96:99]
ds_read_b64_tr_b16 a[212:213], v13 offset:256
v_fma_f32 v63, v63, s50, v234
v_mfma_f32_16x16x32_bf16 a[100:103], a[216:219], v[140:143], a[100:103]
ds_read_b64_tr_b16 a[214:215], v13 offset:8448
v_fma_f32 v44, v44, s50, v235
v_mfma_f32_16x16x32_bf16 a[104:107], a[216:219], v[148:151], a[104:107]
s_waitcnt lgkmcnt(8)
v_exp_f32 v37, v37
v_mfma_f32_16x16x32_bf16 a[116:119], a[220:223], v[148:151], a[116:119]
ds_read_b64_tr_b16 a[216:217], v14 offset:256
v_fma_f32 v45, v45, s50, v235
v_mfma_f32_16x16x32_bf16 a[112:115], a[220:223], v[140:143], a[112:115]
ds_read_b64_tr_b16 a[218:219], v14 offset:8448
v_fma_f32 v46, v46, s50, v235
v_mfma_f32_16x16x32_bf16 a[108:111], a[220:223], v[132:135], a[108:111]
s_waitcnt lgkmcnt(8)
v_exp_f32 v38, v38
v_mfma_f32_16x16x32_bf16 a[120:123], a[224:227], v[132:135], a[120:123]
ds_read_b64_tr_b16 a[220:221], v15 offset:256
v_fma_f32 v47, v47, s50, v235
v_mfma_f32_16x16x32_bf16 a[124:127], a[224:227], v[140:143], a[124:127]
ds_read_b64_tr_b16 a[222:223], v15 offset:8448
v_fma_f32 v68, v68, s50, v235
v_mfma_f32_16x16x32_bf16 a[128:131], a[224:227], v[148:151], a[128:131]
s_waitcnt lgkmcnt(8)
v_exp_f32 v39, v39
v_mfma_f32_16x16x32_bf16 a[140:143], a[228:231], v[148:151], a[140:143]
s_waitcnt vmcnt(20)
s_barrier
v_add_u32 v4, 4294885376, v4
v_mfma_f32_16x16x32_bf16 a[136:139], a[228:231], v[140:143], a[136:139]
ds_read_b128 a[224:227], v4 offset:0
v_fma_f32 v69, v69, s50, v235
v_mfma_f32_16x16x32_bf16 a[132:135], a[228:231], v[132:135], a[132:135]
s_waitcnt lgkmcnt(7)
v_exp_f32 v60, v60
v_mfma_f32_16x16x32_bf16 a[144:147], a[208:211], v[132:135], a[144:147]
ds_read_b128 a[228:231], v4 offset:8192
v_fma_f32 v70, v70, s50, v235
v_mfma_f32_16x16x32_bf16 a[148:151], a[208:211], v[140:143], a[148:151]
v_exp_f32 v61, v61
v_mfma_f32_16x16x32_bf16 a[152:155], a[208:211], v[148:151], a[152:155]
s_waitcnt lgkmcnt(6)
v_exp_f32 v62, v62
v_mfma_f32_16x16x32_bf16 a[164:167], a[212:215], v[148:151], a[164:167]
v_add_u32 v5, 4294885376, v5
v_fma_f32 v71, v71, s50, v235
v_mfma_f32_16x16x32_bf16 a[160:163], a[212:215], v[140:143], a[160:163]
ds_read_b128 a[208:211], v5 offset:0
v_fma_f32 v52, v52, s50, v236
v_mfma_f32_16x16x32_bf16 a[156:159], a[212:215], v[132:135], a[156:159]
s_waitcnt lgkmcnt(5)
v_exp_f32 v63, v63
v_mfma_f32_16x16x32_bf16 a[168:171], a[216:219], v[132:135], a[168:171]
ds_read_b128 a[212:215], v5 offset:8192
v_fma_f32 v53, v53, s50, v236
v_mfma_f32_16x16x32_bf16 a[172:175], a[216:219], v[140:143], a[172:175]
v_exp_f32 v44, v44
v_mfma_f32_16x16x32_bf16 a[176:179], a[216:219], v[148:151], a[176:179]
s_waitcnt lgkmcnt(4)
v_exp_f32 v45, v45
v_mfma_f32_16x16x32_bf16 a[188:191], a[220:223], v[148:151], a[188:191]
v_add_u32 v6, 4294885376, v6
v_fma_f32 v54, v54, s50, v236
v_mfma_f32_16x16x32_bf16 a[184:187], a[220:223], v[140:143], a[184:187]
ds_read_b128 a[216:219], v6 offset:0
v_fma_f32 v55, v55, s50, v236
v_mfma_f32_16x16x32_bf16 a[180:183], a[220:223], v[132:135], a[180:183]
s_cbranch_vccnz L_rb13
L_skipb13:
s_waitcnt lgkmcnt(4)
v_fma_f32 v76, v76, s50, v236
v_mfma_f32_16x16x32_bf16 v[84:87], a[224:227], v[32:35], 0
ds_read_b128 a[220:223], v6 offset:8192
v_fma_f32 v77, v77, s50, v236
v_mfma_f32_16x16x32_bf16 v[92:95], a[224:227], v[40:43], 0
v_exp_f32 v46, v46
v_mfma_f32_16x16x32_bf16 v[100:103], a[224:227], v[48:51], 0
s_waitcnt lgkmcnt(4)
v_exp_f32 v47, v47
v_mfma_f32_16x16x32_bf16 v[124:127], a[228:231], v[48:51], 0
v_add_u32 v7, 4294885376, v7
v_fma_f32 v78, v78, s50, v236
v_mfma_f32_16x16x32_bf16 v[116:119], a[228:231], v[40:43], 0
ds_read_b128 a[224:227], v7 offset:0
v_fma_f32 v79, v79, s50, v236
v_mfma_f32_16x16x32_bf16 v[108:111], a[228:231], v[32:35], 0
s_waitcnt lgkmcnt(4)
v_exp_f32 v68, v68
v_mfma_f32_16x16x32_bf16 v[84:87], a[208:211], v[56:59], v[84:87]
ds_read_b128 a[228:231], v7 offset:8192
v_cvt_pk_bf16_f32 v132, v36, v37
v_mfma_f32_16x16x32_bf16 v[92:95], a[208:211], v[64:67], v[92:95]
v_exp_f32 v69, v69
v_mfma_f32_16x16x32_bf16 v[100:103], a[208:211], v[72:75], v[100:103]
s_waitcnt lgkmcnt(4)
v_exp_f32 v70, v70
v_mfma_f32_16x16x32_bf16 v[124:127], a[212:215], v[72:75], v[124:127]
ds_read_b128 a[208:211], v4 offset:256
v_cvt_pk_bf16_f32 v133, v38, v39
v_mfma_f32_16x16x32_bf16 v[116:119], a[212:215], v[64:67], v[116:119]
v_exp_f32 v71, v71
v_mfma_f32_16x16x32_bf16 v[108:111], a[212:215], v[56:59], v[108:111]
s_waitcnt lgkmcnt(4)
v_exp_f32 v52, v52
v_mfma_f32_16x16x32_bf16 v[84:87], a[216:219], v[80:83], v[84:87]
ds_read_b128 a[212:215], v4 offset:8448
v_cvt_pk_bf16_f32 v134, v60, v61
v_mfma_f32_16x16x32_bf16 v[92:95], a[216:219], v[88:91], v[92:95]
v_exp_f32 v53, v53
v_mfma_f32_16x16x32_bf16 v[100:103], a[216:219], v[96:99], v[100:103]
s_waitcnt lgkmcnt(4)
v_exp_f32 v54, v54
v_mfma_f32_16x16x32_bf16 v[124:127], a[220:223], v[96:99], v[124:127]
ds_read_b128 a[216:219], v5 offset:256
v_cvt_pk_bf16_f32 v135, v62, v63
v_mfma_f32_16x16x32_bf16 v[116:119], a[220:223], v[88:91], v[116:119]
v_exp_f32 v55, v55
v_mfma_f32_16x16x32_bf16 v[108:111], a[220:223], v[80:83], v[108:111]
s_waitcnt lgkmcnt(4)
v_exp_f32 v76, v76
v_mfma_f32_16x16x32_bf16 v[84:87], a[224:227], v[104:107], v[84:87]
ds_read_b128 a[220:223], v5 offset:8448
v_cvt_pk_bf16_f32 v140, v44, v45
v_mfma_f32_16x16x32_bf16 v[92:95], a[224:227], v[112:115], v[92:95]
v_exp_f32 v77, v77
v_mfma_f32_16x16x32_bf16 v[100:103], a[224:227], v[120:123], v[100:103]
s_waitcnt lgkmcnt(4)
v_exp_f32 v78, v78
v_mfma_f32_16x16x32_bf16 v[124:127], a[228:231], v[120:123], v[124:127]
ds_read_b128 a[224:227], v6 offset:256
v_cvt_pk_bf16_f32 v141, v46, v47
v_mfma_f32_16x16x32_bf16 v[116:119], a[228:231], v[112:115], v[116:119]
v_exp_f32 v79, v79
v_mfma_f32_16x16x32_bf16 v[108:111], a[228:231], v[104:107], v[108:111]
s_waitcnt lgkmcnt(4)
v_cvt_pk_bf16_f32 v142, v68, v69
v_cvt_pk_bf16_f32 v143, v70, v71
v_mfma_f32_16x16x32_bf16 v[84:87], a[208:211], v[128:131], v[84:87]
ds_read_b128 a[228:231], v6 offset:8448
v_cvt_pk_bf16_f32 v148, v52, v53
v_mfma_f32_16x16x32_bf16 v[92:95], a[208:211], v[136:139], v[92:95]
v_cvt_pk_bf16_f32 v149, v54, v55
v_cvt_pk_bf16_f32 v150, v76, v77
v_mfma_f32_16x16x32_bf16 v[100:103], a[208:211], v[144:147], v[100:103]
s_waitcnt lgkmcnt(4)
v_cvt_pk_bf16_f32 v151, v78, v79
v_mfma_f32_16x16x32_bf16 v[124:127], a[212:215], v[144:147], v[124:127]
ds_read_b128 a[208:211], v7 offset:256
v_mfma_f32_16x16x32_bf16 v[116:119], a[212:215], v[136:139], v[116:119]
v_mfma_f32_16x16x32_bf16 v[108:111], a[212:215], v[128:131], v[108:111]
s_waitcnt lgkmcnt(4)
v_mfma_f32_16x16x32_bf16 v[84:87], a[216:219], v[152:155], v[84:87]
ds_read_b128 a[212:215], v7 offset:8448
v_mfma_f32_16x16x32_bf16 v[92:95], a[216:219], v[160:163], v[92:95]
v_mfma_f32_16x16x32_bf16 v[100:103], a[216:219], v[168:171], v[100:103]
s_waitcnt lgkmcnt(4)
v_mfma_f32_16x16x32_bf16 v[124:127], a[220:223], v[168:171], v[124:127]
s_waitcnt vmcnt(16)
s_barrier
ds_read_b64_tr_b16 a[216:217], v8 offset:16384
v_mfma_f32_16x16x32_bf16 v[116:119], a[220:223], v[160:163], v[116:119]
s_add_u32 m0, s48, 49152
ds_read_b64_tr_b16 a[218:219], v8 offset:24576
s_add_u32 s49, s65, s0
v_mfma_f32_16x16x32_bf16 v[108:111], a[220:223], v[152:155], v[108:111]
s_waitcnt lgkmcnt(5)
s_add_u32 s49, s49, 114688
v_mfma_f32_16x16x32_bf16 v[84:87], a[224:227], v[176:179], v[84:87]
ds_read_b64_tr_b16 a[220:221], v9 offset:16384
v_mfma_f32_16x16x32_bf16 v[92:95], a[224:227], v[184:187], v[92:95]
ds_read_b64_tr_b16 a[222:223], v9 offset:24576
v_mfma_f32_16x16x32_bf16 v[100:103], a[224:227], v[192:195], v[100:103]
s_waitcnt lgkmcnt(6)
buffer_load_dwordx4 v248, s[36:39], s49 offen lds
v_mfma_f32_16x16x32_bf16 v[124:127], a[228:231], v[192:195], v[124:127]
ds_read_b64_tr_b16 a[224:225], v10 offset:16384
v_mfma_f32_16x16x32_bf16 v[116:119], a[228:231], v[184:187], v[116:119]
ds_read_b64_tr_b16 a[226:227], v10 offset:24576
v_mfma_f32_16x16x32_bf16 v[108:111], a[228:231], v[176:179], v[108:111]
s_waitcnt lgkmcnt(7)
buffer_load_dwordx4 v249, s[36:39], s49 offen offset:1024 lds
v_mfma_f32_16x16x32_bf16 v[84:87], a[208:211], v[200:203], v[84:87]
ds_read_b64_tr_b16 a[228:229], v11 offset:16384
v_mfma_f32_16x16x32_bf16 v[92:95], a[208:211], v[208:211], v[92:95]
ds_read_b64_tr_b16 a[230:231], v11 offset:24576
v_mfma_f32_16x16x32_bf16 v[100:103], a[208:211], v[216:219], v[100:103]
s_waitcnt lgkmcnt(8)
v_mfma_f32_16x16x32_bf16 v[124:127], a[212:215], v[216:219], v[124:127]
ds_read_b64_tr_b16 a[208:209], v12 offset:16384
v_mfma_f32_16x16x32_bf16 v[116:119], a[212:215], v[208:211], v[116:119]
ds_read_b64_tr_b16 a[210:211], v12 offset:24576
v_mfma_f32_16x16x32_bf16 v[108:111], a[212:215], v[200:203], v[108:111]
buffer_load_dwordx4 v250, s[36:39], s49 offen offset:2048 lds
v_mfma_f32_16x16x32_bf16 a[192:195], a[204:207], v[132:135], a[192:195]
v_mfma_f32_16x16x32_bf16 a[196:199], a[204:207], v[140:143], a[196:199]
v_mfma_f32_16x16x32_bf16 a[200:203], a[204:207], v[148:151], a[200:203]
s_waitcnt lgkmcnt(8)
buffer_load_dwordx4 v251, s[36:39], s49 offen offset:3072 lds
v_mfma_f32_16x16x32_bf16 a[0:3], a[216:219], v[132:135], a[0:3]
ds_read_b64_tr_b16 a[212:213], v13 offset:16384
v_max3_f32 v156, v84, v85, v86
v_mfma_f32_16x16x32_bf16 a[4:7], a[216:219], v[140:143], a[4:7]
ds_read_b64_tr_b16 a[214:215], v13 offset:24576
v_max3_f32 v157, v92, v93, v94
v_mfma_f32_16x16x32_bf16 a[8:11], a[216:219], v[148:151], a[8:11]
s_waitcnt lgkmcnt(8)
v_max3_f32 v158, v100, v101, v102
v_max3_f32 v156, v156, v87, v108
v_mfma_f32_16x16x32_bf16 a[20:23], a[220:223], v[148:151], a[20:23]
ds_read_b64_tr_b16 a[216:217], v14 offset:16384
v_max3_f32 v157, v157, v95, v116
v_mfma_f32_16x16x32_bf16 a[16:19], a[220:223], v[140:143], a[16:19]
ds_read_b64_tr_b16 a[218:219], v14 offset:24576
v_max3_f32 v158, v158, v103, v124
v_mfma_f32_16x16x32_bf16 a[12:15], a[220:223], v[132:135], a[12:15]
s_waitcnt lgkmcnt(8)
v_max3_f32 v156, v156, v109, v110
v_max3_f32 v157, v157, v117, v118
v_mfma_f32_16x16x32_bf16 a[24:27], a[224:227], v[132:135], a[24:27]
ds_read_b64_tr_b16 a[220:221], v15 offset:16384
v_max3_f32 v158, v158, v125, v126
v_mfma_f32_16x16x32_bf16 a[28:31], a[224:227], v[140:143], a[28:31]
ds_read_b64_tr_b16 a[222:223], v15 offset:24576
v_max_f32 v156, v156, v111
v_mfma_f32_16x16x32_bf16 a[32:35], a[224:227], v[148:151], a[32:35]
s_waitcnt lgkmcnt(8)
v_max_f32 v157, v157, v119
v_max_f32 v158, v158, v127
v_mfma_f32_16x16x32_bf16 a[44:47], a[228:231], v[148:151], a[44:47]
ds_read_b64_tr_b16 a[224:225], v8 offset:16640
v_fma_f32 v164, v156, s50, v234
v_mfma_f32_16x16x32_bf16 a[40:43], a[228:231], v[140:143], a[40:43]
ds_read_b64_tr_b16 a[226:227], v8 offset:24832
v_fma_f32 v165, v157, s50, v235
v_mfma_f32_16x16x32_bf16 a[36:39], a[228:231], v[132:135], a[36:39]
s_waitcnt lgkmcnt(8)
v_fma_f32 v166, v158, s50, v236
v_max3_f32 v167, v164, v165, v166
v_mfma_f32_16x16x32_bf16 a[48:51], a[208:211], v[132:135], a[48:51]
ds_read_b64_tr_b16 a[228:229], v9 offset:16640
v_cmp_lt_f32 vcc, s51, v167
v_mfma_f32_16x16x32_bf16 a[52:55], a[208:211], v[140:143], a[52:55]
s_cbranch_vccnz L_ra14
L_skipa14:
ds_read_b64_tr_b16 a[230:231], v9 offset:24832
v_fma_f32 v84, v84, s50, v234
v_mfma_f32_16x16x32_bf16 a[56:59], a[208:211], v[148:151], a[56:59]
s_waitcnt lgkmcnt(8)
v_fma_f32 v85, v85, s50, v234
v_fma_f32 v86, v86, s50, v234
v_mfma_f32_16x16x32_bf16 a[68:71], a[212:215], v[148:151], a[68:71]
ds_read_b64_tr_b16 a[208:209], v10 offset:16640
v_fma_f32 v87, v87, s50, v234
v_mfma_f32_16x16x32_bf16 a[64:67], a[212:215], v[140:143], a[64:67]
ds_read_b64_tr_b16 a[210:211], v10 offset:24832
v_fma_f32 v108, v108, s50, v234
v_mfma_f32_16x16x32_bf16 a[60:63], a[212:215], v[132:135], a[60:63]
s_waitcnt lgkmcnt(8)
v_exp_f32 v84, v84
v_mfma_f32_16x16x32_bf16 a[72:75], a[216:219], v[132:135], a[72:75]
ds_read_b64_tr_b16 a[212:213], v11 offset:16640
v_fma_f32 v109, v109, s50, v234
v_mfma_f32_16x16x32_bf16 a[76:79], a[216:219], v[140:143], a[76:79]
ds_read_b64_tr_b16 a[214:215], v11 offset:24832
v_fma_f32 v110, v110, s50, v234
v_mfma_f32_16x16x32_bf16 a[80:83], a[216:219], v[148:151], a[80:83]
s_waitcnt lgkmcnt(8)
v_exp_f32 v85, v85
v_mfma_f32_16x16x32_bf16 a[92:95], a[220:223], v[148:151], a[92:95]
ds_read_b64_tr_b16 a[216:217], v12 offset:16640
v_fma_f32 v111, v111, s50, v234
v_mfma_f32_16x16x32_bf16 a[88:91], a[220:223], v[140:143], a[88:91]
ds_read_b64_tr_b16 a[218:219], v12 offset:24832
v_fma_f32 v92, v92, s50, v235
v_mfma_f32_16x16x32_bf16 a[84:87], a[220:223], v[132:135], a[84:87]
s_waitcnt lgkmcnt(8)
v_exp_f32 v86, v86
v_mfma_f32_16x16x32_bf16 a[96:99], a[224:227], v[132:135], a[96:99]
ds_read_b64_tr_b16 a[220:221], v13 offset:16640
v_fma_f32 v93, v93, s50, v235
v_mfma_f32_16x16x32_bf16 a[100:103], a[224:227], v[140:143], a[100:103]
ds_read_b64_tr_b16 a[222:223], v13 offset:24832
v_fma_f32 v94, v94, s50, v235
v_mfma_f32_16x16x32_bf16 a[104:107], a[224:227], v[148:151], a[104:107]
s_waitcnt lgkmcnt(8)
v_exp_f32 v87, v87
v_mfma_f32_16x16x32_bf16 a[116:119], a[228:231], v[148:151], a[116:119]
ds_read_b64_tr_b16 a[224:225], v14 offset:16640
v_fma_f32 v95, v95, s50, v235
v_mfma_f32_16x16x32_bf16 a[112:115], a[228:231], v[140:143], a[112:115]
ds_read_b64_tr_b16 a[226:227], v14 offset:24832
v_fma_f32 v116, v116, s50, v235
v_mfma_f32_16x16x32_bf16 a[108:111], a[228:231], v[132:135], a[108:111]
s_waitcnt lgkmcnt(8)
v_exp_f32 v108, v108
v_mfma_f32_16x16x32_bf16 a[120:123], a[208:211], v[132:135], a[120:123]
ds_read_b64_tr_b16 a[228:229], v15 offset:16640
v_fma_f32 v117, v117, s50, v235
v_mfma_f32_16x16x32_bf16 a[124:127], a[208:211], v[140:143], a[124:127]
ds_read_b64_tr_b16 a[230:231], v15 offset:24832
v_fma_f32 v118, v118, s50, v235
v_mfma_f32_16x16x32_bf16 a[128:131], a[208:211], v[148:151], a[128:131]
s_waitcnt lgkmcnt(8)
v_exp_f32 v109, v109
v_mfma_f32_16x16x32_bf16 a[140:143], a[212:215], v[148:151], a[140:143]
s_waitcnt vmcnt(16)
s_barrier
ds_read_b64_tr_b16 a[208:209], v8 offset:32768
v_mfma_f32_16x16x32_bf16 a[136:139], a[212:215], v[140:143], a[136:139]
s_add_u32 m0, s48, 16384
ds_read_b64_tr_b16 a[210:211], v8 offset:40960
s_add_u32 s49, s66, s0
v_mfma_f32_16x16x32_bf16 a[132:135], a[212:215], v[132:135], a[132:135]
s_waitcnt lgkmcnt(8)
buffer_load_dwordx4 v248, s[36:39], s49 offen lds
v_mfma_f32_16x16x32_bf16 a[144:147], a[216:219], v[132:135], a[144:147]
ds_read_b64_tr_b16 a[212:213], v9 offset:32768
v_fma_f32 v119, v119, s50, v235
v_mfma_f32_16x16x32_bf16 a[148:151], a[216:219], v[140:143], a[148:151]
ds_read_b64_tr_b16 a[214:215], v9 offset:40960
v_fma_f32 v100, v100, s50, v236
v_mfma_f32_16x16x32_bf16 a[152:155], a[216:219], v[148:151], a[152:155]
s_waitcnt lgkmcnt(8)
buffer_load_dwordx4 v249, s[36:39], s49 offen offset:1024 lds
v_mfma_f32_16x16x32_bf16 a[164:167], a[220:223], v[148:151], a[164:167]
ds_read_b64_tr_b16 a[216:217], v10 offset:32768
v_fma_f32 v101, v101, s50, v236
v_mfma_f32_16x16x32_bf16 a[160:163], a[220:223], v[140:143], a[160:163]
ds_read_b64_tr_b16 a[218:219], v10 offset:40960
v_fma_f32 v102, v102, s50, v236
v_mfma_f32_16x16x32_bf16 a[156:159], a[220:223], v[132:135], a[156:159]
s_waitcnt lgkmcnt(8)
v_exp_f32 v110, v110
v_mfma_f32_16x16x32_bf16 a[168:171], a[224:227], v[132:135], a[168:171]
ds_read_b64_tr_b16 a[220:221], v11 offset:32768
v_fma_f32 v103, v103, s50, v236
v_mfma_f32_16x16x32_bf16 a[172:175], a[224:227], v[140:143], a[172:175]
ds_read_b64_tr_b16 a[222:223], v11 offset:40960
v_fma_f32 v124, v124, s50, v236
v_mfma_f32_16x16x32_bf16 a[176:179], a[224:227], v[148:151], a[176:179]
s_waitcnt lgkmcnt(8)
buffer_load_dwordx4 v250, s[36:39], s49 offen offset:2048 lds
v_mfma_f32_16x16x32_bf16 a[188:191], a[228:231], v[148:151], a[188:191]
ds_read_b64_tr_b16 a[224:225], v12 offset:32768
v_fma_f32 v125, v125, s50, v236
v_mfma_f32_16x16x32_bf16 a[184:187], a[228:231], v[140:143], a[184:187]
ds_read_b64_tr_b16 a[226:227], v12 offset:40960
v_fma_f32 v126, v126, s50, v236
v_mfma_f32_16x16x32_bf16 a[180:183], a[228:231], v[132:135], a[180:183]
s_cbranch_vccnz L_rb14
L_skipb14:
buffer_load_dwordx4 v251, s[36:39], s49 offen offset:3072 lds
v_exp_f32 v111, v111
v_exp_f32 v92, v92
v_exp_f32 v93, v93
v_exp_f32 v94, v94
v_exp_f32 v95, v95
v_exp_f32 v116, v116
v_exp_f32 v117, v117
v_exp_f32 v118, v118
v_exp_f32 v119, v119
v_exp_f32 v100, v100
v_exp_f32 v101, v101
v_exp_f32 v102, v102
v_exp_f32 v103, v103
v_fma_f32 v127, v127, s50, v236
v_exp_f32 v124, v124
v_exp_f32 v125, v125
v_exp_f32 v126, v126
v_exp_f32 v127, v127
v_cvt_pk_bf16_f32 v132, v84, v85
v_cvt_pk_bf16_f32 v133, v86, v87
v_cvt_pk_bf16_f32 v134, v108, v109
v_cvt_pk_bf16_f32 v135, v110, v111
v_cvt_pk_bf16_f32 v140, v92, v93
v_cvt_pk_bf16_f32 v141, v94, v95
v_cvt_pk_bf16_f32 v142, v116, v117
v_cvt_pk_bf16_f32 v143, v118, v119
v_cvt_pk_bf16_f32 v148, v100, v101
v_cvt_pk_bf16_f32 v149, v102, v103
v_cvt_pk_bf16_f32 v150, v124, v125
v_cvt_pk_bf16_f32 v151, v126, v127
v_mfma_f32_16x16x32_bf16 a[192:195], a[204:207], v[132:135], a[192:195]
v_mfma_f32_16x16x32_bf16 a[196:199], a[204:207], v[140:143], a[196:199]
v_mfma_f32_16x16x32_bf16 a[200:203], a[204:207], v[148:151], a[200:203]
s_waitcnt lgkmcnt(8)
v_mfma_f32_16x16x32_bf16 a[0:3], a[208:211], v[132:135], a[0:3]
ds_read_b64_tr_b16 a[228:229], v13 offset:32768
v_mfma_f32_16x16x32_bf16 a[4:7], a[208:211], v[140:143], a[4:7]
ds_read_b64_tr_b16 a[230:231], v13 offset:40960
v_mfma_f32_16x16x32_bf16 a[8:11], a[208:211], v[148:151], a[8:11]
s_waitcnt lgkmcnt(8)
v_mfma_f32_16x16x32_bf16 a[20:23], a[212:215], v[148:151], a[20:23]
ds_read_b64_tr_b16 a[208:209], v14 offset:32768
v_accvgpr_read_b32 v224, a192
v_mfma_f32_16x16x32_bf16 a[16:19], a[212:215], v[140:143], a[16:19]
ds_read_b64_tr_b16 a[210:211], v14 offset:40960
v_accvgpr_read_b32 v226, a196
v_mfma_f32_16x16x32_bf16 a[12:15], a[212:215], v[132:135], a[12:15]
s_waitcnt lgkmcnt(8)
v_accvgpr_read_b32 v228, a200
v_mfma_f32_16x16x32_bf16 a[24:27], a[216:219], v[132:135], a[24:27]
ds_read_b64_tr_b16 a[212:213], v15 offset:32768
v_mfma_f32_16x16x32_bf16 a[28:31], a[216:219], v[140:143], a[28:31]
ds_read_b64_tr_b16 a[214:215], v15 offset:40960
v_mfma_f32_16x16x32_bf16 a[32:35], a[216:219], v[148:151], a[32:35]
s_waitcnt lgkmcnt(8)
v_rcp_f32 v224, v224
v_mfma_f32_16x16x32_bf16 a[44:47], a[220:223], v[148:151], a[44:47]
ds_read_b64_tr_b16 a[216:217], v8 offset:33024
v_accvgpr_read_b32 v172, a0
v_mfma_f32_16x16x32_bf16 a[40:43], a[220:223], v[140:143], a[40:43]
ds_read_b64_tr_b16 a[218:219], v8 offset:41216
v_accvgpr_read_b32 v173, a1
v_mfma_f32_16x16x32_bf16 a[36:39], a[220:223], v[132:135], a[36:39]
s_waitcnt lgkmcnt(8)
v_rcp_f32 v226, v226
v_mfma_f32_16x16x32_bf16 a[48:51], a[224:227], v[132:135], a[48:51]
ds_read_b64_tr_b16 a[220:221], v9 offset:33024
v_accvgpr_read_b32 v174, a2
v_mfma_f32_16x16x32_bf16 a[52:55], a[224:227], v[140:143], a[52:55]
ds_read_b64_tr_b16 a[222:223], v9 offset:41216
v_accvgpr_read_b32 v175, a3
v_mfma_f32_16x16x32_bf16 a[56:59], a[224:227], v[148:151], a[56:59]
s_waitcnt lgkmcnt(8)
v_rcp_f32 v228, v228
v_mfma_f32_16x16x32_bf16 a[68:71], a[228:231], v[148:151], a[68:71]
ds_read_b64_tr_b16 a[224:225], v10 offset:33024
v_accvgpr_read_b32 v180, a12
v_mfma_f32_16x16x32_bf16 a[64:67], a[228:231], v[140:143], a[64:67]
ds_read_b64_tr_b16 a[226:227], v10 offset:41216
v_accvgpr_read_b32 v181, a13
v_mfma_f32_16x16x32_bf16 a[60:63], a[228:231], v[132:135], a[60:63]
s_waitcnt lgkmcnt(8)
v_accvgpr_read_b32 v182, a14
v_accvgpr_read_b32 v183, a15
v_mfma_f32_16x16x32_bf16 a[72:75], a[208:211], v[132:135], a[72:75]
ds_read_b64_tr_b16 a[228:229], v11 offset:33024
v_accvgpr_read_b32 v188, a4
v_mfma_f32_16x16x32_bf16 a[76:79], a[208:211], v[140:143], a[76:79]
ds_read_b64_tr_b16 a[230:231], v11 offset:41216
v_accvgpr_read_b32 v189, a5
v_mfma_f32_16x16x32_bf16 a[80:83], a[208:211], v[148:151], a[80:83]
s_waitcnt lgkmcnt(8)
v_pk_mul_f32 v[172:173], v[172:173], v[224:225] op_sel_hi:[1,0]
v_mfma_f32_16x16x32_bf16 a[92:95], a[212:215], v[148:151], a[92:95]
ds_read_b64_tr_b16 a[208:209], v12 offset:33024
v_cvt_pk_bf16_f32 v32, v172, v173
v_mfma_f32_16x16x32_bf16 a[88:91], a[212:215], v[140:143], a[88:91]
ds_read_b64_tr_b16 a[210:211], v12 offset:41216
v_accvgpr_read_b32 v190, a6
v_mfma_f32_16x16x32_bf16 a[84:87], a[212:215], v[132:135], a[84:87]
s_waitcnt lgkmcnt(8)
v_pk_mul_f32 v[174:175], v[174:175], v[224:225] op_sel_hi:[1,0]
v_mfma_f32_16x16x32_bf16 a[96:99], a[216:219], v[132:135], a[96:99]
ds_read_b64_tr_b16 a[212:213], v13 offset:33024
v_cvt_pk_bf16_f32 v33, v174, v175
v_mfma_f32_16x16x32_bf16 a[100:103], a[216:219], v[140:143], a[100:103]
ds_read_b64_tr_b16 a[214:215], v13 offset:41216
v_accvgpr_read_b32 v191, a7
v_mfma_f32_16x16x32_bf16 a[104:107], a[216:219], v[148:151], a[104:107]
s_waitcnt lgkmcnt(8)
v_pk_mul_f32 v[180:181], v[180:181], v[224:225] op_sel_hi:[1,0]
v_mfma_f32_16x16x32_bf16 a[116:119], a[220:223], v[148:151], a[116:119]
ds_read_b64_tr_b16 a[216:217], v14 offset:33024
v_cvt_pk_bf16_f32 v34, v180, v181
v_mfma_f32_16x16x32_bf16 a[112:115], a[220:223], v[140:143], a[112:115]
ds_read_b64_tr_b16 a[218:219], v14 offset:41216
v_accvgpr_read_b32 v196, a16
v_mfma_f32_16x16x32_bf16 a[108:111], a[220:223], v[132:135], a[108:111]
s_waitcnt lgkmcnt(8)
v_pk_mul_f32 v[182:183], v[182:183], v[224:225] op_sel_hi:[1,0]
v_mfma_f32_16x16x32_bf16 a[120:123], a[224:227], v[132:135], a[120:123]
ds_read_b64_tr_b16 a[220:221], v15 offset:33024
v_cvt_pk_bf16_f32 v35, v182, v183
v_mfma_f32_16x16x32_bf16 a[124:127], a[224:227], v[140:143], a[124:127]
ds_read_b64_tr_b16 a[222:223], v15 offset:41216
v_accvgpr_read_b32 v197, a17
v_mfma_f32_16x16x32_bf16 a[128:131], a[224:227], v[148:151], a[128:131]
s_waitcnt lgkmcnt(8)
v_accvgpr_read_b32 v198, a18
v_accvgpr_read_b32 v199, a19
v_mfma_f32_16x16x32_bf16 a[140:143], a[228:231], v[148:151], a[140:143]
s_waitcnt vmcnt(16)
s_barrier
ds_read_b64_tr_b16 a[224:225], v232 offset:32768
v_mfma_f32_16x16x32_bf16 a[136:139], a[228:231], v[140:143], a[136:139]
s_add_u32 m0, s48, 65536
ds_read_b64_tr_b16 a[226:227], v232 offset:34816
s_add_u32 s49, s66, s0
v_mfma_f32_16x16x32_bf16 a[132:135], a[228:231], v[132:135], a[132:135]
s_waitcnt lgkmcnt(8)
s_add_u32 s49, s49, 114688
v_accvgpr_read_b32 v172, a8
v_mfma_f32_16x16x32_bf16 a[144:147], a[208:211], v[132:135], a[144:147]
ds_read_b64_tr_b16 a[228:229], v233 offset:32768
v_accvgpr_read_b32 v173, a9
v_mfma_f32_16x16x32_bf16 a[148:151], a[208:211], v[140:143], a[148:151]
ds_read_b64_tr_b16 a[230:231], v233 offset:34816
v_accvgpr_read_b32 v174, a10
v_mfma_f32_16x16x32_bf16 a[152:155], a[208:211], v[148:151], a[152:155]
s_waitcnt lgkmcnt(8)
buffer_load_dwordx4 v248, s[36:39], s49 offen lds
v_mfma_f32_16x16x32_bf16 a[164:167], a[212:215], v[148:151], a[164:167]
ds_read_b64_tr_b16 a[208:209], v232 offset:36864
v_accvgpr_read_b32 v175, a11
v_mfma_f32_16x16x32_bf16 a[160:163], a[212:215], v[140:143], a[160:163]
ds_read_b64_tr_b16 a[210:211], v232 offset:38912
v_accvgpr_read_b32 v180, a20
v_mfma_f32_16x16x32_bf16 a[156:159], a[212:215], v[132:135], a[156:159]
s_waitcnt lgkmcnt(8)
buffer_load_dwordx4 v249, s[36:39], s49 offen offset:1024 lds
v_mfma_f32_16x16x32_bf16 a[168:171], a[216:219], v[132:135], a[168:171]
ds_read_b64_tr_b16 a[212:213], v233 offset:36864
v_accvgpr_read_b32 v181, a21
v_mfma_f32_16x16x32_bf16 a[172:175], a[216:219], v[140:143], a[172:175]
ds_read_b64_tr_b16 a[214:215], v233 offset:38912
v_accvgpr_read_b32 v182, a22
v_mfma_f32_16x16x32_bf16 a[176:179], a[216:219], v[148:151], a[176:179]
s_waitcnt lgkmcnt(8)
v_pk_mul_f32 v[188:189], v[188:189], v[226:227] op_sel_hi:[1,0]
v_mfma_f32_16x16x32_bf16 a[188:191], a[220:223], v[148:151], a[188:191]
ds_read_b64_tr_b16 a[216:217], v232 offset:40960
v_cvt_pk_bf16_f32 v40, v188, v189
v_mfma_f32_16x16x32_bf16 a[184:187], a[220:223], v[140:143], a[184:187]
ds_read_b64_tr_b16 a[218:219], v232 offset:43008
v_accvgpr_read_b32 v183, a23
v_mfma_f32_16x16x32_bf16 a[180:183], a[220:223], v[132:135], a[180:183]
s_waitcnt lgkmcnt(8)
buffer_load_dwordx4 v250, s[36:39], s49 offen offset:2048 lds
v_pk_mul_f32 v[190:191], v[190:191], v[226:227] op_sel_hi:[1,0]
v_pk_mul_f32 v[196:197], v[196:197], v[226:227] op_sel_hi:[1,0]
v_pk_mul_f32 v[198:199], v[198:199], v[226:227] op_sel_hi:[1,0]
v_cvt_pk_bf16_f32 v41, v190, v191
v_cvt_pk_bf16_f32 v42, v196, v197
v_cvt_pk_bf16_f32 v43, v198, v199
v_pk_mul_f32 v[172:173], v[172:173], v[228:229] op_sel_hi:[1,0]
v_pk_mul_f32 v[174:175], v[174:175], v[228:229] op_sel_hi:[1,0]
v_pk_mul_f32 v[180:181], v[180:181], v[228:229] op_sel_hi:[1,0]
v_pk_mul_f32 v[182:183], v[182:183], v[228:229] op_sel_hi:[1,0]
v_cvt_pk_bf16_f32 v48, v172, v173
v_cvt_pk_bf16_f32 v49, v174, v175
v_cvt_pk_bf16_f32 v50, v180, v181
v_cvt_pk_bf16_f32 v51, v182, v183
v_accvgpr_read_b32 v188, a24
v_accvgpr_read_b32 v189, a25
v_accvgpr_read_b32 v190, a26
v_accvgpr_read_b32 v191, a27
v_accvgpr_read_b32 v196, a36
v_accvgpr_read_b32 v197, a37
v_accvgpr_read_b32 v198, a38
v_accvgpr_read_b32 v199, a39
v_pk_mul_f32 v[188:189], v[188:189], v[224:225] op_sel_hi:[1,0]
v_pk_mul_f32 v[190:191], v[190:191], v[224:225] op_sel_hi:[1,0]
v_pk_mul_f32 v[196:197], v[196:197], v[224:225] op_sel_hi:[1,0]
v_pk_mul_f32 v[198:199], v[198:199], v[224:225] op_sel_hi:[1,0]
v_cvt_pk_bf16_f32 v56, v188, v189
v_cvt_pk_bf16_f32 v57, v190, v191
v_cvt_pk_bf16_f32 v58, v196, v197
v_cvt_pk_bf16_f32 v59, v198, v199
v_accvgpr_read_b32 v172, a28
v_accvgpr_read_b32 v173, a29
v_accvgpr_read_b32 v174, a30
v_accvgpr_read_b32 v175, a31
v_accvgpr_read_b32 v180, a40
v_accvgpr_read_b32 v181, a41
v_accvgpr_read_b32 v182, a42
v_accvgpr_read_b32 v183, a43
v_pk_mul_f32 v[172:173], v[172:173], v[226:227] op_sel_hi:[1,0]
v_pk_mul_f32 v[174:175], v[174:175], v[226:227] op_sel_hi:[1,0]
v_pk_mul_f32 v[180:181], v[180:181], v[226:227] op_sel_hi:[1,0]
v_pk_mul_f32 v[182:183], v[182:183], v[226:227] op_sel_hi:[1,0]
v_cvt_pk_bf16_f32 v64, v172, v173
v_cvt_pk_bf16_f32 v65, v174, v175
v_cvt_pk_bf16_f32 v66, v180, v181
v_cvt_pk_bf16_f32 v67, v182, v183
v_accvgpr_read_b32 v188, a32
v_accvgpr_read_b32 v189, a33
v_accvgpr_read_b32 v190, a34
v_accvgpr_read_b32 v191, a35
v_accvgpr_read_b32 v196, a44
v_accvgpr_read_b32 v197, a45
v_accvgpr_read_b32 v198, a46
v_accvgpr_read_b32 v199, a47
v_pk_mul_f32 v[188:189], v[188:189], v[228:229] op_sel_hi:[1,0]
v_pk_mul_f32 v[190:191], v[190:191], v[228:229] op_sel_hi:[1,0]
v_pk_mul_f32 v[196:197], v[196:197], v[228:229] op_sel_hi:[1,0]
v_pk_mul_f32 v[198:199], v[198:199], v[228:229] op_sel_hi:[1,0]
v_cvt_pk_bf16_f32 v72, v188, v189
v_cvt_pk_bf16_f32 v73, v190, v191
v_cvt_pk_bf16_f32 v74, v196, v197
v_cvt_pk_bf16_f32 v75, v198, v199
s_mov_b32 s52, 0
s_mov_b32 s73, 3072
s_cmp_eq_u32 s3, 0
s_cbranch_scc1 L_xk1
buffer_store_dwordx4 v[32:35], v29, s[76:79], s52 offen offset:0 sc1
buffer_store_dwordx4 v[40:43], v29, s[76:79], s52 offen offset:1024 sc1
buffer_store_dwordx4 v[48:51], v29, s[76:79], s52 offen offset:2048 sc1
buffer_store_dwordx4 v[56:59], v29, s[76:79], s73 offen offset:0 sc1
buffer_store_dwordx4 v[64:67], v29, s[76:79], s73 offen offset:1024 sc1
buffer_store_dwordx4 v[72:75], v29, s[76:79], s73 offen offset:2048 sc1
s_branch L_xe1
L_xk1:
ds_write_b128 v31, v[32:35] offset:0
ds_write_b128 v31, v[40:43] offset:1024
ds_write_b128 v31, v[48:51] offset:2048
ds_write_b128 v31, v[56:59] offset:3072
ds_write_b128 v31, v[64:67] offset:4096
ds_write_b128 v31, v[72:75] offset:5120
L_xe1:
v_accvgpr_read_b32 v172, a48
v_accvgpr_read_b32 v173, a49
v_accvgpr_read_b32 v174, a50
v_accvgpr_read_b32 v175, a51
v_accvgpr_read_b32 v180, a60
v_accvgpr_read_b32 v181, a61
v_accvgpr_read_b32 v182, a62
v_accvgpr_read_b32 v183, a63
v_pk_mul_f32 v[172:173], v[172:173], v[224:225] op_sel_hi:[1,0]
v_pk_mul_f32 v[174:175], v[174:175], v[224:225] op_sel_hi:[1,0]
v_pk_mul_f32 v[180:181], v[180:181], v[224:225] op_sel_hi:[1,0]
v_pk_mul_f32 v[182:183], v[182:183], v[224:225] op_sel_hi:[1,0]
v_cvt_pk_bf16_f32 v80, v172, v173
v_cvt_pk_bf16_f32 v81, v174, v175
v_cvt_pk_bf16_f32 v82, v180, v181
v_cvt_pk_bf16_f32 v83, v182, v183
v_accvgpr_read_b32 v188, a52
v_accvgpr_read_b32 v189, a53
v_accvgpr_read_b32 v190, a54
v_accvgpr_read_b32 v191, a55
v_accvgpr_read_b32 v196, a64
v_accvgpr_read_b32 v197, a65
v_accvgpr_read_b32 v198, a66
v_accvgpr_read_b32 v199, a67
v_pk_mul_f32 v[188:189], v[188:189], v[226:227] op_sel_hi:[1,0]
v_pk_mul_f32 v[190:191], v[190:191], v[226:227] op_sel_hi:[1,0]
v_pk_mul_f32 v[196:197], v[196:197], v[226:227] op_sel_hi:[1,0]
v_pk_mul_f32 v[198:199], v[198:199], v[226:227] op_sel_hi:[1,0]
v_cvt_pk_bf16_f32 v88, v188, v189
v_cvt_pk_bf16_f32 v89, v190, v191
v_cvt_pk_bf16_f32 v90, v196, v197
v_cvt_pk_bf16_f32 v91, v198, v199
v_accvgpr_read_b32 v172, a56
v_accvgpr_read_b32 v173, a57
v_accvgpr_read_b32 v174, a58
v_accvgpr_read_b32 v175, a59
v_accvgpr_read_b32 v180, a68
v_accvgpr_read_b32 v181, a69
v_accvgpr_read_b32 v182, a70
v_accvgpr_read_b32 v183, a71
v_pk_mul_f32 v[172:173], v[172:173], v[228:229] op_sel_hi:[1,0]
v_pk_mul_f32 v[174:175], v[174:175], v[228:229] op_sel_hi:[1,0]
v_pk_mul_f32 v[180:181], v[180:181], v[228:229] op_sel_hi:[1,0]
v_pk_mul_f32 v[182:183], v[182:183], v[228:229] op_sel_hi:[1,0]
v_cvt_pk_bf16_f32 v96, v172, v173
v_cvt_pk_bf16_f32 v97, v174, v175
v_cvt_pk_bf16_f32 v98, v180, v181
v_cvt_pk_bf16_f32 v99, v182, v183
v_accvgpr_read_b32 v188, a72
v_accvgpr_read_b32 v189, a73
v_accvgpr_read_b32 v190, a74
v_accvgpr_read_b32 v191, a75
v_accvgpr_read_b32 v196, a84
v_accvgpr_read_b32 v197, a85
v_accvgpr_read_b32 v198, a86
v_accvgpr_read_b32 v199, a87
v_pk_mul_f32 v[188:189], v[188:189], v[224:225] op_sel_hi:[1,0]
v_pk_mul_f32 v[190:191], v[190:191], v[224:225] op_sel_hi:[1,0]
v_pk_mul_f32 v[196:197], v[196:197], v[224:225] op_sel_hi:[1,0]
v_pk_mul_f32 v[198:199], v[198:199], v[224:225] op_sel_hi:[1,0]
v_cvt_pk_bf16_f32 v104, v188, v189
v_cvt_pk_bf16_f32 v105, v190, v191
v_cvt_pk_bf16_f32 v106, v196, v197
v_cvt_pk_bf16_f32 v107, v198, v199
v_accvgpr_read_b32 v172, a76
v_accvgpr_read_b32 v173, a77
v_accvgpr_read_b32 v174, a78
v_accvgpr_read_b32 v175, a79
v_accvgpr_read_b32 v180, a88
v_accvgpr_read_b32 v181, a89
v_accvgpr_read_b32 v182, a90
v_accvgpr_read_b32 v183, a91
v_pk_mul_f32 v[172:173], v[172:173], v[226:227] op_sel_hi:[1,0]
v_pk_mul_f32 v[174:175], v[174:175], v[226:227] op_sel_hi:[1,0]
v_pk_mul_f32 v[180:181], v[180:181], v[226:227] op_sel_hi:[1,0]
v_pk_mul_f32 v[182:183], v[182:183], v[226:227] op_sel_hi:[1,0]
v_cvt_pk_bf16_f32 v112, v172, v173
v_cvt_pk_bf16_f32 v113, v174, v175
v_cvt_pk_bf16_f32 v114, v180, v181
v_cvt_pk_bf16_f32 v115, v182, v183
v_accvgpr_read_b32 v188, a80
v_accvgpr_read_b32 v189, a81
v_accvgpr_read_b32 v190, a82
v_accvgpr_read_b32 v191, a83
v_accvgpr_read_b32 v196, a92
v_accvgpr_read_b32 v197, a93
v_accvgpr_read_b32 v198, a94
v_accvgpr_read_b32 v199, a95
v_pk_mul_f32 v[188:189], v[188:189], v[228:229] op_sel_hi:[1,0]
v_pk_mul_f32 v[190:191], v[190:191], v[228:229] op_sel_hi:[1,0]
v_pk_mul_f32 v[196:197], v[196:197], v[228:229] op_sel_hi:[1,0]
v_pk_mul_f32 v[198:199], v[198:199], v[228:229] op_sel_hi:[1,0]
v_cvt_pk_bf16_f32 v120, v188, v189
v_cvt_pk_bf16_f32 v121, v190, v191
v_cvt_pk_bf16_f32 v122, v196, v197
v_cvt_pk_bf16_f32 v123, v198, v199
s_mov_b32 s52, 6144
s_mov_b32 s73, 9216
s_cmp_eq_u32 s3, 0
s_cbranch_scc1 L_xk3
buffer_store_dwordx4 v[80:83], v29, s[76:79], s52 offen offset:0 sc1
buffer_store_dwordx4 v[88:91], v29, s[76:79], s52 offen offset:1024 sc1
buffer_store_dwordx4 v[96:99], v29, s[76:79], s52 offen offset:2048 sc1
buffer_store_dwordx4 v[104:107], v29, s[76:79], s73 offen offset:0 sc1
buffer_store_dwordx4 v[112:115], v29, s[76:79], s73 offen offset:1024 sc1
buffer_store_dwordx4 v[120:123], v29, s[76:79], s73 offen offset:2048 sc1
s_branch L_xe3
L_xk3:
ds_write_b128 v31, v[80:83] offset:6144
ds_write_b128 v31, v[88:91] offset:7168
ds_write_b128 v31, v[96:99] offset:8192
ds_write_b128 v31, v[104:107] offset:9216
ds_write_b128 v31, v[112:115] offset:10240
ds_write_b128 v31, v[120:123] offset:11264
L_xe3:
v_accvgpr_read_b32 v172, a96
v_accvgpr_read_b32 v173, a97
v_accvgpr_read_b32 v174, a98
v_accvgpr_read_b32 v175, a99
v_accvgpr_read_b32 v180, a108
v_accvgpr_read_b32 v181, a109
v_accvgpr_read_b32 v182, a110
v_accvgpr_read_b32 v183, a111
v_pk_mul_f32 v[172:173], v[172:173], v[224:225] op_sel_hi:[1,0]
v_pk_mul_f32 v[174:175], v[174:175], v[224:225] op_sel_hi:[1,0]
v_pk_mul_f32 v[180:181], v[180:181], v[224:225] op_sel_hi:[1,0]
v_pk_mul_f32 v[182:183], v[182:183], v[224:225] op_sel_hi:[1,0]
v_cvt_pk_bf16_f32 v128, v172, v173
v_cvt_pk_bf16_f32 v129, v174, v175
v_cvt_pk_bf16_f32 v130, v180, v181
v_cvt_pk_bf16_f32 v131, v182, v183
v_accvgpr_read_b32 v188, a100
v_accvgpr_read_b32 v189, a101
v_accvgpr_read_b32 v190, a102
v_accvgpr_read_b32 v191, a103
v_accvgpr_read_b32 v196, a112
v_accvgpr_read_b32 v197, a113
v_accvgpr_read_b32 v198, a114
v_accvgpr_read_b32 v199, a115
v_pk_mul_f32 v[188:189], v[188:189], v[226:227] op_sel_hi:[1,0]
v_pk_mul_f32 v[190:191], v[190:191], v[226:227] op_sel_hi:[1,0]
v_pk_mul_f32 v[196:197], v[196:197], v[226:227] op_sel_hi:[1,0]
v_pk_mul_f32 v[198:199], v[198:199], v[226:227] op_sel_hi:[1,0]
v_cvt_pk_bf16_f32 v136, v188, v189
v_cvt_pk_bf16_f32 v137, v190, v191
v_cvt_pk_bf16_f32 v138, v196, v197
v_cvt_pk_bf16_f32 v139, v198, v199
v_accvgpr_read_b32 v172, a104
v_accvgpr_read_b32 v173, a105
v_accvgpr_read_b32 v174, a106
v_accvgpr_read_b32 v175, a107
v_accvgpr_read_b32 v180, a116
v_accvgpr_read_b32 v181, a117
v_accvgpr_read_b32 v182, a118
v_accvgpr_read_b32 v183, a119
v_pk_mul_f32 v[172:173], v[172:173], v[228:229] op_sel_hi:[1,0]
v_pk_mul_f32 v[174:175], v[174:175], v[228:229] op_sel_hi:[1,0]
v_pk_mul_f32 v[180:181], v[180:181], v[228:229] op_sel_hi:[1,0]
v_pk_mul_f32 v[182:183], v[182:183], v[228:229] op_sel_hi:[1,0]
v_cvt_pk_bf16_f32 v144, v172, v173
v_cvt_pk_bf16_f32 v145, v174, v175
v_cvt_pk_bf16_f32 v146, v180, v181
v_cvt_pk_bf16_f32 v147, v182, v183
v_accvgpr_read_b32 v188, a120
v_accvgpr_read_b32 v189, a121
v_accvgpr_read_b32 v190, a122
v_accvgpr_read_b32 v191, a123
v_accvgpr_read_b32 v196, a132
v_accvgpr_read_b32 v197, a133
v_accvgpr_read_b32 v198, a134
v_accvgpr_read_b32 v199, a135
v_pk_mul_f32 v[188:189], v[188:189], v[224:225] op_sel_hi:[1,0]
v_pk_mul_f32 v[190:191], v[190:191], v[224:225] op_sel_hi:[1,0]
v_pk_mul_f32 v[196:197], v[196:197], v[224:225] op_sel_hi:[1,0]
v_pk_mul_f32 v[198:199], v[198:199], v[224:225] op_sel_hi:[1,0]
v_cvt_pk_bf16_f32 v152, v188, v189
v_cvt_pk_bf16_f32 v153, v190, v191
v_cvt_pk_bf16_f32 v154, v196, v197
v_cvt_pk_bf16_f32 v155, v198, v199
v_accvgpr_read_b32 v172, a124
v_accvgpr_read_b32 v173, a125
v_accvgpr_read_b32 v174, a126
v_accvgpr_read_b32 v175, a127
v_accvgpr_read_b32 v180, a136
v_accvgpr_read_b32 v181, a137
v_accvgpr_read_b32 v182, a138
v_accvgpr_read_b32 v183, a139
v_pk_mul_f32 v[172:173], v[172:173], v[226:227] op_sel_hi:[1,0]
v_pk_mul_f32 v[174:175], v[174:175], v[226:227] op_sel_hi:[1,0]
v_pk_mul_f32 v[180:181], v[180:181], v[226:227] op_sel_hi:[1,0]
v_pk_mul_f32 v[182:183], v[182:183], v[226:227] op_sel_hi:[1,0]
v_cvt_pk_bf16_f32 v160, v172, v173
v_cvt_pk_bf16_f32 v161, v174, v175
v_cvt_pk_bf16_f32 v162, v180, v181
v_cvt_pk_bf16_f32 v163, v182, v183
v_accvgpr_read_b32 v188, a128
v_accvgpr_read_b32 v189, a129
v_accvgpr_read_b32 v190, a130
v_accvgpr_read_b32 v191, a131
v_accvgpr_read_b32 v196, a140
v_accvgpr_read_b32 v197, a141
v_accvgpr_read_b32 v198, a142
v_accvgpr_read_b32 v199, a143
v_pk_mul_f32 v[188:189], v[188:189], v[228:229] op_sel_hi:[1,0]
v_pk_mul_f32 v[190:191], v[190:191], v[228:229] op_sel_hi:[1,0]
v_pk_mul_f32 v[196:197], v[196:197], v[228:229] op_sel_hi:[1,0]
v_pk_mul_f32 v[198:199], v[198:199], v[228:229] op_sel_hi:[1,0]
v_cvt_pk_bf16_f32 v168, v188, v189
v_cvt_pk_bf16_f32 v169, v190, v191
v_cvt_pk_bf16_f32 v170, v196, v197
v_cvt_pk_bf16_f32 v171, v198, v199
s_mov_b32 s52, 12288
s_mov_b32 s73, 15360
s_cmp_eq_u32 s3, 0
s_cbranch_scc1 L_xk5
buffer_store_dwordx4 v[128:131], v29, s[76:79], s52 offen offset:0 sc1
buffer_store_dwordx4 v[136:139], v29, s[76:79], s52 offen offset:1024 sc1
buffer_store_dwordx4 v[144:147], v29, s[76:79], s52 offen offset:2048 sc1
buffer_store_dwordx4 v[152:155], v29, s[76:79], s73 offen offset:0 sc1
buffer_store_dwordx4 v[160:163], v29, s[76:79], s73 offen offset:1024 sc1
buffer_store_dwordx4 v[168:171], v29, s[76:79], s73 offen offset:2048 sc1
s_branch L_xe5
L_xk5:
ds_write_b128 v31, v[128:131] offset:12288
ds_write_b128 v31, v[136:139] offset:13312
ds_write_b128 v31, v[144:147] offset:14336
ds_write_b128 v31, v[152:155] offset:15360
ds_write_b128 v31, v[160:163] offset:16384
ds_write_b128 v31, v[168:171] offset:17408
L_xe5:
v_accvgpr_read_b32 v172, a144
v_accvgpr_read_b32 v173, a145
v_accvgpr_read_b32 v174, a146
v_accvgpr_read_b32 v175, a147
v_accvgpr_read_b32 v180, a156
v_accvgpr_read_b32 v181, a157
v_accvgpr_read_b32 v182, a158
v_accvgpr_read_b32 v183, a159
v_pk_mul_f32 v[172:173], v[172:173], v[224:225] op_sel_hi:[1,0]
v_pk_mul_f32 v[174:175], v[174:175], v[224:225] op_sel_hi:[1,0]
v_pk_mul_f32 v[180:181], v[180:181], v[224:225] op_sel_hi:[1,0]
v_pk_mul_f32 v[182:183], v[182:183], v[224:225] op_sel_hi:[1,0]
v_cvt_pk_bf16_f32 v176, v172, v173
v_cvt_pk_bf16_f32 v177, v174, v175
v_cvt_pk_bf16_f32 v178, v180, v181
v_cvt_pk_bf16_f32 v179, v182, v183
v_accvgpr_read_b32 v188, a148
v_accvgpr_read_b32 v189, a149
v_accvgpr_read_b32 v190, a150
v_accvgpr_read_b32 v191, a151
v_accvgpr_read_b32 v196, a160
v_accvgpr_read_b32 v197, a161
v_accvgpr_read_b32 v198, a162
v_accvgpr_read_b32 v199, a163
v_pk_mul_f32 v[188:189], v[188:189], v[226:227] op_sel_hi:[1,0]
v_pk_mul_f32 v[190:191], v[190:191], v[226:227] op_sel_hi:[1,0]
v_pk_mul_f32 v[196:197], v[196:197], v[226:227] op_sel_hi:[1,0]
v_pk_mul_f32 v[198:199], v[198:199], v[226:227] op_sel_hi:[1,0]
v_cvt_pk_bf16_f32 v184, v188, v189
v_cvt_pk_bf16_f32 v185, v190, v191
v_cvt_pk_bf16_f32 v186, v196, v197
v_cvt_pk_bf16_f32 v187, v198, v199
v_accvgpr_read_b32 v172, a152
v_accvgpr_read_b32 v173, a153
v_accvgpr_read_b32 v174, a154
v_accvgpr_read_b32 v175, a155
v_accvgpr_read_b32 v180, a164
v_accvgpr_read_b32 v181, a165
v_accvgpr_read_b32 v182, a166
v_accvgpr_read_b32 v183, a167
v_pk_mul_f32 v[172:173], v[172:173], v[228:229] op_sel_hi:[1,0]
v_pk_mul_f32 v[174:175], v[174:175], v[228:229] op_sel_hi:[1,0]
v_pk_mul_f32 v[180:181], v[180:181], v[228:229] op_sel_hi:[1,0]
v_pk_mul_f32 v[182:183], v[182:183], v[228:229] op_sel_hi:[1,0]
v_cvt_pk_bf16_f32 v192, v172, v173
v_cvt_pk_bf16_f32 v193, v174, v175
v_cvt_pk_bf16_f32 v194, v180, v181
v_cvt_pk_bf16_f32 v195, v182, v183
v_accvgpr_read_b32 v188, a168
v_accvgpr_read_b32 v189, a169
v_accvgpr_read_b32 v190, a170
v_accvgpr_read_b32 v191, a171
v_accvgpr_read_b32 v196, a180
v_accvgpr_read_b32 v197, a181
v_accvgpr_read_b32 v198, a182
v_accvgpr_read_b32 v199, a183
v_pk_mul_f32 v[188:189], v[188:189], v[224:225] op_sel_hi:[1,0]
v_pk_mul_f32 v[190:191], v[190:191], v[224:225] op_sel_hi:[1,0]
v_pk_mul_f32 v[196:197], v[196:197], v[224:225] op_sel_hi:[1,0]
v_pk_mul_f32 v[198:199], v[198:199], v[224:225] op_sel_hi:[1,0]
v_cvt_pk_bf16_f32 v200, v188, v189
v_cvt_pk_bf16_f32 v201, v190, v191
v_cvt_pk_bf16_f32 v202, v196, v197
v_cvt_pk_bf16_f32 v203, v198, v199
v_accvgpr_read_b32 v172, a172
v_accvgpr_read_b32 v173, a173
v_accvgpr_read_b32 v174, a174
v_accvgpr_read_b32 v175, a175
v_accvgpr_read_b32 v180, a184
v_accvgpr_read_b32 v181, a185
v_accvgpr_read_b32 v182, a186
v_accvgpr_read_b32 v183, a187
v_pk_mul_f32 v[172:173], v[172:173], v[226:227] op_sel_hi:[1,0]
v_pk_mul_f32 v[174:175], v[174:175], v[226:227] op_sel_hi:[1,0]
v_pk_mul_f32 v[180:181], v[180:181], v[226:227] op_sel_hi:[1,0]
v_pk_mul_f32 v[182:183], v[182:183], v[226:227] op_sel_hi:[1,0]
v_cvt_pk_bf16_f32 v208, v172, v173
v_cvt_pk_bf16_f32 v209, v174, v175
v_cvt_pk_bf16_f32 v210, v180, v181
v_cvt_pk_bf16_f32 v211, v182, v183
v_accvgpr_read_b32 v188, a176
v_accvgpr_read_b32 v189, a177
v_accvgpr_read_b32 v190, a178
v_accvgpr_read_b32 v191, a179
v_accvgpr_read_b32 v196, a188
v_accvgpr_read_b32 v197, a189
v_accvgpr_read_b32 v198, a190
v_accvgpr_read_b32 v199, a191
v_pk_mul_f32 v[188:189], v[188:189], v[228:229] op_sel_hi:[1,0]
v_pk_mul_f32 v[190:191], v[190:191], v[228:229] op_sel_hi:[1,0]
v_pk_mul_f32 v[196:197], v[196:197], v[228:229] op_sel_hi:[1,0]
v_pk_mul_f32 v[198:199], v[198:199], v[228:229] op_sel_hi:[1,0]
v_cvt_pk_bf16_f32 v216, v188, v189
v_cvt_pk_bf16_f32 v217, v190, v191
v_cvt_pk_bf16_f32 v218, v196, v197
v_cvt_pk_bf16_f32 v219, v198, v199
s_mov_b32 s52, 18432
s_mov_b32 s73, 21504
s_cmp_eq_u32 s3, 0
s_cbranch_scc1 L_xk7
buffer_store_dwordx4 v[176:179], v29, s[76:79], s52 offen offset:0 sc1
buffer_store_dwordx4 v[184:187], v29, s[76:79], s52 offen offset:1024 sc1
buffer_store_dwordx4 v[192:195], v29, s[76:79], s52 offen offset:2048 sc1
buffer_store_dwordx4 v[200:203], v29, s[76:79], s73 offen offset:0 sc1
buffer_store_dwordx4 v[208:211], v29, s[76:79], s73 offen offset:1024 sc1
buffer_store_dwordx4 v[216:219], v29, s[76:79], s73 offen offset:2048 sc1
s_branch L_xe7
L_xk7:
ds_write_b128 v31, v[176:179] offset:18432
ds_write_b128 v31, v[184:187] offset:19456
ds_write_b128 v31, v[192:195] offset:20480
ds_write_b128 v31, v[200:203] offset:21504
ds_write_b128 v31, v[208:211] offset:22528
ds_write_b128 v31, v[216:219] offset:23552
L_xe7:
s_waitcnt lgkmcnt(0)
s_barrier
ds_read_b128 a[0:3], v31 offset:0
ds_read_b128 a[4:7], v31 offset:1024
ds_read_b128 a[8:11], v31 offset:2048
ds_read_b128 a[12:15], v31 offset:3072
ds_read_b128 a[16:19], v31 offset:4096
ds_read_b128 a[20:23], v31 offset:5120
s_waitcnt lgkmcnt(5)
v_mfma_f32_16x16x32_bf16 v[32:35], a[224:227], a[0:3], 0
ds_read_b64_tr_b16 a[220:221], v233 offset:40960
s_waitcnt lgkmcnt(5)
v_mfma_f32_16x16x32_bf16 v[36:39], a[224:227], a[4:7], 0
ds_read_b64_tr_b16 a[222:223], v233 offset:43008
s_waitcnt lgkmcnt(5)
v_mfma_f32_16x16x32_bf16 v[40:43], a[224:227], a[8:11], 0
buffer_load_dwordx4 v251, s[36:39], s49 offen offset:3072 lds
ds_read_b128 a[24:27], v31 offset:6144
ds_read_b128 a[28:31], v31 offset:7168
ds_read_b128 a[32:35], v31 offset:8192
v_mfma_f32_16x16x32_bf16 v[52:55], a[228:231], a[8:11], 0
ds_read_b64_tr_b16 a[224:225], v232 offset:45056
v_mfma_f32_16x16x32_bf16 v[48:51], a[228:231], a[4:7], 0
ds_read_b64_tr_b16 a[226:227], v232 offset:47104
v_mfma_f32_16x16x32_bf16 v[44:47], a[228:231], a[0:3], 0
ds_read_b128 a[36:39], v31 offset:9216
s_waitcnt lgkmcnt(10)
v_mfma_f32_16x16x32_bf16 v[32:35], a[208:211], a[12:15], v[32:35]
ds_read_b64_tr_b16 a[228:229], v233 offset:45056
s_waitcnt lgkmcnt(10)
v_mfma_f32_16x16x32_bf16 v[36:39], a[208:211], a[16:19], v[36:39]
ds_read_b64_tr_b16 a[230:231], v233 offset:47104
s_waitcnt lgkmcnt(10)
v_mfma_f32_16x16x32_bf16 v[40:43], a[208:211], a[20:23], v[40:43]
ds_read_b128 a[40:43], v31 offset:10240
ds_read_b128 a[44:47], v31 offset:11264
v_mfma_f32_16x16x32_bf16 v[52:55], a[212:215], a[20:23], v[52:55]
s_waitcnt vmcnt(16)
s_barrier
ds_read_b64_tr_b16 a[208:209], v232 offset:0
v_mfma_f32_16x16x32_bf16 v[48:51], a[212:215], a[16:19], v[48:51]
s_add_u32 m0, s48, 81920
ds_read_b64_tr_b16 a[210:211], v232 offset:2048
s_add_u32 s49, s67, s0
v_mfma_f32_16x16x32_bf16 v[44:47], a[212:215], a[12:15], v[44:47]
buffer_load_dwordx4 v248, s[36:39], s49 offen lds
s_waitcnt lgkmcnt(11)
v_mfma_f32_16x16x32_bf16 v[32:35], a[216:219], a[24:27], v[32:35]
ds_read_b64_tr_b16 a[212:213], v233 offset:0
s_waitcnt lgkmcnt(11)
v_mfma_f32_16x16x32_bf16 v[36:39], a[216:219], a[28:31], v[36:39]
ds_read_b64_tr_b16 a[214:215], v233 offset:2048
s_waitcnt lgkmcnt(11)
v_mfma_f32_16x16x32_bf16 v[40:43], a[216:219], a[32:35], v[40:43]
buffer_load_dwordx4 v249, s[36:39], s49 offen offset:1024 lds
ds_read_b128 a[48:51], v31 offset:12288
ds_read_b128 a[52:55], v31 offset:13312
ds_read_b128 a[56:59], v31 offset:14336
v_mfma_f32_16x16x32_bf16 v[52:55], a[220:223], a[32:35], v[52:55]
ds_read_b64_tr_b16 a[216:217], v232 offset:4096
v_mfma_f32_16x16x32_bf16 v[48:51], a[220:223], a[28:31], v[48:51]
s_waitcnt lgkmcnt(14)
ds_read_b64_tr_b16 a[218:219], v232 offset:6144
v_mfma_f32_16x16x32_bf16 v[44:47], a[220:223], a[24:27], v[44:47]
s_waitcnt lgkmcnt(14)
ds_read_b128 a[60:63], v31 offset:15360
s_waitcnt lgkmcnt(14)
v_mfma_f32_16x16x32_bf16 v[32:35], a[224:227], a[36:39], v[32:35]
ds_read_b64_tr_b16 a[220:221], v233 offset:4096
s_waitcnt lgkmcnt(12)
v_mfma_f32_16x16x32_bf16 v[36:39], a[224:227], a[40:43], v[36:39]
ds_read_b64_tr_b16 a[222:223], v233 offset:6144
s_waitcnt lgkmcnt(12)
v_mfma_f32_16x16x32_bf16 v[40:43], a[224:227], a[44:47], v[40:43]
buffer_load_dwordx4 v250, s[36:39], s49 offen offset:2048 lds
ds_read_b128 a[64:67], v31 offset:16384
ds_read_b128 a[68:71], v31 offset:17408
v_mfma_f32_16x16x32_bf16 v[52:55], a[228:231], a[44:47], v[52:55]
ds_read_b64_tr_b16 a[224:225], v232 offset:8192
v_mfma_f32_16x16x32_bf16 v[48:51], a[228:231], a[40:43], v[48:51]
s_waitcnt lgkmcnt(14)
ds_read_b64_tr_b16 a[226:227], v232 offset:10240
v_mfma_f32_16x16x32_bf16 v[44:47], a[228:231], a[36:39], v[44:47]
s_waitcnt lgkmcnt(14)
buffer_load_dwordx4 v251, s[36:39], s49 offen offset:3072 lds
s_waitcnt lgkmcnt(11)
v_mfma_f32_16x16x32_bf16 v[32:35], a[208:211], a[48:51], v[32:35]
ds_read_b64_tr_b16 a[228:229], v233 offset:8192
s_waitcnt lgkmcnt(11)
v_mfma_f32_16x16x32_bf16 v[36:39], a[208:211], a[52:55], v[36:39]
ds_read_b64_tr_b16 a[230:231], v233 offset:10240
s_waitcnt lgkmcnt(11)
v_mfma_f32_16x16x32_bf16 v[40:43], a[208:211], a[56:59], v[40:43]
ds_read_b128 a[72:75], v31 offset:18432
ds_read_b128 a[76:79], v31 offset:19456
ds_read_b128 a[80:83], v31 offset:20480
v_mfma_f32_16x16x32_bf16 v[52:55], a[212:215], a[56:59], v[52:55]
ds_read_b64_tr_b16 a[208:209], v232 offset:12288
v_mfma_f32_16x16x32_bf16 v[48:51], a[212:215], a[52:55], v[48:51]
s_waitcnt lgkmcnt(14)
ds_read_b64_tr_b16 a[210:211], v232 offset:14336
v_mfma_f32_16x16x32_bf16 v[44:47], a[212:215], a[48:51], v[44:47]
s_waitcnt lgkmcnt(14)
ds_read_b128 a[84:87], v31 offset:21504
s_waitcnt lgkmcnt(14)
v_mfma_f32_16x16x32_bf16 v[32:35], a[216:219], a[60:63], v[32:35]
ds_read_b64_tr_b16 a[212:213], v233 offset:12288
s_waitcnt lgkmcnt(12)
v_mfma_f32_16x16x32_bf16 v[36:39], a[216:219], a[64:67], v[36:39]
ds_read_b64_tr_b16 a[214:215], v233 offset:14336
s_waitcnt lgkmcnt(12)
v_mfma_f32_16x16x32_bf16 v[40:43], a[216:219], a[68:71], v[40:43]
ds_read_b128 a[88:91], v31 offset:22528
ds_read_b128 a[92:95], v31 offset:23552
v_mfma_f32_16x16x32_bf16 v[52:55], a[220:223], a[68:71], v[52:55]
s_waitcnt vmcnt(16)
s_barrier
v_add_u32 v232, 49152, v232
v_mfma_f32_16x16x32_bf16 v[48:51], a[220:223], a[64:67], v[48:51]
s_add_u32 m0, s48, 32768
ds_read_b64_tr_b16 a[216:217], v232 offset:49152
s_add_u32 s49, s67, s0
v_mfma_f32_16x16x32_bf16 v[44:47], a[220:223], a[60:63], v[44:47]
s_waitcnt lgkmcnt(13)
ds_read_b64_tr_b16 a[218:219], v232 offset:51200
s_add_u32 s49, s49, 114688
s_waitcnt lgkmcnt(11)
v_mfma_f32_16x16x32_bf16 v[32:35], a[224:227], a[72:75], v[32:35]
buffer_load_dwordx4 v248, s[36:39], s49 offen lds
s_waitcnt lgkmcnt(10)
v_mfma_f32_16x16x32_bf16 v[36:39], a[224:227], a[76:79], v[36:39]
v_add_u32 v233, 49152, v233
s_waitcnt lgkmcnt(9)
v_mfma_f32_16x16x32_bf16 v[40:43], a[224:227], a[80:83], v[40:43]
ds_read_b64_tr_b16 a[220:221], v233 offset:49152
v_mfma_f32_16x16x32_bf16 v[52:55], a[228:231], a[80:83], v[52:55]
ds_read_b64_tr_b16 a[222:223], v233 offset:51200
ds_read_b64_tr_b16 a[224:225], v232 offset:53248
v_mfma_f32_16x16x32_bf16 v[48:51], a[228:231], a[76:79], v[48:51]
ds_read_b64_tr_b16 a[226:227], v232 offset:55296
v_mfma_f32_16x16x32_bf16 v[44:47], a[228:231], a[72:75], v[44:47]
s_waitcnt lgkmcnt(11)
buffer_load_dwordx4 v249, s[36:39], s49 offen offset:1024 lds
s_waitcnt lgkmcnt(10)
v_mfma_f32_16x16x32_bf16 v[32:35], a[208:211], a[84:87], v[32:35]
ds_read_b64_tr_b16 a[228:229], v233 offset:53248
s_waitcnt lgkmcnt(8)
v_mfma_f32_16x16x32_bf16 v[36:39], a[208:211], a[88:91], v[36:39]
s_waitcnt vmcnt(7)
v_mov_b32 v246, 1
buffer_store_dword v246, v242, s[44:47], 0 offen sc1
s_waitcnt lgkmcnt(7)
v_mfma_f32_16x16x32_bf16 v[40:43], a[208:211], a[92:95], v[40:43]
ds_read_b64_tr_b16 a[230:231], v233 offset:55296
v_mfma_f32_16x16x32_bf16 v[52:55], a[212:215], a[92:95], v[52:55]
ds_read_b64_tr_b16 a[208:209], v232 offset:57344
v_mfma_f32_16x16x32_bf16 v[48:51], a[212:215], a[88:91], v[48:51]
ds_read_b64_tr_b16 a[210:211], v232 offset:59392
v_mfma_f32_16x16x32_bf16 v[44:47], a[212:215], a[84:87], v[44:47]
s_waitcnt lgkmcnt(8)
buffer_load_dwordx4 v250, s[36:39], s49 offen offset:2048 lds
v_mfma_f32_16x16x32_bf16 v[56:59], a[216:219], a[0:3], 0
ds_read_b64_tr_b16 a[212:213], v233 offset:57344
v_mfma_f32_16x16x32_bf16 v[60:63], a[216:219], a[4:7], 0
ds_read_b64_tr_b16 a[214:215], v233 offset:59392
v_mfma_f32_16x16x32_bf16 v[64:67], a[216:219], a[8:11], 0
s_waitcnt lgkmcnt(8)
buffer_load_dwordx4 v251, s[36:39], s49 offen offset:3072 lds
v_mfma_f32_16x16x32_bf16 v[76:79], a[220:223], a[8:11], 0
ds_read_b64_tr_b16 a[216:217], v232 offset:61440
v_mfma_f32_16x16x32_bf16 v[72:75], a[220:223], a[4:7], 0
ds_read_b64_tr_b16 a[218:219], v232 offset:63488
v_mfma_f32_16x16x32_bf16 v[68:71], a[220:223], a[0:3], 0
s_waitcnt lgkmcnt(8)
v_mfma_f32_16x16x32_bf16 v[56:59], a[224:227], a[12:15], v[56:59]
ds_read_b64_tr_b16 a[220:221], v233 offset:61440
v_mfma_f32_16x16x32_bf16 v[60:63], a[224:227], a[16:19], v[60:63]
ds_read_b64_tr_b16 a[222:223], v233 offset:63488
v_mfma_f32_16x16x32_bf16 v[64:67], a[224:227], a[20:23], v[64:67]
s_waitcnt lgkmcnt(8)
v_mfma_f32_16x16x32_bf16 v[76:79], a[228:231], a[20:23], v[76:79]
s_barrier
ds_read_b64_tr_b16 a[224:225], v232 offset:0
v_mfma_f32_16x16x32_bf16 v[72:75], a[228:231], a[16:19], v[72:75]
s_add_u32 m0, s48, 0
ds_read_b64_tr_b16 a[226:227], v232 offset:2048
s_add_u32 s49, s68, s0
v_mfma_f32_16x16x32_bf16 v[68:71], a[228:231], a[12:15], v[68:71]
s_waitcnt lgkmcnt(8)
buffer_load_dwordx4 v248, s[36:39], s49 offen lds
v_mfma_f32_16x16x32_bf16 v[56:59], a[208:211], a[24:27], v[56:59]
ds_read_b64_tr_b16 a[228:229], v233 offset:0
v_mfma_f32_16x16x32_bf16 v[60:63], a[208:211], a[28:31], v[60:63]
ds_read_b64_tr_b16 a[230:231], v233 offset:2048
v_mfma_f32_16x16x32_bf16 v[64:67], a[208:211], a[32:35], v[64:67]
s_waitcnt lgkmcnt(8)
buffer_load_dwordx4 v249, s[36:39], s49 offen offset:1024 lds
v_mfma_f32_16x16x32_bf16 v[76:79], a[212:215], a[32:35], v[76:79]
ds_read_b64_tr_b16 a[208:209], v232 offset:4096
v_mfma_f32_16x16x32_bf16 v[72:75], a[212:215], a[28:31], v[72:75]
ds_read_b64_tr_b16 a[210:211], v232 offset:6144
v_mfma_f32_16x16x32_bf16 v[68:71], a[212:215], a[24:27], v[68:71]
s_waitcnt lgkmcnt(8)
v_mfma_f32_16x16x32_bf16 v[56:59], a[216:219], a[36:39], v[56:59]
ds_read_b64_tr_b16 a[212:213], v233 offset:4096
v_mfma_f32_16x16x32_bf16 v[60:63], a[216:219], a[40:43], v[60:63]
buffer_load_dword v244, v252, s[44:47], s75 offen sc1
v_mfma_f32_16x16x32_bf16 v[64:67], a[216:219], a[44:47], v[64:67]
s_waitcnt lgkmcnt(7)
ds_read_b64_tr_b16 a[214:215], v233 offset:6144
v_mfma_f32_16x16x32_bf16 v[76:79], a[220:223], a[44:47], v[76:79]
ds_read_b64_tr_b16 a[216:217], v232 offset:8192
v_mfma_f32_16x16x32_bf16 v[72:75], a[220:223], a[40:43], v[72:75]
ds_read_b64_tr_b16 a[218:219], v232 offset:10240
v_mfma_f32_16x16x32_bf16 v[68:71], a[220:223], a[36:39], v[68:71]
s_waitcnt lgkmcnt(8)
buffer_load_dwordx4 v250, s[36:39], s49 offen offset:2048 lds
v_mfma_f32_16x16x32_bf16 v[56:59], a[224:227], a[48:51], v[56:59]
ds_read_b64_tr_b16 a[220:221], v233 offset:8192
v_mfma_f32_16x16x32_bf16 v[60:63], a[224:227], a[52:55], v[60:63]
ds_read_b64_tr_b16 a[222:223], v233 offset:10240
v_mfma_f32_16x16x32_bf16 v[64:67], a[224:227], a[56:59], v[64:67]
s_waitcnt lgkmcnt(8)
buffer_load_dwordx4 v251, s[36:39], s49 offen offset:3072 lds
v_mfma_f32_16x16x32_bf16 v[76:79], a[228:231], a[56:59], v[76:79]
ds_read_b64_tr_b16 a[224:225], v232 offset:12288
v_mfma_f32_16x16x32_bf16 v[72:75], a[228:231], a[52:55], v[72:75]
ds_read_b64_tr_b16 a[226:227], v232 offset:14336
v_mfma_f32_16x16x32_bf16 v[68:71], a[228:231], a[48:51], v[68:71]
s_waitcnt lgkmcnt(8)
v_mfma_f32_16x16x32_bf16 v[56:59], a[208:211], a[60:63], v[56:59]
ds_read_b64_tr_b16 a[228:229], v233 offset:12288
v_mfma_f32_16x16x32_bf16 v[60:63], a[208:211], a[64:67], v[60:63]
ds_read_b64_tr_b16 a[230:231], v233 offset:14336
v_mfma_f32_16x16x32_bf16 v[64:67], a[208:211], a[68:71], v[64:67]
s_waitcnt lgkmcnt(8)
v_mfma_f32_16x16x32_bf16 v[76:79], a[212:215], a[68:71], v[76:79]
s_barrier
v_add_u32 v232, 4294934528, v232
v_mfma_f32_16x16x32_bf16 v[72:75], a[212:215], a[64:67], v[72:75]
s_add_u32 m0, s48, 98304
ds_read_b64_tr_b16 a[208:209], v232 offset:0
s_add_u32 s49, s68, s0
v_mfma_f32_16x16x32_bf16 v[68:71], a[212:215], a[60:63], v[68:71]
s_waitcnt lgkmcnt(7)
ds_read_b64_tr_b16 a[210:211], v232 offset:2048
s_add_u32 s49, s49, 114688
v_mfma_f32_16x16x32_bf16 v[56:59], a[216:219], a[72:75], v[56:59]
buffer_load_dwordx4 v248, s[36:39], s49 offen lds
v_mfma_f32_16x16x32_bf16 v[60:63], a[216:219], a[76:79], v[60:63]
v_add_u32 v233, 4294934528, v233
v_mfma_f32_16x16x32_bf16 v[64:67], a[216:219], a[80:83], v[64:67]
s_waitcnt lgkmcnt(6)
ds_read_b64_tr_b16 a[212:213], v233 offset:0
v_mfma_f32_16x16x32_bf16 v[76:79], a[220:223], a[80:83], v[76:79]
ds_read_b64_tr_b16 a[214:215], v233 offset:2048
ds_read_b64_tr_b16 a[216:217], v232 offset:4096
v_mfma_f32_16x16x32_bf16 v[72:75], a[220:223], a[76:79], v[72:75]
ds_read_b64_tr_b16 a[218:219], v232 offset:6144
v_mfma_f32_16x16x32_bf16 v[68:71], a[220:223], a[72:75], v[68:71]
s_waitcnt lgkmcnt(8)
buffer_load_dwordx4 v249, s[36:39], s49 offen offset:1024 lds
v_mfma_f32_16x16x32_bf16 v[56:59], a[224:227], a[84:87], v[56:59]
ds_read_b64_tr_b16 a[220:221], v233 offset:4096
v_mfma_f32_16x16x32_bf16 v[60:63], a[224:227], a[88:91], v[60:63]
ds_read_b64_tr_b16 a[222:223], v233 offset:6144
v_mfma_f32_16x16x32_bf16 v[64:67], a[224:227], a[92:95], v[64:67]
s_waitcnt lgkmcnt(8)
v_mfma_f32_16x16x32_bf16 v[76:79], a[228:231], a[92:95], v[76:79]
ds_read_b64_tr_b16 a[224:225], v232 offset:8192
v_mfma_f32_16x16x32_bf16 v[72:75], a[228:231], a[88:91], v[72:75]
ds_read_b64_tr_b16 a[226:227], v232 offset:10240
v_mfma_f32_16x16x32_bf16 v[68:71], a[228:231], a[84:87], v[68:71]
s_waitcnt lgkmcnt(8)
buffer_load_dwordx4 v250, s[36:39], s49 offen offset:2048 lds
v_mfma_f32_16x16x32_bf16 v[80:83], a[208:211], a[0:3], 0
ds_read_b64_tr_b16 a[228:229], v233 offset:8192
v_mfma_f32_16x16x32_bf16 v[84:87], a[208:211], a[4:7], 0
s_waitcnt vmcnt(5)
v_cmp_eq_u32 vcc, 0, v244
s_cbranch_vccnz L_xp_slow
L_xp_ok:
v_mfma_f32_16x16x32_bf16 v[88:91], a[208:211], a[8:11], 0
s_waitcnt lgkmcnt(7)
ds_read_b64_tr_b16 a[230:231], v233 offset:10240
v_mfma_f32_16x16x32_bf16 v[100:103], a[212:215], a[8:11], 0
ds_read_b64_tr_b16 a[208:209], v232 offset:12288
v_mfma_f32_16x16x32_bf16 v[96:99], a[212:215], a[4:7], 0
ds_read_b64_tr_b16 a[210:211], v232 offset:14336
v_mfma_f32_16x16x32_bf16 v[92:95], a[212:215], a[0:3], 0
s_waitcnt lgkmcnt(8)
buffer_load_dwordx4 v251, s[36:39], s49 offen offset:3072 lds
v_mfma_f32_16x16x32_bf16 v[80:83], a[216:219], a[12:15], v[80:83]
s_add_u32 m0, s56, 0
ds_read_b64_tr_b16 a[212:213], v233 offset:12288
s_add_u32 s49, s74, 0
v_mfma_f32_16x16x32_bf16 v[84:87], a[216:219], a[16:19], v[84:87]
ds_read_b64_tr_b16 a[214:215], v233 offset:14336
v_mfma_f32_16x16x32_bf16 v[88:91], a[216:219], a[20:23], v[88:91]
s_waitcnt lgkmcnt(8)
buffer_load_dwordx4 v240, s[76:79], s49 offen sc1 lds
v_mfma_f32_16x16x32_bf16 v[100:103], a[220:223], a[20:23], v[100:103]
s_barrier
ds_read_b64_tr_b16 a[216:217], v232 offset:49152
v_mfma_f32_16x16x32_bf16 v[96:99], a[220:223], a[16:19], v[96:99]
ds_read_b64_tr_b16 a[218:219], v232 offset:51200
v_mfma_f32_16x16x32_bf16 v[92:95], a[220:223], a[12:15], v[92:95]
s_waitcnt lgkmcnt(8)
s_add_u32 s50, s71, 1
s_and_b32 s50, s50, 7
s_lshl_b32 s50, s50, 10
v_add_u32 v4, s50, v240
v_mfma_f32_16x16x32_bf16 v[80:83], a[224:227], a[24:27], v[80:83]
ds_read_b64_tr_b16 a[220:221], v233 offset:49152
v_mfma_f32_16x16x32_bf16 v[84:87], a[224:227], a[28:31], v[84:87]
ds_read_b64_tr_b16 a[222:223], v233 offset:51200
v_mfma_f32_16x16x32_bf16 v[88:91], a[224:227], a[32:35], v[88:91]
s_waitcnt lgkmcnt(8)
buffer_load_dwordx4 v240, s[76:79], s49 offen offset:1024 sc1 lds
v_mfma_f32_16x16x32_bf16 v[100:103], a[228:231], a[32:35], v[100:103]
ds_read_b64_tr_b16 a[224:225], v232 offset:53248
v_mfma_f32_16x16x32_bf16 v[96:99], a[228:231], a[28:31], v[96:99]
ds_read_b64_tr_b16 a[226:227], v232 offset:55296
v_mfma_f32_16x16x32_bf16 v[92:95], a[228:231], a[24:27], v[92:95]
s_waitcnt lgkmcnt(8)
buffer_load_dwordx4 v240, s[76:79], s49 offen offset:2048 sc1 lds
v_mfma_f32_16x16x32_bf16 v[80:83], a[208:211], a[36:39], v[80:83]
ds_read_b64_tr_b16 a[228:229], v233 offset:53248
v_mfma_f32_16x16x32_bf16 v[84:87], a[208:211], a[40:43], v[84:87]
ds_read_b64_tr_b16 a[230:231], v233 offset:55296
v_mfma_f32_16x16x32_bf16 v[88:91], a[208:211], a[44:47], v[88:91]
s_waitcnt lgkmcnt(8)
s_add_u32 s50, s71, 2
s_and_b32 s50, s50, 7
s_lshl_b32 s50, s50, 10
v_add_u32 v5, s50, v240
v_mfma_f32_16x16x32_bf16 v[100:103], a[212:215], a[44:47], v[100:103]
ds_read_b64_tr_b16 a[208:209], v232 offset:57344
v_mfma_f32_16x16x32_bf16 v[96:99], a[212:215], a[40:43], v[96:99]
ds_read_b64_tr_b16 a[210:211], v232 offset:59392
v_mfma_f32_16x16x32_bf16 v[92:95], a[212:215], a[36:39], v[92:95]
s_waitcnt lgkmcnt(8)
buffer_load_dwordx4 v240, s[76:79], s49 offen offset:3072 sc1 lds
v_mfma_f32_16x16x32_bf16 v[80:83], a[216:219], a[48:51], v[80:83]
s_add_u32 m0, s56, 4096
ds_read_b64_tr_b16 a[212:213], v233 offset:57344
s_add_u32 s49, s74, 4096
v_mfma_f32_16x16x32_bf16 v[84:87], a[216:219], a[52:55], v[84:87]
ds_read_b64_tr_b16 a[214:215], v233 offset:59392
v_mfma_f32_16x16x32_bf16 v[88:91], a[216:219], a[56:59], v[88:91]
s_waitcnt lgkmcnt(8)
buffer_load_dwordx4 v240, s[76:79], s49 offen sc1 lds
v_mfma_f32_16x16x32_bf16 v[100:103], a[220:223], a[56:59], v[100:103]
ds_read_b64_tr_b16 a[216:217], v232 offset:61440
v_mfma_f32_16x16x32_bf16 v[96:99], a[220:223], a[52:55], v[96:99]
ds_read_b64_tr_b16 a[218:219], v232 offset:63488
v_mfma_f32_16x16x32_bf16 v[92:95], a[220:223], a[48:51], v[92:95]
s_waitcnt lgkmcnt(8)
s_add_u32 s50, s71, 3
s_and_b32 s50, s50, 7
s_lshl_b32 s50, s50, 10
v_add_u32 v6, s50, v240
v_mfma_f32_16x16x32_bf16 v[80:83], a[224:227], a[60:63], v[80:83]
ds_read_b64_tr_b16 a[220:221], v233 offset:61440
v_mfma_f32_16x16x32_bf16 v[84:87], a[224:227], a[64:67], v[84:87]
ds_read_b64_tr_b16 a[222:223], v233 offset:63488
v_mfma_f32_16x16x32_bf16 v[88:91], a[224:227], a[68:71], v[88:91]
s_waitcnt lgkmcnt(8)
buffer_load_dwordx4 v240, s[76:79], s49 offen offset:1024 sc1 lds
v_mfma_f32_16x16x32_bf16 v[100:103], a[228:231], a[68:71], v[100:103]
s_barrier
v_add_u32 v232, 16384, v232
v_mfma_f32_16x16x32_bf16 v[96:99], a[228:231], a[64:67], v[96:99]
ds_read_b64_tr_b16 a[224:225], v232 offset:49152
v_mfma_f32_16x16x32_bf16 v[92:95], a[228:231], a[60:63], v[92:95]
s_waitcnt lgkmcnt(7)
ds_read_b64_tr_b16 a[226:227], v232 offset:51200
v_mfma_f32_16x16x32_bf16 v[80:83], a[208:211], a[72:75], v[80:83]
buffer_load_dwordx4 v240, s[76:79], s49 offen offset:2048 sc1 lds
v_mfma_f32_16x16x32_bf16 v[84:87], a[208:211], a[76:79], v[84:87]
v_add_u32 v233, 16384, v233
v_mfma_f32_16x16x32_bf16 v[88:91], a[208:211], a[80:83], v[88:91]
s_waitcnt lgkmcnt(6)
ds_read_b64_tr_b16 a[228:229], v233 offset:49152
v_mfma_f32_16x16x32_bf16 v[100:103], a[212:215], a[80:83], v[100:103]
ds_read_b64_tr_b16 a[230:231], v233 offset:51200
ds_read_b64_tr_b16 a[208:209], v232 offset:53248
v_mfma_f32_16x16x32_bf16 v[96:99], a[212:215], a[76:79], v[96:99]
ds_read_b64_tr_b16 a[210:211], v232 offset:55296
v_mfma_f32_16x16x32_bf16 v[92:95], a[212:215], a[72:75], v[92:95]
s_waitcnt lgkmcnt(8)
buffer_load_dwordx4 v240, s[76:79], s49 offen offset:3072 sc1 lds
v_mfma_f32_16x16x32_bf16 v[80:83], a[216:219], a[84:87], v[80:83]
s_add_u32 m0, s56, 8192
ds_read_b64_tr_b16 a[212:213], v233 offset:53248
s_add_u32 s49, s74, 8192
v_mfma_f32_16x16x32_bf16 v[84:87], a[216:219], a[88:91], v[84:87]
ds_read_b64_tr_b16 a[214:215], v233 offset:55296
v_mfma_f32_16x16x32_bf16 v[88:91], a[216:219], a[92:95], v[88:91]
s_waitcnt lgkmcnt(8)
s_add_u32 s50, s71, 4
s_and_b32 s50, s50, 7
s_lshl_b32 s50, s50, 10
v_add_u32 v7, s50, v240
v_mfma_f32_16x16x32_bf16 v[100:103], a[220:223], a[92:95], v[100:103]
ds_read_b64_tr_b16 a[216:217], v232 offset:57344
v_mfma_f32_16x16x32_bf16 v[96:99], a[220:223], a[88:91], v[96:99]
ds_read_b64_tr_b16 a[218:219], v232 offset:59392
v_mfma_f32_16x16x32_bf16 v[92:95], a[220:223], a[84:87], v[92:95]
s_waitcnt lgkmcnt(8)
buffer_load_dwordx4 v240, s[76:79], s49 offen sc1 lds
v_mfma_f32_16x16x32_bf16 v[104:107], a[224:227], a[0:3], 0
ds_read_b64_tr_b16 a[220:221], v233 offset:57344
v_mfma_f32_16x16x32_bf16 v[108:111], a[224:227], a[4:7], 0
ds_read_b64_tr_b16 a[222:223], v233 offset:59392
v_mfma_f32_16x16x32_bf16 v[112:115], a[224:227], a[8:11], 0
s_waitcnt lgkmcnt(8)
buffer_load_dwordx4 v240, s[76:79], s49 offen offset:1024 sc1 lds
v_mfma_f32_16x16x32_bf16 v[124:127], a[228:231], a[8:11], 0
ds_read_b64_tr_b16 a[224:225], v232 offset:61440
v_mfma_f32_16x16x32_bf16 v[120:123], a[228:231], a[4:7], 0
ds_read_b64_tr_b16 a[226:227], v232 offset:63488
v_mfma_f32_16x16x32_bf16 v[116:119], a[228:231], a[0:3], 0
s_waitcnt lgkmcnt(8)
s_add_u32 s50, s71, 5
s_and_b32 s50, s50, 7
s_lshl_b32 s50, s50, 10
v_add_u32 v8, s50, v240
v_mfma_f32_16x16x32_bf16 v[104:107], a[208:211], a[12:15], v[104:107]
ds_read_b64_tr_b16 a[228:229], v233 offset:61440
v_mfma_f32_16x16x32_bf16 v[108:111], a[208:211], a[16:19], v[108:111]
ds_read_b64_tr_b16 a[230:231], v233 offset:63488
v_mfma_f32_16x16x32_bf16 v[112:115], a[208:211], a[20:23], v[112:115]
s_waitcnt lgkmcnt(8)
buffer_load_dwordx4 v240, s[76:79], s49 offen offset:2048 sc1 lds
v_mfma_f32_16x16x32_bf16 v[124:127], a[212:215], a[20:23], v[124:127]
s_barrier
ds_read_b64_tr_b16 a[208:209], v232 offset:0
v_mfma_f32_16x16x32_bf16 v[120:123], a[212:215], a[16:19], v[120:123]
ds_read_b64_tr_b16 a[210:211], v232 offset:2048
v_mfma_f32_16x16x32_bf16 v[116:119], a[212:215], a[12:15], v[116:119]
s_waitcnt lgkmcnt(8)
buffer_load_dwordx4 v240, s[76:79], s49 offen offset:3072 sc1 lds
v_mfma_f32_16x16x32_bf16 v[104:107], a[216:219], a[24:27], v[104:107]
s_add_u32 m0, s48, 49152
ds_read_b64_tr_b16 a[212:213], v233 offset:0
s_add_u32 s49, s69, s0
v_mfma_f32_16x16x32_bf16 v[108:111], a[216:219], a[28:31], v[108:111]
ds_read_b64_tr_b16 a[214:215], v233 offset:2048
v_mfma_f32_16x16x32_bf16 v[112:115], a[216:219], a[32:35], v[112:115]
s_waitcnt lgkmcnt(8)
s_add_u32 s50, s71, 6
s_and_b32 s50, s50, 7
s_lshl_b32 s50, s50, 10
v_add_u32 v9, s50, v240
v_mfma_f32_16x16x32_bf16 v[124:127], a[220:223], a[32:35], v[124:127]
ds_read_b64_tr_b16 a[216:217], v232 offset:4096
v_mfma_f32_16x16x32_bf16 v[120:123], a[220:223], a[28:31], v[120:123]
ds_read_b64_tr_b16 a[218:219], v232 offset:6144
v_mfma_f32_16x16x32_bf16 v[116:119], a[220:223], a[24:27], v[116:119]
s_waitcnt lgkmcnt(8)
buffer_load_dwordx4 v248, s[36:39], s49 offen lds
v_mfma_f32_16x16x32_bf16 v[104:107], a[224:227], a[36:39], v[104:107]
ds_read_b64_tr_b16 a[220:221], v233 offset:4096
v_mfma_f32_16x16x32_bf16 v[108:111], a[224:227], a[40:43], v[108:111]
ds_read_b64_tr_b16 a[222:223], v233 offset:6144
v_mfma_f32_16x16x32_bf16 v[112:115], a[224:227], a[44:47], v[112:115]
s_waitcnt lgkmcnt(8)
buffer_load_dwordx4 v249, s[36:39], s49 offen offset:1024 lds
v_mfma_f32_16x16x32_bf16 v[124:127], a[228:231], a[44:47], v[124:127]
ds_read_b64_tr_b16 a[224:225], v232 offset:8192
v_mfma_f32_16x16x32_bf16 v[120:123], a[228:231], a[40:43], v[120:123]
ds_read_b64_tr_b16 a[226:227], v232 offset:10240
v_mfma_f32_16x16x32_bf16 v[116:119], a[228:231], a[36:39], v[116:119]
s_waitcnt lgkmcnt(8)
s_add_u32 s50, s71, 7
s_and_b32 s50, s50, 7
s_lshl_b32 s50, s50, 10
v_add_u32 v10, s50, v240
v_mfma_f32_16x16x32_bf16 v[104:107], a[208:211], a[48:51], v[104:107]
ds_read_b64_tr_b16 a[228:229], v233 offset:8192
v_mfma_f32_16x16x32_bf16 v[108:111], a[208:211], a[52:55], v[108:111]
ds_read_b64_tr_b16 a[230:231], v233 offset:10240
v_mfma_f32_16x16x32_bf16 v[112:115], a[208:211], a[56:59], v[112:115]
s_waitcnt lgkmcnt(8)
buffer_load_dwordx4 v250, s[36:39], s49 offen offset:2048 lds
v_mfma_f32_16x16x32_bf16 v[124:127], a[212:215], a[56:59], v[124:127]
ds_read_b64_tr_b16 a[208:209], v232 offset:12288
v_mfma_f32_16x16x32_bf16 v[120:123], a[212:215], a[52:55], v[120:123]
ds_read_b64_tr_b16 a[210:211], v232 offset:14336
v_mfma_f32_16x16x32_bf16 v[116:119], a[212:215], a[48:51], v[116:119]
s_waitcnt lgkmcnt(8)
buffer_load_dwordx4 v251, s[36:39], s49 offen offset:3072 lds
v_mfma_f32_16x16x32_bf16 v[104:107], a[216:219], a[60:63], v[104:107]
s_add_u32 m0, s48, 16384
ds_read_b64_tr_b16 a[212:213], v233 offset:12288
s_add_u32 s49, s69, s0
v_mfma_f32_16x16x32_bf16 v[108:111], a[216:219], a[64:67], v[108:111]
s_add_u32 s49, s49, 114688
ds_read_b64_tr_b16 a[214:215], v233 offset:14336
v_mfma_f32_16x16x32_bf16 v[112:115], a[216:219], a[68:71], v[112:115]
s_waitcnt lgkmcnt(8)
v_mfma_f32_16x16x32_bf16 v[124:127], a[220:223], a[68:71], v[124:127]
s_waitcnt vmcnt(20)
s_barrier
v_add_u32 v232, 4294934528, v232
v_mfma_f32_16x16x32_bf16 v[120:123], a[220:223], a[64:67], v[120:123]
ds_read_b64_tr_b16 a[216:217], v232 offset:0
v_mfma_f32_16x16x32_bf16 v[116:119], a[220:223], a[60:63], v[116:119]
s_waitcnt lgkmcnt(7)
ds_read_b64_tr_b16 a[218:219], v232 offset:2048
v_mfma_f32_16x16x32_bf16 v[104:107], a[224:227], a[72:75], v[104:107]
buffer_load_dwordx4 v248, s[36:39], s49 offen lds
v_mfma_f32_16x16x32_bf16 v[108:111], a[224:227], a[76:79], v[108:111]
v_add_u32 v233, 4294934528, v233
v_mfma_f32_16x16x32_bf16 v[112:115], a[224:227], a[80:83], v[112:115]
s_waitcnt lgkmcnt(6)
ds_read_b64_tr_b16 a[220:221], v233 offset:0
v_mfma_f32_16x16x32_bf16 v[124:127], a[228:231], a[80:83], v[124:127]
ds_read_b64_tr_b16 a[222:223], v233 offset:2048
ds_read_b64_tr_b16 a[224:225], v232 offset:4096
v_mfma_f32_16x16x32_bf16 v[120:123], a[228:231], a[76:79], v[120:123]
ds_read_b64_tr_b16 a[226:227], v232 offset:6144
v_mfma_f32_16x16x32_bf16 v[116:119], a[228:231], a[72:75], v[116:119]
s_waitcnt lgkmcnt(8)
buffer_load_dwordx4 v249, s[36:39], s49 offen offset:1024 lds
v_mfma_f32_16x16x32_bf16 v[104:107], a[208:211], a[84:87], v[104:107]
ds_read_b64_tr_b16 a[228:229], v233 offset:4096
v_mfma_f32_16x16x32_bf16 v[108:111], a[208:211], a[88:91], v[108:111]
ds_read_b64_tr_b16 a[230:231], v233 offset:6144
v_mfma_f32_16x16x32_bf16 v[112:115], a[208:211], a[92:95], v[112:115]
s_waitcnt lgkmcnt(8)
v_mfma_f32_16x16x32_bf16 v[124:127], a[212:215], a[92:95], v[124:127]
ds_read_b64_tr_b16 a[208:209], v232 offset:8192
v_mfma_f32_16x16x32_bf16 v[120:123], a[212:215], a[88:91], v[120:123]
ds_read_b64_tr_b16 a[210:211], v232 offset:10240
v_mfma_f32_16x16x32_bf16 v[116:119], a[212:215], a[84:87], v[116:119]
s_waitcnt lgkmcnt(8)
buffer_load_dwordx4 v250, s[36:39], s49 offen offset:2048 lds
v_mfma_f32_16x16x32_bf16 v[128:131], a[216:219], a[0:3], 0
ds_read_b64_tr_b16 a[212:213], v233 offset:8192
v_mfma_f32_16x16x32_bf16 v[132:135], a[216:219], a[4:7], 0
ds_read_b64_tr_b16 a[214:215], v233 offset:10240
v_mfma_f32_16x16x32_bf16 v[136:139], a[216:219], a[8:11], 0
s_waitcnt lgkmcnt(8)
buffer_load_dwordx4 v251, s[36:39], s49 offen offset:3072 lds
v_mfma_f32_16x16x32_bf16 v[148:151], a[220:223], a[8:11], 0
s_add_u32 m0, s48, 65536
ds_read_b64_tr_b16 a[216:217], v232 offset:12288
s_add_u32 s49, s70, s0
v_mfma_f32_16x16x32_bf16 v[144:147], a[220:223], a[4:7], 0
ds_read_b64_tr_b16 a[218:219], v232 offset:14336
v_mfma_f32_16x16x32_bf16 v[140:143], a[220:223], a[0:3], 0
s_waitcnt lgkmcnt(8)
v_mfma_f32_16x16x32_bf16 v[128:131], a[224:227], a[12:15], v[128:131]
ds_read_b64_tr_b16 a[220:221], v233 offset:12288
v_mfma_f32_16x16x32_bf16 v[132:135], a[224:227], a[16:19], v[132:135]
ds_read_b64_tr_b16 a[222:223], v233 offset:14336
v_mfma_f32_16x16x32_bf16 v[136:139], a[224:227], a[20:23], v[136:139]
s_waitcnt lgkmcnt(8)
buffer_load_dwordx4 v248, s[36:39], s49 offen lds
v_mfma_f32_16x16x32_bf16 v[148:151], a[228:231], a[20:23], v[148:151]
s_waitcnt vmcnt(21)
s_barrier
v_add_u32 v232, 49152, v232
v_mfma_f32_16x16x32_bf16 v[144:147], a[228:231], a[16:19], v[144:147]
ds_read_b64_tr_b16 a[224:225], v232 offset:49152
v_mfma_f32_16x16x32_bf16 v[140:143], a[228:231], a[12:15], v[140:143]
s_waitcnt lgkmcnt(7)
ds_read_b64_tr_b16 a[226:227], v232 offset:51200
v_mfma_f32_16x16x32_bf16 v[128:131], a[208:211], a[24:27], v[128:131]
buffer_load_dwordx4 v249, s[36:39], s49 offen offset:1024 lds
v_mfma_f32_16x16x32_bf16 v[132:135], a[208:211], a[28:31], v[132:135]
v_add_u32 v233, 49152, v233
v_mfma_f32_16x16x32_bf16 v[136:139], a[208:211], a[32:35], v[136:139]
s_waitcnt lgkmcnt(6)
ds_read_b64_tr_b16 a[228:229], v233 offset:49152
v_mfma_f32_16x16x32_bf16 v[148:151], a[212:215], a[32:35], v[148:151]
ds_read_b64_tr_b16 a[230:231], v233 offset:51200
ds_read_b64_tr_b16 a[208:209], v232 offset:53248
v_mfma_f32_16x16x32_bf16 v[144:147], a[212:215], a[28:31], v[144:147]
ds_read_b64_tr_b16 a[210:211], v232 offset:55296
v_mfma_f32_16x16x32_bf16 v[140:143], a[212:215], a[24:27], v[140:143]
s_waitcnt lgkmcnt(8)
buffer_load_dwordx4 v250, s[36:39], s49 offen offset:2048 lds
v_mfma_f32_16x16x32_bf16 v[128:131], a[216:219], a[36:39], v[128:131]
ds_read_b64_tr_b16 a[212:213], v233 offset:53248
v_mfma_f32_16x16x32_bf16 v[132:135], a[216:219], a[40:43], v[132:135]
ds_read_b64_tr_b16 a[214:215], v233 offset:55296
v_mfma_f32_16x16x32_bf16 v[136:139], a[216:219], a[44:47], v[136:139]
s_waitcnt lgkmcnt(8)
v_mfma_f32_16x16x32_bf16 v[148:151], a[220:223], a[44:47], v[148:151]
ds_read_b64_tr_b16 a[216:217], v232 offset:57344
v_mfma_f32_16x16x32_bf16 v[144:147], a[220:223], a[40:43], v[144:147]
ds_read_b64_tr_b16 a[218:219], v232 offset:59392
v_mfma_f32_16x16x32_bf16 v[140:143], a[220:223], a[36:39], v[140:143]
s_waitcnt lgkmcnt(8)
buffer_load_dwordx4 v251, s[36:39], s49 offen offset:3072 lds
v_mfma_f32_16x16x32_bf16 v[128:131], a[224:227], a[48:51], v[128:131]
s_add_u32 m0, s48, 81920
ds_read_b64_tr_b16 a[220:221], v233 offset:57344
s_add_u32 s49, s70, s0
v_mfma_f32_16x16x32_bf16 v[132:135], a[224:227], a[52:55], v[132:135]
s_add_u32 s49, s49, 114688
ds_read_b64_tr_b16 a[222:223], v233 offset:59392
v_mfma_f32_16x16x32_bf16 v[136:139], a[224:227], a[56:59], v[136:139]
s_waitcnt lgkmcnt(8)
buffer_load_dwordx4 v248, s[36:39], s49 offen lds
v_mfma_f32_16x16x32_bf16 v[148:151], a[228:231], a[56:59], v[148:151]
ds_read_b64_tr_b16 a[224:225], v232 offset:61440
v_mfma_f32_16x16x32_bf16 v[144:147], a[228:231], a[52:55], v[144:147]
ds_read_b64_tr_b16 a[226:227], v232 offset:63488
v_mfma_f32_16x16x32_bf16 v[140:143], a[228:231], a[48:51], v[140:143]
s_waitcnt lgkmcnt(8)
v_mfma_f32_16x16x32_bf16 v[128:131], a[208:211], a[60:63], v[128:131]
ds_read_b64_tr_b16 a[228:229], v233 offset:61440
v_mfma_f32_16x16x32_bf16 v[132:135], a[208:211], a[64:67], v[132:135]
ds_read_b64_tr_b16 a[230:231], v233 offset:63488
v_mfma_f32_16x16x32_bf16 v[136:139], a[208:211], a[68:71], v[136:139]
s_waitcnt lgkmcnt(8)
buffer_load_dwordx4 v249, s[36:39], s49 offen offset:1024 lds
v_mfma_f32_16x16x32_bf16 v[148:151], a[212:215], a[68:71], v[148:151]
s_waitcnt vmcnt(10)
s_barrier
ds_read_b64_tr_b16 a[208:209], v232 offset:0
v_mfma_f32_16x16x32_bf16 v[144:147], a[212:215], a[64:67], v[144:147]
ds_read_b64_tr_b16 a[210:211], v232 offset:2048
v_mfma_f32_16x16x32_bf16 v[140:143], a[212:215], a[60:63], v[140:143]
s_waitcnt lgkmcnt(8)
buffer_load_dwordx4 v250, s[36:39], s49 offen offset:2048 lds
v_mfma_f32_16x16x32_bf16 v[128:131], a[216:219], a[72:75], v[128:131]
ds_read_b64_tr_b16 a[212:213], v233 offset:0
v_mfma_f32_16x16x32_bf16 v[132:135], a[216:219], a[76:79], v[132:135]
ds_read_b64_tr_b16 a[214:215], v233 offset:2048
v_mfma_f32_16x16x32_bf16 v[136:139], a[216:219], a[80:83], v[136:139]
s_waitcnt lgkmcnt(8)
v_mfma_f32_16x16x32_bf16 v[148:151], a[220:223], a[80:83], v[148:151]
ds_read_b64_tr_b16 a[216:217], v232 offset:4096
v_mfma_f32_16x16x32_bf16 v[144:147], a[220:223], a[76:79], v[144:147]
ds_read_b64_tr_b16 a[218:219], v232 offset:6144
v_mfma_f32_16x16x32_bf16 v[140:143], a[220:223], a[72:75], v[140:143]
s_waitcnt lgkmcnt(8)
buffer_load_dwordx4 v251, s[36:39], s49 offen offset:3072 lds
v_mfma_f32_16x16x32_bf16 v[128:131], a[224:227], a[84:87], v[128:131]
s_add_u32 m0, s48, 32768
ds_read_b64_tr_b16 a[220:221], v233 offset:4096
s_add_u32 s49, s64, s1
v_mfma_f32_16x16x32_bf16 v[132:135], a[224:227], a[88:91], v[132:135]
ds_read_b64_tr_b16 a[222:223], v233 offset:6144
v_mfma_f32_16x16x32_bf16 v[136:139], a[224:227], a[92:95], v[136:139]
s_waitcnt lgkmcnt(8)
buffer_load_dwordx4 v248, s[36:39], s49 offen lds
v_mfma_f32_16x16x32_bf16 v[148:151], a[228:231], a[92:95], v[148:151]
ds_read_b64_tr_b16 a[224:225], v232 offset:8192
v_mfma_f32_16x16x32_bf16 v[144:147], a[228:231], a[88:91], v[144:147]
ds_read_b64_tr_b16 a[226:227], v232 offset:10240
v_mfma_f32_16x16x32_bf16 v[140:143], a[228:231], a[84:87], v[140:143]
s_waitcnt lgkmcnt(8)
v_mfma_f32_16x16x32_bf16 v[152:155], a[208:211], a[0:3], 0
ds_read_b64_tr_b16 a[228:229], v233 offset:8192
v_mfma_f32_16x16x32_bf16 v[156:159], a[208:211], a[4:7], 0
ds_read_b64_tr_b16 a[230:231], v233 offset:10240
v_mfma_f32_16x16x32_bf16 v[160:163], a[208:211], a[8:11], 0
s_waitcnt lgkmcnt(8)
buffer_load_dwordx4 v249, s[36:39], s49 offen offset:1024 lds
v_mfma_f32_16x16x32_bf16 v[172:175], a[212:215], a[8:11], 0
ds_read_b64_tr_b16 a[208:209], v232 offset:12288
v_mfma_f32_16x16x32_bf16 v[168:171], a[212:215], a[4:7], 0
ds_read_b64_tr_b16 a[210:211], v232 offset:14336
v_mfma_f32_16x16x32_bf16 v[164:167], a[212:215], a[0:3], 0
s_waitcnt lgkmcnt(8)
buffer_load_dwordx4 v250, s[36:39], s49 offen offset:2048 lds
v_mfma_f32_16x16x32_bf16 v[152:155], a[216:219], a[12:15], v[152:155]
ds_read_b64_tr_b16 a[212:213], v233 offset:12288
v_mfma_f32_16x16x32_bf16 v[156:159], a[216:219], a[16:19], v[156:159]
ds_read_b64_tr_b16 a[214:215], v233 offset:14336
v_mfma_f32_16x16x32_bf16 v[160:163], a[216:219], a[20:23], v[160:163]
s_waitcnt lgkmcnt(8)
v_mfma_f32_16x16x32_bf16 v[172:175], a[220:223], a[20:23], v[172:175]
s_waitcnt vmcnt(11)
s_barrier
v_add_u32 v232, 4294934528, v232
v_mfma_f32_16x16x32_bf16 v[168:171], a[220:223], a[16:19], v[168:171]
ds_read_b64_tr_b16 a[216:217], v232 offset:0
v_mfma_f32_16x16x32_bf16 v[164:167], a[220:223], a[12:15], v[164:167]
s_waitcnt lgkmcnt(7)
ds_read_b64_tr_b16 a[218:219], v232 offset:2048
v_mfma_f32_16x16x32_bf16 v[152:155], a[224:227], a[24:27], v[152:155]
buffer_load_dwordx4 v251, s[36:39], s49 offen offset:3072 lds
v_mfma_f32_16x16x32_bf16 v[156:159], a[224:227], a[28:31], v[156:159]
s_add_u32 m0, s48, 0
v_add_u32 v233, 4294934528, v233
s_add_u32 s49, s64, s1
v_mfma_f32_16x16x32_bf16 v[160:163], a[224:227], a[32:35], v[160:163]
s_waitcnt lgkmcnt(6)
ds_read_b64_tr_b16 a[220:221], v233 offset:0
s_add_u32 s49, s49, 114688
v_mfma_f32_16x16x32_bf16 v[172:175], a[228:231], a[32:35], v[172:175]
ds_read_b64_tr_b16 a[222:223], v233 offset:2048
ds_read_b64_tr_b16 a[224:225], v232 offset:4096
v_mfma_f32_16x16x32_bf16 v[168:171], a[228:231], a[28:31], v[168:171]
ds_read_b64_tr_b16 a[226:227], v232 offset:6144
v_mfma_f32_16x16x32_bf16 v[164:167], a[228:231], a[24:27], v[164:167]
s_waitcnt lgkmcnt(8)
buffer_load_dwordx4 v248, s[36:39], s49 offen lds
v_mfma_f32_16x16x32_bf16 v[152:155], a[208:211], a[36:39], v[152:155]
ds_read_b64_tr_b16 a[228:229], v233 offset:4096
v_mfma_f32_16x16x32_bf16 v[156:159], a[208:211], a[40:43], v[156:159]
ds_read_b64_tr_b16 a[230:231], v233 offset:6144
v_mfma_f32_16x16x32_bf16 v[160:163], a[208:211], a[44:47], v[160:163]
s_waitcnt lgkmcnt(8)
v_mfma_f32_16x16x32_bf16 v[172:175], a[212:215], a[44:47], v[172:175]
ds_read_b64_tr_b16 a[208:209], v232 offset:8192
v_mfma_f32_16x16x32_bf16 v[168:171], a[212:215], a[40:43], v[168:171]
ds_read_b64_tr_b16 a[210:211], v232 offset:10240
v_mfma_f32_16x16x32_bf16 v[164:167], a[212:215], a[36:39], v[164:167]
s_waitcnt lgkmcnt(8)
buffer_load_dwordx4 v249, s[36:39], s49 offen offset:1024 lds
v_mfma_f32_16x16x32_bf16 v[152:155], a[216:219], a[48:51], v[152:155]
ds_read_b64_tr_b16 a[212:213], v233 offset:8192
v_mfma_f32_16x16x32_bf16 v[156:159], a[216:219], a[52:55], v[156:159]
ds_read_b64_tr_b16 a[214:215], v233 offset:10240
v_mfma_f32_16x16x32_bf16 v[160:163], a[216:219], a[56:59], v[160:163]
s_waitcnt lgkmcnt(8)
buffer_load_dwordx4 v250, s[36:39], s49 offen offset:2048 lds
v_mfma_f32_16x16x32_bf16 v[172:175], a[220:223], a[56:59], v[172:175]
ds_read_b64_tr_b16 a[216:217], v232 offset:12288
v_mfma_f32_16x16x32_bf16 v[168:171], a[220:223], a[52:55], v[168:171]
ds_read_b64_tr_b16 a[218:219], v232 offset:14336
v_mfma_f32_16x16x32_bf16 v[164:167], a[220:223], a[48:51], v[164:167]
s_waitcnt lgkmcnt(8)
v_mfma_f32_16x16x32_bf16 v[152:155], a[224:227], a[60:63], v[152:155]
ds_read_b64_tr_b16 a[220:221], v233 offset:12288
v_mfma_f32_16x16x32_bf16 v[156:159], a[224:227], a[64:67], v[156:159]
ds_read_b64_tr_b16 a[222:223], v233 offset:14336
v_mfma_f32_16x16x32_bf16 v[160:163], a[224:227], a[68:71], v[160:163]
s_waitcnt lgkmcnt(8)
buffer_load_dwordx4 v251, s[36:39], s49 offen offset:3072 lds
v_mfma_f32_16x16x32_bf16 v[172:175], a[228:231], a[68:71], v[172:175]
s_waitcnt vmcnt(12)
s_barrier
ds_read_b64_tr_b16 a[224:225], v232 offset:49152
v_mfma_f32_16x16x32_bf16 v[168:171], a[228:231], a[64:67], v[168:171]
s_add_u32 m0, s48, 98304
ds_read_b64_tr_b16 a[226:227], v232 offset:51200
s_add_u32 s49, s65, s1
v_mfma_f32_16x16x32_bf16 v[164:167], a[228:231], a[60:63], v[164:167]
s_waitcnt lgkmcnt(8)
buffer_load_dwordx4 v248, s[36:39], s49 offen lds
v_mfma_f32_16x16x32_bf16 v[152:155], a[208:211], a[72:75], v[152:155]
ds_read_b64_tr_b16 a[228:229], v233 offset:49152
v_mfma_f32_16x16x32_bf16 v[156:159], a[208:211], a[76:79], v[156:159]
ds_read_b64_tr_b16 a[230:231], v233 offset:51200
v_mfma_f32_16x16x32_bf16 v[160:163], a[208:211], a[80:83], v[160:163]
s_waitcnt lgkmcnt(8)
v_mfma_f32_16x16x32_bf16 v[172:175], a[212:215], a[80:83], v[172:175]
ds_read_b64_tr_b16 a[208:209], v232 offset:53248
v_mfma_f32_16x16x32_bf16 v[168:171], a[212:215], a[76:79], v[168:171]
ds_read_b64_tr_b16 a[210:211], v232 offset:55296
v_mfma_f32_16x16x32_bf16 v[164:167], a[212:215], a[72:75], v[164:167]
s_waitcnt lgkmcnt(8)
buffer_load_dwordx4 v249, s[36:39], s49 offen offset:1024 lds
v_mfma_f32_16x16x32_bf16 v[152:155], a[216:219], a[84:87], v[152:155]
ds_read_b64_tr_b16 a[212:213], v233 offset:53248
v_mfma_f32_16x16x32_bf16 v[156:159], a[216:219], a[88:91], v[156:159]
ds_read_b64_tr_b16 a[214:215], v233 offset:55296
v_mfma_f32_16x16x32_bf16 v[160:163], a[216:219], a[92:95], v[160:163]
s_waitcnt lgkmcnt(8)
buffer_load_dwordx4 v250, s[36:39], s49 offen offset:2048 lds
v_mfma_f32_16x16x32_bf16 v[172:175], a[220:223], a[92:95], v[172:175]
ds_read_b64_tr_b16 a[216:217], v232 offset:57344
v_mfma_f32_16x16x32_bf16 v[168:171], a[220:223], a[88:91], v[168:171]
ds_read_b64_tr_b16 a[218:219], v232 offset:59392
v_mfma_f32_16x16x32_bf16 v[164:167], a[220:223], a[84:87], v[164:167]
s_waitcnt lgkmcnt(8)
v_mfma_f32_16x16x32_bf16 v[176:179], a[224:227], a[0:3], 0
ds_read_b64_tr_b16 a[220:221], v233 offset:57344
v_mfma_f32_16x16x32_bf16 v[180:183], a[224:227], a[4:7], 0
ds_read_b64_tr_b16 a[222:223], v233 offset:59392
v_mfma_f32_16x16x32_bf16 v[184:187], a[224:227], a[8:11], 0
s_waitcnt lgkmcnt(8)
buffer_load_dwordx4 v251, s[36:39], s49 offen offset:3072 lds
v_mfma_f32_16x16x32_bf16 v[196:199], a[228:231], a[8:11], 0
s_add_u32 m0, s48, 49152
ds_read_b64_tr_b16 a[224:225], v232 offset:61440
s_add_u32 s49, s65, s1
v_mfma_f32_16x16x32_bf16 v[192:195], a[228:231], a[4:7], 0
s_add_u32 s49, s49, 114688
ds_read_b64_tr_b16 a[226:227], v232 offset:63488
v_mfma_f32_16x16x32_bf16 v[188:191], a[228:231], a[0:3], 0
s_waitcnt lgkmcnt(8)
buffer_load_dwordx4 v248, s[36:39], s49 offen lds
v_mfma_f32_16x16x32_bf16 v[176:179], a[208:211], a[12:15], v[176:179]
ds_read_b64_tr_b16 a[228:229], v233 offset:61440
v_mfma_f32_16x16x32_bf16 v[180:183], a[208:211], a[16:19], v[180:183]
ds_read_b64_tr_b16 a[230:231], v233 offset:63488
v_mfma_f32_16x16x32_bf16 v[184:187], a[208:211], a[20:23], v[184:187]
s_waitcnt lgkmcnt(8)
v_mfma_f32_16x16x32_bf16 v[196:199], a[212:215], a[20:23], v[196:199]
s_waitcnt vmcnt(13)
s_barrier
v_add_u32 v232, 16384, v232
v_mfma_f32_16x16x32_bf16 v[192:195], a[212:215], a[16:19], v[192:195]
ds_read_b64_tr_b16 a[208:209], v232 offset:49152
v_mfma_f32_16x16x32_bf16 v[188:191], a[212:215], a[12:15], v[188:191]
s_waitcnt lgkmcnt(7)
ds_read_b64_tr_b16 a[210:211], v232 offset:51200
v_mfma_f32_16x16x32_bf16 v[176:179], a[216:219], a[24:27], v[176:179]
buffer_load_dwordx4 v249, s[36:39], s49 offen offset:1024 lds
v_mfma_f32_16x16x32_bf16 v[180:183], a[216:219], a[28:31], v[180:183]
v_add_u32 v233, 16384, v233
v_mfma_f32_16x16x32_bf16 v[184:187], a[216:219], a[32:35], v[184:187]
s_waitcnt lgkmcnt(6)
ds_read_b64_tr_b16 a[212:213], v233 offset:49152
v_mfma_f32_16x16x32_bf16 v[196:199], a[220:223], a[32:35], v[196:199]
ds_read_b64_tr_b16 a[214:215], v233 offset:51200
ds_read_b64_tr_b16 a[216:217], v232 offset:53248
v_mfma_f32_16x16x32_bf16 v[192:195], a[220:223], a[28:31], v[192:195]
ds_read_b64_tr_b16 a[218:219], v232 offset:55296
v_mfma_f32_16x16x32_bf16 v[188:191], a[220:223], a[24:27], v[188:191]
s_waitcnt lgkmcnt(8)
buffer_load_dwordx4 v250, s[36:39], s49 offen offset:2048 lds
v_mfma_f32_16x16x32_bf16 v[176:179], a[224:227], a[36:39], v[176:179]
ds_read_b64_tr_b16 a[220:221], v233 offset:53248
v_mfma_f32_16x16x32_bf16 v[180:183], a[224:227], a[40:43], v[180:183]
ds_read_b64_tr_b16 a[222:223], v233 offset:55296
v_mfma_f32_16x16x32_bf16 v[184:187], a[224:227], a[44:47], v[184:187]
s_waitcnt lgkmcnt(8)
v_mfma_f32_16x16x32_bf16 v[196:199], a[228:231], a[44:47], v[196:199]
ds_read_b64_tr_b16 a[224:225], v232 offset:57344
v_mfma_f32_16x16x32_bf16 v[192:195], a[228:231], a[40:43], v[192:195]
ds_read_b64_tr_b16 a[226:227], v232 offset:59392
v_mfma_f32_16x16x32_bf16 v[188:191], a[228:231], a[36:39], v[188:191]
s_waitcnt lgkmcnt(8)
buffer_load_dwordx4 v251, s[36:39], s49 offen offset:3072 lds
v_mfma_f32_16x16x32_bf16 v[176:179], a[208:211], a[48:51], v[176:179]
s_add_u32 m0, s48, 16384
ds_read_b64_tr_b16 a[228:229], v233 offset:57344
s_add_u32 s49, s66, s1
v_mfma_f32_16x16x32_bf16 v[180:183], a[208:211], a[52:55], v[180:183]
ds_read_b64_tr_b16 a[230:231], v233 offset:59392
v_mfma_f32_16x16x32_bf16 v[184:187], a[208:211], a[56:59], v[184:187]
s_waitcnt lgkmcnt(8)
buffer_load_dwordx4 v248, s[36:39], s49 offen lds
v_mfma_f32_16x16x32_bf16 v[196:199], a[212:215], a[56:59], v[196:199]
ds_read_b64_tr_b16 a[208:209], v232 offset:61440
v_mfma_f32_16x16x32_bf16 v[192:195], a[212:215], a[52:55], v[192:195]
ds_read_b64_tr_b16 a[210:211], v232 offset:63488
v_mfma_f32_16x16x32_bf16 v[188:191], a[212:215], a[48:51], v[188:191]
s_waitcnt lgkmcnt(8)
v_mfma_f32_16x16x32_bf16 v[176:179], a[216:219], a[60:63], v[176:179]
ds_read_b64_tr_b16 a[212:213], v233 offset:61440
v_mfma_f32_16x16x32_bf16 v[180:183], a[216:219], a[64:67], v[180:183]
ds_read_b64_tr_b16 a[214:215], v233 offset:63488
v_mfma_f32_16x16x32_bf16 v[184:187], a[216:219], a[68:71], v[184:187]
s_waitcnt lgkmcnt(8)
buffer_load_dwordx4 v249, s[36:39], s49 offen offset:1024 lds
v_mfma_f32_16x16x32_bf16 v[196:199], a[220:223], a[68:71], v[196:199]
s_waitcnt vmcnt(14)
s_barrier
ds_read_b64_tr_b16 a[216:217], v232 offset:0
v_mfma_f32_16x16x32_bf16 v[192:195], a[220:223], a[64:67], v[192:195]
ds_read_b64_tr_b16 a[218:219], v232 offset:2048
v_mfma_f32_16x16x32_bf16 v[188:191], a[220:223], a[60:63], v[188:191]
s_waitcnt lgkmcnt(8)
buffer_load_dwordx4 v250, s[36:39], s49 offen offset:2048 lds
v_mfma_f32_16x16x32_bf16 v[176:179], a[224:227], a[72:75], v[176:179]
ds_read_b64_tr_b16 a[220:221], v233 offset:0
v_mfma_f32_16x16x32_bf16 v[180:183], a[224:227], a[76:79], v[180:183]
ds_read_b64_tr_b16 a[222:223], v233 offset:2048
v_mfma_f32_16x16x32_bf16 v[184:187], a[224:227], a[80:83], v[184:187]
s_waitcnt lgkmcnt(8)
ds_read_b128 a[96:99], v31 offset:0
v_mfma_f32_16x16x32_bf16 v[196:199], a[228:231], a[80:83], v[196:199]
ds_read_b64_tr_b16 a[224:225], v232 offset:4096
v_mfma_f32_16x16x32_bf16 v[192:195], a[228:231], a[76:79], v[192:195]
ds_read_b64_tr_b16 a[226:227], v232 offset:6144
v_mfma_f32_16x16x32_bf16 v[188:191], a[228:231], a[72:75], v[188:191]
s_waitcnt lgkmcnt(9)
buffer_load_dwordx4 v251, s[36:39], s49 offen offset:3072 lds
v_mfma_f32_16x16x32_bf16 v[176:179], a[208:211], a[84:87], v[176:179]
s_add_u32 m0, s48, 65536
ds_read_b64_tr_b16 a[228:229], v233 offset:4096
s_add_u32 s49, s66, s1
v_mfma_f32_16x16x32_bf16 v[180:183], a[208:211], a[88:91], v[180:183]
s_add_u32 s49, s49, 114688
ds_read_b64_tr_b16 a[230:231], v233 offset:6144
v_mfma_f32_16x16x32_bf16 v[184:187], a[208:211], a[92:95], v[184:187]
s_waitcnt lgkmcnt(9)
buffer_load_dwordx4 v248, s[36:39], s49 offen lds
v_mfma_f32_16x16x32_bf16 v[196:199], a[212:215], a[92:95], v[196:199]
ds_read_b64_tr_b16 a[208:209], v232 offset:8192
v_mfma_f32_16x16x32_bf16 v[192:195], a[212:215], a[88:91], v[192:195]
ds_read_b64_tr_b16 a[210:211], v232 offset:10240
v_mfma_f32_16x16x32_bf16 v[188:191], a[212:215], a[84:87], v[188:191]
s_waitcnt lgkmcnt(9)
ds_read_b128 a[100:103], v31 offset:1024
ds_read_b128 a[104:107], v31 offset:2048
ds_read_b128 a[108:111], v31 offset:3072
ds_read_b128 a[112:115], v31 offset:4096
ds_read_b128 a[116:119], v31 offset:5120
s_waitcnt lgkmcnt(11)
v_mfma_f32_16x16x32_bf16 v[32:35], a[216:219], a[96:99], v[32:35]
ds_read_b64_tr_b16 a[212:213], v233 offset:8192
s_waitcnt lgkmcnt(5)
v_mfma_f32_16x16x32_bf16 v[36:39], a[216:219], a[100:103], v[36:39]
ds_read_b64_tr_b16 a[214:215], v233 offset:10240
s_waitcnt lgkmcnt(5)
v_mfma_f32_16x16x32_bf16 v[40:43], a[216:219], a[104:107], v[40:43]
buffer_load_dwordx4 v249, s[36:39], s49 offen offset:1024 lds
ds_read_b128 a[120:123], v31 offset:6144
ds_read_b128 a[124:127], v31 offset:7168
ds_read_b128 a[128:131], v31 offset:8192
v_mfma_f32_16x16x32_bf16 v[52:55], a[220:223], a[104:107], v[52:55]
ds_read_b64_tr_b16 a[216:217], v232 offset:12288
v_mfma_f32_16x16x32_bf16 v[48:51], a[220:223], a[100:103], v[48:51]
ds_read_b64_tr_b16 a[218:219], v232 offset:14336
v_mfma_f32_16x16x32_bf16 v[44:47], a[220:223], a[96:99], v[44:47]
buffer_load_dwordx4 v250, s[36:39], s49 offen offset:2048 lds
s_waitcnt lgkmcnt(9)
v_mfma_f32_16x16x32_bf16 v[32:35], a[224:227], a[108:111], v[32:35]
ds_read_b64_tr_b16 a[220:221], v233 offset:12288
s_waitcnt lgkmcnt(9)
v_mfma_f32_16x16x32_bf16 v[36:39], a[224:227], a[112:115], v[36:39]
ds_read_b64_tr_b16 a[222:223], v233 offset:14336
s_waitcnt lgkmcnt(9)
v_mfma_f32_16x16x32_bf16 v[40:43], a[224:227], a[116:119], v[40:43]
ds_read_b128 a[132:135], v31 offset:9216
ds_read_b128 a[136:139], v31 offset:10240
ds_read_b128 a[140:143], v31 offset:11264
v_mfma_f32_16x16x32_bf16 v[52:55], a[228:231], a[116:119], v[52:55]
s_waitcnt vmcnt(15)
s_barrier
v_add_u32 v232, 4294934528, v232
v_mfma_f32_16x16x32_bf16 v[48:51], a[228:231], a[112:115], v[48:51]
ds_read_b64_tr_b16 a[224:225], v232 offset:0
v_mfma_f32_16x16x32_bf16 v[44:47], a[228:231], a[108:111], v[44:47]
ds_read_b64_tr_b16 a[226:227], v232 offset:2048
s_waitcnt lgkmcnt(11)
v_mfma_f32_16x16x32_bf16 v[32:35], a[208:211], a[120:123], v[32:35]
buffer_load_dwordx4 v251, s[36:39], s49 offen offset:3072 lds
s_waitcnt lgkmcnt(10)
v_mfma_f32_16x16x32_bf16 v[36:39], a[208:211], a[124:127], v[36:39]
s_add_u32 m0, s48, 81920
ds_read_b128 a[144:147], v31 offset:12288
v_add_u32 v233, 4294934528, v233
s_waitcnt lgkmcnt(10)
v_mfma_f32_16x16x32_bf16 v[40:43], a[208:211], a[128:131], v[40:43]
ds_read_b64_tr_b16 a[228:229], v233 offset:0
s_add_u32 s49, s67, s1
ds_read_b128 a[148:151], v31 offset:13312
ds_read_b128 a[152:155], v31 offset:14336
v_mfma_f32_16x16x32_bf16 v[52:55], a[212:215], a[128:131], v[52:55]
ds_read_b64_tr_b16 a[230:231], v233 offset:2048
ds_read_b64_tr_b16 a[208:209], v232 offset:4096
v_mfma_f32_16x16x32_bf16 v[48:51], a[212:215], a[124:127], v[48:51]
s_waitcnt lgkmcnt(14)
ds_read_b64_tr_b16 a[210:211], v232 offset:6144
v_mfma_f32_16x16x32_bf16 v[44:47], a[212:215], a[120:123], v[44:47]
s_waitcnt lgkmcnt(14)
buffer_load_dwordx4 v248, s[36:39], s49 offen lds
s_waitcnt lgkmcnt(11)
v_mfma_f32_16x16x32_bf16 v[32:35], a[216:219], a[132:135], v[32:35]
ds_read_b64_tr_b16 a[212:213], v233 offset:4096
s_waitcnt lgkmcnt(11)
v_mfma_f32_16x16x32_bf16 v[36:39], a[216:219], a[136:139], v[36:39]
ds_read_b64_tr_b16 a[214:215], v233 offset:6144
s_waitcnt lgkmcnt(11)
v_mfma_f32_16x16x32_bf16 v[40:43], a[216:219], a[140:143], v[40:43]
ds_read_b128 a[156:159], v31 offset:15360
ds_read_b128 a[160:163], v31 offset:16384
ds_read_b128 a[164:167], v31 offset:17408
v_mfma_f32_16x16x32_bf16 v[52:55], a[220:223], a[140:143], v[52:55]
ds_read_b64_tr_b16 a[216:217], v232 offset:8192
v_mfma_f32_16x16x32_bf16 v[48:51], a[220:223], a[136:139], v[48:51]
s_waitcnt lgkmcnt(14)
ds_read_b64_tr_b16 a[218:219], v232 offset:10240
v_mfma_f32_16x16x32_bf16 v[44:47], a[220:223], a[132:135], v[44:47]
s_waitcnt lgkmcnt(14)
buffer_load_dwordx4 v249, s[36:39], s49 offen offset:1024 lds
s_waitcnt lgkmcnt(13)
v_mfma_f32_16x16x32_bf16 v[32:35], a[224:227], a[144:147], v[32:35]
ds_read_b64_tr_b16 a[220:221], v233 offset:8192
s_waitcnt lgkmcnt(12)
v_mfma_f32_16x16x32_bf16 v[36:39], a[224:227], a[148:151], v[36:39]
ds_read_b64_tr_b16 a[222:223], v233 offset:10240
s_waitcnt lgkmcnt(12)
v_mfma_f32_16x16x32_bf16 v[40:43], a[224:227], a[152:155], v[40:43]
s_waitcnt lgkmcnt(11)
buffer_load_dwordx4 v250, s[36:39], s49 offen offset:2048 lds
ds_read_b128 a[168:171], v31 offset:18432
ds_read_b128 a[172:175], v31 offset:19456
ds_read_b128 a[176:179], v31 offset:20480
v_mfma_f32_16x16x32_bf16 v[52:55], a[228:231], a[152:155], v[52:55]
ds_read_b64_tr_b16 a[224:225], v232 offset:12288
v_mfma_f32_16x16x32_bf16 v[48:51], a[228:231], a[148:151], v[48:51]
s_waitcnt lgkmcnt(14)
ds_read_b64_tr_b16 a[226:227], v232 offset:14336
v_mfma_f32_16x16x32_bf16 v[44:47], a[228:231], a[144:147], v[44:47]
s_waitcnt lgkmcnt(14)
ds_read_b128 a[180:183], v31 offset:21504
s_waitcnt lgkmcnt(12)
v_mfma_f32_16x16x32_bf16 v[32:35], a[208:211], a[156:159], v[32:35]
ds_read_b64_tr_b16 a[228:229], v233 offset:12288
s_waitcnt lgkmcnt(12)
v_mfma_f32_16x16x32_bf16 v[36:39], a[208:211], a[160:163], v[36:39]
ds_read_b64_tr_b16 a[230:231], v233 offset:14336
s_waitcnt lgkmcnt(12)
v_mfma_f32_16x16x32_bf16 v[40:43], a[208:211], a[164:167], v[40:43]
buffer_load_dwordx4 v251, s[36:39], s49 offen offset:3072 lds
ds_read_b128 a[184:187], v31 offset:22528
ds_read_b128 a[188:191], v31 offset:23552
v_mfma_f32_16x16x32_bf16 v[52:55], a[212:215], a[164:167], v[52:55]
s_waitcnt vmcnt(16)
s_barrier
v_add_u32 v232, 49152, v232
v_mfma_f32_16x16x32_bf16 v[48:51], a[212:215], a[160:163], v[48:51]
s_add_u32 m0, s48, 32768
ds_read_b64_tr_b16 a[208:209], v232 offset:49152
s_add_u32 s49, s67, s1
v_mfma_f32_16x16x32_bf16 v[44:47], a[212:215], a[156:159], v[44:47]
s_waitcnt lgkmcnt(13)
ds_read_b64_tr_b16 a[210:211], v232 offset:51200
s_add_u32 s49, s49, 114688
s_waitcnt lgkmcnt(11)
v_mfma_f32_16x16x32_bf16 v[32:35], a[216:219], a[168:171], v[32:35]
buffer_load_dwordx4 v248, s[36:39], s49 offen lds
s_waitcnt lgkmcnt(10)
v_mfma_f32_16x16x32_bf16 v[36:39], a[216:219], a[172:175], v[36:39]
v_add_u32 v233, 49152, v233
s_waitcnt lgkmcnt(9)
v_mfma_f32_16x16x32_bf16 v[40:43], a[216:219], a[176:179], v[40:43]
ds_read_b64_tr_b16 a[212:213], v233 offset:49152
v_mfma_f32_16x16x32_bf16 v[52:55], a[220:223], a[176:179], v[52:55]
ds_read_b64_tr_b16 a[214:215], v233 offset:51200
ds_read_b64_tr_b16 a[216:217], v232 offset:53248
v_mfma_f32_16x16x32_bf16 v[48:51], a[220:223], a[172:175], v[48:51]
ds_read_b64_tr_b16 a[218:219], v232 offset:55296
v_mfma_f32_16x16x32_bf16 v[44:47], a[220:223], a[168:171], v[44:47]
s_waitcnt lgkmcnt(11)
buffer_load_dwordx4 v249, s[36:39], s49 offen offset:1024 lds
s_waitcnt lgkmcnt(10)
v_mfma_f32_16x16x32_bf16 v[32:35], a[224:227], a[180:183], v[32:35]
ds_read_b64_tr_b16 a[220:221], v233 offset:53248
s_waitcnt lgkmcnt(8)
v_mfma_f32_16x16x32_bf16 v[36:39], a[224:227], a[184:187], v[36:39]
ds_read_b64_tr_b16 a[222:223], v233 offset:55296
s_waitcnt lgkmcnt(8)
v_mfma_f32_16x16x32_bf16 v[40:43], a[224:227], a[188:191], v[40:43]
v_mfma_f32_16x16x32_bf16 v[52:55], a[228:231], a[188:191], v[52:55]
ds_read_b64_tr_b16 a[224:225], v232 offset:57344
v_mfma_f32_16x16x32_bf16 v[48:51], a[228:231], a[184:187], v[48:51]
ds_read_b64_tr_b16 a[226:227], v232 offset:59392
v_mfma_f32_16x16x32_bf16 v[44:47], a[228:231], a[180:183], v[44:47]
s_waitcnt lgkmcnt(8)
buffer_load_dwordx4 v250, s[36:39], s49 offen offset:2048 lds
v_mfma_f32_16x16x32_bf16 v[56:59], a[208:211], a[96:99], v[56:59]
ds_read_b64_tr_b16 a[228:229], v233 offset:57344
v_mfma_f32_16x16x32_bf16 v[60:63], a[208:211], a[100:103], v[60:63]
s_add_u32 s60, s71, 0
ds_read_b64_tr_b16 a[230:231], v233 offset:59392
v_mfma_f32_16x16x32_bf16 v[64:67], a[208:211], a[104:107], v[64:67]
s_waitcnt lgkmcnt(8)
buffer_load_dwordx4 v251, s[36:39], s49 offen offset:3072 lds
v_mfma_f32_16x16x32_bf16 v[76:79], a[212:215], a[104:107], v[76:79]
s_mul_i32 s30, s60, 11
ds_read_b64_tr_b16 a[208:209], v232 offset:61440
v_cvt_pk_bf16_f32 v200, v32, v33
v_mfma_f32_16x16x32_bf16 v[72:75], a[212:215], a[100:103], v[72:75]
s_lshr_b32 s30, s30, 5
ds_read_b64_tr_b16 a[210:211], v232 offset:63488
v_cvt_pk_bf16_f32 v201, v34, v35
v_mfma_f32_16x16x32_bf16 v[68:71], a[212:215], a[96:99], v[68:71]
s_waitcnt lgkmcnt(8)
v_cvt_pk_bf16_f32 v202, v44, v45
v_cvt_pk_bf16_f32 v203, v46, v47
v_mfma_f32_16x16x32_bf16 v[56:59], a[216:219], a[108:111], v[56:59]
s_mul_i32 s52, s64, 1536
ds_read_b64_tr_b16 a[212:213], v233 offset:61440
v_mfma_f32_16x16x32_bf16 v[60:63], a[216:219], a[112:115], v[60:63]
s_mul_i32 s61, s30, 3
ds_read_b64_tr_b16 a[214:215], v233 offset:63488
v_mfma_f32_16x16x32_bf16 v[64:67], a[216:219], a[116:119], v[64:67]
s_waitcnt lgkmcnt(8)
s_cmp_eq_u32 s71, 0
s_cselect_b32 s51, 0x40000000, s52
buffer_store_dwordx4 v[200:203], v28, s[40:43], s51 offen sc1
s_cbranch_scc0 L_ow0
v_accvgpr_write_b32 a28, v200
v_accvgpr_write_b32 a29, v201
v_accvgpr_write_b32 a30, v202
v_accvgpr_write_b32 a31, v203
L_ow0:
v_mfma_f32_16x16x32_bf16 v[76:79], a[220:223], a[116:119], v[76:79]
s_waitcnt vmcnt(17)
s_barrier
ds_read_b64_tr_b16 a[216:217], v232 offset:0
v_mfma_f32_16x16x32_bf16 v[72:75], a[220:223], a[112:115], v[72:75]
s_add_u32 m0, s48, 0
ds_read_b64_tr_b16 a[218:219], v232 offset:2048
s_add_u32 s49, s68, s1
v_mfma_f32_16x16x32_bf16 v[68:71], a[220:223], a[108:111], v[68:71]
s_waitcnt lgkmcnt(8)
buffer_load_dwordx4 v248, s[36:39], s49 offen lds
v_mfma_f32_16x16x32_bf16 v[56:59], a[224:227], a[120:123], v[56:59]
s_sub_u32 s60, s60, s61
ds_read_b64_tr_b16 a[220:221], v233 offset:0
v_cvt_pk_bf16_f32 v204, v36, v37
v_mfma_f32_16x16x32_bf16 v[60:63], a[224:227], a[124:127], v[60:63]
s_and_b32 s61, s54, 1
ds_read_b64_tr_b16 a[222:223], v233 offset:2048
v_cvt_pk_bf16_f32 v205, v38, v39
v_mfma_f32_16x16x32_bf16 v[64:67], a[224:227], a[128:131], v[64:67]
s_waitcnt lgkmcnt(8)
buffer_load_dwordx4 v249, s[36:39], s49 offen offset:1024 lds
v_mfma_f32_16x16x32_bf16 v[76:79], a[228:231], a[128:131], v[76:79]
s_lshl_b32 s31, s61, 2
ds_read_b64_tr_b16 a[224:225], v232 offset:4096
v_cvt_pk_bf16_f32 v206, v48, v49
v_mfma_f32_16x16x32_bf16 v[72:75], a[228:231], a[124:127], v[72:75]
s_add_u32 s31, s31, s55
ds_read_b64_tr_b16 a[226:227], v232 offset:6144
v_cvt_pk_bf16_f32 v207, v50, v51
v_mfma_f32_16x16x32_bf16 v[68:71], a[228:231], a[120:123], v[68:71]
s_waitcnt lgkmcnt(8)
s_add_u32 s52, s52, 8192
v_mfma_f32_16x16x32_bf16 v[56:59], a[208:211], a[132:135], v[56:59]
s_lshl_b32 s31, s31, 9
ds_read_b64_tr_b16 a[228:229], v233 offset:4096
v_mfma_f32_16x16x32_bf16 v[60:63], a[208:211], a[136:139], v[60:63]
s_lshl_b32 s61, s61, 1
ds_read_b64_tr_b16 a[230:231], v233 offset:6144
v_mfma_f32_16x16x32_bf16 v[64:67], a[208:211], a[140:143], v[64:67]
s_waitcnt lgkmcnt(8)
buffer_load_dwordx4 v250, s[36:39], s49 offen offset:2048 lds
v_mfma_f32_16x16x32_bf16 v[76:79], a[212:215], a[140:143], v[76:79]
s_and_b32 s72, s55, 1
ds_read_b64_tr_b16 a[208:209], v232 offset:8192
v_mfma_f32_16x16x32_bf16 v[72:75], a[212:215], a[136:139], v[72:75]
s_add_u32 s61, s61, s72
ds_read_b64_tr_b16 a[210:211], v232 offset:10240
v_mfma_f32_16x16x32_bf16 v[68:71], a[212:215], a[132:135], v[68:71]
s_waitcnt lgkmcnt(8)
buffer_load_dwordx4 v251, s[36:39], s49 offen offset:3072 lds
v_mfma_f32_16x16x32_bf16 v[56:59], a[216:219], a[144:147], v[56:59]
s_mul_i32 s61, s61, 3
ds_read_b64_tr_b16 a[212:213], v233 offset:8192
v_mfma_f32_16x16x32_bf16 v[60:63], a[216:219], a[148:151], v[60:63]
s_add_u32 s60, s60, s61
ds_read_b64_tr_b16 a[214:215], v233 offset:10240
v_mfma_f32_16x16x32_bf16 v[64:67], a[216:219], a[152:155], v[64:67]
s_waitcnt lgkmcnt(8)
s_cmp_eq_u32 s71, 1
s_cselect_b32 s51, 0x40000000, s52
buffer_store_dwordx4 v[204:207], v28, s[40:43], s51 offen sc1
s_cbranch_scc0 L_ow1
v_accvgpr_write_b32 a28, v204
v_accvgpr_write_b32 a29, v205
v_accvgpr_write_b32 a30, v206
v_accvgpr_write_b32 a31, v207
L_ow1:
v_mfma_f32_16x16x32_bf16 v[76:79], a[220:223], a[152:155], v[76:79]
s_add_u32 s61, s30, s57
ds_read_b64_tr_b16 a[216:217], v232 offset:12288
v_cvt_pk_bf16_f32 v208, v40, v41
v_mfma_f32_16x16x32_bf16 v[72:75], a[220:223], a[148:151], v[72:75]
s_cmp_ge_u32 s61, 7
s_cselect_b32 s72, 7, 0
ds_read_b64_tr_b16 a[218:219], v232 offset:14336
v_mfma_f32_16x16x32_bf16 v[68:71], a[220:223], a[144:147], v[68:71]
s_waitcnt lgkmcnt(8)
v_cvt_pk_bf16_f32 v209, v42, v43
v_cvt_pk_bf16_f32 v210, v52, v53
v_cvt_pk_bf16_f32 v211, v54, v55
s_add_u32 s52, s52, 8192
s_cmp_eq_u32 s71, 2
s_cselect_b32 s51, 0x40000000, s52
buffer_store_dwordx4 v[208:211], v28, s[40:43], s51 offen sc1
s_cbranch_scc0 L_ow2
v_accvgpr_write_b32 a28, v208
v_accvgpr_write_b32 a29, v209
v_accvgpr_write_b32 a30, v210
v_accvgpr_write_b32 a31, v211
L_ow2:
v_mfma_f32_16x16x32_bf16 v[56:59], a[224:227], a[156:159], v[56:59]
s_sub_u32 s61, s61, s72
ds_read_b64_tr_b16 a[220:221], v233 offset:12288
v_mfma_f32_16x16x32_bf16 v[60:63], a[224:227], a[160:163], v[60:63]
s_lshl_b32 s61, s61, 1
ds_read_b64_tr_b16 a[222:223], v233 offset:14336
v_mfma_f32_16x16x32_bf16 v[64:67], a[224:227], a[164:167], v[64:67]
s_waitcnt lgkmcnt(8)
v_mfma_f32_16x16x32_bf16 v[76:79], a[228:231], a[164:167], v[76:79]
s_waitcnt vmcnt(19)
s_barrier
v_add_u32 v232, 4294934528, v232
v_mfma_f32_16x16x32_bf16 v[72:75], a[228:231], a[160:163], v[72:75]
s_add_u32 m0, s48, 147456
ds_read_b64_tr_b16 a[224:225], v232 offset:0
s_add_u32 s49, s68, s1
v_mfma_f32_16x16x32_bf16 v[68:71], a[228:231], a[156:159], v[68:71]
s_waitcnt lgkmcnt(7)
ds_read_b64_tr_b16 a[226:227], v232 offset:2048
s_add_u32 s49, s49, 114688
v_mfma_f32_16x16x32_bf16 v[56:59], a[208:211], a[168:171], v[56:59]
s_lshr_b32 s72, s55, 1
buffer_load_dwordx4 v248, s[36:39], s49 offen lds
v_mfma_f32_16x16x32_bf16 v[60:63], a[208:211], a[172:175], v[60:63]
s_add_u32 s61, s61, s72
v_add_u32 v233, 4294934528, v233
v_mfma_f32_16x16x32_bf16 v[64:67], a[208:211], a[176:179], v[64:67]
s_waitcnt lgkmcnt(6)
ds_read_b64_tr_b16 a[228:229], v233 offset:0
v_mfma_f32_16x16x32_bf16 v[76:79], a[212:215], a[176:179], v[76:79]
ds_read_b64_tr_b16 a[230:231], v233 offset:2048
s_mul_i32 s72, s61, 12
ds_read_b64_tr_b16 a[208:209], v232 offset:4096
v_mfma_f32_16x16x32_bf16 v[72:75], a[212:215], a[172:175], v[72:75]
s_add_u32 s72, s72, s60
ds_read_b64_tr_b16 a[210:211], v232 offset:6144
v_mfma_f32_16x16x32_bf16 v[68:71], a[212:215], a[168:171], v[68:71]
s_waitcnt lgkmcnt(8)
buffer_load_dwordx4 v249, s[36:39], s49 offen offset:1024 lds
v_mfma_f32_16x16x32_bf16 v[56:59], a[216:219], a[180:183], v[56:59]
s_lshl_b32 s24, s72, 13
ds_read_b64_tr_b16 a[212:213], v233 offset:4096
v_mfma_f32_16x16x32_bf16 v[60:63], a[216:219], a[184:187], v[60:63]
s_lshl_b32 s61, s61, 6
ds_read_b64_tr_b16 a[214:215], v233 offset:6144
v_mfma_f32_16x16x32_bf16 v[64:67], a[216:219], a[188:191], v[64:67]
s_waitcnt lgkmcnt(8)
v_mfma_f32_16x16x32_bf16 v[76:79], a[220:223], a[188:191], v[76:79]
s_mul_i32 s27, s53, 12
ds_read_b64_tr_b16 a[216:217], v232 offset:8192
v_mfma_f32_16x16x32_bf16 v[72:75], a[220:223], a[184:187], v[72:75]
s_add_u32 s27, s27, s60
ds_read_b64_tr_b16 a[218:219], v232 offset:10240
v_mfma_f32_16x16x32_bf16 v[68:71], a[220:223], a[180:183], v[68:71]
s_waitcnt lgkmcnt(8)
buffer_load_dwordx4 v250, s[36:39], s49 offen offset:2048 lds
v_mfma_f32_16x16x32_bf16 v[80:83], a[224:227], a[96:99], v[80:83]
s_mul_i32 s27, s27, 14336
ds_read_b64_tr_b16 a[220:221], v233 offset:8192
v_mfma_f32_16x16x32_bf16 v[84:87], a[224:227], a[100:103], v[84:87]
s_add_u32 s27, s27, s61
ds_read_b64_tr_b16 a[222:223], v233 offset:10240
v_mfma_f32_16x16x32_bf16 v[88:91], a[224:227], a[104:107], v[88:91]
s_waitcnt lgkmcnt(8)
buffer_load_dwordx4 v251, s[36:39], s49 offen offset:3072 lds
v_mfma_f32_16x16x32_bf16 v[100:103], a[228:231], a[104:107], v[100:103]
s_add_u32 m0, s48, 131072
ds_read_b64_tr_b16 a[224:225], v232 offset:12288
s_add_u32 s49, s69, s1
v_mfma_f32_16x16x32_bf16 v[96:99], a[228:231], a[100:103], v[96:99]
s_add_u32 s30, s30, 1
ds_read_b64_tr_b16 a[226:227], v232 offset:14336
v_cvt_pk_bf16_f32 v200, v56, v57
v_mfma_f32_16x16x32_bf16 v[92:95], a[228:231], a[96:99], v[92:95]
s_waitcnt lgkmcnt(8)
v_cvt_pk_bf16_f32 v201, v58, v59
v_cvt_pk_bf16_f32 v202, v68, v69
v_mfma_f32_16x16x32_bf16 v[80:83], a[208:211], a[108:111], v[80:83]
s_add_u32 s60, s71, 8
ds_read_b64_tr_b16 a[228:229], v233 offset:12288
v_cvt_pk_bf16_f32 v203, v70, v71
v_mfma_f32_16x16x32_bf16 v[84:87], a[208:211], a[112:115], v[84:87]
s_mul_i32 s52, s65, 1536
ds_read_b64_tr_b16 a[230:231], v233 offset:14336
v_mfma_f32_16x16x32_bf16 v[88:91], a[208:211], a[116:119], v[88:91]
s_waitcnt lgkmcnt(8)
buffer_load_dwordx4 v248, s[36:39], s49 offen lds
v_mfma_f32_16x16x32_bf16 v[100:103], a[212:215], a[116:119], v[100:103]
s_waitcnt vmcnt(20)
s_barrier
ds_read_b64_tr_b16 a[208:209], v232 offset:49152
v_mfma_f32_16x16x32_bf16 v[96:99], a[212:215], a[112:115], v[96:99]
s_mul_i32 s76, s60, 11
ds_read_b64_tr_b16 a[210:211], v232 offset:51200
v_mfma_f32_16x16x32_bf16 v[92:95], a[212:215], a[108:111], v[92:95]
s_waitcnt lgkmcnt(8)
buffer_load_dwordx4 v249, s[36:39], s49 offen offset:1024 lds
v_mfma_f32_16x16x32_bf16 v[80:83], a[216:219], a[120:123], v[80:83]
s_lshr_b32 s76, s76, 5
ds_read_b64_tr_b16 a[212:213], v233 offset:49152
v_mfma_f32_16x16x32_bf16 v[84:87], a[216:219], a[124:127], v[84:87]
s_mul_i32 s61, s76, 3
ds_read_b64_tr_b16 a[214:215], v233 offset:51200
v_mfma_f32_16x16x32_bf16 v[88:91], a[216:219], a[128:131], v[88:91]
s_waitcnt lgkmcnt(8)
s_cmp_eq_u32 s71, 3
s_cselect_b32 s51, 0x40000000, s52
buffer_store_dwordx4 v[200:203], v28, s[40:43], s51 offen sc1
s_cbranch_scc0 L_ow3
v_accvgpr_write_b32 a28, v200
v_accvgpr_write_b32 a29, v201
v_accvgpr_write_b32 a30, v202
v_accvgpr_write_b32 a31, v203
L_ow3:
v_mfma_f32_16x16x32_bf16 v[100:103], a[220:223], a[128:131], v[100:103]
s_sub_u32 s60, s60, s61
ds_read_b64_tr_b16 a[216:217], v232 offset:53248
v_cvt_pk_bf16_f32 v204, v60, v61
v_mfma_f32_16x16x32_bf16 v[96:99], a[220:223], a[124:127], v[96:99]
s_and_b32 s61, s54, 1
ds_read_b64_tr_b16 a[218:219], v232 offset:55296
v_cvt_pk_bf16_f32 v205, v62, v63
v_mfma_f32_16x16x32_bf16 v[92:95], a[220:223], a[120:123], v[92:95]
s_waitcnt lgkmcnt(8)
buffer_load_dwordx4 v250, s[36:39], s49 offen offset:2048 lds
v_mfma_f32_16x16x32_bf16 v[80:83], a[224:227], a[132:135], v[80:83]
s_lshl_b32 s78, s61, 2
ds_read_b64_tr_b16 a[220:221], v233 offset:53248
v_cvt_pk_bf16_f32 v206, v72, v73
v_mfma_f32_16x16x32_bf16 v[84:87], a[224:227], a[136:139], v[84:87]
s_add_u32 s78, s78, s55
ds_read_b64_tr_b16 a[222:223], v233 offset:55296
v_cvt_pk_bf16_f32 v207, v74, v75
v_mfma_f32_16x16x32_bf16 v[88:91], a[224:227], a[140:143], v[88:91]
s_waitcnt lgkmcnt(8)
buffer_load_dwordx4 v251, s[36:39], s49 offen offset:3072 lds
v_mfma_f32_16x16x32_bf16 v[100:103], a[228:231], a[140:143], v[100:103]
s_add_u32 m0, s48, 114688
ds_read_b64_tr_b16 a[224:225], v232 offset:57344
s_add_u32 s49, s69, s1
v_mfma_f32_16x16x32_bf16 v[96:99], a[228:231], a[136:139], v[96:99]
s_add_u32 s49, s49, 114688
ds_read_b64_tr_b16 a[226:227], v232 offset:59392
s_add_u32 s52, s52, 8192
v_mfma_f32_16x16x32_bf16 v[92:95], a[228:231], a[132:135], v[92:95]
s_waitcnt lgkmcnt(8)
s_cmp_eq_u32 s71, 4
s_cselect_b32 s51, 0x40000000, s52
buffer_store_dwordx4 v[204:207], v28, s[40:43], s51 offen sc1
s_cbranch_scc0 L_ow4
v_accvgpr_write_b32 a28, v204
v_accvgpr_write_b32 a29, v205
v_accvgpr_write_b32 a30, v206
v_accvgpr_write_b32 a31, v207
L_ow4:
v_mfma_f32_16x16x32_bf16 v[80:83], a[208:211], a[144:147], v[80:83]
s_lshl_b32 s78, s78, 9
ds_read_b64_tr_b16 a[228:229], v233 offset:57344
v_cvt_pk_bf16_f32 v208, v64, v65
v_mfma_f32_16x16x32_bf16 v[84:87], a[208:211], a[148:151], v[84:87]
s_lshl_b32 s61, s61, 1
ds_read_b64_tr_b16 a[230:231], v233 offset:59392
v_cvt_pk_bf16_f32 v209, v66, v67
v_mfma_f32_16x16x32_bf16 v[88:91], a[208:211], a[152:155], v[88:91]
s_waitcnt lgkmcnt(8)
buffer_load_dwordx4 v248, s[36:39], s49 offen lds
v_mfma_f32_16x16x32_bf16 v[100:103], a[212:215], a[152:155], v[100:103]
s_and_b32 s72, s55, 1
ds_read_b64_tr_b16 a[208:209], v232 offset:61440
v_cvt_pk_bf16_f32 v210, v76, v77
v_mfma_f32_16x16x32_bf16 v[96:99], a[212:215], a[148:151], v[96:99]
s_add_u32 s61, s61, s72
ds_read_b64_tr_b16 a[210:211], v232 offset:63488
v_cvt_pk_bf16_f32 v211, v78, v79
v_mfma_f32_16x16x32_bf16 v[92:95], a[212:215], a[144:147], v[92:95]
s_waitcnt lgkmcnt(8)
buffer_load_dwordx4 v249, s[36:39], s49 offen offset:1024 lds
s_add_u32 s52, s52, 8192
s_cmp_eq_u32 s71, 5
s_cselect_b32 s51, 0x40000000, s52
buffer_store_dwordx4 v[208:211], v28, s[40:43], s51 offen sc1
s_cbranch_scc0 L_ow5
v_accvgpr_write_b32 a28, v208
v_accvgpr_write_b32 a29, v209
v_accvgpr_write_b32 a30, v210
v_accvgpr_write_b32 a31, v211
L_ow5:
v_mfma_f32_16x16x32_bf16 v[80:83], a[216:219], a[156:159], v[80:83]
s_mul_i32 s61, s61, 3
ds_read_b64_tr_b16 a[212:213], v233 offset:61440
v_mfma_f32_16x16x32_bf16 v[84:87], a[216:219], a[160:163], v[84:87]
s_add_u32 s60, s60, s61
ds_read_b64_tr_b16 a[214:215], v233 offset:63488
v_mfma_f32_16x16x32_bf16 v[88:91], a[216:219], a[164:167], v[88:91]
s_waitcnt lgkmcnt(8)
v_mfma_f32_16x16x32_bf16 v[100:103], a[220:223], a[164:167], v[100:103]
s_waitcnt vmcnt(24)
s_barrier
v_add_u32 v232, 16384, v232
v_mfma_f32_16x16x32_bf16 v[96:99], a[220:223], a[160:163], v[96:99]
s_add_u32 s61, s76, s57
ds_read_b64_tr_b16 a[216:217], v232 offset:49152
v_mfma_f32_16x16x32_bf16 v[92:95], a[220:223], a[156:159], v[92:95]
s_waitcnt lgkmcnt(7)
ds_read_b64_tr_b16 a[218:219], v232 offset:51200
v_mfma_f32_16x16x32_bf16 v[80:83], a[224:227], a[168:171], v[80:83]
s_cmp_ge_u32 s61, 7
s_cselect_b32 s72, 7, 0
v_add_u32 v233, 16384, v233
v_mfma_f32_16x16x32_bf16 v[84:87], a[224:227], a[172:175], v[84:87]
s_sub_u32 s61, s61, s72
ds_read_b64_tr_b16 a[220:221], v233 offset:49152
v_mfma_f32_16x16x32_bf16 v[88:91], a[224:227], a[176:179], v[88:91]
s_waitcnt lgkmcnt(7)
ds_read_b64_tr_b16 a[222:223], v233 offset:51200
v_mfma_f32_16x16x32_bf16 v[100:103], a[228:231], a[176:179], v[100:103]
s_lshl_b32 s61, s61, 1
ds_read_b64_tr_b16 a[224:225], v232 offset:53248
v_mfma_f32_16x16x32_bf16 v[96:99], a[228:231], a[172:175], v[96:99]
s_lshr_b32 s72, s55, 1
ds_read_b64_tr_b16 a[226:227], v232 offset:55296
v_mfma_f32_16x16x32_bf16 v[92:95], a[228:231], a[168:171], v[92:95]
s_waitcnt lgkmcnt(8)
buffer_load_dwordx4 v250, s[36:39], s49 offen offset:2048 lds
v_mfma_f32_16x16x32_bf16 v[80:83], a[208:211], a[180:183], v[80:83]
s_add_u32 s61, s61, s72
ds_read_b64_tr_b16 a[228:229], v233 offset:53248
v_mfma_f32_16x16x32_bf16 v[84:87], a[208:211], a[184:187], v[84:87]
s_mul_i32 s72, s61, 12
ds_read_b64_tr_b16 a[230:231], v233 offset:55296
v_mfma_f32_16x16x32_bf16 v[88:91], a[208:211], a[188:191], v[88:91]
s_waitcnt lgkmcnt(8)
buffer_load_dwordx4 v251, s[36:39], s49 offen offset:3072 lds
v_mfma_f32_16x16x32_bf16 v[100:103], a[212:215], a[188:191], v[100:103]
s_add_u32 m0, s48, 98304
ds_read_b64_tr_b16 a[208:209], v232 offset:57344
s_add_u32 s49, s70, s1
v_mfma_f32_16x16x32_bf16 v[96:99], a[212:215], a[184:187], v[96:99]
s_add_u32 s72, s72, s60
ds_read_b64_tr_b16 a[210:211], v232 offset:59392
v_mfma_f32_16x16x32_bf16 v[92:95], a[212:215], a[180:183], v[92:95]
s_waitcnt lgkmcnt(8)
v_mfma_f32_16x16x32_bf16 v[104:107], a[216:219], a[96:99], v[104:107]
s_lshl_b32 s25, s72, 13
ds_read_b64_tr_b16 a[212:213], v233 offset:57344
v_mfma_f32_16x16x32_bf16 v[108:111], a[216:219], a[100:103], v[108:111]
s_lshl_b32 s61, s61, 6
ds_read_b64_tr_b16 a[214:215], v233 offset:59392
v_mfma_f32_16x16x32_bf16 v[112:115], a[216:219], a[104:107], v[112:115]
s_waitcnt lgkmcnt(8)
buffer_load_dwordx4 v248, s[36:39], s49 offen lds
v_mfma_f32_16x16x32_bf16 v[124:127], a[220:223], a[104:107], v[124:127]
s_mul_i32 s28, s53, 12
ds_read_b64_tr_b16 a[216:217], v232 offset:61440
v_cvt_pk_bf16_f32 v200, v80, v81
v_mfma_f32_16x16x32_bf16 v[120:123], a[220:223], a[100:103], v[120:123]
s_add_u32 s28, s28, s60
ds_read_b64_tr_b16 a[218:219], v232 offset:63488
v_cvt_pk_bf16_f32 v201, v82, v83
v_mfma_f32_16x16x32_bf16 v[116:119], a[220:223], a[96:99], v[116:119]
s_waitcnt lgkmcnt(8)
buffer_load_dwordx4 v249, s[36:39], s49 offen offset:1024 lds
v_mfma_f32_16x16x32_bf16 v[104:107], a[224:227], a[108:111], v[104:107]
s_mul_i32 s28, s28, 14336
ds_read_b64_tr_b16 a[220:221], v233 offset:61440
v_cvt_pk_bf16_f32 v202, v92, v93
v_mfma_f32_16x16x32_bf16 v[108:111], a[224:227], a[112:115], v[108:111]
s_add_u32 s28, s28, s61
ds_read_b64_tr_b16 a[222:223], v233 offset:63488
v_cvt_pk_bf16_f32 v203, v94, v95
v_mfma_f32_16x16x32_bf16 v[112:115], a[224:227], a[116:119], v[112:115]
s_waitcnt lgkmcnt(8)
s_mul_i32 s52, s66, 1536
v_mfma_f32_16x16x32_bf16 v[124:127], a[228:231], a[116:119], v[124:127]
s_waitcnt vmcnt(24)
s_barrier
ds_read_b64_tr_b16 a[224:225], v232 offset:0
v_mfma_f32_16x16x32_bf16 v[120:123], a[228:231], a[112:115], v[120:123]
s_add_u32 s76, s76, 1
ds_read_b64_tr_b16 a[226:227], v232 offset:2048
v_mfma_f32_16x16x32_bf16 v[116:119], a[228:231], a[108:111], v[116:119]
s_waitcnt lgkmcnt(8)
buffer_load_dwordx4 v250, s[36:39], s49 offen offset:2048 lds
v_mfma_f32_16x16x32_bf16 v[104:107], a[208:211], a[120:123], v[104:107]
s_add_u32 s60, s71, 16
ds_read_b64_tr_b16 a[228:229], v233 offset:0
v_mfma_f32_16x16x32_bf16 v[108:111], a[208:211], a[124:127], v[108:111]
s_mul_i32 s77, s60, 11
ds_read_b64_tr_b16 a[230:231], v233 offset:2048
v_mfma_f32_16x16x32_bf16 v[112:115], a[208:211], a[128:131], v[112:115]
s_waitcnt lgkmcnt(8)
buffer_load_dwordx4 v251, s[36:39], s49 offen offset:3072 lds
v_mfma_f32_16x16x32_bf16 v[124:127], a[212:215], a[128:131], v[124:127]
s_add_u32 m0, s48, 49152
ds_read_b64_tr_b16 a[208:209], v232 offset:4096
s_add_u32 s49, s70, s1
v_mfma_f32_16x16x32_bf16 v[120:123], a[212:215], a[124:127], v[120:123]
s_add_u32 s49, s49, 114688
ds_read_b64_tr_b16 a[210:211], v232 offset:6144
v_mfma_f32_16x16x32_bf16 v[116:119], a[212:215], a[120:123], v[116:119]
s_waitcnt lgkmcnt(8)
s_cmp_eq_u32 s71, 6
s_cselect_b32 s51, 0x40000000, s52
buffer_store_dwordx4 v[200:203], v28, s[40:43], s51 offen sc1
s_cbranch_scc0 L_ow6
v_accvgpr_write_b32 a28, v200
v_accvgpr_write_b32 a29, v201
v_accvgpr_write_b32 a30, v202
v_accvgpr_write_b32 a31, v203
L_ow6:
v_mfma_f32_16x16x32_bf16 v[104:107], a[216:219], a[132:135], v[104:107]
s_lshr_b32 s77, s77, 5
ds_read_b64_tr_b16 a[212:213], v233 offset:4096
v_cvt_pk_bf16_f32 v204, v84, v85
v_mfma_f32_16x16x32_bf16 v[108:111], a[216:219], a[136:139], v[108:111]
s_mul_i32 s61, s77, 3
ds_read_b64_tr_b16 a[214:215], v233 offset:6144
v_cvt_pk_bf16_f32 v205, v86, v87
v_mfma_f32_16x16x32_bf16 v[112:115], a[216:219], a[140:143], v[112:115]
s_waitcnt lgkmcnt(8)
buffer_load_dwordx4 v248, s[36:39], s49 offen lds
v_mfma_f32_16x16x32_bf16 v[124:127], a[220:223], a[140:143], v[124:127]
s_sub_u32 s60, s60, s61
ds_read_b64_tr_b16 a[216:217], v232 offset:8192
v_cvt_pk_bf16_f32 v206, v96, v97
v_mfma_f32_16x16x32_bf16 v[120:123], a[220:223], a[136:139], v[120:123]
s_and_b32 s61, s54, 1
ds_read_b64_tr_b16 a[218:219], v232 offset:10240
v_cvt_pk_bf16_f32 v207, v98, v99
v_mfma_f32_16x16x32_bf16 v[116:119], a[220:223], a[132:135], v[116:119]
s_waitcnt lgkmcnt(8)
buffer_load_dwordx4 v249, s[36:39], s49 offen offset:1024 lds
v_mfma_f32_16x16x32_bf16 v[104:107], a[224:227], a[144:147], v[104:107]
s_add_u32 s52, s52, 8192
ds_read_b64_tr_b16 a[220:221], v233 offset:8192
v_mfma_f32_16x16x32_bf16 v[108:111], a[224:227], a[148:151], v[108:111]
s_lshl_b32 s79, s61, 2
ds_read_b64_tr_b16 a[222:223], v233 offset:10240
v_mfma_f32_16x16x32_bf16 v[112:115], a[224:227], a[152:155], v[112:115]
s_waitcnt lgkmcnt(8)
s_cmp_eq_u32 s71, 7
s_cselect_b32 s51, 0x40000000, s52
buffer_store_dwordx4 v[204:207], v28, s[40:43], s51 offen sc1
s_cbranch_scc0 L_ow7
v_accvgpr_write_b32 a28, v204
v_accvgpr_write_b32 a29, v205
v_accvgpr_write_b32 a30, v206
v_accvgpr_write_b32 a31, v207
L_ow7:
v_mfma_f32_16x16x32_bf16 v[124:127], a[228:231], a[152:155], v[124:127]
s_add_u32 s79, s79, s55
ds_read_b64_tr_b16 a[224:225], v232 offset:12288
v_cvt_pk_bf16_f32 v208, v88, v89
v_mfma_f32_16x16x32_bf16 v[120:123], a[228:231], a[148:151], v[120:123]
s_lshl_b32 s79, s79, 9
ds_read_b64_tr_b16 a[226:227], v232 offset:14336
v_cvt_pk_bf16_f32 v209, v90, v91
v_mfma_f32_16x16x32_bf16 v[116:119], a[228:231], a[144:147], v[116:119]
s_waitcnt lgkmcnt(8)
buffer_load_dwordx4 v250, s[36:39], s49 offen offset:2048 lds
v_cvt_pk_bf16_f32 v210, v100, v101
v_cvt_pk_bf16_f32 v211, v102, v103
s_add_u32 s52, s52, 8192
s_cmp_eq_u32 s71, 0
s_cselect_b32 s51, 0x40000000, s52
buffer_store_dwordx4 v[208:211], v28, s[40:43], s51 offen sc1
s_cbranch_scc0 L_ow8
v_accvgpr_write_b32 a60, v208
v_accvgpr_write_b32 a61, v209
v_accvgpr_write_b32 a62, v210
v_accvgpr_write_b32 a63, v211
L_ow8:
v_mfma_f32_16x16x32_bf16 v[104:107], a[208:211], a[156:159], v[104:107]
s_lshl_b32 s61, s61, 1
ds_read_b64_tr_b16 a[228:229], v233 offset:12288
v_mfma_f32_16x16x32_bf16 v[108:111], a[208:211], a[160:163], v[108:111]
s_and_b32 s72, s55, 1
ds_read_b64_tr_b16 a[230:231], v233 offset:14336
v_mfma_f32_16x16x32_bf16 v[112:115], a[208:211], a[164:167], v[112:115]
s_waitcnt lgkmcnt(8)
buffer_load_dwordx4 v251, s[36:39], s49 offen offset:3072 lds
v_mfma_f32_16x16x32_bf16 v[124:127], a[212:215], a[164:167], v[124:127]
s_waitcnt vmcnt(28)
s_barrier
v_add_u32 v232, 4294934528, v232
v_mfma_f32_16x16x32_bf16 v[120:123], a[212:215], a[160:163], v[120:123]
s_add_u32 s61, s61, s72
ds_read_b64_tr_b16 a[208:209], v232 offset:0
v_mfma_f32_16x16x32_bf16 v[116:119], a[212:215], a[156:159], v[116:119]
s_waitcnt lgkmcnt(7)
ds_read_b64_tr_b16 a[210:211], v232 offset:2048
v_mfma_f32_16x16x32_bf16 v[104:107], a[216:219], a[168:171], v[104:107]
s_mul_i32 s61, s61, 3
v_add_u32 v233, 4294934528, v233
v_mfma_f32_16x16x32_bf16 v[108:111], a[216:219], a[172:175], v[108:111]
s_add_u32 s60, s60, s61
ds_read_b64_tr_b16 a[212:213], v233 offset:0
v_mfma_f32_16x16x32_bf16 v[112:115], a[216:219], a[176:179], v[112:115]
s_waitcnt lgkmcnt(7)
ds_read_b64_tr_b16 a[214:215], v233 offset:2048
v_mfma_f32_16x16x32_bf16 v[124:127], a[220:223], a[176:179], v[124:127]
s_add_u32 s61, s77, s57
ds_read_b64_tr_b16 a[216:217], v232 offset:4096
v_mfma_f32_16x16x32_bf16 v[120:123], a[220:223], a[172:175], v[120:123]
s_cmp_ge_u32 s61, 7
s_cselect_b32 s72, 7, 0
ds_read_b64_tr_b16 a[218:219], v232 offset:6144
v_mfma_f32_16x16x32_bf16 v[116:119], a[220:223], a[168:171], v[116:119]
s_waitcnt lgkmcnt(8)
v_mfma_f32_16x16x32_bf16 v[104:107], a[224:227], a[180:183], v[104:107]
s_sub_u32 s61, s61, s72
ds_read_b64_tr_b16 a[220:221], v233 offset:4096
v_mfma_f32_16x16x32_bf16 v[108:111], a[224:227], a[184:187], v[108:111]
s_lshl_b32 s61, s61, 1
ds_read_b64_tr_b16 a[222:223], v233 offset:6144
v_mfma_f32_16x16x32_bf16 v[112:115], a[224:227], a[188:191], v[112:115]
s_waitcnt lgkmcnt(8)
v_mfma_f32_16x16x32_bf16 v[124:127], a[228:231], a[188:191], v[124:127]
s_lshr_b32 s72, s55, 1
ds_read_b64_tr_b16 a[224:225], v232 offset:8192
v_mfma_f32_16x16x32_bf16 v[120:123], a[228:231], a[184:187], v[120:123]
s_add_u32 s61, s61, s72
ds_read_b64_tr_b16 a[226:227], v232 offset:10240
v_mfma_f32_16x16x32_bf16 v[116:119], a[228:231], a[180:183], v[116:119]
s_waitcnt lgkmcnt(8)
v_mfma_f32_16x16x32_bf16 v[128:131], a[208:211], a[96:99], v[128:131]
s_mul_i32 s72, s61, 12
ds_read_b64_tr_b16 a[228:229], v233 offset:8192
v_mfma_f32_16x16x32_bf16 v[132:135], a[208:211], a[100:103], v[132:135]
s_add_u32 s72, s72, s60
ds_read_b64_tr_b16 a[230:231], v233 offset:10240
v_mfma_f32_16x16x32_bf16 v[136:139], a[208:211], a[104:107], v[136:139]
s_waitcnt lgkmcnt(8)
v_mfma_f32_16x16x32_bf16 v[148:151], a[212:215], a[104:107], v[148:151]
s_lshl_b32 s26, s72, 13
ds_read_b64_tr_b16 a[208:209], v232 offset:12288
v_cvt_pk_bf16_f32 v200, v104, v105
v_mfma_f32_16x16x32_bf16 v[144:147], a[212:215], a[100:103], v[144:147]
s_lshl_b32 s61, s61, 6
ds_read_b64_tr_b16 a[210:211], v232 offset:14336
v_cvt_pk_bf16_f32 v201, v106, v107
v_mfma_f32_16x16x32_bf16 v[140:143], a[212:215], a[96:99], v[140:143]
s_waitcnt lgkmcnt(8)
v_cvt_pk_bf16_f32 v202, v116, v117
v_cvt_pk_bf16_f32 v203, v118, v119
v_mfma_f32_16x16x32_bf16 v[128:131], a[216:219], a[108:111], v[128:131]
s_mul_i32 s52, s67, 1536
ds_read_b64_tr_b16 a[212:213], v233 offset:12288
v_mfma_f32_16x16x32_bf16 v[132:135], a[216:219], a[112:115], v[132:135]
s_mul_i32 s29, s53, 12
ds_read_b64_tr_b16 a[214:215], v233 offset:14336
v_mfma_f32_16x16x32_bf16 v[136:139], a[216:219], a[116:119], v[136:139]
s_waitcnt lgkmcnt(8)
s_cmp_eq_u32 s71, 1
s_cselect_b32 s51, 0x40000000, s52
buffer_store_dwordx4 v[200:203], v28, s[40:43], s51 offen sc1
s_cbranch_scc0 L_ow9
v_accvgpr_write_b32 a60, v200
v_accvgpr_write_b32 a61, v201
v_accvgpr_write_b32 a62, v202
v_accvgpr_write_b32 a63, v203
L_ow9:
v_mfma_f32_16x16x32_bf16 v[148:151], a[220:223], a[116:119], v[148:151]
s_waitcnt vmcnt(23)
s_barrier
v_add_u32 v232, 98304, v232
v_mfma_f32_16x16x32_bf16 v[144:147], a[220:223], a[112:115], v[144:147]
s_add_u32 s29, s29, s60
ds_read_b64_tr_b16 a[216:217], v232 offset:49152
v_cvt_pk_bf16_f32 v204, v108, v109
v_mfma_f32_16x16x32_bf16 v[140:143], a[220:223], a[108:111], v[140:143]
s_waitcnt lgkmcnt(7)
ds_read_b64_tr_b16 a[218:219], v232 offset:51200
v_cvt_pk_bf16_f32 v205, v110, v111
v_mfma_f32_16x16x32_bf16 v[128:131], a[224:227], a[120:123], v[128:131]
s_mul_i32 s29, s29, 14336
v_add_u32 v233, 98304, v233
v_cvt_pk_bf16_f32 v206, v120, v121
v_mfma_f32_16x16x32_bf16 v[132:135], a[224:227], a[124:127], v[132:135]
s_add_u32 s29, s29, s61
ds_read_b64_tr_b16 a[220:221], v233 offset:49152
v_cvt_pk_bf16_f32 v207, v122, v123
v_mfma_f32_16x16x32_bf16 v[136:139], a[224:227], a[128:131], v[136:139]
s_waitcnt lgkmcnt(7)
ds_read_b64_tr_b16 a[222:223], v233 offset:51200
s_add_u32 s52, s52, 8192
v_mfma_f32_16x16x32_bf16 v[148:151], a[228:231], a[128:131], v[148:151]
s_add_u32 s77, s77, 1
ds_read_b64_tr_b16 a[224:225], v232 offset:53248
v_mfma_f32_16x16x32_bf16 v[144:147], a[228:231], a[124:127], v[144:147]
s_cmp_gt_u32 s77, 7
s_cselect_b32 s26, 0x40000000, s26
s_cselect_b32 s29, 0x40000000, s29
s_cselect_b32 s77, 0, s77
v_mfma_f32_16x16x32_bf16 v[140:143], a[228:231], a[120:123], v[140:143]
s_waitcnt lgkmcnt(7)
ds_read_b64_tr_b16 a[226:227], v232 offset:55296
v_mfma_f32_16x16x32_bf16 v[128:131], a[208:211], a[132:135], v[128:131]
ds_read_b64_tr_b16 a[228:229], v233 offset:53248
v_mfma_f32_16x16x32_bf16 v[132:135], a[208:211], a[136:139], v[132:135]
ds_read_b64_tr_b16 a[230:231], v233 offset:55296
v_mfma_f32_16x16x32_bf16 v[136:139], a[208:211], a[140:143], v[136:139]
s_waitcnt lgkmcnt(8)
s_cmp_eq_u32 s71, 2
s_cselect_b32 s51, 0x40000000, s52
buffer_store_dwordx4 v[204:207], v28, s[40:43], s51 offen sc1
s_cbranch_scc0 L_ow10
v_accvgpr_write_b32 a60, v204
v_accvgpr_write_b32 a61, v205
v_accvgpr_write_b32 a62, v206
v_accvgpr_write_b32 a63, v207
L_ow10:
v_mfma_f32_16x16x32_bf16 v[148:151], a[212:215], a[140:143], v[148:151]
ds_read_b64_tr_b16 a[208:209], v232 offset:57344
v_cvt_pk_bf16_f32 v208, v112, v113
v_mfma_f32_16x16x32_bf16 v[144:147], a[212:215], a[136:139], v[144:147]
ds_read_b64_tr_b16 a[210:211], v232 offset:59392
v_cvt_pk_bf16_f32 v209, v114, v115
v_mfma_f32_16x16x32_bf16 v[140:143], a[212:215], a[132:135], v[140:143]
s_waitcnt lgkmcnt(8)
v_cvt_pk_bf16_f32 v210, v124, v125
v_cvt_pk_bf16_f32 v211, v126, v127
v_mfma_f32_16x16x32_bf16 v[128:131], a[216:219], a[144:147], v[128:131]
s_add_u32 s52, s52, 8192
ds_read_b64_tr_b16 a[212:213], v233 offset:57344
v_mfma_f32_16x16x32_bf16 v[132:135], a[216:219], a[148:151], v[132:135]
ds_read_b64_tr_b16 a[214:215], v233 offset:59392
v_mfma_f32_16x16x32_bf16 v[136:139], a[216:219], a[152:155], v[136:139]
s_waitcnt lgkmcnt(8)
s_cmp_eq_u32 s71, 3
s_cselect_b32 s51, 0x40000000, s52
buffer_store_dwordx4 v[208:211], v28, s[40:43], s51 offen sc1
s_cbranch_scc0 L_ow11
v_accvgpr_write_b32 a60, v208
v_accvgpr_write_b32 a61, v209
v_accvgpr_write_b32 a62, v210
v_accvgpr_write_b32 a63, v211
L_ow11:
v_mfma_f32_16x16x32_bf16 v[148:151], a[220:223], a[152:155], v[148:151]
ds_read_b64_tr_b16 a[216:217], v232 offset:61440
v_mfma_f32_16x16x32_bf16 v[144:147], a[220:223], a[148:151], v[144:147]
ds_read_b64_tr_b16 a[218:219], v232 offset:63488
v_mfma_f32_16x16x32_bf16 v[140:143], a[220:223], a[144:147], v[140:143]
s_waitcnt lgkmcnt(8)
v_mfma_f32_16x16x32_bf16 v[128:131], a[224:227], a[156:159], v[128:131]
ds_read_b64_tr_b16 a[220:221], v233 offset:61440
v_mfma_f32_16x16x32_bf16 v[132:135], a[224:227], a[160:163], v[132:135]
ds_read_b64_tr_b16 a[222:223], v233 offset:63488
v_mfma_f32_16x16x32_bf16 v[136:139], a[224:227], a[164:167], v[136:139]
s_waitcnt lgkmcnt(8)
v_mfma_f32_16x16x32_bf16 v[148:151], a[228:231], a[164:167], v[148:151]
s_waitcnt vmcnt(20)
s_barrier
ds_read_b64_tr_b16 a[224:225], v232 offset:32768
v_mfma_f32_16x16x32_bf16 v[144:147], a[228:231], a[160:163], v[144:147]
ds_read_b64_tr_b16 a[226:227], v232 offset:34816
v_mfma_f32_16x16x32_bf16 v[140:143], a[228:231], a[156:159], v[140:143]
s_waitcnt lgkmcnt(8)
v_mfma_f32_16x16x32_bf16 v[128:131], a[208:211], a[168:171], v[128:131]
ds_read_b64_tr_b16 a[228:229], v233 offset:32768
v_mfma_f32_16x16x32_bf16 v[132:135], a[208:211], a[172:175], v[132:135]
ds_read_b64_tr_b16 a[230:231], v233 offset:34816
v_mfma_f32_16x16x32_bf16 v[136:139], a[208:211], a[176:179], v[136:139]
s_waitcnt lgkmcnt(8)
v_mfma_f32_16x16x32_bf16 v[148:151], a[212:215], a[176:179], v[148:151]
ds_read_b64_tr_b16 a[208:209], v232 offset:36864
v_mfma_f32_16x16x32_bf16 v[144:147], a[212:215], a[172:175], v[144:147]
ds_read_b64_tr_b16 a[210:211], v232 offset:38912
v_mfma_f32_16x16x32_bf16 v[140:143], a[212:215], a[168:171], v[140:143]
s_waitcnt lgkmcnt(8)
v_mfma_f32_16x16x32_bf16 v[128:131], a[216:219], a[180:183], v[128:131]
ds_read_b64_tr_b16 a[212:213], v233 offset:36864
v_mfma_f32_16x16x32_bf16 v[132:135], a[216:219], a[184:187], v[132:135]
ds_read_b64_tr_b16 a[214:215], v233 offset:38912
v_mfma_f32_16x16x32_bf16 v[136:139], a[216:219], a[188:191], v[136:139]
s_waitcnt lgkmcnt(8)
v_mfma_f32_16x16x32_bf16 v[148:151], a[220:223], a[188:191], v[148:151]
ds_read_b64_tr_b16 a[216:217], v232 offset:40960
v_mfma_f32_16x16x32_bf16 v[144:147], a[220:223], a[184:187], v[144:147]
ds_read_b64_tr_b16 a[218:219], v232 offset:43008
v_mfma_f32_16x16x32_bf16 v[140:143], a[220:223], a[180:183], v[140:143]
s_waitcnt lgkmcnt(8)
v_mfma_f32_16x16x32_bf16 v[152:155], a[224:227], a[96:99], v[152:155]
ds_read_b64_tr_b16 a[220:221], v233 offset:40960
v_mfma_f32_16x16x32_bf16 v[156:159], a[224:227], a[100:103], v[156:159]
s_waitcnt vmcnt(4)
v_mov_b32 v246, 3
buffer_store_dword v246, v241, s[44:47], 0 offen sc1
v_mfma_f32_16x16x32_bf16 v[160:163], a[224:227], a[104:107], v[160:163]
s_waitcnt lgkmcnt(7)
ds_read_b64_tr_b16 a[222:223], v233 offset:43008
v_mfma_f32_16x16x32_bf16 v[172:175], a[228:231], a[104:107], v[172:175]
ds_read_b64_tr_b16 a[224:225], v232 offset:45056
v_cvt_pk_bf16_f32 v200, v128, v129
v_mfma_f32_16x16x32_bf16 v[168:171], a[228:231], a[100:103], v[168:171]
ds_read_b64_tr_b16 a[226:227], v232 offset:47104
v_cvt_pk_bf16_f32 v201, v130, v131
v_mfma_f32_16x16x32_bf16 v[164:167], a[228:231], a[96:99], v[164:167]
s_waitcnt lgkmcnt(8)
v_cvt_pk_bf16_f32 v202, v140, v141
v_cvt_pk_bf16_f32 v203, v142, v143
v_mfma_f32_16x16x32_bf16 v[152:155], a[208:211], a[108:111], v[152:155]
s_mul_i32 s52, s68, 1536
ds_read_b64_tr_b16 a[228:229], v233 offset:45056
v_mfma_f32_16x16x32_bf16 v[156:159], a[208:211], a[112:115], v[156:159]
ds_read_b64_tr_b16 a[230:231], v233 offset:47104
v_mfma_f32_16x16x32_bf16 v[160:163], a[208:211], a[116:119], v[160:163]
s_waitcnt lgkmcnt(8)
s_cmp_eq_u32 s71, 4
s_cselect_b32 s51, 0x40000000, s52
buffer_store_dwordx4 v[200:203], v28, s[40:43], s51 offen sc1
s_cbranch_scc0 L_ow12
v_accvgpr_write_b32 a60, v200
v_accvgpr_write_b32 a61, v201
v_accvgpr_write_b32 a62, v202
v_accvgpr_write_b32 a63, v203
L_ow12:
v_mfma_f32_16x16x32_bf16 v[172:175], a[212:215], a[116:119], v[172:175]
s_barrier
ds_read_b64_tr_b16 a[208:209], v232 offset:16384
v_mfma_f32_16x16x32_bf16 v[168:171], a[212:215], a[112:115], v[168:171]
ds_read_b64_tr_b16 a[210:211], v232 offset:18432
v_cvt_pk_bf16_f32 v204, v132, v133
v_mfma_f32_16x16x32_bf16 v[164:167], a[212:215], a[108:111], v[164:167]
s_waitcnt lgkmcnt(8)
v_cvt_pk_bf16_f32 v205, v134, v135
v_cvt_pk_bf16_f32 v206, v144, v145
v_mfma_f32_16x16x32_bf16 v[152:155], a[216:219], a[120:123], v[152:155]
ds_read_b64_tr_b16 a[212:213], v233 offset:16384
v_cvt_pk_bf16_f32 v207, v146, v147
v_mfma_f32_16x16x32_bf16 v[156:159], a[216:219], a[124:127], v[156:159]
s_add_u32 s52, s52, 8192
ds_read_b64_tr_b16 a[214:215], v233 offset:18432
v_mfma_f32_16x16x32_bf16 v[160:163], a[216:219], a[128:131], v[160:163]
s_waitcnt lgkmcnt(8)
s_cmp_eq_u32 s71, 5
s_cselect_b32 s51, 0x40000000, s52
buffer_store_dwordx4 v[204:207], v28, s[40:43], s51 offen sc1
s_cbranch_scc0 L_ow13
v_accvgpr_write_b32 a60, v204
v_accvgpr_write_b32 a61, v205
v_accvgpr_write_b32 a62, v206
v_accvgpr_write_b32 a63, v207
L_ow13:
v_mfma_f32_16x16x32_bf16 v[172:175], a[220:223], a[128:131], v[172:175]
ds_read_b64_tr_b16 a[216:217], v232 offset:20480
v_cvt_pk_bf16_f32 v208, v136, v137
v_mfma_f32_16x16x32_bf16 v[168:171], a[220:223], a[124:127], v[168:171]
ds_read_b64_tr_b16 a[218:219], v232 offset:22528
v_cvt_pk_bf16_f32 v209, v138, v139
v_mfma_f32_16x16x32_bf16 v[164:167], a[220:223], a[120:123], v[164:167]
s_waitcnt lgkmcnt(8)
v_cvt_pk_bf16_f32 v210, v148, v149
v_cvt_pk_bf16_f32 v211, v150, v151
v_mfma_f32_16x16x32_bf16 v[152:155], a[224:227], a[132:135], v[152:155]
s_add_u32 s52, s52, 8192
ds_read_b64_tr_b16 a[220:221], v233 offset:20480
v_mfma_f32_16x16x32_bf16 v[156:159], a[224:227], a[136:139], v[156:159]
ds_read_b64_tr_b16 a[222:223], v233 offset:22528
v_mfma_f32_16x16x32_bf16 v[160:163], a[224:227], a[140:143], v[160:163]
s_waitcnt lgkmcnt(8)
s_cmp_eq_u32 s71, 6
s_cselect_b32 s51, 0x40000000, s52
buffer_store_dwordx4 v[208:211], v28, s[40:43], s51 offen sc1
s_cbranch_scc0 L_ow14
v_accvgpr_write_b32 a60, v208
v_accvgpr_write_b32 a61, v209
v_accvgpr_write_b32 a62, v210
v_accvgpr_write_b32 a63, v211
L_ow14:
v_mfma_f32_16x16x32_bf16 v[172:175], a[228:231], a[140:143], v[172:175]
ds_read_b64_tr_b16 a[224:225], v232 offset:24576
v_mfma_f32_16x16x32_bf16 v[168:171], a[228:231], a[136:139], v[168:171]
ds_read_b64_tr_b16 a[226:227], v232 offset:26624
v_mfma_f32_16x16x32_bf16 v[164:167], a[228:231], a[132:135], v[164:167]
s_waitcnt lgkmcnt(8)
v_mfma_f32_16x16x32_bf16 v[152:155], a[208:211], a[144:147], v[152:155]
ds_read_b64_tr_b16 a[228:229], v233 offset:24576
v_mfma_f32_16x16x32_bf16 v[156:159], a[208:211], a[148:151], v[156:159]
ds_read_b64_tr_b16 a[230:231], v233 offset:26624
v_mfma_f32_16x16x32_bf16 v[160:163], a[208:211], a[152:155], v[160:163]
s_waitcnt lgkmcnt(8)
v_mfma_f32_16x16x32_bf16 v[172:175], a[212:215], a[152:155], v[172:175]
ds_read_b64_tr_b16 a[208:209], v232 offset:28672
v_mfma_f32_16x16x32_bf16 v[168:171], a[212:215], a[148:151], v[168:171]
ds_read_b64_tr_b16 a[210:211], v232 offset:30720
v_mfma_f32_16x16x32_bf16 v[164:167], a[212:215], a[144:147], v[164:167]
s_waitcnt lgkmcnt(8)
v_mfma_f32_16x16x32_bf16 v[152:155], a[216:219], a[156:159], v[152:155]
ds_read_b64_tr_b16 a[212:213], v233 offset:28672
v_mfma_f32_16x16x32_bf16 v[156:159], a[216:219], a[160:163], v[156:159]
ds_read_b64_tr_b16 a[214:215], v233 offset:30720
v_mfma_f32_16x16x32_bf16 v[160:163], a[216:219], a[164:167], v[160:163]
s_waitcnt lgkmcnt(8)
v_mfma_f32_16x16x32_bf16 v[172:175], a[220:223], a[164:167], v[172:175]
s_barrier
ds_read_b64_tr_b16 a[216:217], v232 offset:0
v_mfma_f32_16x16x32_bf16 v[168:171], a[220:223], a[160:163], v[168:171]
ds_read_b64_tr_b16 a[218:219], v232 offset:2048
v_mfma_f32_16x16x32_bf16 v[164:167], a[220:223], a[156:159], v[164:167]
s_waitcnt lgkmcnt(8)
v_mfma_f32_16x16x32_bf16 v[152:155], a[224:227], a[168:171], v[152:155]
ds_read_b64_tr_b16 a[220:221], v233 offset:0
v_mfma_f32_16x16x32_bf16 v[156:159], a[224:227], a[172:175], v[156:159]
ds_read_b64_tr_b16 a[222:223], v233 offset:2048
v_mfma_f32_16x16x32_bf16 v[160:163], a[224:227], a[176:179], v[160:163]
s_waitcnt lgkmcnt(8)
v_mfma_f32_16x16x32_bf16 v[172:175], a[228:231], a[176:179], v[172:175]
ds_read_b64_tr_b16 a[224:225], v232 offset:4096
v_mfma_f32_16x16x32_bf16 v[168:171], a[228:231], a[172:175], v[168:171]
ds_read_b64_tr_b16 a[226:227], v232 offset:6144
v_mfma_f32_16x16x32_bf16 v[164:167], a[228:231], a[168:171], v[164:167]
s_waitcnt lgkmcnt(8)
v_mfma_f32_16x16x32_bf16 v[152:155], a[208:211], a[180:183], v[152:155]
ds_read_b64_tr_b16 a[228:229], v233 offset:4096
v_mfma_f32_16x16x32_bf16 v[156:159], a[208:211], a[184:187], v[156:159]
ds_read_b64_tr_b16 a[230:231], v233 offset:6144
v_mfma_f32_16x16x32_bf16 v[160:163], a[208:211], a[188:191], v[160:163]
s_waitcnt lgkmcnt(8)
v_mfma_f32_16x16x32_bf16 v[172:175], a[212:215], a[188:191], v[172:175]
ds_read_b64_tr_b16 a[208:209], v232 offset:8192
v_mfma_f32_16x16x32_bf16 v[168:171], a[212:215], a[184:187], v[168:171]
ds_read_b64_tr_b16 a[210:211], v232 offset:10240
v_mfma_f32_16x16x32_bf16 v[164:167], a[212:215], a[180:183], v[164:167]
s_waitcnt lgkmcnt(8)
v_mfma_f32_16x16x32_bf16 v[176:179], a[216:219], a[96:99], v[176:179]
ds_read_b64_tr_b16 a[212:213], v233 offset:8192
v_mfma_f32_16x16x32_bf16 v[180:183], a[216:219], a[100:103], v[180:183]
ds_read_b64_tr_b16 a[214:215], v233 offset:10240
v_mfma_f32_16x16x32_bf16 v[184:187], a[216:219], a[104:107], v[184:187]
s_waitcnt lgkmcnt(8)
v_mfma_f32_16x16x32_bf16 v[196:199], a[220:223], a[104:107], v[196:199]
ds_read_b64_tr_b16 a[216:217], v232 offset:12288
v_cvt_pk_bf16_f32 v200, v152, v153
v_mfma_f32_16x16x32_bf16 v[192:195], a[220:223], a[100:103], v[192:195]
ds_read_b64_tr_b16 a[218:219], v232 offset:14336
v_cvt_pk_bf16_f32 v201, v154, v155
v_mfma_f32_16x16x32_bf16 v[188:191], a[220:223], a[96:99], v[188:191]
s_waitcnt lgkmcnt(8)
v_cvt_pk_bf16_f32 v202, v164, v165
v_cvt_pk_bf16_f32 v203, v166, v167
v_mfma_f32_16x16x32_bf16 v[176:179], a[224:227], a[108:111], v[176:179]
s_mul_i32 s52, s69, 1536
ds_read_b64_tr_b16 a[220:221], v233 offset:12288
v_mfma_f32_16x16x32_bf16 v[180:183], a[224:227], a[112:115], v[180:183]
ds_read_b64_tr_b16 a[222:223], v233 offset:14336
v_mfma_f32_16x16x32_bf16 v[184:187], a[224:227], a[116:119], v[184:187]
s_waitcnt lgkmcnt(8)
s_cmp_eq_u32 s71, 7
s_cselect_b32 s51, 0x40000000, s52
buffer_store_dwordx4 v[200:203], v28, s[40:43], s51 offen sc1
s_cbranch_scc0 L_ow15
v_accvgpr_write_b32 a60, v200
v_accvgpr_write_b32 a61, v201
v_accvgpr_write_b32 a62, v202
v_accvgpr_write_b32 a63, v203
L_ow15:
v_mfma_f32_16x16x32_bf16 v[196:199], a[228:231], a[116:119], v[196:199]
s_waitcnt vmcnt(8)
s_barrier
v_add_u32 v232, 4294918144, v232
v_mfma_f32_16x16x32_bf16 v[192:195], a[228:231], a[112:115], v[192:195]
ds_read_b64_tr_b16 a[224:225], v232 offset:0
v_cvt_pk_bf16_f32 v204, v156, v157
v_mfma_f32_16x16x32_bf16 v[188:191], a[228:231], a[108:111], v[188:191]
s_waitcnt lgkmcnt(7)
ds_read_b64_tr_b16 a[226:227], v232 offset:2048
v_cvt_pk_bf16_f32 v205, v158, v159
v_mfma_f32_16x16x32_bf16 v[176:179], a[208:211], a[120:123], v[176:179]
v_add_u32 v233, 4294918144, v233
v_cvt_pk_bf16_f32 v206, v168, v169
v_mfma_f32_16x16x32_bf16 v[180:183], a[208:211], a[124:127], v[180:183]
ds_read_b64_tr_b16 a[228:229], v233 offset:0
v_cvt_pk_bf16_f32 v207, v170, v171
v_mfma_f32_16x16x32_bf16 v[184:187], a[208:211], a[128:131], v[184:187]
s_waitcnt lgkmcnt(7)
ds_read_b64_tr_b16 a[230:231], v233 offset:2048
s_add_u32 s52, s52, 8192
v_mfma_f32_16x16x32_bf16 v[196:199], a[212:215], a[128:131], v[196:199]
ds_read_b64_tr_b16 a[208:209], v232 offset:4096
v_mfma_f32_16x16x32_bf16 v[192:195], a[212:215], a[124:127], v[192:195]
ds_read_b64_tr_b16 a[210:211], v232 offset:6144
v_mfma_f32_16x16x32_bf16 v[188:191], a[212:215], a[120:123], v[188:191]
s_waitcnt lgkmcnt(8)
s_cmp_eq_u32 s71, 0
s_cselect_b32 s51, 0x40000000, s52
buffer_store_dwordx4 v[204:207], v28, s[40:43], s51 offen sc1
s_cbranch_scc0 L_ow16
v_accvgpr_write_b32 a92, v204
v_accvgpr_write_b32 a93, v205
v_accvgpr_write_b32 a94, v206
v_accvgpr_write_b32 a95, v207
L_ow16:
v_mfma_f32_16x16x32_bf16 v[176:179], a[216:219], a[132:135], v[176:179]
ds_read_b64_tr_b16 a[212:213], v233 offset:4096
v_cvt_pk_bf16_f32 v208, v160, v161
v_mfma_f32_16x16x32_bf16 v[180:183], a[216:219], a[136:139], v[180:183]
buffer_load_dword v244, v243, s[44:47], s31 offen sc1
v_mfma_f32_16x16x32_bf16 v[184:187], a[216:219], a[140:143], v[184:187]
s_waitcnt lgkmcnt(7)
ds_read_b64_tr_b16 a[214:215], v233 offset:6144
v_cvt_pk_bf16_f32 v209, v162, v163
v_mfma_f32_16x16x32_bf16 v[196:199], a[220:223], a[140:143], v[196:199]
ds_read_b64_tr_b16 a[216:217], v232 offset:8192
v_cvt_pk_bf16_f32 v210, v172, v173
v_mfma_f32_16x16x32_bf16 v[192:195], a[220:223], a[136:139], v[192:195]
ds_read_b64_tr_b16 a[218:219], v232 offset:10240
v_cvt_pk_bf16_f32 v211, v174, v175
v_mfma_f32_16x16x32_bf16 v[188:191], a[220:223], a[132:135], v[188:191]
s_waitcnt lgkmcnt(8)
s_add_u32 s52, s52, 8192
v_mfma_f32_16x16x32_bf16 v[176:179], a[224:227], a[144:147], v[176:179]
ds_read_b64_tr_b16 a[220:221], v233 offset:8192
v_mfma_f32_16x16x32_bf16 v[180:183], a[224:227], a[148:151], v[180:183]
ds_read_b64_tr_b16 a[222:223], v233 offset:10240
v_mfma_f32_16x16x32_bf16 v[184:187], a[224:227], a[152:155], v[184:187]
s_waitcnt lgkmcnt(8)
s_cmp_eq_u32 s71, 1
s_cselect_b32 s51, 0x40000000, s52
buffer_store_dwordx4 v[208:211], v28, s[40:43], s51 offen sc1
s_cbranch_scc0 L_ow17
v_accvgpr_write_b32 a92, v208
v_accvgpr_write_b32 a93, v209
v_accvgpr_write_b32 a94, v210
v_accvgpr_write_b32 a95, v211
L_ow17:
v_mfma_f32_16x16x32_bf16 v[196:199], a[228:231], a[152:155], v[196:199]
ds_read_b64_tr_b16 a[224:225], v232 offset:12288
v_mfma_f32_16x16x32_bf16 v[192:195], a[228:231], a[148:151], v[192:195]
ds_read_b64_tr_b16 a[226:227], v232 offset:14336
v_mfma_f32_16x16x32_bf16 v[188:191], a[228:231], a[144:147], v[188:191]
s_waitcnt lgkmcnt(8)
v_mfma_f32_16x16x32_bf16 v[176:179], a[208:211], a[156:159], v[176:179]
ds_read_b64_tr_b16 a[228:229], v233 offset:12288
v_mfma_f32_16x16x32_bf16 v[180:183], a[208:211], a[160:163], v[180:183]
ds_read_b64_tr_b16 a[230:231], v233 offset:14336
v_mfma_f32_16x16x32_bf16 v[184:187], a[208:211], a[164:167], v[184:187]
s_waitcnt lgkmcnt(8)
v_mfma_f32_16x16x32_bf16 v[196:199], a[212:215], a[164:167], v[196:199]
v_mfma_f32_16x16x32_bf16 v[192:195], a[212:215], a[160:163], v[192:195]
v_mfma_f32_16x16x32_bf16 v[188:191], a[212:215], a[156:159], v[188:191]
s_waitcnt lgkmcnt(6)
v_mfma_f32_16x16x32_bf16 v[176:179], a[216:219], a[168:171], v[176:179]
v_mfma_f32_16x16x32_bf16 v[180:183], a[216:219], a[172:175], v[180:183]
v_mfma_f32_16x16x32_bf16 v[184:187], a[216:219], a[176:179], v[184:187]
s_waitcnt lgkmcnt(4)
v_mfma_f32_16x16x32_bf16 v[196:199], a[220:223], a[176:179], v[196:199]
v_mfma_f32_16x16x32_bf16 v[192:195], a[220:223], a[172:175], v[192:195]
v_mfma_f32_16x16x32_bf16 v[188:191], a[220:223], a[168:171], v[188:191]
s_waitcnt lgkmcnt(2)
v_mfma_f32_16x16x32_bf16 v[176:179], a[224:227], a[180:183], v[176:179]
v_mfma_f32_16x16x32_bf16 v[180:183], a[224:227], a[184:187], v[180:183]
v_mfma_f32_16x16x32_bf16 v[184:187], a[224:227], a[188:191], v[184:187]
s_waitcnt lgkmcnt(0)
v_mfma_f32_16x16x32_bf16 v[196:199], a[228:231], a[188:191], v[196:199]
v_mfma_f32_16x16x32_bf16 v[192:195], a[228:231], a[184:187], v[192:195]
v_mfma_f32_16x16x32_bf16 v[188:191], a[228:231], a[180:183], v[188:191]
s_nop 1
v_cvt_pk_bf16_f32 v200, v176, v177
v_cvt_pk_bf16_f32 v201, v178, v179
s_nop 3
v_cvt_pk_bf16_f32 v202, v188, v189
v_cvt_pk_bf16_f32 v203, v190, v191
s_mul_i32 s52, s70, 1536
s_cmp_eq_u32 s71, 2
s_cselect_b32 s51, 0x40000000, s52
buffer_store_dwordx4 v[200:203], v28, s[40:43], s51 offen sc1
s_cbranch_scc0 L_ow18
v_accvgpr_write_b32 a92, v200
v_accvgpr_write_b32 a93, v201
v_accvgpr_write_b32 a94, v202
v_accvgpr_write_b32 a95, v203
L_ow18:
v_cvt_pk_bf16_f32 v204, v180, v181
v_cvt_pk_bf16_f32 v205, v182, v183
v_cvt_pk_bf16_f32 v206, v192, v193
v_cvt_pk_bf16_f32 v207, v194, v195
s_add_u32 s52, s52, 8192
s_cmp_eq_u32 s71, 3
s_cselect_b32 s51, 0x40000000, s52
buffer_store_dwordx4 v[204:207], v28, s[40:43], s51 offen sc1
s_cbranch_scc0 L_ow19
v_accvgpr_write_b32 a92, v204
v_accvgpr_write_b32 a93, v205
v_accvgpr_write_b32 a94, v206
v_accvgpr_write_b32 a95, v207
L_ow19:
v_cvt_pk_bf16_f32 v208, v184, v185
v_cvt_pk_bf16_f32 v209, v186, v187
v_cvt_pk_bf16_f32 v210, v196, v197
v_cvt_pk_bf16_f32 v211, v198, v199
s_add_u32 s52, s52, 8192
s_cmp_eq_u32 s71, 4
s_cselect_b32 s51, 0x40000000, s52
buffer_store_dwordx4 v[208:211], v28, s[40:43], s51 offen sc1
s_cbranch_scc0 L_ow20
v_accvgpr_write_b32 a92, v208
v_accvgpr_write_b32 a93, v209
v_accvgpr_write_b32 a94, v210
v_accvgpr_write_b32 a95, v211
L_ow20:
s_waitcnt vmcnt(3)
v_mov_b32 v246, 6
buffer_store_dword v246, v241, s[44:47], 0 offen sc1
v_cmp_gt_u32 vcc, s30, v244
s_cbranch_vccnz L_fl0_slow
L_fl0_ok:
buffer_load_dwordx4 a[0:3], v4, s[20:23], s24 offen sc1
buffer_load_dwordx4 a[4:7], v5, s[20:23], s24 offen sc1
buffer_load_dwordx4 a[8:11], v6, s[20:23], s24 offen sc1
buffer_load_dwordx4 a[12:15], v7, s[20:23], s24 offen sc1
buffer_load_dwordx4 a[16:19], v8, s[20:23], s24 offen sc1
buffer_load_dwordx4 a[20:23], v9, s[20:23], s24 offen sc1
buffer_load_dwordx4 a[24:27], v10, s[20:23], s24 offen sc1
s_waitcnt vmcnt(8)
v_mov_b32 v246, 7
buffer_store_dword v246, v241, s[44:47], 0 offen sc1
buffer_load_dword v253, v243, s[44:47], s78 offen sc1
s_waitcnt vmcnt(0)
v_cmp_gt_u32 vcc, s76, v253
s_cbranch_vccnz L_fl1_slow
L_fl1_ok:
buffer_load_dwordx4 a[32:35], v4, s[20:23], s25 offen sc1
buffer_load_dwordx4 a[36:39], v5, s[20:23], s25 offen sc1
buffer_load_dwordx4 a[40:43], v6, s[20:23], s25 offen sc1
buffer_load_dwordx4 a[44:47], v7, s[20:23], s25 offen sc1
buffer_load_dwordx4 a[48:51], v8, s[20:23], s25 offen sc1
buffer_load_dwordx4 a[52:55], v9, s[20:23], s25 offen sc1
buffer_load_dwordx4 a[56:59], v10, s[20:23], s25 offen sc1
v_mfma_f32_16x16x32_bf16 v[212:215], a[240:243], a[0:3], 0
v_mfma_f32_16x16x32_bf16 v[216:219], a[244:247], a[0:3], 0
v_mfma_f32_16x16x32_bf16 v[212:215], a[240:243], a[4:7], v[212:215]
v_mfma_f32_16x16x32_bf16 v[216:219], a[244:247], a[4:7], v[216:219]
v_mfma_f32_16x16x32_bf16 v[212:215], a[240:243], a[8:11], v[212:215]
v_mfma_f32_16x16x32_bf16 v[216:219], a[244:247], a[8:11], v[216:219]
v_mfma_f32_16x16x32_bf16 v[212:215], a[240:243], a[12:15], v[212:215]
v_mfma_f32_16x16x32_bf16 v[216:219], a[244:247], a[12:15], v[216:219]
v_mfma_f32_16x16x32_bf16 v[212:215], a[240:243], a[16:19], v[212:215]
v_mfma_f32_16x16x32_bf16 v[216:219], a[244:247], a[16:19], v[216:219]
v_mfma_f32_16x16x32_bf16 v[212:215], a[240:243], a[20:23], v[212:215]
v_mfma_f32_16x16x32_bf16 v[216:219], a[244:247], a[20:23], v[216:219]
v_mfma_f32_16x16x32_bf16 v[212:215], a[240:243], a[24:27], v[212:215]
v_mfma_f32_16x16x32_bf16 v[216:219], a[244:247], a[24:27], v[216:219]
v_mfma_f32_16x16x32_bf16 v[212:215], a[240:243], a[28:31], v[212:215]
v_mfma_f32_16x16x32_bf16 v[216:219], a[244:247], a[28:31], v[216:219]
s_nop 6
v_cvt_pk_bf16_f32 v220, v212, v213
v_cvt_pk_bf16_f32 v221, v214, v215
v_cvt_pk_bf16_f32 v222, v216, v217
v_cvt_pk_bf16_f32 v223, v218, v219
buffer_store_dwordx4 v[220:223], v245, s[32:35], s27 offen
v_cmp_gt_u32 vcc, s77, v253
s_cbranch_vccnz L_fl2_slow
L_fl2_ok:
buffer_load_dwordx4 a[64:67], v4, s[20:23], s26 offen sc1
buffer_load_dwordx4 a[68:71], v5, s[20:23], s26 offen sc1
buffer_load_dwordx4 a[72:75], v6, s[20:23], s26 offen sc1
buffer_load_dwordx4 a[76:79], v7, s[20:23], s26 offen sc1
buffer_load_dwordx4 a[80:83], v8, s[20:23], s26 offen sc1
buffer_load_dwordx4 a[84:87], v9, s[20:23], s26 offen sc1
buffer_load_dwordx4 a[88:91], v10, s[20:23], s26 offen sc1
s_waitcnt vmcnt(14)
v_mfma_f32_16x16x32_bf16 v[212:215], a[240:243], a[32:35], 0
v_mfma_f32_16x16x32_bf16 v[216:219], a[244:247], a[32:35], 0
s_waitcnt vmcnt(13)
v_mfma_f32_16x16x32_bf16 v[212:215], a[240:243], a[36:39], v[212:215]
v_mfma_f32_16x16x32_bf16 v[216:219], a[244:247], a[36:39], v[216:219]
s_waitcnt vmcnt(12)
v_mfma_f32_16x16x32_bf16 v[212:215], a[240:243], a[40:43], v[212:215]
v_mfma_f32_16x16x32_bf16 v[216:219], a[244:247], a[40:43], v[216:219]
s_waitcnt vmcnt(11)
v_mfma_f32_16x16x32_bf16 v[212:215], a[240:243], a[44:47], v[212:215]
v_mfma_f32_16x16x32_bf16 v[216:219], a[244:247], a[44:47], v[216:219]
s_waitcnt vmcnt(10)
v_mfma_f32_16x16x32_bf16 v[212:215], a[240:243], a[48:51], v[212:215]
v_mfma_f32_16x16x32_bf16 v[216:219], a[244:247], a[48:51], v[216:219]
s_waitcnt vmcnt(9)
v_mfma_f32_16x16x32_bf16 v[212:215], a[240:243], a[52:55], v[212:215]
v_mfma_f32_16x16x32_bf16 v[216:219], a[244:247], a[52:55], v[216:219]
s_waitcnt vmcnt(8)
v_mfma_f32_16x16x32_bf16 v[212:215], a[240:243], a[56:59], v[212:215]
v_mfma_f32_16x16x32_bf16 v[216:219], a[244:247], a[56:59], v[216:219]
v_mfma_f32_16x16x32_bf16 v[212:215], a[240:243], a[60:63], v[212:215]
v_mfma_f32_16x16x32_bf16 v[216:219], a[244:247], a[60:63], v[216:219]
s_nop 6
v_cvt_pk_bf16_f32 v220, v212, v213
v_cvt_pk_bf16_f32 v221, v214, v215
v_cvt_pk_bf16_f32 v222, v216, v217
v_cvt_pk_bf16_f32 v223, v218, v219
buffer_store_dwordx4 v[220:223], v245, s[32:35], s28 offen
s_waitcnt vmcnt(7)
v_mfma_f32_16x16x32_bf16 v[212:215], a[240:243], a[64:67], 0
v_mfma_f32_16x16x32_bf16 v[216:219], a[244:247], a[64:67], 0
s_waitcnt vmcnt(6)
v_mfma_f32_16x16x32_bf16 v[212:215], a[240:243], a[68:71], v[212:215]
v_mfma_f32_16x16x32_bf16 v[216:219], a[244:247], a[68:71], v[216:219]
s_waitcnt vmcnt(5)
v_mfma_f32_16x16x32_bf16 v[212:215], a[240:243], a[72:75], v[212:215]
v_mfma_f32_16x16x32_bf16 v[216:219], a[244:247], a[72:75], v[216:219]
s_waitcnt vmcnt(4)
v_mfma_f32_16x16x32_bf16 v[212:215], a[240:243], a[76:79], v[212:215]
v_mfma_f32_16x16x32_bf16 v[216:219], a[244:247], a[76:79], v[216:219]
s_waitcnt vmcnt(3)
v_mfma_f32_16x16x32_bf16 v[212:215], a[240:243], a[80:83], v[212:215]
v_mfma_f32_16x16x32_bf16 v[216:219], a[244:247], a[80:83], v[216:219]
s_waitcnt vmcnt(2)
v_mfma_f32_16x16x32_bf16 v[212:215], a[240:243], a[84:87], v[212:215]
v_mfma_f32_16x16x32_bf16 v[216:219], a[244:247], a[84:87], v[216:219]
s_waitcnt vmcnt(1)
v_mfma_f32_16x16x32_bf16 v[212:215], a[240:243], a[88:91], v[212:215]
v_mfma_f32_16x16x32_bf16 v[216:219], a[244:247], a[88:91], v[216:219]
v_mfma_f32_16x16x32_bf16 v[212:215], a[240:243], a[92:95], v[212:215]
v_mfma_f32_16x16x32_bf16 v[216:219], a[244:247], a[92:95], v[216:219]
s_nop 6
v_cvt_pk_bf16_f32 v220, v212, v213
v_cvt_pk_bf16_f32 v221, v214, v215
v_cvt_pk_bf16_f32 v222, v216, v217
v_cvt_pk_bf16_f32 v223, v218, v219
buffer_store_dwordx4 v[220:223], v245, s[32:35], s29 offen
L_end:
s_endpgm
L_ra0:
s_call_b64 s[58:59], L_newmax
s_branch L_skipa0
L_rb0:
s_call_b64 s[58:59], L_rescale
s_branch L_skipb0
L_ra1:
s_call_b64 s[58:59], L_newmax
s_branch L_skipa1
L_rb1:
s_call_b64 s[58:59], L_rescale
s_branch L_skipb1
L_ra2:
s_call_b64 s[58:59], L_newmax
s_branch L_skipa2
L_rb2:
s_call_b64 s[58:59], L_rescale
s_branch L_skipb2
L_ra3:
s_call_b64 s[58:59], L_newmax
s_branch L_skipa3
L_rb3:
s_call_b64 s[58:59], L_rescale
s_branch L_skipb3
L_ra4:
s_call_b64 s[58:59], L_newmax
s_branch L_skipa4
L_rb4:
s_call_b64 s[58:59], L_rescale
s_branch L_skipb4
L_ra5:
s_call_b64 s[58:59], L_newmax
s_branch L_skipa5
L_rb5:
s_call_b64 s[58:59], L_rescale
s_branch L_skipb5
L_ra6:
s_call_b64 s[58:59], L_newmax
s_branch L_skipa6
L_rb6:
s_call_b64 s[58:59], L_rescale
s_branch L_skipb6
L_ra7:
s_call_b64 s[58:59], L_newmax
s_branch L_skipa7
L_rb7:
s_call_b64 s[58:59], L_rescale
s_branch L_skipb7
L_ra8:
s_call_b64 s[58:59], L_newmax
s_branch L_skipa8
L_rb8:
s_call_b64 s[58:59], L_rescale
s_branch L_skipb8
L_ra9:
s_call_b64 s[58:59], L_newmax
s_branch L_skipa9
L_rb9:
s_call_b64 s[58:59], L_rescale
s_branch L_skipb9
L_ra10:
s_call_b64 s[58:59], L_newmax
s_branch L_skipa10
L_rb10:
s_call_b64 s[58:59], L_rescale
s_branch L_skipb10
L_ra11:
s_call_b64 s[58:59], L_newmax
s_branch L_skipa11
L_rb11:
s_call_b64 s[58:59], L_rescale
s_branch L_skipb11
L_ra12:
s_call_b64 s[58:59], L_newmax
s_branch L_skipa12
L_rb12:
s_call_b64 s[58:59], L_rescale
s_branch L_skipb12
L_ra13:
s_call_b64 s[58:59], L_newmax
s_branch L_skipa13
L_rb13:
s_call_b64 s[58:59], L_rescale
s_branch L_skipb13
L_ra14:
s_call_b64 s[58:59], L_newmax
s_branch L_skipa14
L_rb14:
s_call_b64 s[58:59], L_rescale
s_branch L_skipb14
L_rdy_slow:
s_mov_b32 s72, 0
L_rdy_loop:
s_sleep 1
global_load_dword v247, v246, s[16:17] offset:64 sc1
s_waitcnt vmcnt(0)
v_cmp_eq_u32 vcc, 0, v247
s_cbranch_vccz L_rdy_ok
s_add_u32 s72, s72, 1
s_cmp_lt_u32 s72, 0x40000
s_cbranch_scc1 L_rdy_loop
s_branch L_rdy_ok
L_xp_slow:
s_mov_b32 s72, 0
L_xp_loop:
s_sleep 1
buffer_load_dword v244, v252, s[44:47], s75 offen sc1
s_waitcnt vmcnt(0)
v_cmp_eq_u32 vcc, 0, v244
s_cbranch_vccz L_xp_ok
s_add_u32 s72, s72, 1
s_cmp_lt_u32 s72, 0x40000
s_cbranch_scc1 L_xp_loop
s_branch L_xp_ok
L_fl0_slow:
s_mov_b32 s72, 0
L_fl0_loop:
buffer_load_dword v244, v243, s[44:47], s31 offen sc1
s_waitcnt vmcnt(0)
v_cmp_gt_u32 vcc, s30, v244
s_cbranch_vccz L_fl0_ok
s_add_u32 s72, s72, 1
s_cmp_lt_u32 s72, 0x40000
s_cbranch_scc1 L_fl0_loop
s_branch L_fl0_ok
L_fl1_slow:
s_mov_b32 s72, 0
L_fl1_loop:
buffer_load_dword v253, v243, s[44:47], s78 offen sc1
s_waitcnt vmcnt(0)
v_cmp_gt_u32 vcc, s76, v253
s_cbranch_vccz L_fl1_ok
s_add_u32 s72, s72, 1
s_cmp_lt_u32 s72, 0x40000
s_cbranch_scc1 L_fl1_loop
s_branch L_fl1_ok
L_fl2_slow:
s_mov_b32 s72, 0
L_fl2_loop:
buffer_load_dword v253, v243, s[44:47], s79 offen sc1
s_waitcnt vmcnt(0)
v_cmp_gt_u32 vcc, s77, v253
s_cbranch_vccz L_fl2_ok
s_add_u32 s72, s72, 1
s_cmp_lt_u32 s72, 0x40000
s_cbranch_scc1 L_fl2_loop
s_branch L_fl2_ok
L_newmax:
s_nop 2
v_mov_b32 v164, v156
v_mov_b32 v165, v157
v_mov_b32 v166, v158
v_permlane32_swap_b32 v164, v156
v_permlane32_swap_b32 v165, v157
v_permlane32_swap_b32 v166, v158
v_max_f32 v156, v156, v164
v_max_f32 v157, v157, v165
v_max_f32 v158, v158, v166
v_mov_b32 v164, v156
v_mov_b32 v165, v157
v_mov_b32 v166, v158
v_permlane16_swap_b32 v164, v156
v_permlane16_swap_b32 v165, v157
v_permlane16_swap_b32 v166, v158
v_max_f32 v156, v156, v164
v_max_f32 v157, v157, v165
v_max_f32 v158, v158, v166
v_max_f32 v156, v156, v24
v_max_f32 v157, v157, v25
v_max_f32 v158, v158, v26
v_mul_f32 v234, s50, v156
v_mul_f32 v235, s50, v157
v_mul_f32 v236, s50, v158
v_sub_f32 v234, 0, v234
v_sub_f32 v235, 0, v235
v_sub_f32 v236, 0, v236
v_fma_f32 v237, v24, s50, v234
v_fma_f32 v238, v25, s50, v235
v_fma_f32 v239, v26, s50, v236
v_exp_f32 v237, v237
v_exp_f32 v238, v238
v_exp_f32 v239, v239
v_mov_b32 v24, v156
v_mov_b32 v25, v157
v_mov_b32 v26, v158
s_nop 2
s_setpc_b64 s[58:59]
L_rescale:
s_nop 9
v_accvgpr_read_b32 v172, a0
v_accvgpr_read_b32 v173, a1
v_accvgpr_read_b32 v174, a2
v_accvgpr_read_b32 v175, a3
v_mul_f32 v172, v172, v237
v_mul_f32 v173, v173, v237
v_mul_f32 v174, v174, v237
v_mul_f32 v175, v175, v237
v_accvgpr_write_b32 a0, v172
v_accvgpr_write_b32 a1, v173
v_accvgpr_write_b32 a2, v174
v_accvgpr_write_b32 a3, v175
v_accvgpr_read_b32 v180, a4
v_accvgpr_read_b32 v181, a5
v_accvgpr_read_b32 v182, a6
v_accvgpr_read_b32 v183, a7
v_mul_f32 v180, v180, v238
v_mul_f32 v181, v181, v238
v_mul_f32 v182, v182, v238
v_mul_f32 v183, v183, v238
v_accvgpr_write_b32 a4, v180
v_accvgpr_write_b32 a5, v181
v_accvgpr_write_b32 a6, v182
v_accvgpr_write_b32 a7, v183
v_accvgpr_read_b32 v188, a8
v_accvgpr_read_b32 v189, a9
v_accvgpr_read_b32 v190, a10
v_accvgpr_read_b32 v191, a11
v_mul_f32 v188, v188, v239
v_mul_f32 v189, v189, v239
v_mul_f32 v190, v190, v239
v_mul_f32 v191, v191, v239
v_accvgpr_write_b32 a8, v188
v_accvgpr_write_b32 a9, v189
v_accvgpr_write_b32 a10, v190
v_accvgpr_write_b32 a11, v191
v_accvgpr_read_b32 v196, a12
v_accvgpr_read_b32 v197, a13
v_accvgpr_read_b32 v198, a14
v_accvgpr_read_b32 v199, a15
v_mul_f32 v196, v196, v237
v_mul_f32 v197, v197, v237
v_mul_f32 v198, v198, v237
v_mul_f32 v199, v199, v237
v_accvgpr_write_b32 a12, v196
v_accvgpr_write_b32 a13, v197
v_accvgpr_write_b32 a14, v198
v_accvgpr_write_b32 a15, v199
v_accvgpr_read_b32 v172, a16
v_accvgpr_read_b32 v173, a17
v_accvgpr_read_b32 v174, a18
v_accvgpr_read_b32 v175, a19
v_mul_f32 v172, v172, v238
v_mul_f32 v173, v173, v238
v_mul_f32 v174, v174, v238
v_mul_f32 v175, v175, v238
v_accvgpr_write_b32 a16, v172
v_accvgpr_write_b32 a17, v173
v_accvgpr_write_b32 a18, v174
v_accvgpr_write_b32 a19, v175
v_accvgpr_read_b32 v180, a20
v_accvgpr_read_b32 v181, a21
v_accvgpr_read_b32 v182, a22
v_accvgpr_read_b32 v183, a23
v_mul_f32 v180, v180, v239
v_mul_f32 v181, v181, v239
v_mul_f32 v182, v182, v239
v_mul_f32 v183, v183, v239
v_accvgpr_write_b32 a20, v180
v_accvgpr_write_b32 a21, v181
v_accvgpr_write_b32 a22, v182
v_accvgpr_write_b32 a23, v183
v_accvgpr_read_b32 v188, a24
v_accvgpr_read_b32 v189, a25
v_accvgpr_read_b32 v190, a26
v_accvgpr_read_b32 v191, a27
v_mul_f32 v188, v188, v237
v_mul_f32 v189, v189, v237
v_mul_f32 v190, v190, v237
v_mul_f32 v191, v191, v237
v_accvgpr_write_b32 a24, v188
v_accvgpr_write_b32 a25, v189
v_accvgpr_write_b32 a26, v190
v_accvgpr_write_b32 a27, v191
v_accvgpr_read_b32 v196, a28
v_accvgpr_read_b32 v197, a29
v_accvgpr_read_b32 v198, a30
v_accvgpr_read_b32 v199, a31
v_mul_f32 v196, v196, v238
v_mul_f32 v197, v197, v238
v_mul_f32 v198, v198, v238
v_mul_f32 v199, v199, v238
v_accvgpr_write_b32 a28, v196
v_accvgpr_write_b32 a29, v197
v_accvgpr_write_b32 a30, v198
v_accvgpr_write_b32 a31, v199
v_accvgpr_read_b32 v172, a32
v_accvgpr_read_b32 v173, a33
v_accvgpr_read_b32 v174, a34
v_accvgpr_read_b32 v175, a35
v_mul_f32 v172, v172, v239
v_mul_f32 v173, v173, v239
v_mul_f32 v174, v174, v239
v_mul_f32 v175, v175, v239
v_accvgpr_write_b32 a32, v172
v_accvgpr_write_b32 a33, v173
v_accvgpr_write_b32 a34, v174
v_accvgpr_write_b32 a35, v175
v_accvgpr_read_b32 v180, a36
v_accvgpr_read_b32 v181, a37
v_accvgpr_read_b32 v182, a38
v_accvgpr_read_b32 v183, a39
v_mul_f32 v180, v180, v237
v_mul_f32 v181, v181, v237
v_mul_f32 v182, v182, v237
v_mul_f32 v183, v183, v237
v_accvgpr_write_b32 a36, v180
v_accvgpr_write_b32 a37, v181
v_accvgpr_write_b32 a38, v182
v_accvgpr_write_b32 a39, v183
v_accvgpr_read_b32 v188, a40
v_accvgpr_read_b32 v189, a41
v_accvgpr_read_b32 v190, a42
v_accvgpr_read_b32 v191, a43
v_mul_f32 v188, v188, v238
v_mul_f32 v189, v189, v238
v_mul_f32 v190, v190, v238
v_mul_f32 v191, v191, v238
v_accvgpr_write_b32 a40, v188
v_accvgpr_write_b32 a41, v189
v_accvgpr_write_b32 a42, v190
v_accvgpr_write_b32 a43, v191
v_accvgpr_read_b32 v196, a44
v_accvgpr_read_b32 v197, a45
v_accvgpr_read_b32 v198, a46
v_accvgpr_read_b32 v199, a47
v_mul_f32 v196, v196, v239
v_mul_f32 v197, v197, v239
v_mul_f32 v198, v198, v239
v_mul_f32 v199, v199, v239
v_accvgpr_write_b32 a44, v196
v_accvgpr_write_b32 a45, v197
v_accvgpr_write_b32 a46, v198
v_accvgpr_write_b32 a47, v199
v_accvgpr_read_b32 v172, a48
v_accvgpr_read_b32 v173, a49
v_accvgpr_read_b32 v174, a50
v_accvgpr_read_b32 v175, a51
v_mul_f32 v172, v172, v237
v_mul_f32 v173, v173, v237
v_mul_f32 v174, v174, v237
v_mul_f32 v175, v175, v237
v_accvgpr_write_b32 a48, v172
v_accvgpr_write_b32 a49, v173
v_accvgpr_write_b32 a50, v174
v_accvgpr_write_b32 a51, v175
v_accvgpr_read_b32 v180, a52
v_accvgpr_read_b32 v181, a53
v_accvgpr_read_b32 v182, a54
v_accvgpr_read_b32 v183, a55
v_mul_f32 v180, v180, v238
v_mul_f32 v181, v181, v238
v_mul_f32 v182, v182, v238
v_mul_f32 v183, v183, v238
v_accvgpr_write_b32 a52, v180
v_accvgpr_write_b32 a53, v181
v_accvgpr_write_b32 a54, v182
v_accvgpr_write_b32 a55, v183
v_accvgpr_read_b32 v188, a56
v_accvgpr_read_b32 v189, a57
v_accvgpr_read_b32 v190, a58
v_accvgpr_read_b32 v191, a59
v_mul_f32 v188, v188, v239
v_mul_f32 v189, v189, v239
v_mul_f32 v190, v190, v239
v_mul_f32 v191, v191, v239
v_accvgpr_write_b32 a56, v188
v_accvgpr_write_b32 a57, v189
v_accvgpr_write_b32 a58, v190
v_accvgpr_write_b32 a59, v191
v_accvgpr_read_b32 v196, a60
v_accvgpr_read_b32 v197, a61
v_accvgpr_read_b32 v198, a62
v_accvgpr_read_b32 v199, a63
v_mul_f32 v196, v196, v237
v_mul_f32 v197, v197, v237
v_mul_f32 v198, v198, v237
v_mul_f32 v199, v199, v237
v_accvgpr_write_b32 a60, v196
v_accvgpr_write_b32 a61, v197
v_accvgpr_write_b32 a62, v198
v_accvgpr_write_b32 a63, v199
v_accvgpr_read_b32 v172, a64
v_accvgpr_read_b32 v173, a65
v_accvgpr_read_b32 v174, a66
v_accvgpr_read_b32 v175, a67
v_mul_f32 v172, v172, v238
v_mul_f32 v173, v173, v238
v_mul_f32 v174, v174, v238
v_mul_f32 v175, v175, v238
v_accvgpr_write_b32 a64, v172
v_accvgpr_write_b32 a65, v173
v_accvgpr_write_b32 a66, v174
v_accvgpr_write_b32 a67, v175
v_accvgpr_read_b32 v180, a68
v_accvgpr_read_b32 v181, a69
v_accvgpr_read_b32 v182, a70
v_accvgpr_read_b32 v183, a71
v_mul_f32 v180, v180, v239
v_mul_f32 v181, v181, v239
v_mul_f32 v182, v182, v239
v_mul_f32 v183, v183, v239
v_accvgpr_write_b32 a68, v180
v_accvgpr_write_b32 a69, v181
v_accvgpr_write_b32 a70, v182
v_accvgpr_write_b32 a71, v183
v_accvgpr_read_b32 v188, a72
v_accvgpr_read_b32 v189, a73
v_accvgpr_read_b32 v190, a74
v_accvgpr_read_b32 v191, a75
v_mul_f32 v188, v188, v237
v_mul_f32 v189, v189, v237
v_mul_f32 v190, v190, v237
v_mul_f32 v191, v191, v237
v_accvgpr_write_b32 a72, v188
v_accvgpr_write_b32 a73, v189
v_accvgpr_write_b32 a74, v190
v_accvgpr_write_b32 a75, v191
v_accvgpr_read_b32 v196, a76
v_accvgpr_read_b32 v197, a77
v_accvgpr_read_b32 v198, a78
v_accvgpr_read_b32 v199, a79
v_mul_f32 v196, v196, v238
v_mul_f32 v197, v197, v238
v_mul_f32 v198, v198, v238
v_mul_f32 v199, v199, v238
v_accvgpr_write_b32 a76, v196
v_accvgpr_write_b32 a77, v197
v_accvgpr_write_b32 a78, v198
v_accvgpr_write_b32 a79, v199
v_accvgpr_read_b32 v172, a80
v_accvgpr_read_b32 v173, a81
v_accvgpr_read_b32 v174, a82
v_accvgpr_read_b32 v175, a83
v_mul_f32 v172, v172, v239
v_mul_f32 v173, v173, v239
v_mul_f32 v174, v174, v239
v_mul_f32 v175, v175, v239
v_accvgpr_write_b32 a80, v172
v_accvgpr_write_b32 a81, v173
v_accvgpr_write_b32 a82, v174
v_accvgpr_write_b32 a83, v175
v_accvgpr_read_b32 v180, a84
v_accvgpr_read_b32 v181, a85
v_accvgpr_read_b32 v182, a86
v_accvgpr_read_b32 v183, a87
v_mul_f32 v180, v180, v237
v_mul_f32 v181, v181, v237
v_mul_f32 v182, v182, v237
v_mul_f32 v183, v183, v237
v_accvgpr_write_b32 a84, v180
v_accvgpr_write_b32 a85, v181
v_accvgpr_write_b32 a86, v182
v_accvgpr_write_b32 a87, v183
v_accvgpr_read_b32 v188, a88
v_accvgpr_read_b32 v189, a89
v_accvgpr_read_b32 v190, a90
v_accvgpr_read_b32 v191, a91
v_mul_f32 v188, v188, v238
v_mul_f32 v189, v189, v238
v_mul_f32 v190, v190, v238
v_mul_f32 v191, v191, v238
v_accvgpr_write_b32 a88, v188
v_accvgpr_write_b32 a89, v189
v_accvgpr_write_b32 a90, v190
v_accvgpr_write_b32 a91, v191
v_accvgpr_read_b32 v196, a92
v_accvgpr_read_b32 v197, a93
v_accvgpr_read_b32 v198, a94
v_accvgpr_read_b32 v199, a95
v_mul_f32 v196, v196, v239
v_mul_f32 v197, v197, v239
v_mul_f32 v198, v198, v239
v_mul_f32 v199, v199, v239
v_accvgpr_write_b32 a92, v196
v_accvgpr_write_b32 a93, v197
v_accvgpr_write_b32 a94, v198
v_accvgpr_write_b32 a95, v199
v_accvgpr_read_b32 v172, a96
v_accvgpr_read_b32 v173, a97
v_accvgpr_read_b32 v174, a98
v_accvgpr_read_b32 v175, a99
v_mul_f32 v172, v172, v237
v_mul_f32 v173, v173, v237
v_mul_f32 v174, v174, v237
v_mul_f32 v175, v175, v237
v_accvgpr_write_b32 a96, v172
v_accvgpr_write_b32 a97, v173
v_accvgpr_write_b32 a98, v174
v_accvgpr_write_b32 a99, v175
v_accvgpr_read_b32 v180, a100
v_accvgpr_read_b32 v181, a101
v_accvgpr_read_b32 v182, a102
v_accvgpr_read_b32 v183, a103
v_mul_f32 v180, v180, v238
v_mul_f32 v181, v181, v238
v_mul_f32 v182, v182, v238
v_mul_f32 v183, v183, v238
v_accvgpr_write_b32 a100, v180
v_accvgpr_write_b32 a101, v181
v_accvgpr_write_b32 a102, v182
v_accvgpr_write_b32 a103, v183
v_accvgpr_read_b32 v188, a104
v_accvgpr_read_b32 v189, a105
v_accvgpr_read_b32 v190, a106
v_accvgpr_read_b32 v191, a107
v_mul_f32 v188, v188, v239
v_mul_f32 v189, v189, v239
v_mul_f32 v190, v190, v239
v_mul_f32 v191, v191, v239
v_accvgpr_write_b32 a104, v188
v_accvgpr_write_b32 a105, v189
v_accvgpr_write_b32 a106, v190
v_accvgpr_write_b32 a107, v191
v_accvgpr_read_b32 v196, a108
v_accvgpr_read_b32 v197, a109
v_accvgpr_read_b32 v198, a110
v_accvgpr_read_b32 v199, a111
v_mul_f32 v196, v196, v237
v_mul_f32 v197, v197, v237
v_mul_f32 v198, v198, v237
v_mul_f32 v199, v199, v237
v_accvgpr_write_b32 a108, v196
v_accvgpr_write_b32 a109, v197
v_accvgpr_write_b32 a110, v198
v_accvgpr_write_b32 a111, v199
v_accvgpr_read_b32 v172, a112
v_accvgpr_read_b32 v173, a113
v_accvgpr_read_b32 v174, a114
v_accvgpr_read_b32 v175, a115
v_mul_f32 v172, v172, v238
v_mul_f32 v173, v173, v238
v_mul_f32 v174, v174, v238
v_mul_f32 v175, v175, v238
v_accvgpr_write_b32 a112, v172
v_accvgpr_write_b32 a113, v173
v_accvgpr_write_b32 a114, v174
v_accvgpr_write_b32 a115, v175
v_accvgpr_read_b32 v180, a116
v_accvgpr_read_b32 v181, a117
v_accvgpr_read_b32 v182, a118
v_accvgpr_read_b32 v183, a119
v_mul_f32 v180, v180, v239
v_mul_f32 v181, v181, v239
v_mul_f32 v182, v182, v239
v_mul_f32 v183, v183, v239
v_accvgpr_write_b32 a116, v180
v_accvgpr_write_b32 a117, v181
v_accvgpr_write_b32 a118, v182
v_accvgpr_write_b32 a119, v183
v_accvgpr_read_b32 v188, a120
v_accvgpr_read_b32 v189, a121
v_accvgpr_read_b32 v190, a122
v_accvgpr_read_b32 v191, a123
v_mul_f32 v188, v188, v237
v_mul_f32 v189, v189, v237
v_mul_f32 v190, v190, v237
v_mul_f32 v191, v191, v237
v_accvgpr_write_b32 a120, v188
v_accvgpr_write_b32 a121, v189
v_accvgpr_write_b32 a122, v190
v_accvgpr_write_b32 a123, v191
v_accvgpr_read_b32 v196, a124
v_accvgpr_read_b32 v197, a125
v_accvgpr_read_b32 v198, a126
v_accvgpr_read_b32 v199, a127
v_mul_f32 v196, v196, v238
v_mul_f32 v197, v197, v238
v_mul_f32 v198, v198, v238
v_mul_f32 v199, v199, v238
v_accvgpr_write_b32 a124, v196
v_accvgpr_write_b32 a125, v197
v_accvgpr_write_b32 a126, v198
v_accvgpr_write_b32 a127, v199
v_accvgpr_read_b32 v172, a128
v_accvgpr_read_b32 v173, a129
v_accvgpr_read_b32 v174, a130
v_accvgpr_read_b32 v175, a131
v_mul_f32 v172, v172, v239
v_mul_f32 v173, v173, v239
v_mul_f32 v174, v174, v239
v_mul_f32 v175, v175, v239
v_accvgpr_write_b32 a128, v172
v_accvgpr_write_b32 a129, v173
v_accvgpr_write_b32 a130, v174
v_accvgpr_write_b32 a131, v175
v_accvgpr_read_b32 v180, a132
v_accvgpr_read_b32 v181, a133
v_accvgpr_read_b32 v182, a134
v_accvgpr_read_b32 v183, a135
v_mul_f32 v180, v180, v237
v_mul_f32 v181, v181, v237
v_mul_f32 v182, v182, v237
v_mul_f32 v183, v183, v237
v_accvgpr_write_b32 a132, v180
v_accvgpr_write_b32 a133, v181
v_accvgpr_write_b32 a134, v182
v_accvgpr_write_b32 a135, v183
v_accvgpr_read_b32 v188, a136
v_accvgpr_read_b32 v189, a137
v_accvgpr_read_b32 v190, a138
v_accvgpr_read_b32 v191, a139
v_mul_f32 v188, v188, v238
v_mul_f32 v189, v189, v238
v_mul_f32 v190, v190, v238
v_mul_f32 v191, v191, v238
v_accvgpr_write_b32 a136, v188
v_accvgpr_write_b32 a137, v189
v_accvgpr_write_b32 a138, v190
v_accvgpr_write_b32 a139, v191
v_accvgpr_read_b32 v196, a140
v_accvgpr_read_b32 v197, a141
v_accvgpr_read_b32 v198, a142
v_accvgpr_read_b32 v199, a143
v_mul_f32 v196, v196, v239
v_mul_f32 v197, v197, v239
v_mul_f32 v198, v198, v239
v_mul_f32 v199, v199, v239
v_accvgpr_write_b32 a140, v196
v_accvgpr_write_b32 a141, v197
v_accvgpr_write_b32 a142, v198
v_accvgpr_write_b32 a143, v199
v_accvgpr_read_b32 v172, a144
v_accvgpr_read_b32 v173, a145
v_accvgpr_read_b32 v174, a146
v_accvgpr_read_b32 v175, a147
v_mul_f32 v172, v172, v237
v_mul_f32 v173, v173, v237
v_mul_f32 v174, v174, v237
v_mul_f32 v175, v175, v237
v_accvgpr_write_b32 a144, v172
v_accvgpr_write_b32 a145, v173
v_accvgpr_write_b32 a146, v174
v_accvgpr_write_b32 a147, v175
v_accvgpr_read_b32 v180, a148
v_accvgpr_read_b32 v181, a149
v_accvgpr_read_b32 v182, a150
v_accvgpr_read_b32 v183, a151
v_mul_f32 v180, v180, v238
v_mul_f32 v181, v181, v238
v_mul_f32 v182, v182, v238
v_mul_f32 v183, v183, v238
v_accvgpr_write_b32 a148, v180
v_accvgpr_write_b32 a149, v181
v_accvgpr_write_b32 a150, v182
v_accvgpr_write_b32 a151, v183
v_accvgpr_read_b32 v188, a152
v_accvgpr_read_b32 v189, a153
v_accvgpr_read_b32 v190, a154
v_accvgpr_read_b32 v191, a155
v_mul_f32 v188, v188, v239
v_mul_f32 v189, v189, v239
v_mul_f32 v190, v190, v239
v_mul_f32 v191, v191, v239
v_accvgpr_write_b32 a152, v188
v_accvgpr_write_b32 a153, v189
v_accvgpr_write_b32 a154, v190
v_accvgpr_write_b32 a155, v191
v_accvgpr_read_b32 v196, a156
v_accvgpr_read_b32 v197, a157
v_accvgpr_read_b32 v198, a158
v_accvgpr_read_b32 v199, a159
v_mul_f32 v196, v196, v237
v_mul_f32 v197, v197, v237
v_mul_f32 v198, v198, v237
v_mul_f32 v199, v199, v237
v_accvgpr_write_b32 a156, v196
v_accvgpr_write_b32 a157, v197
v_accvgpr_write_b32 a158, v198
v_accvgpr_write_b32 a159, v199
v_accvgpr_read_b32 v172, a160
v_accvgpr_read_b32 v173, a161
v_accvgpr_read_b32 v174, a162
v_accvgpr_read_b32 v175, a163
v_mul_f32 v172, v172, v238
v_mul_f32 v173, v173, v238
v_mul_f32 v174, v174, v238
v_mul_f32 v175, v175, v238
v_accvgpr_write_b32 a160, v172
v_accvgpr_write_b32 a161, v173
v_accvgpr_write_b32 a162, v174
v_accvgpr_write_b32 a163, v175
v_accvgpr_read_b32 v180, a164
v_accvgpr_read_b32 v181, a165
v_accvgpr_read_b32 v182, a166
v_accvgpr_read_b32 v183, a167
v_mul_f32 v180, v180, v239
v_mul_f32 v181, v181, v239
v_mul_f32 v182, v182, v239
v_mul_f32 v183, v183, v239
v_accvgpr_write_b32 a164, v180
v_accvgpr_write_b32 a165, v181
v_accvgpr_write_b32 a166, v182
v_accvgpr_write_b32 a167, v183
v_accvgpr_read_b32 v188, a168
v_accvgpr_read_b32 v189, a169
v_accvgpr_read_b32 v190, a170
v_accvgpr_read_b32 v191, a171
v_mul_f32 v188, v188, v237
v_mul_f32 v189, v189, v237
v_mul_f32 v190, v190, v237
v_mul_f32 v191, v191, v237
v_accvgpr_write_b32 a168, v188
v_accvgpr_write_b32 a169, v189
v_accvgpr_write_b32 a170, v190
v_accvgpr_write_b32 a171, v191
v_accvgpr_read_b32 v196, a172
v_accvgpr_read_b32 v197, a173
v_accvgpr_read_b32 v198, a174
v_accvgpr_read_b32 v199, a175
v_mul_f32 v196, v196, v238
v_mul_f32 v197, v197, v238
v_mul_f32 v198, v198, v238
v_mul_f32 v199, v199, v238
v_accvgpr_write_b32 a172, v196
v_accvgpr_write_b32 a173, v197
v_accvgpr_write_b32 a174, v198
v_accvgpr_write_b32 a175, v199
v_accvgpr_read_b32 v172, a176
v_accvgpr_read_b32 v173, a177
v_accvgpr_read_b32 v174, a178
v_accvgpr_read_b32 v175, a179
v_mul_f32 v172, v172, v239
v_mul_f32 v173, v173, v239
v_mul_f32 v174, v174, v239
v_mul_f32 v175, v175, v239
v_accvgpr_write_b32 a176, v172
v_accvgpr_write_b32 a177, v173
v_accvgpr_write_b32 a178, v174
v_accvgpr_write_b32 a179, v175
v_accvgpr_read_b32 v180, a180
v_accvgpr_read_b32 v181, a181
v_accvgpr_read_b32 v182, a182
v_accvgpr_read_b32 v183, a183
v_mul_f32 v180, v180, v237
v_mul_f32 v181, v181, v237
v_mul_f32 v182, v182, v237
v_mul_f32 v183, v183, v237
v_accvgpr_write_b32 a180, v180
v_accvgpr_write_b32 a181, v181
v_accvgpr_write_b32 a182, v182
v_accvgpr_write_b32 a183, v183
v_accvgpr_read_b32 v188, a184
v_accvgpr_read_b32 v189, a185
v_accvgpr_read_b32 v190, a186
v_accvgpr_read_b32 v191, a187
v_mul_f32 v188, v188, v238
v_mul_f32 v189, v189, v238
v_mul_f32 v190, v190, v238
v_mul_f32 v191, v191, v238
v_accvgpr_write_b32 a184, v188
v_accvgpr_write_b32 a185, v189
v_accvgpr_write_b32 a186, v190
v_accvgpr_write_b32 a187, v191
v_accvgpr_read_b32 v196, a188
v_accvgpr_read_b32 v197, a189
v_accvgpr_read_b32 v198, a190
v_accvgpr_read_b32 v199, a191
v_mul_f32 v196, v196, v239
v_mul_f32 v197, v197, v239
v_mul_f32 v198, v198, v239
v_mul_f32 v199, v199, v239
v_accvgpr_write_b32 a188, v196
v_accvgpr_write_b32 a189, v197
v_accvgpr_write_b32 a190, v198
v_accvgpr_write_b32 a191, v199
v_accvgpr_read_b32 v172, a192
v_accvgpr_read_b32 v173, a193
v_accvgpr_read_b32 v174, a194
v_accvgpr_read_b32 v175, a195
v_mul_f32 v172, v172, v237
v_mul_f32 v173, v173, v237
v_mul_f32 v174, v174, v237
v_mul_f32 v175, v175, v237
v_accvgpr_write_b32 a192, v172
v_accvgpr_write_b32 a193, v173
v_accvgpr_write_b32 a194, v174
v_accvgpr_write_b32 a195, v175
v_accvgpr_read_b32 v180, a196
v_accvgpr_read_b32 v181, a197
v_accvgpr_read_b32 v182, a198
v_accvgpr_read_b32 v183, a199
v_mul_f32 v180, v180, v238
v_mul_f32 v181, v181, v238
v_mul_f32 v182, v182, v238
v_mul_f32 v183, v183, v238
v_accvgpr_write_b32 a196, v180
v_accvgpr_write_b32 a197, v181
v_accvgpr_write_b32 a198, v182
v_accvgpr_write_b32 a199, v183
v_accvgpr_read_b32 v188, a200
v_accvgpr_read_b32 v189, a201
v_accvgpr_read_b32 v190, a202
v_accvgpr_read_b32 v191, a203
v_mul_f32 v188, v188, v239
v_mul_f32 v189, v189, v239
v_mul_f32 v190, v190, v239
v_mul_f32 v191, v191, v239
v_accvgpr_write_b32 a200, v188
v_accvgpr_write_b32 a201, v189
v_accvgpr_write_b32 a202, v190
v_accvgpr_write_b32 a203, v191
s_nop 2
s_setpc_b64 s[58:59]
s_nop 0
s_nop 0
s_nop 0
s_nop 0
s_nop 0
s_nop 0
s_nop 0
s_nop 0
s_nop 0
s_nop 0
s_nop 0
s_nop 0
s_nop 0
s_nop 0
s_nop 0
s_nop 0
s_nop 0
s_nop 0
s_nop 0
s_nop 0
s_nop 0
s_nop 0
s_nop 0
s_nop 0
s_nop 0
s_nop 0
s_nop 0
s_nop 0
s_nop 0
s_nop 0
s_nop 0
s_nop 0
s_nop 0
s_nop 0
s_nop 0
s_nop 0
s_nop 0
s_nop 0
s_nop 0
s_nop 0
s_nop 0
s_nop 0
s_nop 0
s_nop 0
s_nop 0
s_nop 0
s_nop 0
s_nop 0
s_nop 0
s_nop 0
s_nop 0
s_nop 0
s_nop 0
s_nop 0
s_nop 0
s_nop 0
s_nop 0
s_nop 0
s_nop 0
s_nop 0
s_nop 0
s_nop 0
s_nop 0
s_nop 0
L_textend:
.section .rodata,"a"
.p2align 6
.amdhsa_kernel standalone__mha_block_cached__near_ridge_kernel
  .amdhsa_next_free_vgpr 512
  .amdhsa_next_free_sgpr 102
  .amdhsa_accum_offset 256
  .amdhsa_group_segment_fixed_size 0
  .amdhsa_kernarg_size 64
  .amdhsa_user_sgpr_count 2
  .amdhsa_user_sgpr_kernarg_segment_ptr 1
  .amdhsa_system_sgpr_workgroup_id_x 1
.end_amdhsa_kernel
```
